```python
import torch

def _softmax(x, axis=-1):
    return torch.softmax(x, dim=axis)
def _gelu(x):
    return torch.nn.functional.gelu(x, approximate="tanh")
def _silu(x):
    return torch.nn.functional.silu(x)
def _sigmoid(x):
    return torch.sigmoid(x)
def _layernorm(x, axis=-1, eps=1e-5):
    m = x.mean(dim=axis, keepdim=True)
    v = x.var(dim=axis, keepdim=True, unbiased=False)
    return (x - m) / torch.sqrt(v + eps)
def _scatter_add(tgt, idx, src, axis=0):
    return tgt.clone().index_add_(axis, idx, src)
def _segment_sum(src, seg, n):
    out = torch.zeros((n,) + src.shape[1:], dtype=src.dtype)
    return out.index_add_(0, seg, src)
def _pad(x, pw):
    flat = tuple(v for pair in reversed(pw) for v in pair)
    return torch.nn.functional.pad(x, flat)

kernel_name = 'sequential_preLN__grouped_kv_mqa__mixer_token_mlp__prompt'

def setup_inputs():

    _w = (lambda a: (lambda t: t.to(torch.bfloat16) if t.is_floating_point() else t)(torch.as_tensor(a)))
    def _A_setup():
        B, S, D, H = 1, 2048, 640, 32
        Dh = D // H
        return {
            "x": _w((lambda *s: torch.randn(*s, dtype=torch.bfloat16) * 0.05)(B, S, D)),
            "wq": _w((lambda *s: torch.randn(*s, dtype=torch.bfloat16) * 0.05)(D, H * Dh)),
            "wk": _w((lambda *s: torch.randn(*s, dtype=torch.bfloat16) * 0.05)(D, Dh)),
            "wv": _w((lambda *s: torch.randn(*s, dtype=torch.bfloat16) * 0.05)(D, Dh)),
            "wo": _w((lambda *s: torch.randn(*s, dtype=torch.bfloat16) * 0.05)(H * Dh, D)),
        }
    _A_in = _A_setup()

    def _B_setup():
        B, S, D, F = 1, 2048, 640, 1536
        return {
            "x": _w((lambda *s: torch.randn(*s, dtype=torch.bfloat16) * 0.05)(B, S, D)),
            "w1": _w((lambda *s: torch.randn(*s, dtype=torch.bfloat16) * 1.6)(S, F) * (S ** -0.5)),
            "b1": _w((lambda *s: torch.randn(*s, dtype=torch.bfloat16) * 1.6)(F) * 0.02),
            "w2": _w((lambda *s: torch.randn(*s, dtype=torch.bfloat16) * 1.6)(F, S) * (F ** -0.5)),
            "b2": _w((lambda *s: torch.randn(*s, dtype=torch.bfloat16) * 0.8)(S) * 0.02),
        }
    _B_in = _B_setup()

    return {
        "A_x": _A_in["x"],
        "A_wq": _A_in["wq"],
        "A_wk": _A_in["wk"],
        "A_wv": _A_in["wv"],
        "A_wo": _A_in["wo"],
        "B_x": _B_in["x"],
        "B_w1": _B_in["w1"],
        "B_b1": _B_in["b1"],
        "B_w2": _B_in["w2"],
        "B_b2": _B_in["b2"],
    }

def reference(A_x, A_wq, A_wk, A_wv, A_wo, B_x, B_w1, B_b1, B_w2, B_b2):
    def _A_ref(x, wq, wk, wv, wo):
        B, S, D = x.shape
        H = 32
        Dh = D // H
        q = (lambda x, *d: x.permute(*d))((x @ wq).reshape(B, S, H, Dh), 0, 2, 1, 3)
        k = x @ wk
        v = x @ wv
        scores = torch.einsum("bhqd,bkd->bhqk", q, k) * (Dh ** -0.5)
        p = _softmax(scores, axis=-1)
        o = torch.einsum("bhqk,bkd->bhqd", p, v)
        return (lambda x, *d: x.permute(*d))(o, 0, 2, 1, 3).reshape(B, S, H * Dh) @ wo

    def _B_ref(x, w1, b1, w2, b2):
        B, S, D = x.shape
        h = _layernorm(x, axis=-1)
        u = torch.einsum("bsd,sf->bdf", h, w1) + b1
        u = _gelu(u)
        y = torch.einsum("bdf,fs->bds", u, w2) + b2
        return (lambda x, *d: x.permute(*d))(y, 0, 2, 1)

    x = A_x
    h = x + _A_ref(_layernorm(x, axis=-1), A_wq, A_wk, A_wv, A_wo)
    h2 = h + _B_ref(_layernorm(h, axis=-1), B_w1, B_b1, B_w2, B_b2)
    return h2
```

```asm
; @launch grid=(256,1,1) block=(256,1,1) lds=163840
.amdgcn_target "amdgcn-amd-amdhsa--gfx950"
.text
.globl sequential_preLN__grouped_kv_mqa__mixer_token_mlp__prompt_kernel
.p2align 8
.type sequential_preLN__grouped_kv_mqa__mixer_token_mlp__prompt_kernel,@function
sequential_preLN__grouped_kv_mqa__mixer_token_mlp__prompt_kernel:
    s_cmp_ge_u32 s2, 256
    s_cbranch_scc1 L_end
    s_load_dwordx8 s[4:11], s[0:1], 0
    s_load_dwordx2 s[12:13], s[0:1], 32
    s_load_dwordx2 s[14:15], s[0:1], 96
    s_load_dwordx8 s[76:83], s[0:1], 48
    s_load_dwordx4 s[84:87], s[0:1], 80
    s_getpc_b64 s[96:97]
    v_lshrrev_b32 v240, 4, v0
    s_lshr_b32 s52, s2, 3
    s_lshl_b32 s3, s52, 7
    v_lshl_add_u32 v240, v240, 12, s3
    global_load_dword v248, v240, s[96:97]
    s_lshl_b32 s3, s2, 12
    s_add_u32 s3, s3, 8224768
    v_cmp_gt_u32 vcc, 64, v0
    v_lshl_add_u32 v240, v0, 4, s3
    v_bfrev_b32 v241, 1
    v_cndmask_b32 v148, v241, v240, vcc
    v_mov_b32 v147, v0
    v_lshrrev_b32 v240, 6, v0
    v_and_b32 v0, 63, v0
    v_readfirstlane_b32 s40, v240
    s_bfe_u32 s50, s2, 0x20001
    s_lshl_b32 s50, s50, 3
    s_and_b32 s51, s52, 7
    s_add_u32 s65, s50, s51
    s_and_b32 s50, s2, 1
    s_lshl_b32 s50, s50, 2
    s_lshr_b32 s51, s52, 3
    s_add_u32 s66, s50, s51
    v_lshrrev_b32 v240, 2, v0
    v_lshrrev_b32 v241, 5, v0
    v_lshlrev_b32 v241, 1, v241
    v_xor_b32 v241, v241, v0
    v_and_b32 v241, 3, v241
    v_lshlrev_b32 v241, 4, v241
    s_lshl_b32 s50, s65, 2
    s_add_u32 s50, s50, s40
    s_mul_i32 s50, s50, 20480
    s_add_u32 s50, s50, 4096
    v_mul_u32_u24 v240, 1280, v240
    v_add3_u32 v136, v240, v241, s50
    v_subrev_u32 v137, 960, v136
    v_subrev_u32 v138, 1920, v136
    v_subrev_u32 v139, 2880, v136
    s_add_u32 s70, s65, s66
    s_mul_i32 s50, s70, 52
    s_lshr_b32 s50, s50, 8
    s_mul_i32 s50, s50, 5
    s_sub_u32 s70, s70, s50
    s_lshl_b32 s71, s40, 12
    s_mul_i32 s51, s40, 40960
    s_mul_i32 s50, s66, 160
    s_add_u32 s51, s51, s50
    v_add_u32 v240, 0, v0
    v_mul_u32_u24 v241, 205, v240
    v_lshrrev_b32 v241, 11, v241
    v_mul_u32_u24 v242, 10, v241
    v_sub_u32 v240, v240, v242
    v_bfe_u32 v243, v241, 2, 2
    v_and_b32 v242, 3, v241
    v_lshl_add_u32 v242, v243, 3, v242
    v_bfe_u32 v243, v241, 4, 1
    v_lshl_add_u32 v242, v243, 2, v242
    v_mul_u32_u24 v242, 1280, v242
    v_lshl_add_u32 v242, v240, 4, v242
    s_add_u32 s50, s51, 4096
    v_add_u32 v140, s50, v242
    v_add_u32 v240, 64, v0
    v_mul_u32_u24 v241, 205, v240
    v_lshrrev_b32 v241, 11, v241
    v_mul_u32_u24 v242, 10, v241
    v_sub_u32 v240, v240, v242
    v_bfe_u32 v243, v241, 2, 2
    v_and_b32 v242, 3, v241
    v_lshl_add_u32 v242, v243, 3, v242
    v_bfe_u32 v243, v241, 4, 1
    v_lshl_add_u32 v242, v243, 2, v242
    v_mul_u32_u24 v242, 1280, v242
    v_lshl_add_u32 v242, v240, 4, v242
    s_add_u32 s50, s51, 3072
    v_add_u32 v141, s50, v242
    v_add_u32 v240, 128, v0
    v_mul_u32_u24 v241, 205, v240
    v_lshrrev_b32 v241, 11, v241
    v_mul_u32_u24 v242, 10, v241
    v_sub_u32 v240, v240, v242
    v_bfe_u32 v243, v241, 2, 2
    v_and_b32 v242, 3, v241
    v_lshl_add_u32 v242, v243, 3, v242
    v_bfe_u32 v243, v241, 4, 1
    v_lshl_add_u32 v242, v243, 2, v242
    v_mul_u32_u24 v242, 1280, v242
    v_lshl_add_u32 v242, v240, 4, v242
    s_add_u32 s50, s51, 2048
    v_add_u32 v142, s50, v242
    v_add_u32 v240, 192, v0
    v_mul_u32_u24 v241, 205, v240
    v_lshrrev_b32 v241, 11, v241
    v_mul_u32_u24 v242, 10, v241
    v_sub_u32 v240, v240, v242
    v_bfe_u32 v243, v241, 2, 2
    v_and_b32 v242, 3, v241
    v_lshl_add_u32 v242, v243, 3, v242
    v_bfe_u32 v243, v241, 4, 1
    v_lshl_add_u32 v242, v243, 2, v242
    v_mul_u32_u24 v242, 1280, v242
    v_lshl_add_u32 v242, v240, 4, v242
    s_add_u32 s50, s51, 1024
    v_add_u32 v143, s50, v242
    v_add_u32 v240, 256, v0
    v_mul_u32_u24 v241, 205, v240
    v_lshrrev_b32 v241, 11, v241
    v_mul_u32_u24 v242, 10, v241
    v_sub_u32 v240, v240, v242
    v_bfe_u32 v243, v241, 2, 2
    v_and_b32 v242, 3, v241
    v_lshl_add_u32 v242, v243, 3, v242
    v_bfe_u32 v243, v241, 4, 1
    v_lshl_add_u32 v242, v243, 2, v242
    v_mul_u32_u24 v242, 1280, v242
    v_lshl_add_u32 v242, v240, 4, v242
    s_add_u32 s50, s51, 4096
    v_add_u32 v144, s50, v242
    s_cmp_ge_u32 s66, 3
    s_cselect_b32 s50, 3, 0
    s_sub_u32 s68, s66, s50
    v_bfe_u32 v243, v0, 2, 2
    v_and_b32 v242, 3, v0
    v_lshl_add_u32 v242, v243, 3, v242
    v_bfe_u32 v243, v0, 4, 1
    v_lshl_add_u32 v242, v243, 2, v242
    v_mul_u32_u24 v242, 40, v242
    s_mul_i32 s51, s40, 1280
    s_lshl_b32 s50, s68, 4
    s_add_u32 s51, s51, s50
    v_add_u32 v145, s51, v242
    v_mov_b32 v244, 0
    v_mov_b32 v245, 0
    v_mov_b32 v246, 0
    v_mov_b32 v247, 0
    s_waitcnt lgkmcnt(0)
    s_sub_u32 s32, s4, 4096
    s_subb_u32 s33, s5, 0
    s_mov_b32 s34, 2625536
    s_mov_b32 s35, 0x20000
    s_sub_u32 s36, s6, 4096
    s_subb_u32 s37, s7, 0
    s_mov_b32 s38, 823296
    s_mov_b32 s39, 0x20000
    s_mov_b32 s16, s14
    s_mov_b32 s17, s15
    s_mov_b32 s18, 8486912
    s_mov_b32 s19, 0x20000
    s_cmp_ge_u32 s66, 3
    s_cselect_b32 s72, s10, s8
    s_cselect_b32 s73, s11, s9
    s_mov_b32 s74, 25600
    s_mov_b32 s75, 0x20000
    s_mul_i32 s10, s40, 5120
    s_lshl_b32 s11, s40, 9
    s_cmp_ge_u32 s2, 64
    s_cbranch_scc1 L_noclr
    buffer_store_dwordx4 v[244:247], v148, s[16:19], 0 offen offset:0 sc1
    buffer_store_dwordx4 v[244:247], v148, s[16:19], 0 offen offset:1024 sc1
    buffer_store_dwordx4 v[244:247], v148, s[16:19], 0 offen offset:2048 sc1
    buffer_store_dwordx4 v[244:247], v148, s[16:19], 0 offen offset:3072 sc1
L_noclr:
    s_add_u32 m0, s71, 16384
    s_lshl_b32 s69, s70, 8
    buffer_load_dwordx4 v136, s[32:35], s69 offen  lds
    s_mul_i32 s58, s70, 163840
    buffer_load_dwordx4 v137, s[32:35], s69 offen offset:1024  lds
    s_mul_i32 s59, s70, 5120
    buffer_load_dwordx4 v138, s[32:35], s69 offen offset:2048  lds
    s_add_u32 s70, s70, 1
    buffer_load_dwordx4 v139, s[32:35], s69 offen offset:3072  lds
    s_add_u32 m0, s10, 32768
    s_cmp_eq_u32 s70, 5
    s_cselect_b32 s70, 0, s70
    buffer_load_dwordx4 v140, s[36:39], s58 offen offset:0  lds
    buffer_load_dwordx4 v141, s[36:39], s58 offen offset:1024  lds
    buffer_load_dwordx4 v142, s[36:39], s58 offen offset:2048  lds
    buffer_load_dwordx4 v143, s[36:39], s58 offen offset:3072  lds
    s_add_u32 m0, s10, 36864
    s_nop 0
    buffer_load_dwordx4 v144, s[36:39], s58 offen offset:0  lds
    s_add_u32 m0, s11, 0
    s_mov_b32 exec_hi, 0
    buffer_load_dwordx4 v145, s[72:75], s59 offen  lds
    s_mov_b32 exec_hi, -1
    s_mov_b32 s20, s12
    s_mov_b32 s21, s13
    s_mov_b32 s22, 819200
    s_mov_b32 s23, 0x20000
    s_mul_i32 s50, s2, 205
    s_lshr_b32 s52, s50, 11
    s_mul_i32 s50, s52, 10
    s_sub_u32 s53, s2, s50
    s_lshl_b32 s50, s52, 2
    s_add_u32 s50, s50, s40
    s_mul_i32 s50, s50, 10240
    s_lshl_b32 s51, s53, 7
    s_add_u32 s51, s51, s50
    v_lshrrev_b32 v240, 3, v0
    v_mul_u32_u24 v240, 1280, v240
    v_and_b32 v241, 7, v0
    v_lshlrev_b32 v241, 4, v241
    v_add3_u32 v146, v240, v241, s51
    s_lshl_b32 s50, s40, 10
    s_add_u32 m0, s50, 10240
    s_nop 0
    buffer_load_dwordx4 v146, s[20:23], 0 offen lds
    s_mov_b64 exec, 0
    s_cmp_eq_u32 s40, 0
    s_cbranch_scc1 L_hop0
    s_cmp_eq_u32 s40, 1
    s_cbranch_scc1 L_hop1
    s_cmp_eq_u32 s40, 2
    s_cbranch_scc1 L_hop2
    s_branch L_hop3
.p2align 12
L_hop_back:
    s_mov_b64 exec, -1
    s_mov_b32 s96, s86
    s_mov_b32 s97, s87
    s_mov_b32 s98, 256
    s_mov_b32 s99, 0x20000
    s_mov_b32 s100, s4
    s_mov_b32 s101, s5
    v_lshrrev_b32 v240, 4, v0
    v_bfe_u32 v241, v0, 2, 2
    v_lshl_add_u32 v240, v240, 3, v241
    v_lshlrev_b32 v240, 7, v240
    v_and_b32 v241, 3, v0
    v_lshl_add_u32 v240, v241, 3, v240
    s_lshl_b32 s50, s40, 5
    v_add_u32 v155, s50, v240
    s_lshr_b32 s50, s52, 1
    s_mul_i32 s50, s50, 40
    s_lshl_b32 s51, s53, 2
    s_add_u32 s50, s50, s51
    s_add_u32 s50, s50, s40
    s_lshl_b32 s50, s50, 1
    s_and_b32 s51, s52, 1
    s_add_u32 s50, s50, s51
    s_lshl_b32 s50, s50, 10
    s_add_u32 s50, s50, 2801664
    s_cmp_ge_u32 s2, 200
    s_cselect_b32 s50, 0x80000000, s50
    v_lshl_add_u32 v149, v0, 4, s50
    v_cmp_gt_u32 vcc, 4, v147
    v_bfrev_b32 v240, 1
    v_lshlrev_b32 v241, 13, v147
    v_cndmask_b32 v29, v240, v241, vcc
    v_cmp_eq_u32 vcc, 0, v147
    s_lshl_b32 s50, s2, 2
    v_mov_b32 v241, s50
    v_cndmask_b32 v147, v240, v241, vcc
    v_lshlrev_b32 v250, 2, v0
    s_lshl_b32 s41, s65, 3
    s_add_u32 s41, s41, s66
    s_and_b32 s52, s40, 1
    s_lshr_b32 s53, s40, 1
    s_lshl_b32 s50, s53, 4
    v_mad_u32_u24 v240, v0, 40, s50
    s_xor_b32 s50, s52, 0
    s_mul_i32 s50, s50, 10240
    s_add_u32 s51, s50, 32768
    v_add_u32 v172, s51, v240
    s_add_u32 s51, s50, 69632
    v_add_u32 v174, s51, v240
    s_add_u32 s51, s50, 106496
    v_add_u32 v176, s51, v240
    s_add_u32 s51, s50, 143360
    v_add_u32 v178, s51, v240
    s_xor_b32 s50, s52, 1
    s_mul_i32 s50, s50, 10240
    s_add_u32 s51, s50, 32768
    v_add_u32 v173, s51, v240
    s_add_u32 s51, s50, 69632
    v_add_u32 v175, s51, v240
    s_add_u32 s51, s50, 106496
    v_add_u32 v177, s51, v240
    s_add_u32 s51, s50, 143360
    v_add_u32 v179, s51, v240
    v_and_b32 v240, 15, v0
    v_lshrrev_b32 v241, 3, v240
    v_lshlrev_b32 v241, 1, v241
    v_lshrrev_b32 v242, 4, v0
    v_xor_b32 v241, v241, v242
    v_lshlrev_b32 v241, 4, v241
    v_lshl_add_u32 v240, v240, 6, v241
    s_lshl_b32 s50, s52, 1
    s_add_u32 s67, s50, s53
    s_xor_b32 s50, s67, 0
    s_lshl_b32 s50, s50, 1
    s_xor_b32 s51, s52, 0
    s_add_u32 s50, s50, s51
    s_lshl_b32 s50, s50, 11
    s_add_u32 s51, s50, 16384
    v_add_u32 v180, s51, v240
    s_add_u32 s51, s50, 53248
    v_add_u32 v184, s51, v240
    s_add_u32 s51, s50, 90112
    v_add_u32 v188, s51, v240
    s_add_u32 s51, s50, 126976
    v_add_u32 v192, s51, v240
    s_xor_b32 s50, s67, 0
    s_lshl_b32 s50, s50, 1
    s_xor_b32 s51, s52, 1
    s_add_u32 s50, s50, s51
    s_lshl_b32 s50, s50, 11
    s_add_u32 s51, s50, 16384
    v_add_u32 v182, s51, v240
    s_add_u32 s51, s50, 53248
    v_add_u32 v186, s51, v240
    s_add_u32 s51, s50, 90112
    v_add_u32 v190, s51, v240
    s_add_u32 s51, s50, 126976
    v_add_u32 v194, s51, v240
    s_xor_b32 s50, s67, 1
    s_lshl_b32 s50, s50, 1
    s_xor_b32 s51, s52, 0
    s_add_u32 s50, s50, s51
    s_lshl_b32 s50, s50, 11
    s_add_u32 s51, s50, 16384
    v_add_u32 v181, s51, v240
    s_add_u32 s51, s50, 53248
    v_add_u32 v185, s51, v240
    s_add_u32 s51, s50, 90112
    v_add_u32 v189, s51, v240
    s_add_u32 s51, s50, 126976
    v_add_u32 v193, s51, v240
    s_xor_b32 s50, s67, 1
    s_lshl_b32 s50, s50, 1
    s_xor_b32 s51, s52, 1
    s_add_u32 s50, s50, s51
    s_lshl_b32 s50, s50, 11
    s_add_u32 s51, s50, 16384
    v_add_u32 v183, s51, v240
    s_add_u32 s51, s50, 53248
    v_add_u32 v187, s51, v240
    s_add_u32 s51, s50, 90112
    v_add_u32 v191, s51, v240
    s_add_u32 s51, s50, 126976
    v_add_u32 v195, s51, v240
    v_lshrrev_b32 v240, 2, v0
    v_lshlrev_b32 v240, 4, v240
    v_and_b32 v241, 1, v0
    v_lshl_add_u32 v240, v241, 3, v240
    s_cmp_eq_u32 s53, 0
    s_cselect_b64 vcc, -1, 0
    v_mul_u32_u24 v241, 40, v0
    v_cndmask_b32 v240, v240, v241, vcc
    s_cselect_b32 vcc_lo, 0, 0xcccccccc
    s_mov_b32 vcc_hi, vcc_lo
    v_mov_b32 v242, 14336
    s_cselect_b32 s50, 10, 1
    s_cselect_b32 s51, 32800, 0
    s_cselect_b32 s54, 36864, 0
    s_cselect_b32 s56, -110592, 0
    s_lshl_b32 s50, s50, 8
    s_lshl_b32 s57, s53, 11
    s_add_u32 s54, s54, s57
    s_add_u32 s56, s56, s57
    v_mov_b32 v241, s50
    v_cndmask_b32 v76, v241, v244, vcc
    v_mov_b32 v241, s54
    v_cndmask_b32 v77, v241, v244, vcc
    v_mov_b32 v241, s56
    v_cndmask_b32 v78, v241, v244, vcc
    v_add_u32 v241, s51, v240
    v_cndmask_b32 v240, v241, v242, vcc
    s_xor_b32 s50, s52, 0
    s_lshl_b32 s50, s50, 2
    v_mad_u32_u24 v196, v76, s50, v240
    v_add_u32 v197, v76, v196
    v_add_u32 v198, v76, v197
    v_add_u32 v199, v76, v198
    s_xor_b32 s50, s52, 1
    s_lshl_b32 s50, s50, 2
    v_mad_u32_u24 v200, v76, s50, v240
    v_add_u32 v201, v76, v200
    v_add_u32 v202, v76, v201
    v_add_u32 v203, v76, v202
    v_add_u32 v204, v77, v196
    v_add_u32 v205, v77, v197
    v_add_u32 v206, v77, v198
    v_add_u32 v207, v77, v199
    v_add_u32 v208, v77, v200
    v_add_u32 v209, v77, v201
    v_add_u32 v210, v77, v202
    v_add_u32 v211, v77, v203
    v_add_u32 v212, v77, v204
    v_add_u32 v213, v77, v205
    v_add_u32 v214, v77, v206
    v_add_u32 v215, v77, v207
    v_add_u32 v216, v77, v208
    v_add_u32 v217, v77, v209
    v_add_u32 v218, v77, v210
    v_add_u32 v219, v77, v211
    v_add_u32 v220, v77, v212
    v_add_u32 v221, v77, v213
    v_add_u32 v222, v77, v214
    v_add_u32 v223, v77, v215
    v_add_u32 v224, v77, v216
    v_add_u32 v225, v77, v217
    v_add_u32 v226, v77, v218
    v_add_u32 v227, v77, v219
    v_add_u32 v228, v78, v220
    v_add_u32 v229, v78, v221
    v_add_u32 v230, v78, v222
    v_add_u32 v231, v78, v223
    v_add_u32 v232, v78, v224
    v_add_u32 v233, v78, v225
    v_add_u32 v234, v78, v226
    v_add_u32 v235, v78, v227
    v_mov_b32 v240, 0x3f803f80
    v_mov_b32 v241, 0x3f803f80
    ds_write_b64 v242, v[240:241]
    v_and_b32 v243, 15, v0
    v_cmp_eq_u32 vcc, 0, v243
    s_nop 1
    v_cndmask_b32 v64, 0, v240, vcc
    v_mov_b32 v65, v64
    v_mov_b32 v66, v64
    v_mov_b32 v67, v64
    v_cmp_eq_u32 vcc, 1, v243
    s_nop 1
    v_cndmask_b32 v68, 0, v240, vcc
    v_mov_b32 v69, v68
    v_mov_b32 v70, v68
    v_mov_b32 v71, v68
    v_cmp_eq_u32 vcc, 2, v243
    s_nop 1
    v_cndmask_b32 v72, 0, v240, vcc
    v_mov_b32 v73, v72
    v_mov_b32 v74, v72
    v_mov_b32 v75, v72
    s_cmp_eq_u32 s53, 0
    s_cselect_b32 s12, 0x3ea52b5c, 1.0
    s_lshl_b32 s50, s40, 10
    s_add_u32 s50, s50, 53248
    v_lshl_add_u32 v157, v0, 4, s50
    v_xor_b32 v159, 1024, v157
    s_lshl_b32 s50, s40, 9
    s_add_u32 s50, s50, 61440
    v_lshl_add_u32 v158, v0, 2, s50
    v_lshrrev_b32 v240, 2, v243
    v_lshl_add_u32 v240, v240, 4, v243
    v_lshlrev_b32 v240, 4, v240
    v_and_b32 v241, 3, v0
    v_lshl_add_u32 v240, v241, 2, v240
    s_xor_b32 s50, s40, 0
    s_lshl_b32 s50, s50, 10
    s_add_u32 s50, s50, 57344
    v_add_u32 v160, s50, v240
    s_xor_b32 s50, s53, 1
    s_lshl_b32 s50, s50, 8
    s_lshl_b32 s51, s52, 9
    s_add_u32 s50, s50, s51
    s_add_u32 s50, s50, 62592
    v_lshl_add_u32 v162, v243, 2, s50
    s_xor_b32 s50, s40, 2
    s_lshl_b32 s50, s50, 10
    s_add_u32 s50, s50, 57344
    v_add_u32 v161, s50, v240
    s_xor_b32 s50, s53, 0
    s_lshl_b32 s50, s50, 8
    s_lshl_b32 s51, s52, 9
    s_add_u32 s50, s50, s51
    s_add_u32 s50, s50, 62592
    v_lshl_add_u32 v163, v243, 2, s50
    v_bfe_u32 v240, v0, 3, 1
    v_mul_u32_u24 v240, 10240, v240
    v_and_b32 v242, 7, v0
    v_lshl_add_u32 v240, v242, 4, v240
    v_lshrrev_b32 v241, 4, v0
    v_lshl_add_u32 v166, v241, 7, v240
    v_lshrrev_b32 v242, 5, v0
    v_lshl_add_u32 v240, v242, 7, v240
    v_bfe_u32 v242, v0, 4, 1
    v_mul_u32_u24 v168, 20480, v242
    v_add_u32 v168, v168, v240
    v_lshlrev_b32 v240, 4, v243
    v_lshl_add_u32 v240, v242, 11, v240
    s_cmp_eq_u32 s53, 0
    s_cselect_b64 vcc, -1, 0
    v_cndmask_b32 v240, v240, v168, vcc
    s_cmp_lt_u32 s66, 3
    s_cselect_b32 s50, 16, 0
    s_cmp_lt_u32 s66, 2
    s_cselect_b32 s50, 32, s50
    s_cmp_eq_u32 s53, 0
    s_cselect_b32 s3, 64, s50
    v_cmp_gt_u32 vcc, s3, v0
    v_bfrev_b32 v242, 1
    s_nop 0
    v_cndmask_b32 v240, v242, v240, vcc
    s_xor_b32 s50, s67, 1
    s_lshl_b32 s51, s65, 2
    s_add_u32 s54, s50, s51
    s_mul_i32 s50, s54, 20480
    s_mul_i32 s51, s66, 1280
    s_add_u32 s50, s50, s51
    s_lshl_b32 s51, s53, 9
    s_add_u32 s51, s51, s50
    v_add_u32 v167, s51, v166
    s_xor_b32 s50, s67, 0
    s_lshl_b32 s51, s65, 2
    s_add_u32 s54, s50, s51
    s_mul_i32 s50, s54, 20480
    s_mul_i32 s51, s66, 1280
    s_add_u32 s50, s50, s51
    s_lshl_b32 s51, s53, 9
    s_add_u32 s51, s51, s50
    v_add_u32 v166, s51, v166
    s_add_u32 s57, s50, 1024
    s_lshr_b32 s54, s65, 1
    s_and_b32 s51, s65, 1
    s_lshl_b32 s50, s54, 2
    s_add_u32 s50, s50, s51
    s_lshl_b32 s50, s50, 1
    s_add_u32 s50, s50, s68
    s_lshl_b32 s50, s50, 1
    s_add_u32 s50, s50, s52
    s_lshl_b32 s50, s50, 8
    s_add_u32 s56, s50, 2621440
    s_lshl_b32 s50, s65, 1
    s_add_u32 s50, s50, s52
    s_lshl_b32 s50, s50, 8
    s_add_u32 s50, s50, 2686976
    s_cmp_lt_u32 s66, 2
    s_cselect_b32 s50, s56, s50
    s_cmp_eq_u32 s53, 0
    s_cselect_b32 s50, s57, s50
    v_add_u32 v168, s50, v240
    s_lshl_b32 s50, s40, 10
    s_add_u32 s50, s50, 106496
    v_lshl_add_u32 v240, v243, 5, s50
    v_lshl_add_u32 v164, v241, 3, v240
    v_bfe_u32 v240, v0, 2, 2
    v_bfe_u32 v241, v0, 1, 1
    v_lshl_add_u32 v240, v241, 3, v240
    v_bfe_u32 v241, v0, 4, 1
    v_lshl_add_u32 v240, v241, 4, v240
    v_lshl_add_u32 v240, v240, 5, s50
    v_and_b32 v241, 1, v0
    v_lshl_add_u32 v165, v241, 3, v240
    v_bfe_u32 v240, v0, 3, 1
    v_bfe_u32 v241, v0, 4, 1
    v_lshl_add_u32 v240, v241, 3, v240
    v_mul_u32_u24 v240, 384, v240
    v_and_b32 v241, 7, v0
    v_lshl_add_u32 v240, v241, 4, v240
    s_lshl_b32 s50, s54, 2
    s_add_u32 s50, s50, s51
    s_lshl_b32 s50, s50, 1
    s_add_u32 s50, s50, s52
    s_mul_i32 s50, s50, 768
    s_lshl_b32 s51, s68, 7
    s_add_u32 s50, s50, s51
    s_add_u32 s50, s50, 2703360
    v_add_u32 v240, s50, v240
    s_sub_u32 s50, s66, 3
    s_cmp_lt_u32 s50, 3
    s_cselect_b32 s50, 32, 0
    s_mul_i32 s50, s50, s53
    v_cmp_gt_u32 vcc, s50, v0
    s_cmp_eq_u32 s66, 5
    s_cselect_b32 s13, 0xffff0000, 0
    v_cndmask_b32 v170, v242, v240, vcc
    s_mul_i32 s13, s13, s53
    s_mul_i32 s50, s41, 10240
    s_mul_i32 s51, s40, 320
    s_add_u32 s50, s50, s51
    s_add_u32 s50, s50, 4096
    v_add_u32 v240, 0, v0
    v_mul_u32_u24 v241, 205, v240
    v_lshrrev_b32 v241, 12, v241
    v_mul_u32_u24 v241, 960, v241
    v_lshl_add_u32 v241, v0, 4, v241
    v_add_u32 v150, s50, v241
    v_add_u32 v240, 64, v0
    v_mul_u32_u24 v241, 205, v240
    v_lshrrev_b32 v241, 12, v241
    v_mul_u32_u24 v241, 960, v241
    v_lshl_add_u32 v241, v0, 4, v241
    v_add_u32 v151, s50, v241
    v_add_u32 v240, 128, v0
    v_mul_u32_u24 v241, 205, v240
    v_lshrrev_b32 v241, 12, v241
    v_mul_u32_u24 v241, 960, v241
    v_lshl_add_u32 v241, v0, 4, v241
    v_add_u32 v152, s50, v241
    v_mov_b32 v244, -1
    v_mov_b32 v245, -1
    v_mov_b32 v246, -1
    v_mov_b32 v247, -1
    v_mov_b32 v240, 1
    s_waitcnt vmcnt(11)
    buffer_store_dword v240, v147, s[96:99], 0 offen sc1
    s_add_u32 m0, s71, 53248
    s_lshl_b32 s69, s70, 8
    buffer_load_dwordx4 v136, s[32:35], s69 offen  lds
    s_mul_i32 s58, s70, 163840
    buffer_load_dwordx4 v137, s[32:35], s69 offen offset:1024  lds
    s_mul_i32 s59, s70, 5120
    buffer_load_dwordx4 v138, s[32:35], s69 offen offset:2048  lds
    s_add_u32 s70, s70, 1
    buffer_load_dwordx4 v139, s[32:35], s69 offen offset:3072  lds
    s_add_u32 m0, s10, 69632
    s_cmp_eq_u32 s70, 5
    s_cselect_b32 s70, 0, s70
    buffer_load_dwordx4 v140, s[36:39], s58 offen offset:0  lds
    buffer_load_dwordx4 v141, s[36:39], s58 offen offset:1024  lds
    buffer_load_dwordx4 v142, s[36:39], s58 offen offset:2048  lds
    buffer_load_dwordx4 v143, s[36:39], s58 offen offset:3072  lds
    s_add_u32 m0, s10, 73728
    s_nop 0
    buffer_load_dwordx4 v144, s[36:39], s58 offen offset:0  lds
    s_add_u32 m0, s11, 2048
    s_mov_b32 exec_hi, 0
    buffer_load_dwordx4 v145, s[72:75], s59 offen  lds
    s_mov_b32 exec_hi, -1
    s_waitcnt vmcnt(12)
    s_waitcnt lgkmcnt(0)
    s_barrier
    ds_read_b128 v[88:91], v180 offset:0
    ds_read_b64_tr_b16 v[84:85], v196
    ds_read_b64_tr_b16 v[86:87], v197
    ds_read_b128 v[92:95], v181 offset:0
    ds_read_b64_tr_b16 v[76:77], v172 offset:0
    ds_read_b64_tr_b16 v[78:79], v172 offset:2560
    ds_read_b64_tr_b16 v[80:81], v172 offset:8
    ds_read_b64_tr_b16 v[82:83], v172 offset:2568
    s_waitcnt lgkmcnt(7)
    v_mfma_f32_16x16x32_bf16 v[60:63], v[88:91], v[88:91], 0
    s_waitcnt lgkmcnt(5)
    ds_read_b128 v[108:111], v180 offset:1024
    ds_read_b64_tr_b16 v[104:105], v198
    v_mfma_f32_16x16x32_bf16 v[40:43], v[84:87], v[88:91], 0
    s_waitcnt lgkmcnt(6)
    ds_read_b64_tr_b16 v[106:107], v199
    v_mfma_f32_16x16x32_bf16 v[52:55], v[84:87], v[92:95], 0
    ds_read_b128 v[112:115], v181 offset:1024
    s_add_u32 m0, s71, 90112
    s_lshl_b32 s69, s70, 8
    buffer_load_dwordx4 v136, s[32:35], s69 offen  lds
    v_mfma_f32_16x16x32_bf16 v[56:59], v[84:87], v[72:75], 0
    s_waitcnt lgkmcnt(6)
    ds_read_b64_tr_b16 v[96:97], v172 offset:5120
    v_mfma_f32_16x16x32_bf16 v[32:35], v[76:79], v[88:91], 0
    ds_read_b64_tr_b16 v[98:99], v172 offset:7680
    s_mul_i32 s58, s70, 163840
    buffer_load_dwordx4 v137, s[32:35], s69 offen offset:1024  lds
    v_mfma_f32_16x16x32_bf16 v[44:47], v[76:79], v[92:95], 0
    ds_read_b64_tr_b16 v[100:101], v172 offset:5128
    v_mfma_f32_16x16x32_bf16 v[56:59], v[76:79], v[64:67], v[56:59]
    s_waitcnt lgkmcnt(7)
    ds_read_b64_tr_b16 v[102:103], v172 offset:7688
    s_mul_i32 s59, s70, 5120
    buffer_load_dwordx4 v138, s[32:35], s69 offen offset:2048  lds
    v_mfma_f32_16x16x32_bf16 v[36:39], v[80:83], v[88:91], 0
    v_mfma_f32_16x16x32_bf16 v[48:51], v[80:83], v[92:95], 0
    s_add_u32 s70, s70, 1
    buffer_load_dwordx4 v139, s[32:35], s69 offen offset:3072  lds
    v_mfma_f32_16x16x32_bf16 v[56:59], v[80:83], v[68:71], v[56:59]
    s_waitcnt lgkmcnt(7)
    v_mfma_f32_16x16x32_bf16 v[60:63], v[108:111], v[108:111], v[60:63]
    s_waitcnt lgkmcnt(5)
    ds_read_b128 v[128:131], v182 offset:0
    ds_read_b64_tr_b16 v[124:125], v200
    v_lshlrev_b32 v1, 4, v0
    v_mov_b32 v2, 0xdddd
    v_and_b32 v20, 8, v0
    v_mfma_f32_16x16x32_bf16 v[40:43], v[104:107], v[108:111], v[40:43]
    s_waitcnt lgkmcnt(6)
    ds_read_b64_tr_b16 v[126:127], v201
    v_cmp_eq_u32 vcc, 0, v20
    v_mov_b32 v20, 0xeeee
    v_mov_b32 v21, 0x4444
    v_mfma_f32_16x16x32_bf16 v[52:55], v[104:107], v[112:115], v[52:55]
    ds_read_b128 v[132:135], v183 offset:0
    s_add_u32 m0, s10, 106496
    s_cmp_eq_u32 s70, 5
    s_cselect_b32 s70, 0, s70
    buffer_load_dwordx4 v140, s[36:39], s58 offen offset:0  lds
    v_cndmask_b32 v3, v20, v21, vcc
    v_mov_b32 v4, 0
    v_mov_b32 v5, 0
    v_mfma_f32_16x16x32_bf16 v[56:59], v[104:107], v[72:75], v[56:59]
    s_waitcnt lgkmcnt(6)
    ds_read_b64_tr_b16 v[116:117], v173 offset:0
    s_mul_i32 s42, s41, 10240
    v_add_u32 v11, s42, v1
    v_bfe_u32 v20, v0, 4, 1
    v_mfma_f32_16x16x32_bf16 v[32:35], v[96:99], v[108:111], v[32:35]
    ds_read_b64_tr_b16 v[118:119], v173 offset:2560
    buffer_load_dwordx4 v141, s[36:39], s58 offen offset:1024  lds
    v_lshl_add_u32 v20, v20, 7, s42
    v_and_b32 v21, 7, v0
    v_lshl_add_u32 v20, v21, 4, v20
    v_mfma_f32_16x16x32_bf16 v[44:47], v[96:99], v[112:115], v[44:47]
    ds_read_b64_tr_b16 v[120:121], v173 offset:8
    v_and_b32 v21, 8, v0
    v_add_u32 v12, v20, v21
    v_and_b32 v20, 31, v0
    v_mfma_f32_16x16x32_bf16 v[56:59], v[96:99], v[64:67], v[56:59]
    s_waitcnt lgkmcnt(7)
    ds_read_b64_tr_b16 v[122:123], v173 offset:2568
    buffer_load_dwordx4 v142, s[36:39], s58 offen offset:2048  lds
    v_min_u32 v20, 23, v20
    v_lshrrev_b32 v21, 5, v0
    v_mul_u32_u24 v21, 384, v21
    v_mfma_f32_16x16x32_bf16 v[36:39], v[100:103], v[108:111], v[36:39]
    v_lshl_add_u32 v13, v20, 4, v21
    s_mul_i32 s43, s40, 3072
    v_add_u32 v6, s43, v1
    v_mfma_f32_16x16x32_bf16 v[48:51], v[100:103], v[112:115], v[48:51]
    buffer_load_dwordx4 v143, s[36:39], s58 offen offset:3072  lds
    v_and_b32 v20, 7, v0
    v_lshlrev_b32 v21, 2, v20
    s_mov_b32 s44, 0x54435210
    v_mfma_f32_16x16x32_bf16 v[56:59], v[100:103], v[68:71], v[56:59]
    v_mov_b32 v22, s44
    v_lshrrev_b32 v21, v21, v22
    v_and_b32 v21, 7, v21
    s_waitcnt lgkmcnt(7)
    v_mfma_f32_16x16x32_bf16 v[60:63], v[128:131], v[128:131], v[60:63]
    s_waitcnt lgkmcnt(5)
    ds_read_b128 v[88:91], v182 offset:1024
    ds_read_b64_tr_b16 v[84:85], v202
    v_lshrrev_b32 v22, 3, v0
    s_lshl_b32 s44, s40, 7
    v_lshl_add_u32 v23, v21, 9, s44
    v_mfma_f32_16x16x32_bf16 v[40:43], v[124:127], v[128:131], v[40:43]
    s_waitcnt lgkmcnt(6)
    ds_read_b64_tr_b16 v[86:87], v203
    v_lshl_add_u32 v7, v22, 4, v23
    v_and_b32 v20, 7, v0
    v_lshlrev_b32 v21, 2, v20
    v_mfma_f32_16x16x32_bf16 v[52:55], v[124:127], v[132:135], v[52:55]
    s_waitcnt lgkmcnt(5)
    ds_read_b128 v[92:95], v183 offset:1024
    s_add_u32 m0, s10, 110592
    s_nop 0
    buffer_load_dwordx4 v144, s[36:39], s58 offen offset:0  lds
    v_mov_b32 v22, 0x54435210
    v_lshrrev_b32 v21, v21, v22
    v_and_b32 v21, 7, v21
    v_mfma_f32_16x16x32_bf16 v[32:35], v[116:119], v[128:131], v[32:35]
    ds_read_b64_tr_b16 v[76:77], v173 offset:5120
    v_lshrrev_b32 v22, 3, v0
    s_mul_i32 s44, s40, 5
    v_add_u32 v21, s44, v21
    v_mfma_f32_16x16x32_bf16 v[44:47], v[116:119], v[132:135], v[44:47]
    s_waitcnt lgkmcnt(5)
    ds_read_b64_tr_b16 v[78:79], v173 offset:7680
    v_lshrrev_b32 v23, 2, v21
    v_lshlrev_b32 v23, 8, v23
    v_and_b32 v21, 3, v21
    v_mfma_f32_16x16x32_bf16 v[36:39], v[120:123], v[128:131], v[36:39]
    ds_read_b64_tr_b16 v[80:81], v173 offset:5128
    s_add_u32 m0, s11, 4096
    s_mov_b32 exec_hi, 0
    buffer_load_dwordx4 v145, s[72:75], s59 offen  lds
    s_mov_b32 exec_hi, -1
    v_lshl_add_u32 v23, v21, 2, v23
    v_lshl_add_u32 v23, v22, 4, v23
    v_add_u32 v23, 24576, v23
    v_mfma_f32_16x16x32_bf16 v[48:51], v[120:123], v[132:135], v[48:51]
    ds_read_b64_tr_b16 v[82:83], v173 offset:7688
    v_mov_b32 v21, 0x37
    v_lshrrev_b32 v21, v20, v21
    v_and_b32 v21, 1, v21
    s_waitcnt vmcnt(10)
    s_barrier
    ds_read_b64_tr_b16 v[236:237], v155 offset:10240
    ds_read_b64_tr_b16 v[238:239], v155 offset:10752
    s_waitcnt lgkmcnt(9)
    v_mfma_f32_16x16x32_bf16 v[60:63], v[88:91], v[88:91], v[60:63]
    s_waitcnt lgkmcnt(7)
    ds_read_b128 v[108:111], v184 offset:0
    ds_read_b64_tr_b16 v[104:105], v204
    v_cmp_eq_u32 vcc, 1, v21
    v_mov_b32 v22, 30272
    s_nop 0
    v_cndmask_b32 v8, v22, v23, vcc
    v_mfma_f32_16x16x32_bf16 v[40:43], v[84:87], v[88:91], v[40:43]
    s_waitcnt lgkmcnt(8)
    ds_read_b64_tr_b16 v[106:107], v205
    v_mul_u32_u24 v9, 1280, v21
    v_mov_b32 v10, 0
    s_lshl_b32 s46, s40, 14
    v_mfma_f32_16x16x32_bf16 v[52:55], v[84:87], v[92:95], v[52:55]
    s_waitcnt lgkmcnt(7)
    ds_read_b128 v[112:115], v185 offset:0
    s_add_u32 s46, s46, 2621440
    s_lshl_b32 s47, s40, 12
    s_add_u32 s47, s47, 2686976
    v_mfma_f32_16x16x32_bf16 v[32:35], v[76:79], v[88:91], v[32:35]
    ds_read_b64_tr_b16 v[96:97], v174 offset:0
    s_mul_i32 s48, s40, 24576
    s_add_u32 s48, s48, 2703360
    s_mul_i32 s49, s40, 20480
    v_mfma_f32_16x16x32_bf16 v[44:47], v[76:79], v[92:95], v[44:47]
    s_waitcnt lgkmcnt(7)
    ds_read_b64_tr_b16 v[98:99], v174 offset:2560
    s_add_u32 s49, s49, 2801664
    s_add_u32 s44, s43, 90112
    s_and_b32 s50, s2, 7
    v_mfma_f32_16x16x32_bf16 v[36:39], v[80:83], v[88:91], v[36:39]
    ds_read_b64_tr_b16 v[100:101], v174 offset:8
    s_lshr_b32 s51, s2, 3
    s_mul_i32 s52, s51, 52
    s_lshr_b32 s52, s52, 8
    v_mfma_f32_16x16x32_bf16 v[48:51], v[80:83], v[92:95], v[48:51]
    ds_read_b64_tr_b16 v[102:103], v174 offset:2568
    s_mul_i32 s53, s52, 5
    s_sub_u32 s60, s51, s53
    s_and_b32 s53, s50, 1
    s_waitcnt lgkmcnt(7)
    v_mfma_f32_16x16x32_bf16 v[60:63], v[108:111], v[108:111], v[60:63]
    s_waitcnt lgkmcnt(5)
    ds_read_b128 v[128:131], v184 offset:1024
    ds_read_b64_tr_b16 v[124:125], v206
    s_mul_i32 s53, s53, 5
    s_add_u32 s60, s60, s53
    s_lshr_b32 s53, s50, 1
    v_mfma_f32_16x16x32_bf16 v[40:43], v[104:107], v[108:111], v[40:43]
    s_waitcnt lgkmcnt(6)
    ds_read_b64_tr_b16 v[126:127], v207
    s_lshl_b32 s52, s52, 2
    s_add_u32 s61, s52, s53
    s_and_b32 s50, s2, 7
    v_mfma_f32_16x16x32_bf16 v[52:55], v[104:107], v[112:115], v[52:55]
    ds_read_b128 v[132:135], v185 offset:1024
    s_add_u32 m0, s71, 126976
    s_lshl_b32 s69, s70, 8
    buffer_load_dwordx4 v136, s[32:35], s69 offen  lds
    s_lshr_b32 s51, s2, 3
    s_and_b32 s52, s50, 1
    s_lshl_b32 s52, s52, 2
    v_mfma_f32_16x16x32_bf16 v[56:59], v[104:107], v[72:75], v[56:59]
    s_waitcnt lgkmcnt(6)
    ds_read_b64_tr_b16 v[116:117], v174 offset:5120
    s_and_b32 s53, s51, 3
    s_add_u32 s62, s52, s53
    s_lshr_b32 s52, s50, 1
    v_mfma_f32_16x16x32_bf16 v[32:35], v[96:99], v[108:111], v[32:35]
    ds_read_b64_tr_b16 v[118:119], v174 offset:7680
    s_mul_i32 s58, s70, 163840
    buffer_load_dwordx4 v137, s[32:35], s69 offen offset:1024  lds
    s_and_b32 s53, s51, 28
    s_add_u32 s63, s52, s53
    s_lshl_b32 s64, s40, 15
    v_mfma_f32_16x16x32_bf16 v[44:47], v[96:99], v[112:115], v[44:47]
    ds_read_b64_tr_b16 v[120:121], v174 offset:5128
    s_add_u32 s64, s64, 32768
    v_lshrrev_b32 v20, 5, v0
    v_bfe_u32 v21, v0, 2, 2
    v_mfma_f32_16x16x32_bf16 v[56:59], v[96:99], v[64:67], v[56:59]
    s_waitcnt lgkmcnt(7)
    ds_read_b64_tr_b16 v[122:123], v174 offset:7688
    s_mul_i32 s59, s70, 5120
    buffer_load_dwordx4 v138, s[32:35], s69 offen offset:2048  lds
    v_lshl_add_u32 v20, v20, 2, v21
    v_mul_u32_u24 v20, 3072, v20
    v_bfe_u32 v21, v0, 4, 1
    v_mfma_f32_16x16x32_bf16 v[36:39], v[100:103], v[108:111], v[36:39]
    v_lshl_add_u32 v20, v21, 6, v20
    v_and_b32 v21, 3, v0
    v_lshl_add_u32 v20, v21, 4, v20
    v_mfma_f32_16x16x32_bf16 v[48:51], v[100:103], v[112:115], v[48:51]
    s_add_u32 s70, s70, 1
    buffer_load_dwordx4 v139, s[32:35], s69 offen offset:3072  lds
    s_mul_i32 s50, s40, 1572864
    s_lshl_b32 s51, s61, 7
    s_add_u32 s50, s50, s51
    v_mfma_f32_16x16x32_bf16 v[56:59], v[100:103], v[68:71], v[56:59]
    v_add_u32 v17, s50, v20
    s_mov_b32 s24, s76
    s_mov_b32 s25, s77
    s_waitcnt lgkmcnt(7)
    v_mfma_f32_16x16x32_bf16 v[60:63], v[128:131], v[128:131], v[60:63]
    s_waitcnt lgkmcnt(5)
    ds_read_b128 v[88:91], v186 offset:0
    ds_read_b64_tr_b16 v[84:85], v208
    s_mov_b32 s26, 6291456
    s_mov_b32 s27, 0x20000
    s_cmp_ge_u32 s2, 240
    s_cselect_b32 s26, 0, s26
    v_mfma_f32_16x16x32_bf16 v[40:43], v[124:127], v[128:131], v[40:43]
    s_waitcnt lgkmcnt(6)
    ds_read_b64_tr_b16 v[86:87], v209
    s_mov_b32 s28, s80
    s_mov_b32 s29, s81
    s_mov_b32 s30, 6291456
    v_mfma_f32_16x16x32_bf16 v[52:55], v[124:127], v[132:135], v[52:55]
    ds_read_b128 v[92:95], v187 offset:0
    s_add_u32 m0, s10, 143360
    s_cmp_eq_u32 s70, 5
    s_cselect_b32 s70, 0, s70
    buffer_load_dwordx4 v140, s[36:39], s58 offen offset:0  lds
    s_mov_b32 s31, 0x20000
    v_lshrrev_b32 v20, 5, v0
    v_lshlrev_b32 v20, 10, v20
    v_mfma_f32_16x16x32_bf16 v[56:59], v[124:127], v[72:75], v[56:59]
    s_waitcnt lgkmcnt(6)
    ds_read_b64_tr_b16 v[76:77], v175 offset:0
    v_bfe_u32 v21, v0, 2, 2
    v_lshl_add_u32 v20, v21, 6, v20
    v_bfe_u32 v21, v0, 4, 1
    v_mfma_f32_16x16x32_bf16 v[32:35], v[116:119], v[128:131], v[32:35]
    ds_read_b64_tr_b16 v[78:79], v175 offset:2560
    buffer_load_dwordx4 v141, s[36:39], s58 offen offset:1024  lds
    v_lshl_add_u32 v20, v21, 5, v20
    v_and_b32 v21, 1, v0
    v_lshl_add_u32 v20, v21, 4, v20
    v_mfma_f32_16x16x32_bf16 v[44:47], v[116:119], v[132:135], v[44:47]
    ds_read_b64_tr_b16 v[80:81], v175 offset:8
    v_bfe_u32 v21, v0, 1, 1
    v_lshl_add_u32 v20, v21, 3, v20
    s_and_b32 s50, s40, 1
    v_mfma_f32_16x16x32_bf16 v[56:59], v[116:119], v[64:67], v[56:59]
    s_waitcnt lgkmcnt(7)
    ds_read_b64_tr_b16 v[82:83], v175 offset:2568
    buffer_load_dwordx4 v142, s[36:39], s58 offen offset:2048  lds
    s_lshl_b32 s50, s50, 5
    s_lshr_b32 s51, s40, 1
    s_lshl_b32 s51, s51, 8
    v_mfma_f32_16x16x32_bf16 v[36:39], v[120:123], v[128:131], v[36:39]
    s_or_b32 s50, s50, s51
    s_or_b32 s50, s50, s64
    v_xor_b32 v18, s50, v20
    v_mfma_f32_16x16x32_bf16 v[48:51], v[120:123], v[132:135], v[48:51]
L_hop0:
    s_cbranch_execz L_hop4
    buffer_load_dwordx4 v143, s[36:39], s58 offen offset:3072  lds
    v_xor_b32 v19, 256, v18
    v_lshrrev_b32 v20, 5, v0
    v_and_b32 v21, 31, v0
    v_mfma_f32_16x16x32_bf16 v[56:59], v[120:123], v[68:71], v[56:59]
    v_lshlrev_b32 v21, 4, v21
    v_lshl_add_u32 v15, v20, 17, v21
    v_and_b32 v24, 48, v21
    s_waitcnt lgkmcnt(7)
    v_mfma_f32_16x16x32_bf16 v[60:63], v[88:91], v[88:91], v[60:63]
    s_waitcnt lgkmcnt(5)
    ds_read_b128 v[108:111], v186 offset:1024
    ds_read_b64_tr_b16 v[104:105], v210
    s_mul_i32 s4, s40, 655360
    s_lshl_b32 s50, s41, 9
    s_add_u32 s4, s4, s50
    v_mfma_f32_16x16x32_bf16 v[40:43], v[84:87], v[88:91], v[40:43]
    s_waitcnt lgkmcnt(6)
    ds_read_b64_tr_b16 v[106:107], v211
    s_add_u32 s4, s4, 3620864
    s_add_u32 s8, s4, 262144
    s_add_u32 s9, s4, 393216
    v_mfma_f32_16x16x32_bf16 v[52:55], v[84:87], v[92:95], v[52:55]
    s_waitcnt lgkmcnt(5)
    ds_read_b128 v[112:115], v187 offset:1024
    s_add_u32 m0, s10, 147456
    s_nop 0
    buffer_load_dwordx4 v144, s[36:39], s58 offen offset:0  lds
    s_lshl_b32 s5, s41, 6
    s_add_u32 s5, s5, 6242304
    s_lshl_b32 s6, s60, 2
    v_mfma_f32_16x16x32_bf16 v[32:35], v[76:79], v[88:91], v[32:35]
    ds_read_b64_tr_b16 v[96:97], v175 offset:5120
    s_add_u32 s6, s6, s40
    s_mul_i32 s6, s6, 24
    s_add_u32 s6, s6, s61
    v_mfma_f32_16x16x32_bf16 v[44:47], v[76:79], v[92:95], v[44:47]
    s_waitcnt lgkmcnt(5)
    ds_read_b64_tr_b16 v[98:99], v175 offset:7680
    s_lshl_b32 s6, s6, 11
    s_add_u32 s6, s6, 6258688
    s_cmp_ge_u32 s2, 240
    s_cselect_b32 s50, 0x80000000, 0
    v_mfma_f32_16x16x32_bf16 v[36:39], v[80:83], v[88:91], v[36:39]
    ds_read_b64_tr_b16 v[100:101], v175 offset:5128
    s_add_u32 m0, s11, 6144
    s_mov_b32 exec_hi, 0
    buffer_load_dwordx4 v145, s[72:75], s59 offen  lds
    s_mov_b32 exec_hi, -1
    v_or_b32 v25, s50, v1
    s_mov_b32 s88, s76
    s_mov_b32 s89, s77
    v_mfma_f32_16x16x32_bf16 v[48:51], v[80:83], v[92:95], v[48:51]
    ds_read_b64_tr_b16 v[102:103], v175 offset:7688
    s_mov_b32 s90, 6291456
    s_mov_b32 s91, 0x20000
    s_lshl_b32 s55, s2, 2
    s_waitcnt vmcnt(10)
    s_barrier
    s_waitcnt lgkmcnt(7)
    v_mfma_f32_16x16x32_bf16 v[60:63], v[108:111], v[108:111], v[60:63]
    s_waitcnt lgkmcnt(5)
    ds_read_b128 v[128:131], v188 offset:0
    ds_read_b64_tr_b16 v[124:125], v212
    s_add_u32 s55, s55, s40
    s_mul_i32 s55, s55, 6144
    v_add_u32 v28, 0, v0
    v_mfma_f32_16x16x32_bf16 v[40:43], v[104:107], v[108:111], v[40:43]
    s_waitcnt lgkmcnt(6)
    ds_read_b64_tr_b16 v[126:127], v213
    v_min_u32 v28, 47, v28
    v_lshlrev_b32 v28, 7, v28
    s_lshr_b32 s50, s2, 3
    v_mfma_f32_16x16x32_bf16 v[52:55], v[104:107], v[112:115], v[52:55]
    s_waitcnt lgkmcnt(5)
    ds_read_b128 v[132:135], v189 offset:0
    s_lshl_b32 s52, s50, 2
    s_add_u32 s52, s52, s40
    s_bfe_u32 s51, s2, 0x20001
    v_mfma_f32_16x16x32_bf16 v[32:35], v[96:99], v[108:111], v[32:35]
    ds_read_b64_tr_b16 v[116:117], v176 offset:0
    v_min_u32 v20, 11, v0
    v_lshlrev_b32 v20, 9, v20
    s_lshl_b32 s53, s40, 6
    v_mfma_f32_16x16x32_bf16 v[44:47], v[96:99], v[112:115], v[44:47]
    s_waitcnt lgkmcnt(5)
    ds_read_b64_tr_b16 v[118:119], v176 offset:2560
    s_add_u32 s53, s53, s50
    s_add_u32 s53, s53, 32
    s_mul_i32 s53, s53, 24576
    v_mfma_f32_16x16x32_bf16 v[36:39], v[100:103], v[108:111], v[36:39]
    ds_read_b64_tr_b16 v[120:121], v176 offset:8
    s_lshl_b32 s57, s51, 7
    s_add_u32 s53, s53, s57
    v_add_u32 v30, s53, v20
    v_mfma_f32_16x16x32_bf16 v[48:51], v[100:103], v[112:115], v[48:51]
    ds_read_b64_tr_b16 v[122:123], v176 offset:2568
    s_mul_i32 s52, s52, 49152
    s_add_u32 s52, s52, s57
    s_and_b32 s51, s2, 1
    s_waitcnt lgkmcnt(7)
    v_mfma_f32_16x16x32_bf16 v[60:63], v[128:131], v[128:131], v[60:63]
    s_waitcnt lgkmcnt(5)
    ds_read_b128 v[88:91], v188 offset:1024
    ds_read_b64_tr_b16 v[84:85], v214
    s_mul_i32 s51, s51, 24576
    s_add_u32 s53, s52, s51
    s_add_u32 s86, s80, s53
    s_addc_u32 s87, s81, 0
    v_mfma_f32_16x16x32_bf16 v[40:43], v[124:127], v[128:131], v[40:43]
    s_waitcnt lgkmcnt(6)
    ds_read_b64_tr_b16 v[86:87], v215
    v_min_u32 v20, 12, v0
    v_lshl_add_u32 v14, v20, 9, s53
    s_add_u32 s52, s52, 24576
    v_mfma_f32_16x16x32_bf16 v[52:55], v[124:127], v[132:135], v[52:55]
    ds_read_b128 v[92:95], v189 offset:1024
    s_add_u32 m0, s71, 16384
    s_lshl_b32 s69, s70, 8
    buffer_load_dwordx4 v136, s[32:35], s69 offen  lds
    s_sub_u32 s52, s52, s51
    v_min_u32 v20, 7, v0
    v_lshl_add_u32 v31, v20, 9, s52
    v_mfma_f32_16x16x32_bf16 v[56:59], v[124:127], v[72:75], v[56:59]
    s_waitcnt lgkmcnt(6)
    ds_read_b64_tr_b16 v[76:77], v176 offset:5120
    v_bfe_u32 v20, v0, 2, 3
    v_mul_u32_u24 v20, 320, v20
    v_and_b32 v21, 3, v0
    v_mfma_f32_16x16x32_bf16 v[32:35], v[116:119], v[128:131], v[32:35]
    ds_read_b64_tr_b16 v[78:79], v176 offset:7680
    s_mul_i32 s58, s70, 163840
    buffer_load_dwordx4 v137, s[32:35], s69 offen offset:1024  lds
    v_lshl_add_u32 v20, v21, 3, v20
    v_add_u32 v20, s44, v20
    v_cmp_gt_u32 vcc, 32, v0
    v_mfma_f32_16x16x32_bf16 v[44:47], v[116:119], v[132:135], v[44:47]
    ds_read_b64_tr_b16 v[80:81], v176 offset:5128
    v_mov_b32 v21, 0xffff0000
    v_mov_b32 v22, 0x0c0c0c0c
    v_mov_b32 v23, 0x01000c0c
    v_mfma_f32_16x16x32_bf16 v[56:59], v[116:119], v[64:67], v[56:59]
    s_waitcnt lgkmcnt(7)
    ds_read_b64_tr_b16 v[82:83], v176 offset:7688
    s_mul_i32 s59, s70, 5120
    buffer_load_dwordx4 v138, s[32:35], s69 offen offset:2048  lds
    v_cndmask_b32 v21, 0, v21, vcc
    v_cndmask_b32 v22, v22, v23, vcc
    v_mfma_f32_16x16x32_bf16 v[36:39], v[120:123], v[128:131], v[36:39]
    v_mfma_f32_16x16x32_bf16 v[48:51], v[120:123], v[132:135], v[48:51]
    s_add_u32 s70, s70, 1
    buffer_load_dwordx4 v139, s[32:35], s69 offen offset:3072  lds
    v_mfma_f32_16x16x32_bf16 v[56:59], v[120:123], v[68:71], v[56:59]
    s_waitcnt lgkmcnt(7)
    v_mfma_f32_16x16x32_bf16 v[60:63], v[88:91], v[88:91], v[60:63]
    s_waitcnt lgkmcnt(5)
    ds_read_b128 v[108:111], v190 offset:0
    ds_read_b64_tr_b16 v[104:105], v216
    v_mfma_f32_16x16x32_bf16 v[40:43], v[84:87], v[88:91], v[40:43]
    s_waitcnt lgkmcnt(6)
    ds_read_b64_tr_b16 v[106:107], v217
    v_mfma_f32_16x16x32_bf16 v[52:55], v[84:87], v[92:95], v[52:55]
    ds_read_b128 v[112:115], v191 offset:0
    s_add_u32 m0, s10, 32768
    s_cmp_eq_u32 s70, 5
    s_cselect_b32 s70, 0, s70
    buffer_load_dwordx4 v140, s[36:39], s58 offen offset:0  lds
    v_mfma_f32_16x16x32_bf16 v[56:59], v[84:87], v[72:75], v[56:59]
    s_waitcnt lgkmcnt(6)
    ds_read_b64_tr_b16 v[96:97], v177 offset:0
    v_mfma_f32_16x16x32_bf16 v[32:35], v[76:79], v[88:91], v[32:35]
    ds_read_b64_tr_b16 v[98:99], v177 offset:2560
    buffer_load_dwordx4 v141, s[36:39], s58 offen offset:1024  lds
    v_mfma_f32_16x16x32_bf16 v[44:47], v[76:79], v[92:95], v[44:47]
    ds_read_b64_tr_b16 v[100:101], v177 offset:8
    v_mfma_f32_16x16x32_bf16 v[56:59], v[76:79], v[64:67], v[56:59]
    s_waitcnt lgkmcnt(7)
    ds_read_b64_tr_b16 v[102:103], v177 offset:2568
    buffer_load_dwordx4 v142, s[36:39], s58 offen offset:2048  lds
    v_mfma_f32_16x16x32_bf16 v[36:39], v[80:83], v[88:91], v[36:39]
    v_mfma_f32_16x16x32_bf16 v[48:51], v[80:83], v[92:95], v[48:51]
    buffer_load_dwordx4 v143, s[36:39], s58 offen offset:3072  lds
    v_mfma_f32_16x16x32_bf16 v[56:59], v[80:83], v[68:71], v[56:59]
    s_waitcnt lgkmcnt(7)
    v_mfma_f32_16x16x32_bf16 v[60:63], v[108:111], v[108:111], v[60:63]
    s_waitcnt lgkmcnt(5)
    ds_read_b128 v[128:131], v190 offset:1024
    ds_read_b64_tr_b16 v[124:125], v218
    v_mfma_f32_16x16x32_bf16 v[40:43], v[104:107], v[108:111], v[40:43]
    s_waitcnt lgkmcnt(6)
    ds_read_b64_tr_b16 v[126:127], v219
    v_mfma_f32_16x16x32_bf16 v[52:55], v[104:107], v[112:115], v[52:55]
    s_waitcnt lgkmcnt(5)
    ds_read_b128 v[132:135], v191 offset:1024
    s_add_u32 m0, s10, 36864
    s_nop 0
    buffer_load_dwordx4 v144, s[36:39], s58 offen offset:0  lds
    v_mfma_f32_16x16x32_bf16 v[32:35], v[96:99], v[108:111], v[32:35]
    ds_read_b64_tr_b16 v[116:117], v177 offset:5120
    v_mfma_f32_16x16x32_bf16 v[44:47], v[96:99], v[112:115], v[44:47]
    s_waitcnt lgkmcnt(5)
    ds_read_b64_tr_b16 v[118:119], v177 offset:7680
    v_mfma_f32_16x16x32_bf16 v[36:39], v[100:103], v[108:111], v[36:39]
    ds_read_b64_tr_b16 v[120:121], v177 offset:5128
    s_add_u32 m0, s11, 8192
    s_mov_b32 exec_hi, 0
    buffer_load_dwordx4 v145, s[72:75], s59 offen  lds
    s_mov_b32 exec_hi, -1
    v_mfma_f32_16x16x32_bf16 v[48:51], v[100:103], v[112:115], v[48:51]
    ds_read_b64_tr_b16 v[122:123], v177 offset:7688
    s_waitcnt vmcnt(10)
    s_barrier
    s_waitcnt lgkmcnt(7)
    v_mfma_f32_16x16x32_bf16 v[60:63], v[128:131], v[128:131], v[60:63]
    s_waitcnt lgkmcnt(5)
    ds_read_b128 v[88:91], v192 offset:0
    ds_read_b64_tr_b16 v[84:85], v220
    v_mfma_f32_16x16x32_bf16 v[40:43], v[124:127], v[128:131], v[40:43]
    s_waitcnt lgkmcnt(6)
    ds_read_b64_tr_b16 v[86:87], v221
    v_mfma_f32_16x16x32_bf16 v[52:55], v[124:127], v[132:135], v[52:55]
    s_waitcnt lgkmcnt(5)
    ds_read_b128 v[92:95], v193 offset:0
    v_mfma_f32_16x16x32_bf16 v[32:35], v[116:119], v[128:131], v[32:35]
    ds_read_b64_tr_b16 v[76:77], v178 offset:0
    v_mfma_f32_16x16x32_bf16 v[44:47], v[116:119], v[132:135], v[44:47]
    s_waitcnt lgkmcnt(5)
    ds_read_b64_tr_b16 v[78:79], v178 offset:2560
    v_mfma_f32_16x16x32_bf16 v[36:39], v[120:123], v[128:131], v[36:39]
    ds_read_b64_tr_b16 v[80:81], v178 offset:8
    v_mfma_f32_16x16x32_bf16 v[48:51], v[120:123], v[132:135], v[48:51]
    ds_read_b64_tr_b16 v[82:83], v178 offset:2568
    buffer_store_dwordx4 v[236:239], v149, s[16:19], 0 offen sc1
    s_waitcnt lgkmcnt(7)
    v_mfma_f32_16x16x32_bf16 v[60:63], v[88:91], v[88:91], v[60:63]
    s_waitcnt lgkmcnt(5)
    ds_read_b128 v[108:111], v192 offset:1024
    ds_read_b64_tr_b16 v[104:105], v222
    v_mfma_f32_16x16x32_bf16 v[40:43], v[84:87], v[88:91], v[40:43]
    s_waitcnt lgkmcnt(6)
    ds_read_b64_tr_b16 v[106:107], v223
    v_mfma_f32_16x16x32_bf16 v[52:55], v[84:87], v[92:95], v[52:55]
    ds_read_b128 v[112:115], v193 offset:1024
    v_mfma_f32_16x16x32_bf16 v[56:59], v[84:87], v[72:75], v[56:59]
    s_waitcnt lgkmcnt(6)
    ds_read_b64_tr_b16 v[96:97], v178 offset:5120
    v_mfma_f32_16x16x32_bf16 v[32:35], v[76:79], v[88:91], v[32:35]
    ds_read_b64_tr_b16 v[98:99], v178 offset:7680
    v_mfma_f32_16x16x32_bf16 v[44:47], v[76:79], v[92:95], v[44:47]
    ds_read_b64_tr_b16 v[100:101], v178 offset:5128
    v_mfma_f32_16x16x32_bf16 v[56:59], v[76:79], v[64:67], v[56:59]
    s_waitcnt lgkmcnt(7)
    ds_read_b64_tr_b16 v[102:103], v178 offset:7688
    v_mfma_f32_16x16x32_bf16 v[36:39], v[80:83], v[88:91], v[36:39]
    v_mfma_f32_16x16x32_bf16 v[48:51], v[80:83], v[92:95], v[48:51]
    v_mfma_f32_16x16x32_bf16 v[56:59], v[80:83], v[68:71], v[56:59]
    s_waitcnt lgkmcnt(7)
    v_mfma_f32_16x16x32_bf16 v[60:63], v[108:111], v[108:111], v[60:63]
    s_waitcnt lgkmcnt(5)
    ds_read_b128 v[128:131], v194 offset:0
    ds_read_b64_tr_b16 v[124:125], v224
    v_mfma_f32_16x16x32_bf16 v[40:43], v[104:107], v[108:111], v[40:43]
    s_waitcnt lgkmcnt(6)
    ds_read_b64_tr_b16 v[126:127], v225
    v_mfma_f32_16x16x32_bf16 v[52:55], v[104:107], v[112:115], v[52:55]
    ds_read_b128 v[132:135], v195 offset:0
    v_mfma_f32_16x16x32_bf16 v[56:59], v[104:107], v[72:75], v[56:59]
    s_waitcnt lgkmcnt(6)
    ds_read_b64_tr_b16 v[116:117], v179 offset:0
    v_mfma_f32_16x16x32_bf16 v[32:35], v[96:99], v[108:111], v[32:35]
    ds_read_b64_tr_b16 v[118:119], v179 offset:2560
    v_mfma_f32_16x16x32_bf16 v[44:47], v[96:99], v[112:115], v[44:47]
    ds_read_b64_tr_b16 v[120:121], v179 offset:8
    v_mfma_f32_16x16x32_bf16 v[56:59], v[96:99], v[64:67], v[56:59]
    s_waitcnt lgkmcnt(7)
    ds_read_b64_tr_b16 v[122:123], v179 offset:2568
    v_mfma_f32_16x16x32_bf16 v[36:39], v[100:103], v[108:111], v[36:39]
    v_mfma_f32_16x16x32_bf16 v[48:51], v[100:103], v[112:115], v[48:51]
    v_mfma_f32_16x16x32_bf16 v[56:59], v[100:103], v[68:71], v[56:59]
    s_waitcnt lgkmcnt(7)
    v_mfma_f32_16x16x32_bf16 v[60:63], v[128:131], v[128:131], v[60:63]
    s_waitcnt lgkmcnt(5)
    ds_read_b128 v[88:91], v194 offset:1024
    ds_read_b64_tr_b16 v[84:85], v226
    v_mfma_f32_16x16x32_bf16 v[40:43], v[124:127], v[128:131], v[40:43]
    s_waitcnt lgkmcnt(6)
    ds_read_b64_tr_b16 v[86:87], v227
    v_mfma_f32_16x16x32_bf16 v[52:55], v[124:127], v[132:135], v[52:55]
    s_waitcnt lgkmcnt(5)
    ds_read_b128 v[92:95], v195 offset:1024
    v_mfma_f32_16x16x32_bf16 v[32:35], v[116:119], v[128:131], v[32:35]
    ds_read_b64_tr_b16 v[76:77], v179 offset:5120
    v_mfma_f32_16x16x32_bf16 v[44:47], v[116:119], v[132:135], v[44:47]
    s_waitcnt lgkmcnt(5)
    ds_read_b64_tr_b16 v[78:79], v179 offset:7680
    v_mfma_f32_16x16x32_bf16 v[36:39], v[120:123], v[128:131], v[36:39]
    ds_read_b64_tr_b16 v[80:81], v179 offset:5128
    v_mfma_f32_16x16x32_bf16 v[48:51], v[120:123], v[132:135], v[48:51]
    ds_read_b64_tr_b16 v[82:83], v179 offset:7688
    s_waitcnt vmcnt(1)
    s_barrier
    s_waitcnt lgkmcnt(7)
    v_mfma_f32_16x16x32_bf16 v[60:63], v[88:91], v[88:91], v[60:63]
    s_waitcnt lgkmcnt(5)
    ds_read_b128 v[108:111], v180 offset:0
    ds_read_b64_tr_b16 v[104:105], v228
    v_mfma_f32_16x16x32_bf16 v[40:43], v[84:87], v[88:91], v[40:43]
    s_waitcnt lgkmcnt(6)
    ds_read_b64_tr_b16 v[106:107], v229
    v_mfma_f32_16x16x32_bf16 v[52:55], v[84:87], v[92:95], v[52:55]
    s_waitcnt lgkmcnt(5)
    ds_read_b128 v[112:115], v181 offset:0
    v_mfma_f32_16x16x32_bf16 v[32:35], v[76:79], v[88:91], v[32:35]
    ds_read_b64_tr_b16 v[96:97], v172 offset:0
    v_mfma_f32_16x16x32_bf16 v[44:47], v[76:79], v[92:95], v[44:47]
    s_waitcnt lgkmcnt(5)
    ds_read_b64_tr_b16 v[98:99], v172 offset:2560
    v_mfma_f32_16x16x32_bf16 v[36:39], v[80:83], v[88:91], v[36:39]
    ds_read_b64_tr_b16 v[100:101], v172 offset:8
    v_mfma_f32_16x16x32_bf16 v[48:51], v[80:83], v[92:95], v[48:51]
    ds_read_b64_tr_b16 v[102:103], v172 offset:2568
    s_waitcnt lgkmcnt(7)
    v_mfma_f32_16x16x32_bf16 v[60:63], v[108:111], v[108:111], v[60:63]
    s_waitcnt lgkmcnt(5)
    ds_read_b128 v[128:131], v180 offset:1024
    ds_read_b64_tr_b16 v[124:125], v230
    v_mfma_f32_16x16x32_bf16 v[40:43], v[104:107], v[108:111], v[40:43]
    s_waitcnt lgkmcnt(6)
    ds_read_b64_tr_b16 v[126:127], v231
    v_mfma_f32_16x16x32_bf16 v[52:55], v[104:107], v[112:115], v[52:55]
    ds_read_b128 v[132:135], v181 offset:1024
    v_mfma_f32_16x16x32_bf16 v[56:59], v[104:107], v[72:75], v[56:59]
    s_waitcnt lgkmcnt(6)
    ds_read_b64_tr_b16 v[116:117], v172 offset:5120
    v_mfma_f32_16x16x32_bf16 v[32:35], v[96:99], v[108:111], v[32:35]
    ds_read_b64_tr_b16 v[118:119], v172 offset:7680
    v_mfma_f32_16x16x32_bf16 v[44:47], v[96:99], v[112:115], v[44:47]
    ds_read_b64_tr_b16 v[120:121], v172 offset:5128
    v_mfma_f32_16x16x32_bf16 v[56:59], v[96:99], v[64:67], v[56:59]
    s_waitcnt lgkmcnt(7)
    ds_read_b64_tr_b16 v[122:123], v172 offset:7688
    v_mfma_f32_16x16x32_bf16 v[36:39], v[100:103], v[108:111], v[36:39]
    v_mfma_f32_16x16x32_bf16 v[48:51], v[100:103], v[112:115], v[48:51]
    v_mfma_f32_16x16x32_bf16 v[56:59], v[100:103], v[68:71], v[56:59]
    s_add_u32 m0, s43, 90112
    buffer_load_dword v251, v250, s[96:99], 0 offen sc1
    buffer_load_dwordx4 v150, s[32:35], 0 offen offset:0 lds
    buffer_load_dwordx4 v151, s[32:35], 0 offen offset:1024 lds
    buffer_load_dwordx4 v152, s[32:35], 0 offen offset:2048 lds
    s_waitcnt lgkmcnt(7)
    v_mfma_f32_16x16x32_bf16 v[60:63], v[128:131], v[128:131], v[60:63]
    s_waitcnt lgkmcnt(5)
    ds_read_b128 v[88:91], v182 offset:0
    ds_read_b64_tr_b16 v[84:85], v232
    v_mfma_f32_16x16x32_bf16 v[40:43], v[124:127], v[128:131], v[40:43]
    s_waitcnt lgkmcnt(6)
    ds_read_b64_tr_b16 v[86:87], v233
    ds_read_b128 v[92:95], v183 offset:0
    v_mfma_f32_16x16x32_bf16 v[52:55], v[124:127], v[132:135], v[52:55]
    ds_read_b64_tr_b16 v[76:77], v173 offset:0
    ds_read_b64_tr_b16 v[78:79], v173 offset:2560
    v_mfma_f32_16x16x32_bf16 v[56:59], v[124:127], v[72:75], v[56:59]
    s_waitcnt lgkmcnt(8)
    ds_read_b64_tr_b16 v[80:81], v173 offset:8
    ds_read_b64_tr_b16 v[82:83], v173 offset:2568
    v_mfma_f32_16x16x32_bf16 v[32:35], v[116:119], v[128:131], v[32:35]
    ds_read_b128 v[108:111], v182 offset:1024
    ds_read_b64_tr_b16 v[104:105], v234
    v_mfma_f32_16x16x32_bf16 v[44:47], v[116:119], v[132:135], v[44:47]
    ds_read_b64_tr_b16 v[106:107], v235
    ds_read_b128 v[112:115], v183 offset:1024
    v_mfma_f32_16x16x32_bf16 v[56:59], v[116:119], v[64:67], v[56:59]
    s_waitcnt lgkmcnt(12)
    ds_read_b64_tr_b16 v[96:97], v173 offset:5120
    v_mfma_f32_16x16x32_bf16 v[36:39], v[120:123], v[128:131], v[36:39]
    ds_read_b64_tr_b16 v[98:99], v173 offset:7680
    v_mfma_f32_16x16x32_bf16 v[48:51], v[120:123], v[132:135], v[48:51]
    ds_read_b64_tr_b16 v[100:101], v173 offset:5128
    v_mfma_f32_16x16x32_bf16 v[56:59], v[120:123], v[68:71], v[56:59]
    ds_read_b64_tr_b16 v[102:103], v173 offset:7688
    s_waitcnt lgkmcnt(15)
    v_mfma_f32_16x16x32_bf16 v[60:63], v[88:91], v[88:91], v[60:63]
    s_waitcnt lgkmcnt(13)
    v_mfma_f32_16x16x32_bf16 v[40:43], v[84:87], v[88:91], v[40:43]
    s_waitcnt lgkmcnt(12)
    v_mfma_f32_16x16x32_bf16 v[52:55], v[84:87], v[92:95], v[52:55]
    s_waitcnt lgkmcnt(7)
    v_mfma_f32_16x16x32_bf16 v[60:63], v[108:111], v[108:111], v[60:63]
    s_waitcnt lgkmcnt(5)
    v_mfma_f32_16x16x32_bf16 v[40:43], v[104:107], v[108:111], v[40:43]
    s_waitcnt lgkmcnt(4)
    v_mfma_f32_16x16x32_bf16 v[52:55], v[104:107], v[112:115], v[52:55]
    v_mfma_f32_16x16x32_bf16 v[32:35], v[76:79], v[88:91], v[32:35]
    v_mfma_f32_16x16x32_bf16 v[44:47], v[76:79], v[92:95], v[44:47]
    ds_write_b128 v157, v[56:59]
    v_mfma_f32_16x16x32_bf16 v[36:39], v[80:83], v[88:91], v[36:39]
    v_mfma_f32_16x16x32_bf16 v[48:51], v[80:83], v[92:95], v[48:51]
    s_waitcnt lgkmcnt(3)
    v_mfma_f32_16x16x32_bf16 v[32:35], v[96:99], v[108:111], v[32:35]
    ds_write_b128 v157, v[60:63] offset:4096
    v_mfma_f32_16x16x32_bf16 v[44:47], v[96:99], v[112:115], v[44:47]
    s_waitcnt lgkmcnt(2)
    v_mfma_f32_16x16x32_bf16 v[36:39], v[100:103], v[108:111], v[36:39]
    ds_write2st64_b32 v158, v40, v52 offset0:0 offset1:1
    v_mfma_f32_16x16x32_bf16 v[48:51], v[100:103], v[112:115], v[48:51]
    s_waitcnt lgkmcnt(0)
    s_barrier
    ds_read_b32 v76, v162
    ds_read_b32 v78, v160
    ds_read_b32 v77, v163
    ds_read_b32 v79, v161
    ds_read_b128 v[80:83], v159
    s_mov_b32 s50, 0xbacccccd
    s_mov_b32 s52, 0x3acccccd
    s_waitcnt lgkmcnt(2)
    v_pk_mul_f32 v[76:77], v[76:77], s[50:51] op_sel_hi:[1,0]
    s_waitcnt lgkmcnt(1)
    v_pk_mul_f32 v[78:79], v[78:79], s[52:53] op_sel_hi:[1,0]
    v_pk_fma_f32 v[78:79], v[76:77], v[76:77], v[78:79] neg_lo:[1,0,0] neg_hi:[1,0,0]
    s_waitcnt lgkmcnt(0)
    v_pk_add_f32 v[56:57], v[56:57], v[80:81]
    v_pk_add_f32 v[58:59], v[58:59], v[82:83]
    v_max_f32 v78, 0, v78
    v_max_f32 v79, 0, v79
    v_add_f32 v78, 0x3727c5ac, v78
    v_add_f32 v79, 0x3727c5ac, v79
    v_rsq_f32 v78, v78
    v_rsq_f32 v79, v79
    v_fmac_f32_dpp v40, v56, v76 row_newbcast:2 row_mask:0xf bank_mask:0xf
    v_fmac_f32_dpp v41, v57, v76 row_newbcast:2 row_mask:0xf bank_mask:0xf
    v_fmac_f32_dpp v42, v58, v76 row_newbcast:2 row_mask:0xf bank_mask:0xf
    v_fmac_f32_dpp v43, v59, v76 row_newbcast:2 row_mask:0xf bank_mask:0xf
    v_fmac_f32_dpp v52, v56, v77 row_newbcast:2 row_mask:0xf bank_mask:0xf
    v_fmac_f32_dpp v53, v57, v77 row_newbcast:2 row_mask:0xf bank_mask:0xf
    v_fmac_f32_dpp v54, v58, v77 row_newbcast:2 row_mask:0xf bank_mask:0xf
    v_fmac_f32_dpp v55, v59, v77 row_newbcast:2 row_mask:0xf bank_mask:0xf
    v_mul_f32 v80, s12, v78
    v_mul_f32 v82, 0x3ea52b5c, v78
    v_mul_f32 v81, s12, v79
    v_mul_f32 v83, 0x3ea52b5c, v79
    s_mov_b32 vcc_lo, s13
    s_mov_b32 vcc_hi, 0
    v_mov_b32 v240, 0x3f80
    v_mov_b32 v241, 0
    v_pk_mul_f32 v[40:41], v[40:41], v[80:81] op_sel:[0,0] op_sel_hi:[1,0]
    v_pk_mul_f32 v[42:43], v[42:43], v[80:81] op_sel:[0,0] op_sel_hi:[1,0]
    v_cvt_pk_bf16_f32 v104, v40, v41
    v_cvt_pk_bf16_f32 v105, v42, v43
    v_cndmask_b32 v104, v104, v240, vcc
    v_cndmask_b32 v105, v105, v241, vcc
    ds_write_b64 v164, v[104:105] offset:0
    v_pk_mul_f32 v[52:53], v[52:53], v[80:81] op_sel:[0,1] op_sel_hi:[1,1]
    v_pk_mul_f32 v[54:55], v[54:55], v[80:81] op_sel:[0,1] op_sel_hi:[1,1]
    v_cvt_pk_bf16_f32 v106, v52, v53
    v_cvt_pk_bf16_f32 v107, v54, v55
    v_cndmask_b32 v106, v106, v240, vcc
    v_cndmask_b32 v107, v107, v241, vcc
    ds_write_b64 v164, v[106:107] offset:512
    ds_read_b64_tr_b16 v[108:109], v165 offset:0
    ds_read_b64_tr_b16 v[110:111], v165 offset:128
    s_cmp_eq_u32 s3, 16
    s_cbranch_scc1 L_k1_noswap
    v_permlane16_swap_b32 v104, v106
    v_permlane16_swap_b32 v105, v107
L_k1_noswap:
    buffer_store_dwordx4 v[104:107], v168, s[16:19], 0 offen sc1
    v_fmac_f32_dpp v32, v56, v76 row_newbcast:0 row_mask:0xf bank_mask:0xf
    v_fmac_f32_dpp v33, v57, v76 row_newbcast:0 row_mask:0xf bank_mask:0xf
    v_fmac_f32_dpp v34, v58, v76 row_newbcast:0 row_mask:0xf bank_mask:0xf
    v_fmac_f32_dpp v35, v59, v76 row_newbcast:0 row_mask:0xf bank_mask:0xf
    v_fmac_f32_dpp v36, v56, v76 row_newbcast:1 row_mask:0xf bank_mask:0xf
    v_fmac_f32_dpp v37, v57, v76 row_newbcast:1 row_mask:0xf bank_mask:0xf
    v_fmac_f32_dpp v38, v58, v76 row_newbcast:1 row_mask:0xf bank_mask:0xf
    v_fmac_f32_dpp v39, v59, v76 row_newbcast:1 row_mask:0xf bank_mask:0xf
    v_pk_mul_f32 v[32:33], v[32:33], v[82:83] op_sel:[0,0] op_sel_hi:[1,0]
    v_pk_mul_f32 v[34:35], v[34:35], v[82:83] op_sel:[0,0] op_sel_hi:[1,0]
    v_cvt_pk_bf16_f32 v96, v32, v33
    v_cvt_pk_bf16_f32 v97, v34, v35
    v_pk_mul_f32 v[36:37], v[36:37], v[82:83] op_sel:[0,0] op_sel_hi:[1,0]
    v_pk_mul_f32 v[38:39], v[38:39], v[82:83] op_sel:[0,0] op_sel_hi:[1,0]
    v_cvt_pk_bf16_f32 v98, v36, v37
    v_cvt_pk_bf16_f32 v99, v38, v39
    s_waitcnt lgkmcnt(0)
    buffer_store_dwordx4 v[108:111], v170, s[16:19], 0 offen sc1
    buffer_store_dwordx4 v[96:99], v166, s[16:19], 0 offen sc1
    v_fmac_f32_dpp v44, v56, v77 row_newbcast:0 row_mask:0xf bank_mask:0xf
    v_fmac_f32_dpp v45, v57, v77 row_newbcast:0 row_mask:0xf bank_mask:0xf
    v_fmac_f32_dpp v46, v58, v77 row_newbcast:0 row_mask:0xf bank_mask:0xf
    v_fmac_f32_dpp v47, v59, v77 row_newbcast:0 row_mask:0xf bank_mask:0xf
    v_fmac_f32_dpp v48, v56, v77 row_newbcast:1 row_mask:0xf bank_mask:0xf
    v_fmac_f32_dpp v49, v57, v77 row_newbcast:1 row_mask:0xf bank_mask:0xf
    v_fmac_f32_dpp v50, v58, v77 row_newbcast:1 row_mask:0xf bank_mask:0xf
    v_fmac_f32_dpp v51, v59, v77 row_newbcast:1 row_mask:0xf bank_mask:0xf
    v_pk_mul_f32 v[44:45], v[44:45], v[82:83] op_sel:[0,1] op_sel_hi:[1,1]
    v_pk_mul_f32 v[46:47], v[46:47], v[82:83] op_sel:[0,1] op_sel_hi:[1,1]
    v_cvt_pk_bf16_f32 v100, v44, v45
    v_cvt_pk_bf16_f32 v101, v46, v47
    v_pk_mul_f32 v[48:49], v[48:49], v[82:83] op_sel:[0,1] op_sel_hi:[1,1]
    v_pk_mul_f32 v[50:51], v[50:51], v[82:83] op_sel:[0,1] op_sel_hi:[1,1]
    v_cvt_pk_bf16_f32 v102, v48, v49
    v_cvt_pk_bf16_f32 v103, v50, v51
    buffer_store_dwordx4 v[100:103], v167, s[16:19], 0 offen sc1
    s_mov_b32 s32, s78
    s_mov_b32 s33, s79
    s_mov_b32 s34, 3072
    s_mov_b32 s35, 0x20000
    s_mov_b32 s36, s82
    s_mov_b32 s37, s83
    s_mov_b32 s38, 4096
    s_mov_b32 s39, 0x20000
    s_mov_b32 s72, s84
    s_mov_b32 s73, s85
    s_mov_b32 s74, 2621440
    s_mov_b32 s75, 0x20000
    s_mov_b32 s20, s100
    s_mov_b32 s21, s101
    s_mov_b32 s22, 2621440
    s_mov_b32 s23, 0x20000
    s_lshl_b32 s56, s41, 5
    s_add_u32 s56, s56, 8355840
    s_waitcnt vmcnt(7)
    v_cmp_ne_u32 vcc, 1, v251
    s_nop 0
    s_cbranch_vccz L_rdy_end
    s_mov_b32 s54, 0x40000
L_rdy:
    buffer_load_dword v251, v250, s[96:99], 0 offen sc1
    s_waitcnt vmcnt(0)
    v_cmp_ne_u32 vcc, 1, v251
    s_sub_u32 s54, s54, 1
    s_cbranch_scc1 L_rdy_x
    s_cbranch_vccnz L_rdy
L_rdy_x:
L_rdy_end:
    v_mov_b32 v26, 1
    s_waitcnt vmcnt(0)
    s_barrier
    buffer_store_dword v26, v29, s[16:19], s56 offen sc1
    ds_read_b64_tr_b16 v[64:65], v20 offset:0
    ds_read_b64_tr_b16 v[66:67], v20 offset:32
    ds_read_b64_tr_b16 v[68:69], v20 offset:64
    ds_read_b64_tr_b16 v[70:71], v20 offset:96
    ds_read_b64_tr_b16 v[72:73], v20 offset:128
    ds_read_b64_tr_b16 v[74:75], v20 offset:160
    ds_read_b64_tr_b16 v[76:77], v20 offset:192
    ds_read_b64_tr_b16 v[78:79], v20 offset:224
    ds_read_b64_tr_b16 v[80:81], v20 offset:256
    ds_read_b64_tr_b16 v[82:83], v20 offset:288
    s_waitcnt lgkmcnt(9)
    v_perm_b32 v140, v64, v64, v22
    v_and_b32 v141, v21, v64
    v_perm_b32 v142, v65, v65, v22
    v_and_b32 v143, v21, v65
    s_waitcnt lgkmcnt(8)
    v_perm_b32 v144, v66, v66, v22
    v_and_b32 v145, v21, v66
    v_perm_b32 v146, v67, v67, v22
    v_and_b32 v147, v21, v67
    s_waitcnt lgkmcnt(7)
    v_perm_b32 v148, v68, v68, v22
    v_and_b32 v149, v21, v68
    v_perm_b32 v150, v69, v69, v22
    v_and_b32 v151, v21, v69
    s_waitcnt lgkmcnt(6)
    v_perm_b32 v152, v70, v70, v22
    v_and_b32 v153, v21, v70
    v_perm_b32 v154, v71, v71, v22
    v_and_b32 v155, v21, v71
    s_waitcnt lgkmcnt(5)
    v_perm_b32 v156, v72, v72, v22
    v_and_b32 v157, v21, v72
    v_perm_b32 v158, v73, v73, v22
    v_and_b32 v159, v21, v73
    s_waitcnt lgkmcnt(4)
    v_perm_b32 v160, v74, v74, v22
    v_and_b32 v161, v21, v74
    v_perm_b32 v162, v75, v75, v22
    v_and_b32 v163, v21, v75
    s_waitcnt lgkmcnt(3)
    v_perm_b32 v164, v76, v76, v22
    v_and_b32 v165, v21, v76
    v_perm_b32 v166, v77, v77, v22
    v_and_b32 v167, v21, v77
    s_waitcnt lgkmcnt(2)
    v_perm_b32 v168, v78, v78, v22
    v_and_b32 v169, v21, v78
    v_perm_b32 v170, v79, v79, v22
    v_and_b32 v171, v21, v79
    s_waitcnt lgkmcnt(1)
    v_perm_b32 v172, v80, v80, v22
    v_and_b32 v173, v21, v80
    v_perm_b32 v174, v81, v81, v22
    v_and_b32 v175, v21, v81
    s_waitcnt lgkmcnt(0)
    v_perm_b32 v176, v82, v82, v22
    v_and_b32 v177, v21, v82
    v_perm_b32 v178, v83, v83, v22
    v_and_b32 v179, v21, v83
    v_mov_b32 v20, -1
    v_mov_b32 v21, -1
    v_mov_b32 v22, -1
    v_mov_b32 v23, -1
    v_lshlrev_b32 v235, 5, v0
    s_and_b32 s56, s2, 3
    s_lshl_b32 s56, s56, 2
    s_add_u32 s56, s56, s40
    s_lshl_b32 s56, s56, 11
    s_add_u32 s56, s56, 8355840
    s_load_dwordx2 s[58:59], s[86:87], 60
    s_load_dwordx2 s[58:59], s[86:87], 572
    s_load_dwordx2 s[58:59], s[86:87], 1084
    s_load_dwordx2 s[58:59], s[86:87], 1596
    s_load_dwordx2 s[58:59], s[86:87], 2108
    s_load_dwordx2 s[58:59], s[86:87], 2620
    s_load_dwordx2 s[58:59], s[86:87], 3132
    s_mov_b32 s54, 0x40000
L_s1:
    buffer_load_dword v26, v235, s[16:19], s56 offen sc1
    s_waitcnt vmcnt(0)
    v_cmp_ne_u32 vcc, 1, v26
    s_sub_u32 s54, s54, 1
    s_cbranch_scc1 L_s1_x
    s_cbranch_vccnz L_s1
L_s1_x:
L_s1_end:
    s_barrier
    s_mov_b32 s45, 0
    buffer_load_dwordx4 v[128:131], v11, s[16:19], s45 offen sc1
L_hop1:
    s_cbranch_execz L_hop5
    buffer_load_dwordx2 v[132:133], v12, s[16:19], s45 offen offset:1024 sc1
    buffer_load_dwordx4 a[64:67], v1, s[16:19], s47 offen offset:0 sc1
    buffer_load_dwordx4 a[0:3], v1, s[16:19], s46 offen offset:0 sc1
    buffer_load_dwordx4 a[4:7], v1, s[16:19], s46 offen offset:1024 sc1
    buffer_load_dwordx4 a[8:11], v1, s[16:19], s46 offen offset:2048 sc1
    buffer_load_dwordx4 a[12:15], v1, s[16:19], s46 offen offset:3072 sc1
    s_add_u32 s46, s46, 4096
    buffer_load_dwordx4 a[80:83], v13, s[16:19], s48 offen offset:0 sc1
    buffer_load_dwordx4 a[84:87], v13, s[16:19], s48 offen offset:768 sc1
    buffer_load_dwordx4 a[88:91], v13, s[16:19], s48 offen offset:1536 sc1
    buffer_load_dwordx4 a[92:95], v13, s[16:19], s48 offen offset:2304 sc1
    s_add_u32 s48, s48, 3072
    v_mfma_f32_32x32x8_bf16 v[96:111], v[4:5], v[4:5], 0
    s_waitcnt vmcnt(8)
    v_mfma_f32_32x32x4_2b_bf16 v[32:63], a[64:65], v[132:133], 0
    buffer_load_dwordx4 a[68:71], v1, s[16:19], s47 offen offset:1024 sc1
    buffer_load_dwordx4 a[16:19], v1, s[16:19], s46 offen offset:0 sc1
    buffer_load_dwordx4 a[20:23], v1, s[16:19], s46 offen offset:1024 sc1
    buffer_load_dwordx4 a[96:99], v13, s[16:19], s48 offen offset:0 sc1
    buffer_load_dwordx4 a[100:103], v13, s[16:19], s48 offen offset:768 sc1
    buffer_load_dwordx4 a[104:107], v13, s[16:19], s48 offen offset:1536 sc1
    buffer_load_dwordx4 a[108:111], v13, s[16:19], s48 offen offset:2304 sc1
    s_add_u32 s48, s48, 3072
    s_waitcnt vmcnt(14)
    s_nop 8
    v_mfma_f32_32x32x16_bf16 v[32:47], a[0:3], v[128:131], v[32:47]
    s_waitcnt vmcnt(13)
    v_mfma_f32_32x32x16_bf16 v[48:63], a[4:7], v[128:131], v[48:63]
    s_nop 9
    v_exp_f32 v32, v32
    v_exp_f32 v33, v33
    s_add_u32 s50, s49, 0
    buffer_load_dwordx4 a[24:27], v1, s[16:19], s46 offen offset:2048 sc1
    buffer_load_dwordx4 a[28:31], v1, s[16:19], s46 offen offset:3072 sc1
    s_add_u32 s46, s46, 4096
    v_exp_f32 v34, v34
    v_exp_f32 v35, v35
    v_exp_f32 v36, v36
    v_mfma_f32_32x32x4_2b_bf16 v[64:95], a[66:67], v[132:133], 0
    v_exp_f32 v37, v37
    v_exp_f32 v38, v38
    v_exp_f32 v39, v39
    v_exp_f32 v40, v40
    v_exp_f32 v41, v41
    v_exp_f32 v42, v42
    v_exp_f32 v43, v43
    v_exp_f32 v44, v44
    s_waitcnt vmcnt(12)
    v_smfmac_f32_32x32x32_bf16 v[96:111], a[80:83], v[32:39], v2
    buffer_load_dwordx4 a[112:115], v13, s[16:19], s48 offen offset:0 sc1
    buffer_load_dwordx4 a[116:119], v13, s[16:19], s48 offen offset:768 sc1
    v_exp_f32 v45, v45
    v_exp_f32 v46, v46
    v_exp_f32 v47, v47
    v_exp_f32 v48, v48
    v_exp_f32 v49, v49
    s_waitcnt vmcnt(13)
    v_smfmac_f32_32x32x32_bf16 v[96:111], a[84:87], v[40:47], v2
    buffer_load_dwordx4 a[120:123], v13, s[16:19], s48 offen offset:1536 sc1
    buffer_load_dwordx4 a[124:127], v13, s[16:19], s48 offen offset:2304 sc1
    s_add_u32 s48, s48, 3072
    v_exp_f32 v50, v50
    v_exp_f32 v51, v51
    v_exp_f32 v52, v52
    v_mfma_f32_32x32x16_bf16 v[64:79], a[8:11], v[128:131], v[64:79]
    v_exp_f32 v53, v53
    v_exp_f32 v54, v54
    v_exp_f32 v55, v55
    v_mfma_f32_32x32x16_bf16 v[80:95], a[12:15], v[128:131], v[80:95]
    v_exp_f32 v56, v56
    v_exp_f32 v57, v57
    v_exp_f32 v58, v58
    s_waitcnt vmcnt(14)
    v_smfmac_f32_32x32x32_bf16 v[96:111], a[88:91], v[48:55], v2
    v_exp_f32 v59, v59
    v_exp_f32 v60, v60
    v_exp_f32 v61, v61
    v_exp_f32 v62, v62
    v_exp_f32 v63, v63
    v_exp_f32 v64, v64
    v_exp_f32 v65, v65
    s_waitcnt vmcnt(13)
    v_smfmac_f32_32x32x32_bf16 v[96:111], a[92:95], v[56:63], v2
    s_waitcnt vmcnt(12)
    buffer_load_dwordx4 a[72:75], v1, s[16:19], s47 offen offset:2048 sc1
    buffer_load_dwordx4 a[32:35], v1, s[16:19], s46 offen offset:0 sc1
    v_exp_f32 v66, v66
    v_exp_f32 v67, v67
    v_exp_f32 v68, v68
    v_mfma_f32_32x32x4_2b_bf16 v[32:63], a[68:69], v[132:133], 0
    v_exp_f32 v69, v69
    v_exp_f32 v70, v70
    v_exp_f32 v71, v71
    v_exp_f32 v72, v72
    v_exp_f32 v73, v73
    v_exp_f32 v74, v74
    v_exp_f32 v75, v75
    v_exp_f32 v76, v76
    s_waitcnt vmcnt(11)
    v_smfmac_f32_32x32x32_bf16 v[96:111], a[96:99], v[64:71], v2
    buffer_load_dwordx4 a[36:39], v1, s[16:19], s46 offen offset:1024 sc1
    buffer_load_dwordx4 a[128:131], v13, s[16:19], s48 offen offset:0 sc1
    v_exp_f32 v77, v77
    v_exp_f32 v78, v78
    v_exp_f32 v79, v79
    v_exp_f32 v80, v80
    v_exp_f32 v81, v81
    s_waitcnt vmcnt(12)
    v_smfmac_f32_32x32x32_bf16 v[96:111], a[100:103], v[72:79], v2
    buffer_load_dwordx4 a[132:135], v13, s[16:19], s48 offen offset:768 sc1
    buffer_load_dwordx4 a[136:139], v13, s[16:19], s48 offen offset:1536 sc1
    v_exp_f32 v82, v82
    v_exp_f32 v83, v83
    v_exp_f32 v84, v84
    v_mfma_f32_32x32x16_bf16 v[32:47], a[16:19], v[128:131], v[32:47]
    v_exp_f32 v85, v85
    v_exp_f32 v86, v86
    v_exp_f32 v87, v87
    v_mfma_f32_32x32x16_bf16 v[48:63], a[20:23], v[128:131], v[48:63]
    v_exp_f32 v88, v88
    v_exp_f32 v89, v89
    v_exp_f32 v90, v90
    s_waitcnt vmcnt(13)
    v_smfmac_f32_32x32x32_bf16 v[96:111], a[104:107], v[80:87], v2
    buffer_load_dwordx4 a[140:143], v13, s[16:19], s48 offen offset:2304 sc1
    s_add_u32 s48, s48, 3072
    v_exp_f32 v91, v91
    v_exp_f32 v92, v92
    v_exp_f32 v93, v93
    v_mfma_f32_32x32x8_bf16 v[112:127], v[4:5], v[4:5], 0
    v_exp_f32 v94, v94
    v_exp_f32 v95, v95
    v_exp_f32 v32, v32
    v_exp_f32 v33, v33
    s_waitcnt vmcnt(13)
    v_smfmac_f32_32x32x32_bf16 v[96:111], a[108:111], v[88:95], v2
    buffer_load_dwordx4 a[40:43], v1, s[16:19], s46 offen offset:2048 sc1
    buffer_load_dwordx4 a[44:47], v1, s[16:19], s46 offen offset:3072 sc1
    s_add_u32 s46, s46, 4096
    s_load_dwordx2 s[58:59], s[86:87], 3644
    v_exp_f32 v34, v34
    v_exp_f32 v35, v35
    v_exp_f32 v36, v36
    v_mfma_f32_32x32x4_2b_bf16 v[64:95], a[70:71], v[132:133], 0
    v_exp_f32 v37, v37
    v_exp_f32 v38, v38
    v_exp_f32 v39, v39
    v_exp_f32 v40, v40
    v_exp_f32 v41, v41
    v_exp_f32 v42, v42
    v_exp_f32 v43, v43
    v_exp_f32 v44, v44
    s_waitcnt vmcnt(12)
    v_smfmac_f32_32x32x32_bf16 v[96:111], a[112:115], v[32:39], v2
    buffer_load_dwordx4 a[144:147], v13, s[16:19], s48 offen offset:0 sc1
    buffer_load_dwordx4 a[148:151], v13, s[16:19], s48 offen offset:768 sc1
    s_load_dwordx2 s[58:59], s[86:87], 4156
    v_exp_f32 v45, v45
    v_exp_f32 v46, v46
    v_exp_f32 v47, v47
    v_exp_f32 v48, v48
    v_exp_f32 v49, v49
    s_waitcnt vmcnt(13)
    v_smfmac_f32_32x32x32_bf16 v[96:111], a[116:119], v[40:47], v2
    buffer_load_dwordx4 a[152:155], v13, s[16:19], s48 offen offset:1536 sc1
    buffer_load_dwordx4 a[156:159], v13, s[16:19], s48 offen offset:2304 sc1
    s_add_u32 s48, s48, 3072
    s_load_dwordx2 s[58:59], s[86:87], 4668
    v_exp_f32 v50, v50
    v_exp_f32 v51, v51
    v_exp_f32 v52, v52
    v_mfma_f32_32x32x16_bf16 v[64:79], a[24:27], v[128:131], v[64:79]
    v_exp_f32 v53, v53
    v_exp_f32 v54, v54
    v_exp_f32 v55, v55
    v_mfma_f32_32x32x16_bf16 v[80:95], a[28:31], v[128:131], v[80:95]
    s_load_dwordx2 s[58:59], s[86:87], 5180
    v_exp_f32 v56, v56
    v_exp_f32 v57, v57
    v_exp_f32 v58, v58
    s_waitcnt vmcnt(14)
    v_smfmac_f32_32x32x32_bf16 v[96:111], a[120:123], v[48:55], v2
    s_load_dwordx2 s[58:59], s[86:87], 5692
    v_exp_f32 v59, v59
    v_exp_f32 v60, v60
    v_exp_f32 v61, v61
    v_exp_f32 v62, v62
    v_exp_f32 v63, v63
    v_exp_f32 v64, v64
    v_exp_f32 v65, v65
    s_waitcnt vmcnt(13)
    v_smfmac_f32_32x32x32_bf16 v[96:111], a[124:127], v[56:63], v2
    s_waitcnt vmcnt(12)
    buffer_load_dwordx4 a[76:79], v1, s[16:19], s47 offen offset:3072 sc1
    buffer_load_dwordx4 a[48:51], v1, s[16:19], s46 offen offset:0 sc1
    s_load_dwordx2 s[58:59], s[86:87], 6204
    v_exp_f32 v66, v66
    v_exp_f32 v67, v67
    v_exp_f32 v68, v68
    v_mfma_f32_32x32x4_2b_bf16 v[32:63], a[72:73], v[132:133], 0
    v_exp_f32 v69, v69
    v_exp_f32 v70, v70
    v_exp_f32 v71, v71
    v_exp_f32 v72, v72
    v_exp_f32 v73, v73
    v_exp_f32 v74, v74
    v_exp_f32 v75, v75
    v_exp_f32 v76, v76
    s_waitcnt vmcnt(11)
    v_smfmac_f32_32x32x32_bf16 v[96:111], a[128:131], v[64:71], v2
    buffer_load_dwordx4 a[52:55], v1, s[16:19], s46 offen offset:1024 sc1
    buffer_load_dwordx4 a[160:163], v13, s[16:19], s48 offen offset:0 sc1
    s_load_dwordx2 s[58:59], s[86:87], 6716
    v_exp_f32 v77, v77
    v_exp_f32 v78, v78
    v_exp_f32 v79, v79
    v_exp_f32 v80, v80
    v_exp_f32 v81, v81
    s_waitcnt vmcnt(12)
    v_smfmac_f32_32x32x32_bf16 v[96:111], a[132:135], v[72:79], v2
    buffer_load_dwordx4 a[164:167], v13, s[16:19], s48 offen offset:768 sc1
    buffer_load_dwordx4 a[168:171], v13, s[16:19], s48 offen offset:1536 sc1
    v_exp_f32 v82, v82
    v_exp_f32 v83, v83
    v_exp_f32 v84, v84
    v_mfma_f32_32x32x16_bf16 v[32:47], a[32:35], v[128:131], v[32:47]
    v_exp_f32 v85, v85
    v_exp_f32 v86, v86
    v_exp_f32 v87, v87
    v_mfma_f32_32x32x16_bf16 v[48:63], a[36:39], v[128:131], v[48:63]
    v_exp_f32 v88, v88
    v_exp_f32 v89, v89
    v_exp_f32 v90, v90
    s_waitcnt vmcnt(13)
    v_smfmac_f32_32x32x32_bf16 v[96:111], a[136:139], v[80:87], v2
    buffer_load_dwordx4 a[172:175], v13, s[16:19], s48 offen offset:2304 sc1
    s_add_u32 s48, s48, 3072
    v_exp_f32 v91, v91
    v_exp_f32 v92, v92
    v_exp_f32 v93, v93
    v_exp_f32 v94, v94
    v_exp_f32 v95, v95
    v_exp_f32 v32, v32
    v_exp_f32 v33, v33
    s_waitcnt vmcnt(13)
    v_smfmac_f32_32x32x32_bf16 v[96:111], a[140:143], v[88:95], v2
    buffer_load_dwordx4 a[56:59], v1, s[16:19], s46 offen offset:2048 sc1
    buffer_load_dwordx4 a[60:63], v1, s[16:19], s46 offen offset:3072 sc1
    s_add_u32 s46, s46, 4096
    s_mov_b32 s45, 1280
    buffer_load_dwordx4 v[134:137], v11, s[16:19], s45 offen sc1
    buffer_load_dwordx2 v[138:139], v12, s[16:19], s45 offen offset:1024 sc1
    v_exp_f32 v34, v34
    v_exp_f32 v35, v35
    v_exp_f32 v36, v36
    v_mfma_f32_32x32x4_2b_bf16 v[64:95], a[74:75], v[132:133], 0
    v_exp_f32 v37, v37
    v_exp_f32 v38, v38
    v_exp_f32 v39, v39
    v_exp_f32 v40, v40
    v_exp_f32 v41, v41
    v_exp_f32 v42, v42
    v_exp_f32 v43, v43
    v_exp_f32 v44, v44
    s_waitcnt vmcnt(14)
    v_smfmac_f32_32x32x32_bf16 v[96:111], a[144:147], v[32:39], v2
    buffer_load_dwordx4 a[176:179], v13, s[16:19], s48 offen offset:0 sc1
    buffer_load_dwordx4 a[180:183], v13, s[16:19], s48 offen offset:768 sc1
    v_exp_f32 v45, v45
    v_exp_f32 v46, v46
    v_exp_f32 v47, v47
    v_exp_f32 v48, v48
    v_exp_f32 v49, v49
    s_waitcnt vmcnt(15)
    v_smfmac_f32_32x32x32_bf16 v[96:111], a[148:151], v[40:47], v2
    buffer_load_dwordx4 a[184:187], v13, s[16:19], s48 offen offset:1536 sc1
    buffer_load_dwordx4 a[188:191], v13, s[16:19], s48 offen offset:2304 sc1
    s_add_u32 s48, s48, 3072
    v_exp_f32 v50, v50
    v_exp_f32 v51, v51
    v_exp_f32 v52, v52
    v_mfma_f32_32x32x16_bf16 v[64:79], a[40:43], v[128:131], v[64:79]
    v_exp_f32 v53, v53
    v_exp_f32 v54, v54
    v_exp_f32 v55, v55
    v_mfma_f32_32x32x16_bf16 v[80:95], a[44:47], v[128:131], v[80:95]
    v_exp_f32 v56, v56
    v_exp_f32 v57, v57
    v_exp_f32 v58, v58
    s_waitcnt vmcnt(16)
    v_smfmac_f32_32x32x32_bf16 v[96:111], a[152:155], v[48:55], v2
    v_exp_f32 v59, v59
    v_exp_f32 v60, v60
    v_exp_f32 v61, v61
    v_exp_f32 v62, v62
    v_exp_f32 v63, v63
    v_exp_f32 v64, v64
    v_exp_f32 v65, v65
    s_waitcnt vmcnt(15)
    v_smfmac_f32_32x32x32_bf16 v[96:111], a[156:159], v[56:63], v2
    s_waitcnt vmcnt(14)
    buffer_load_dwordx4 a[192:195], v13, s[16:19], s48 offen offset:0 sc1
    buffer_load_dwordx4 a[196:199], v13, s[16:19], s48 offen offset:768 sc1
    v_exp_f32 v66, v66
    v_exp_f32 v67, v67
    v_exp_f32 v68, v68
    v_mfma_f32_32x32x4_2b_bf16 v[32:63], a[76:77], v[132:133], 0
    v_exp_f32 v69, v69
    v_exp_f32 v70, v70
    v_exp_f32 v71, v71
    v_exp_f32 v72, v72
    v_exp_f32 v73, v73
    v_exp_f32 v74, v74
    v_exp_f32 v75, v75
    v_exp_f32 v76, v76
    s_waitcnt vmcnt(13)
    v_smfmac_f32_32x32x32_bf16 v[96:111], a[160:163], v[64:71], v2
    buffer_load_dwordx4 a[200:203], v13, s[16:19], s48 offen offset:1536 sc1
    buffer_load_dwordx4 a[204:207], v13, s[16:19], s48 offen offset:2304 sc1
    s_add_u32 s48, s48, 3072
    v_exp_f32 v77, v77
    v_exp_f32 v78, v78
    v_exp_f32 v79, v79
    v_exp_f32 v80, v80
    v_exp_f32 v81, v81
    s_waitcnt vmcnt(14)
    v_smfmac_f32_32x32x32_bf16 v[96:111], a[164:167], v[72:79], v2
    v_exp_f32 v82, v82
    v_exp_f32 v83, v83
    v_exp_f32 v84, v84
    v_mfma_f32_32x32x16_bf16 v[32:47], a[48:51], v[128:131], v[32:47]
    v_exp_f32 v85, v85
    v_exp_f32 v86, v86
    v_exp_f32 v87, v87
    v_mfma_f32_32x32x16_bf16 v[48:63], a[52:55], v[128:131], v[48:63]
    v_exp_f32 v88, v88
    v_exp_f32 v89, v89
    v_exp_f32 v90, v90
    s_waitcnt vmcnt(13)
    v_smfmac_f32_32x32x32_bf16 v[96:111], a[168:171], v[80:87], v2
    v_exp_f32 v91, v91
    v_exp_f32 v92, v92
    v_exp_f32 v93, v93
    v_exp_f32 v94, v94
    v_exp_f32 v95, v95
    v_exp_f32 v32, v32
    v_exp_f32 v33, v33
    s_waitcnt vmcnt(12)
    v_smfmac_f32_32x32x32_bf16 v[96:111], a[172:175], v[88:95], v2
    buffer_store_dwordx4 v[20:23], v15, s[16:19], s4 offen sc1
    v_exp_f32 v34, v34
    v_exp_f32 v35, v35
    v_exp_f32 v36, v36
    v_mfma_f32_32x32x4_2b_bf16 v[64:95], a[78:79], v[132:133], 0
    v_exp_f32 v37, v37
    v_exp_f32 v38, v38
    v_exp_f32 v39, v39
    v_exp_f32 v40, v40
    v_exp_f32 v41, v41
    v_exp_f32 v42, v42
    v_exp_f32 v43, v43
    v_exp_f32 v44, v44
    s_waitcnt vmcnt(8)
    v_smfmac_f32_32x32x32_bf16 v[96:111], a[176:179], v[32:39], v2
    buffer_load_dwordx4 a[208:211], v1, s[16:19], s50 offen offset:0 sc1
    buffer_load_dwordx4 a[212:215], v1, s[16:19], s50 offen offset:1024 sc1
    v_exp_f32 v45, v45
    v_exp_f32 v46, v46
    v_exp_f32 v47, v47
    v_exp_f32 v48, v48
    v_exp_f32 v49, v49
    s_waitcnt vmcnt(9)
    v_smfmac_f32_32x32x32_bf16 v[96:111], a[180:183], v[40:47], v2
    buffer_store_dwordx4 v[20:23], v15, s[16:19], s8 offen sc1
    v_exp_f32 v50, v50
    v_exp_f32 v51, v51
    v_exp_f32 v52, v52
    v_mfma_f32_32x32x16_bf16 v[64:79], a[56:59], v[128:131], v[64:79]
    v_exp_f32 v53, v53
    v_exp_f32 v54, v54
    v_exp_f32 v55, v55
    v_mfma_f32_32x32x16_bf16 v[80:95], a[60:63], v[128:131], v[80:95]
    v_exp_f32 v56, v56
    v_exp_f32 v57, v57
    v_exp_f32 v58, v58
    s_waitcnt vmcnt(9)
    v_smfmac_f32_32x32x32_bf16 v[96:111], a[184:187], v[48:55], v2
    buffer_load_dwordx4 a[216:219], v1, s[16:19], s50 offen offset:2048 sc1
    buffer_load_dwordx4 a[220:223], v1, s[16:19], s50 offen offset:3072 sc1
    v_exp_f32 v59, v59
    v_exp_f32 v60, v60
    v_exp_f32 v61, v61
    v_exp_f32 v62, v62
    v_exp_f32 v63, v63
    v_exp_f32 v64, v64
    v_exp_f32 v65, v65
    s_waitcnt vmcnt(10)
    v_smfmac_f32_32x32x32_bf16 v[96:111], a[188:191], v[56:63], v2
    s_add_u32 s50, s49, 4096
    buffer_store_dwordx4 v[20:23], v15, s[16:19], s9 offen sc1
    v_exp_f32 v66, v66
    v_exp_f32 v67, v67
    v_exp_f32 v68, v68
    v_mfma_f32_32x32x4_2b_bf16 v[32:63], a[64:65], v[138:139], 0
    v_exp_f32 v69, v69
    v_exp_f32 v70, v70
    v_exp_f32 v71, v71
    v_exp_f32 v72, v72
    v_exp_f32 v73, v73
    v_exp_f32 v74, v74
    v_exp_f32 v75, v75
    v_exp_f32 v76, v76
    s_waitcnt vmcnt(10)
    v_smfmac_f32_32x32x32_bf16 v[96:111], a[192:195], v[64:71], v2
    buffer_load_dwordx4 a[224:227], v1, s[16:19], s50 offen offset:0 sc1
    buffer_load_dwordx4 a[228:231], v1, s[16:19], s50 offen offset:1024 sc1
    v_exp_f32 v77, v77
    v_exp_f32 v78, v78
    v_exp_f32 v79, v79
    v_exp_f32 v80, v80
    v_exp_f32 v81, v81
    s_waitcnt vmcnt(11)
    v_smfmac_f32_32x32x32_bf16 v[96:111], a[196:199], v[72:79], v2
    buffer_store_dwordx4 v[20:23], v24, s[16:19], s5 offen sc1
    v_exp_f32 v82, v82
    v_exp_f32 v83, v83
    v_exp_f32 v84, v84
    v_mfma_f32_32x32x16_bf16 v[32:47], a[0:3], v[134:137], v[32:47]
    v_exp_f32 v85, v85
    v_exp_f32 v86, v86
    v_exp_f32 v87, v87
    v_mfma_f32_32x32x16_bf16 v[48:63], a[4:7], v[134:137], v[48:63]
    v_exp_f32 v88, v88
    v_exp_f32 v89, v89
    v_exp_f32 v90, v90
    s_waitcnt vmcnt(11)
    v_smfmac_f32_32x32x32_bf16 v[96:111], a[200:203], v[80:87], v2
    buffer_load_dwordx4 a[232:235], v1, s[16:19], s50 offen offset:2048 sc1
    buffer_load_dwordx4 a[236:239], v1, s[16:19], s50 offen offset:3072 sc1
    v_exp_f32 v91, v91
    v_exp_f32 v92, v92
    v_exp_f32 v93, v93
    v_exp_f32 v94, v94
    v_exp_f32 v95, v95
    v_exp_f32 v32, v32
    v_exp_f32 v33, v33
    s_waitcnt vmcnt(12)
    v_smfmac_f32_32x32x32_bf16 v[96:111], a[204:207], v[88:95], v2
    s_add_u32 s50, s49, 8192
    buffer_store_dwordx4 v[20:23], v25, s[16:19], s6 offen sc1
    v_exp_f32 v34, v34
    v_exp_f32 v35, v35
    v_exp_f32 v36, v36
    v_mfma_f32_32x32x4_2b_bf16 v[64:95], a[66:67], v[138:139], 0
    v_exp_f32 v37, v37
    v_exp_f32 v38, v38
    v_exp_f32 v39, v39
    v_exp_f32 v40, v40
    v_exp_f32 v41, v41
    v_exp_f32 v42, v42
    v_exp_f32 v43, v43
    v_exp_f32 v44, v44
    v_smfmac_f32_32x32x32_bf16 v[112:127], a[80:83], v[32:39], v2
    ds_write_b128 v6, v[96:99] offset:0
    buffer_load_dwordx4 a[240:243], v1, s[16:19], s50 offen offset:0 sc1
    buffer_load_dwordx4 a[244:247], v1, s[16:19], s50 offen offset:1024 sc1
    v_exp_f32 v45, v45
    v_exp_f32 v46, v46
    v_exp_f32 v47, v47
    v_exp_f32 v48, v48
    v_exp_f32 v49, v49
    v_smfmac_f32_32x32x32_bf16 v[112:127], a[84:87], v[40:47], v2
    ds_write_b128 v6, v[100:103] offset:1024
    s_mov_b32 s45, 2560
    buffer_load_dwordx4 v[128:131], v11, s[16:19], s45 offen sc1
    buffer_load_dwordx2 v[132:133], v12, s[16:19], s45 offen offset:1024 sc1
    buffer_store_dwordx4 v[20:23], v25, s[16:19], s6 offen offset:1024 sc1
    v_exp_f32 v50, v50
    v_exp_f32 v51, v51
    v_exp_f32 v52, v52
    v_mfma_f32_32x32x16_bf16 v[64:79], a[8:11], v[134:137], v[64:79]
    v_exp_f32 v53, v53
    v_exp_f32 v54, v54
    v_exp_f32 v55, v55
    v_mfma_f32_32x32x16_bf16 v[80:95], a[12:15], v[134:137], v[80:95]
    v_exp_f32 v56, v56
    v_exp_f32 v57, v57
    v_exp_f32 v58, v58
    v_smfmac_f32_32x32x32_bf16 v[112:127], a[88:91], v[48:55], v2
    ds_write_b128 v6, v[104:107] offset:2048
    buffer_load_dwordx4 a[248:251], v1, s[16:19], s50 offen offset:2048 sc1
    buffer_load_dwordx4 a[252:255], v1, s[16:19], s50 offen offset:3072 sc1
    v_exp_f32 v59, v59
    v_exp_f32 v60, v60
    v_exp_f32 v61, v61
    v_exp_f32 v62, v62
    v_exp_f32 v63, v63
    v_exp_f32 v64, v64
    v_exp_f32 v65, v65
    v_smfmac_f32_32x32x32_bf16 v[112:127], a[92:95], v[56:63], v2
    s_add_u32 s50, s49, 12288
    v_exp_f32 v66, v66
    v_exp_f32 v67, v67
    v_exp_f32 v68, v68
    v_mfma_f32_32x32x4_2b_bf16 v[32:63], a[68:69], v[138:139], 0
    v_exp_f32 v69, v69
    v_exp_f32 v70, v70
    v_exp_f32 v71, v71
    v_exp_f32 v72, v72
    v_exp_f32 v73, v73
    v_exp_f32 v74, v74
    v_exp_f32 v75, v75
    v_exp_f32 v76, v76
    v_smfmac_f32_32x32x32_bf16 v[112:127], a[96:99], v[64:71], v2
    s_waitcnt lgkmcnt(0)
    s_barrier
    buffer_load_dwordx4 v[208:211], v1, s[16:19], s50 offen offset:0 sc1
    buffer_load_dwordx4 v[212:215], v1, s[16:19], s50 offen offset:1024 sc1
    v_exp_f32 v77, v77
    v_exp_f32 v78, v78
    v_exp_f32 v79, v79
    v_exp_f32 v80, v80
    v_exp_f32 v81, v81
    v_smfmac_f32_32x32x32_bf16 v[112:127], a[100:103], v[72:79], v2
    ds_read_b128 v[188:191], v7 offset:0
    v_exp_f32 v82, v82
    v_exp_f32 v83, v83
    v_exp_f32 v84, v84
    v_mfma_f32_32x32x16_bf16 v[32:47], a[16:19], v[134:137], v[32:47]
    ds_read_b128 v[192:195], v7 offset:3072
    v_exp_f32 v85, v85
    v_exp_f32 v86, v86
    v_exp_f32 v87, v87
    v_mfma_f32_32x32x16_bf16 v[48:63], a[20:23], v[134:137], v[48:63]
    ds_read_b128 v[196:199], v7 offset:6144
    v_exp_f32 v88, v88
    v_exp_f32 v89, v89
    v_exp_f32 v90, v90
    v_smfmac_f32_32x32x32_bf16 v[112:127], a[104:107], v[80:87], v2
    ds_read_b128 v[200:203], v7 offset:9216
    buffer_load_dwordx4 v[216:219], v1, s[16:19], s50 offen offset:2048 sc1
    buffer_load_dwordx4 v[220:223], v1, s[16:19], s50 offen offset:3072 sc1
    v_exp_f32 v91, v91
    v_exp_f32 v92, v92
    v_exp_f32 v93, v93
    v_mfma_f32_32x32x8_bf16 v[96:111], v[4:5], v[4:5], 0
    s_add_u32 s50, s49, 16384
    buffer_load_dwordx4 v[224:227], v1, s[16:19], s50 offen offset:0 sc1
    buffer_load_dwordx4 v[228:231], v1, s[16:19], s50 offen offset:1024 sc1
    v_exp_f32 v94, v94
    v_exp_f32 v95, v95
    v_exp_f32 v32, v32
    v_exp_f32 v33, v33
    v_smfmac_f32_32x32x32_bf16 v[112:127], a[108:111], v[88:95], v2
    v_exp_f32 v34, v34
    v_exp_f32 v35, v35
    v_exp_f32 v36, v36
    v_mfma_f32_32x32x4_2b_bf16 v[64:95], a[70:71], v[138:139], 0
    s_waitcnt lgkmcnt(0)
    v_exp_f32 v37, v37
    v_add_f32 v188, v188, v192
    v_exp_f32 v38, v38
    v_add_f32 v189, v189, v193
    v_exp_f32 v39, v39
    v_add_f32 v190, v190, v194
    v_exp_f32 v40, v40
    v_add_f32 v191, v191, v195
    v_exp_f32 v41, v41
    v_add_f32 v196, v196, v200
    v_exp_f32 v42, v42
    v_add_f32 v197, v197, v201
    v_exp_f32 v43, v43
    v_add_f32 v198, v198, v202
    v_exp_f32 v44, v44
    v_add_f32 v199, v199, v203
    v_smfmac_f32_32x32x32_bf16 v[112:127], a[112:115], v[32:39], v2
    buffer_load_dwordx4 v[232:235], v1, s[16:19], s50 offen offset:2048 sc1
    buffer_load_dwordx4 v[236:239], v1, s[16:19], s50 offen offset:3072 sc1
    v_exp_f32 v45, v45
    v_add_f32 v188, v188, v196
    v_exp_f32 v46, v46
    v_add_f32 v189, v189, v197
    v_exp_f32 v47, v47
    v_add_f32 v190, v190, v198
    v_exp_f32 v48, v48
    v_rcp_f32_dpp v192, v188 quad_perm:[3,3,3,3] row_mask:0xf bank_mask:0xf
    v_exp_f32 v49, v49
    v_add_f32 v191, v191, v199
    v_smfmac_f32_32x32x32_bf16 v[112:127], a[116:119], v[40:47], v2
    s_add_u32 s50, s49, 81920
    v_exp_f32 v50, v50
    v_mul_f32 v188, v188, v192
    v_exp_f32 v51, v51
    v_mul_f32 v189, v189, v192
    v_exp_f32 v52, v52
    v_mul_f32 v190, v190, v192
    v_mfma_f32_32x32x16_bf16 v[64:79], a[24:27], v[134:137], v[64:79]
    v_exp_f32 v53, v53
    v_mul_f32 v191, v191, v192
    v_exp_f32 v54, v54
    v_cvt_pk_bf16_f32 v188, v188, v189
    v_exp_f32 v55, v55
    v_cvt_pk_bf16_f32 v189, v190, v191
    v_mfma_f32_32x32x16_bf16 v[80:95], a[28:31], v[134:137], v[80:95]
    v_exp_f32 v56, v56
    v_subrev_u32 v192, 528482304, v192
    v_exp_f32 v57, v57
    v_max_u32 v10, v10, v192
    v_exp_f32 v58, v58
    v_smfmac_f32_32x32x32_bf16 v[112:127], a[120:123], v[48:55], v2
    ds_write2_b32 v8, v188, v189 offset0:0 offset1:32
    v_add_u32 v8, v9, v8
    buffer_load_dwordx4 v[240:243], v1, s[16:19], s50 offen offset:0 sc1
    buffer_load_dwordx4 v[244:247], v1, s[16:19], s50 offen offset:1024 sc1
    v_exp_f32 v59, v59
    v_exp_f32 v60, v60
    v_exp_f32 v61, v61
    v_exp_f32 v62, v62
    v_exp_f32 v63, v63
    v_exp_f32 v64, v64
    v_exp_f32 v65, v65
    v_smfmac_f32_32x32x32_bf16 v[112:127], a[124:127], v[56:63], v2
    v_exp_f32 v66, v66
    v_exp_f32 v67, v67
    v_exp_f32 v68, v68
    v_mfma_f32_32x32x4_2b_bf16 v[32:63], a[72:73], v[138:139], 0
    v_exp_f32 v69, v69
    v_exp_f32 v70, v70
    v_exp_f32 v71, v71
    v_exp_f32 v72, v72
    v_exp_f32 v73, v73
    v_exp_f32 v74, v74
    v_exp_f32 v75, v75
    v_exp_f32 v76, v76
    v_smfmac_f32_32x32x32_bf16 v[112:127], a[128:131], v[64:71], v2
    v_exp_f32 v77, v77
    v_exp_f32 v78, v78
    v_exp_f32 v79, v79
    v_exp_f32 v80, v80
    v_exp_f32 v81, v81
    v_smfmac_f32_32x32x32_bf16 v[112:127], a[132:135], v[72:79], v2
    v_exp_f32 v82, v82
    v_exp_f32 v83, v83
    v_exp_f32 v84, v84
    v_mfma_f32_32x32x16_bf16 v[32:47], a[32:35], v[134:137], v[32:47]
    v_exp_f32 v85, v85
    v_exp_f32 v86, v86
    v_exp_f32 v87, v87
    v_mfma_f32_32x32x16_bf16 v[48:63], a[36:39], v[134:137], v[48:63]
    v_exp_f32 v88, v88
    v_exp_f32 v89, v89
    v_exp_f32 v90, v90
    v_smfmac_f32_32x32x32_bf16 v[112:127], a[136:139], v[80:87], v2
    v_exp_f32 v91, v91
    v_exp_f32 v92, v92
    v_exp_f32 v93, v93
    v_exp_f32 v94, v94
    v_exp_f32 v95, v95
    v_exp_f32 v32, v32
    v_exp_f32 v33, v33
    v_smfmac_f32_32x32x32_bf16 v[112:127], a[140:143], v[88:95], v2
    v_exp_f32 v34, v34
    v_exp_f32 v35, v35
    v_exp_f32 v36, v36
    v_mfma_f32_32x32x4_2b_bf16 v[64:95], a[74:75], v[138:139], 0
    v_exp_f32 v37, v37
    v_exp_f32 v38, v38
    v_exp_f32 v39, v39
    v_exp_f32 v40, v40
    v_exp_f32 v41, v41
    v_exp_f32 v42, v42
    v_exp_f32 v43, v43
    v_exp_f32 v44, v44
    v_smfmac_f32_32x32x32_bf16 v[112:127], a[144:147], v[32:39], v2
    s_lshl_b32 s57, s61, 7
    s_lshl_b32 s7, s63, 7
    buffer_load_dword v27, v4, s[32:35], s57 offen
    buffer_load_dword v27, v4, s[36:39], s7 offen
    buffer_load_dword v27, v28, s[88:91], s55 offen
    v_exp_f32 v45, v45
    v_exp_f32 v46, v46
    v_exp_f32 v47, v47
    v_exp_f32 v48, v48
    v_exp_f32 v49, v49
    v_smfmac_f32_32x32x32_bf16 v[112:127], a[148:151], v[40:47], v2
    v_exp_f32 v50, v50
    v_exp_f32 v51, v51
    v_exp_f32 v52, v52
    v_mfma_f32_32x32x16_bf16 v[64:79], a[40:43], v[134:137], v[64:79]
    v_exp_f32 v53, v53
    v_exp_f32 v54, v54
    v_exp_f32 v55, v55
    v_mfma_f32_32x32x16_bf16 v[80:95], a[44:47], v[134:137], v[80:95]
    v_exp_f32 v56, v56
    v_exp_f32 v57, v57
    v_exp_f32 v58, v58
    v_smfmac_f32_32x32x32_bf16 v[112:127], a[152:155], v[48:55], v2
    v_exp_f32 v59, v59
    v_exp_f32 v60, v60
    v_exp_f32 v61, v61
    v_exp_f32 v62, v62
    v_exp_f32 v63, v63
    v_exp_f32 v64, v64
    v_exp_f32 v65, v65
    v_smfmac_f32_32x32x32_bf16 v[112:127], a[156:159], v[56:63], v2
    v_exp_f32 v66, v66
    v_exp_f32 v67, v67
    v_exp_f32 v68, v68
    v_mfma_f32_32x32x4_2b_bf16 v[32:63], a[76:77], v[138:139], 0
    v_exp_f32 v69, v69
    v_exp_f32 v70, v70
    v_exp_f32 v71, v71
    v_exp_f32 v72, v72
    v_exp_f32 v73, v73
    v_exp_f32 v74, v74
    v_exp_f32 v75, v75
    v_exp_f32 v76, v76
    v_smfmac_f32_32x32x32_bf16 v[112:127], a[160:163], v[64:71], v2
    v_exp_f32 v77, v77
    v_exp_f32 v78, v78
    v_exp_f32 v79, v79
    v_exp_f32 v80, v80
    v_exp_f32 v81, v81
    v_smfmac_f32_32x32x32_bf16 v[112:127], a[164:167], v[72:79], v2
    v_exp_f32 v82, v82
    v_exp_f32 v83, v83
    v_exp_f32 v84, v84
    v_mfma_f32_32x32x16_bf16 v[32:47], a[48:51], v[134:137], v[32:47]
    v_exp_f32 v85, v85
    v_exp_f32 v86, v86
    v_exp_f32 v87, v87
    v_mfma_f32_32x32x16_bf16 v[48:63], a[52:55], v[134:137], v[48:63]
    v_exp_f32 v88, v88
    v_exp_f32 v89, v89
    v_exp_f32 v90, v90
    v_smfmac_f32_32x32x32_bf16 v[112:127], a[168:171], v[80:87], v2
    v_exp_f32 v91, v91
    v_exp_f32 v92, v92
    v_exp_f32 v93, v93
    v_exp_f32 v94, v94
    v_exp_f32 v95, v95
    v_exp_f32 v32, v32
    v_exp_f32 v33, v33
    v_smfmac_f32_32x32x32_bf16 v[112:127], a[172:175], v[88:95], v2
    v_exp_f32 v34, v34
    v_exp_f32 v35, v35
    v_exp_f32 v36, v36
    v_mfma_f32_32x32x4_2b_bf16 v[64:95], a[78:79], v[138:139], 0
    v_exp_f32 v37, v37
    v_exp_f32 v38, v38
    v_exp_f32 v39, v39
    v_exp_f32 v40, v40
    v_exp_f32 v41, v41
    v_exp_f32 v42, v42
    v_exp_f32 v43, v43
    v_exp_f32 v44, v44
    v_smfmac_f32_32x32x32_bf16 v[112:127], a[176:179], v[32:39], v2
    v_exp_f32 v45, v45
    v_exp_f32 v46, v46
    v_exp_f32 v47, v47
    v_exp_f32 v48, v48
    v_exp_f32 v49, v49
    v_smfmac_f32_32x32x32_bf16 v[112:127], a[180:183], v[40:47], v2
    v_exp_f32 v50, v50
    v_exp_f32 v51, v51
    v_exp_f32 v52, v52
    v_mfma_f32_32x32x16_bf16 v[64:79], a[56:59], v[134:137], v[64:79]
    v_exp_f32 v53, v53
    v_exp_f32 v54, v54
    v_exp_f32 v55, v55
    v_mfma_f32_32x32x16_bf16 v[80:95], a[60:63], v[134:137], v[80:95]
    v_exp_f32 v56, v56
    v_exp_f32 v57, v57
    v_exp_f32 v58, v58
    v_smfmac_f32_32x32x32_bf16 v[112:127], a[184:187], v[48:55], v2
    v_exp_f32 v59, v59
    v_exp_f32 v60, v60
    v_exp_f32 v61, v61
    v_exp_f32 v62, v62
    v_exp_f32 v63, v63
    v_exp_f32 v64, v64
    v_exp_f32 v65, v65
    v_smfmac_f32_32x32x32_bf16 v[112:127], a[188:191], v[56:63], v2
    s_waitcnt vmcnt(16)
    v_exp_f32 v66, v66
    v_exp_f32 v67, v67
    v_exp_f32 v68, v68
    v_mfma_f32_32x32x4_2b_bf16 v[32:63], a[64:65], v[132:133], 0
L_hop2:
    s_cbranch_execz L_hop6
    v_exp_f32 v69, v69
    v_exp_f32 v70, v70
    v_exp_f32 v71, v71
    v_exp_f32 v72, v72
    v_exp_f32 v73, v73
    v_exp_f32 v74, v74
    v_exp_f32 v75, v75
    v_exp_f32 v76, v76
    v_smfmac_f32_32x32x32_bf16 v[112:127], a[192:195], v[64:71], v2
    v_exp_f32 v77, v77
    v_exp_f32 v78, v78
    v_exp_f32 v79, v79
    v_exp_f32 v80, v80
    v_exp_f32 v81, v81
    v_smfmac_f32_32x32x32_bf16 v[112:127], a[196:199], v[72:79], v2
    v_exp_f32 v82, v82
    v_exp_f32 v83, v83
    v_exp_f32 v84, v84
    v_mfma_f32_32x32x16_bf16 v[32:47], a[0:3], v[128:131], v[32:47]
    v_exp_f32 v85, v85
    v_exp_f32 v86, v86
    v_exp_f32 v87, v87
    v_mfma_f32_32x32x16_bf16 v[48:63], a[4:7], v[128:131], v[48:63]
    v_exp_f32 v88, v88
    v_exp_f32 v89, v89
    v_exp_f32 v90, v90
    v_smfmac_f32_32x32x32_bf16 v[112:127], a[200:203], v[80:87], v2
    v_exp_f32 v91, v91
    v_exp_f32 v92, v92
    v_exp_f32 v93, v93
    v_exp_f32 v94, v94
    v_exp_f32 v95, v95
    v_exp_f32 v32, v32
    v_exp_f32 v33, v33
    v_smfmac_f32_32x32x32_bf16 v[112:127], a[204:207], v[88:95], v2
    v_exp_f32 v34, v34
    v_exp_f32 v35, v35
    v_exp_f32 v36, v36
    v_mfma_f32_32x32x4_2b_bf16 v[64:95], a[66:67], v[132:133], 0
    v_exp_f32 v37, v37
    v_exp_f32 v38, v38
    v_exp_f32 v39, v39
    v_exp_f32 v40, v40
    v_exp_f32 v41, v41
    v_exp_f32 v42, v42
    v_exp_f32 v43, v43
    v_exp_f32 v44, v44
    v_smfmac_f32_32x32x32_bf16 v[96:111], a[80:83], v[32:39], v2
    ds_write_b128 v6, v[112:115] offset:12288
    v_exp_f32 v45, v45
    v_exp_f32 v46, v46
    v_exp_f32 v47, v47
    v_exp_f32 v48, v48
    v_exp_f32 v49, v49
    v_smfmac_f32_32x32x32_bf16 v[96:111], a[84:87], v[40:47], v2
    ds_write_b128 v6, v[116:119] offset:13312
    s_mov_b32 s45, 3840
    buffer_load_dwordx4 v[134:137], v11, s[16:19], s45 offen sc1
    buffer_load_dwordx2 v[138:139], v12, s[16:19], s45 offen offset:1024 sc1
    v_exp_f32 v50, v50
    v_exp_f32 v51, v51
    v_exp_f32 v52, v52
    v_mfma_f32_32x32x16_bf16 v[64:79], a[8:11], v[128:131], v[64:79]
    v_exp_f32 v53, v53
    v_exp_f32 v54, v54
    v_exp_f32 v55, v55
    v_mfma_f32_32x32x16_bf16 v[80:95], a[12:15], v[128:131], v[80:95]
    v_exp_f32 v56, v56
    v_exp_f32 v57, v57
    v_exp_f32 v58, v58
    v_smfmac_f32_32x32x32_bf16 v[96:111], a[88:91], v[48:55], v2
    ds_write_b128 v6, v[120:123] offset:14336
    v_exp_f32 v59, v59
    v_exp_f32 v60, v60
    v_exp_f32 v61, v61
    v_exp_f32 v62, v62
    v_exp_f32 v63, v63
    v_exp_f32 v64, v64
    v_exp_f32 v65, v65
    v_smfmac_f32_32x32x32_bf16 v[96:111], a[92:95], v[56:63], v2
    v_exp_f32 v66, v66
    v_exp_f32 v67, v67
    v_exp_f32 v68, v68
    v_mfma_f32_32x32x4_2b_bf16 v[32:63], a[68:69], v[132:133], 0
    v_exp_f32 v69, v69
    v_exp_f32 v70, v70
    v_exp_f32 v71, v71
    v_exp_f32 v72, v72
    v_exp_f32 v73, v73
    v_exp_f32 v74, v74
    v_exp_f32 v75, v75
    v_exp_f32 v76, v76
    v_smfmac_f32_32x32x32_bf16 v[96:111], a[96:99], v[64:71], v2
    s_waitcnt lgkmcnt(0)
    s_barrier
    v_exp_f32 v77, v77
    v_exp_f32 v78, v78
    v_exp_f32 v79, v79
    v_exp_f32 v80, v80
    v_exp_f32 v81, v81
    v_smfmac_f32_32x32x32_bf16 v[96:111], a[100:103], v[72:79], v2
    ds_read_b128 v[188:191], v7 offset:12288
    v_exp_f32 v82, v82
    v_exp_f32 v83, v83
    v_exp_f32 v84, v84
    v_mfma_f32_32x32x16_bf16 v[32:47], a[16:19], v[128:131], v[32:47]
    ds_read_b128 v[192:195], v7 offset:15360
    v_exp_f32 v85, v85
    v_exp_f32 v86, v86
    v_exp_f32 v87, v87
    v_mfma_f32_32x32x16_bf16 v[48:63], a[20:23], v[128:131], v[48:63]
    ds_read_b128 v[196:199], v7 offset:18432
    v_exp_f32 v88, v88
    v_exp_f32 v89, v89
    v_exp_f32 v90, v90
    v_smfmac_f32_32x32x32_bf16 v[96:111], a[104:107], v[80:87], v2
    ds_read_b128 v[200:203], v7 offset:21504
    ds_read_b128 v[180:183], v1 offset:24576
    v_exp_f32 v91, v91
    v_exp_f32 v92, v92
    v_exp_f32 v93, v93
    v_mfma_f32_32x32x8_bf16 v[112:127], v[4:5], v[4:5], 0
    v_exp_f32 v94, v94
    v_exp_f32 v95, v95
    v_exp_f32 v32, v32
    v_exp_f32 v33, v33
    v_smfmac_f32_32x32x32_bf16 v[96:111], a[108:111], v[88:95], v2
    v_exp_f32 v34, v34
    v_exp_f32 v35, v35
    v_exp_f32 v36, v36
    v_mfma_f32_32x32x4_2b_bf16 v[64:95], a[70:71], v[132:133], 0
    s_waitcnt lgkmcnt(0)
    v_exp_f32 v37, v37
    v_add_f32 v188, v188, v192
    v_exp_f32 v38, v38
    v_add_f32 v189, v189, v193
    v_exp_f32 v39, v39
    v_add_f32 v190, v190, v194
    v_exp_f32 v40, v40
    v_add_f32 v191, v191, v195
    v_exp_f32 v41, v41
    v_add_f32 v196, v196, v200
    v_exp_f32 v42, v42
    v_add_f32 v197, v197, v201
    v_exp_f32 v43, v43
    v_add_f32 v198, v198, v202
    v_exp_f32 v44, v44
    v_add_f32 v199, v199, v203
    v_smfmac_f32_32x32x32_bf16 v[96:111], a[112:115], v[32:39], v2
    v_exp_f32 v45, v45
    v_add_f32 v188, v188, v196
    v_exp_f32 v46, v46
    v_add_f32 v189, v189, v197
    v_exp_f32 v47, v47
    v_add_f32 v190, v190, v198
    v_smfmac_f32_16x16x64_bf16 v[140:143], v[180:183], a[208:215], v3
    v_exp_f32 v48, v48
    v_rcp_f32_dpp v192, v188 quad_perm:[3,3,3,3] row_mask:0xf bank_mask:0xf
    v_exp_f32 v49, v49
    v_add_f32 v191, v191, v199
    v_smfmac_f32_32x32x32_bf16 v[96:111], a[116:119], v[40:47], v2
    v_exp_f32 v50, v50
    v_mul_f32 v188, v188, v192
    v_exp_f32 v51, v51
    v_mul_f32 v189, v189, v192
    v_exp_f32 v52, v52
    v_mul_f32 v190, v190, v192
    v_mfma_f32_32x32x16_bf16 v[64:79], a[24:27], v[128:131], v[64:79]
    v_exp_f32 v53, v53
    v_mul_f32 v191, v191, v192
    v_exp_f32 v54, v54
    v_cvt_pk_bf16_f32 v188, v188, v189
    v_exp_f32 v55, v55
    v_cvt_pk_bf16_f32 v189, v190, v191
    v_mfma_f32_32x32x16_bf16 v[80:95], a[28:31], v[128:131], v[80:95]
    v_exp_f32 v56, v56
    v_subrev_u32 v192, 528482304, v192
    v_exp_f32 v57, v57
    v_max_u32 v10, v10, v192
    v_exp_f32 v58, v58
    v_smfmac_f32_32x32x32_bf16 v[96:111], a[120:123], v[48:55], v2
    ds_write2_b32 v8, v188, v189 offset0:0 offset1:32
    v_add_u32 v8, v9, v8
    v_exp_f32 v59, v59
    v_exp_f32 v60, v60
    v_exp_f32 v61, v61
    v_smfmac_f32_16x16x64_bf16 v[144:147], v[180:183], a[216:223], v3
    v_exp_f32 v62, v62
    v_exp_f32 v63, v63
    v_exp_f32 v64, v64
    v_exp_f32 v65, v65
    v_smfmac_f32_32x32x32_bf16 v[96:111], a[124:127], v[56:63], v2
    v_exp_f32 v66, v66
    v_exp_f32 v67, v67
    v_exp_f32 v68, v68
    v_mfma_f32_32x32x4_2b_bf16 v[32:63], a[72:73], v[132:133], 0
    v_exp_f32 v69, v69
    v_exp_f32 v70, v70
    v_exp_f32 v71, v71
    v_exp_f32 v72, v72
    v_exp_f32 v73, v73
    v_exp_f32 v74, v74
    v_exp_f32 v75, v75
    v_exp_f32 v76, v76
    v_smfmac_f32_32x32x32_bf16 v[96:111], a[128:131], v[64:71], v2
    v_exp_f32 v77, v77
    v_exp_f32 v78, v78
    v_exp_f32 v79, v79
    v_smfmac_f32_16x16x64_bf16 v[148:151], v[180:183], a[224:231], v3
    v_exp_f32 v80, v80
    v_exp_f32 v81, v81
    v_smfmac_f32_32x32x32_bf16 v[96:111], a[132:135], v[72:79], v2
    v_exp_f32 v82, v82
    v_exp_f32 v83, v83
    v_exp_f32 v84, v84
    v_mfma_f32_32x32x16_bf16 v[32:47], a[32:35], v[128:131], v[32:47]
    v_exp_f32 v85, v85
    v_exp_f32 v86, v86
    v_exp_f32 v87, v87
    v_mfma_f32_32x32x16_bf16 v[48:63], a[36:39], v[128:131], v[48:63]
    v_exp_f32 v88, v88
    v_exp_f32 v89, v89
    v_exp_f32 v90, v90
    v_smfmac_f32_32x32x32_bf16 v[96:111], a[136:139], v[80:87], v2
    v_exp_f32 v91, v91
    v_exp_f32 v92, v92
    v_exp_f32 v93, v93
    v_smfmac_f32_16x16x64_bf16 v[152:155], v[180:183], a[232:239], v3
    v_exp_f32 v94, v94
    v_exp_f32 v95, v95
    v_exp_f32 v32, v32
    v_exp_f32 v33, v33
    v_smfmac_f32_32x32x32_bf16 v[96:111], a[140:143], v[88:95], v2
    s_load_dwordx2 s[58:59], s[86:87], 7228
    v_exp_f32 v34, v34
    v_exp_f32 v35, v35
    v_exp_f32 v36, v36
    v_mfma_f32_32x32x4_2b_bf16 v[64:95], a[74:75], v[132:133], 0
    v_exp_f32 v37, v37
    v_exp_f32 v38, v38
    v_exp_f32 v39, v39
    v_exp_f32 v40, v40
    v_exp_f32 v41, v41
    v_exp_f32 v42, v42
    v_exp_f32 v43, v43
    v_exp_f32 v44, v44
    v_smfmac_f32_32x32x32_bf16 v[96:111], a[144:147], v[32:39], v2
    s_load_dwordx2 s[58:59], s[86:87], 7740
    v_exp_f32 v45, v45
    v_exp_f32 v46, v46
    v_exp_f32 v47, v47
    v_smfmac_f32_16x16x64_bf16 v[156:159], v[180:183], a[240:247], v3
    v_exp_f32 v48, v48
    v_exp_f32 v49, v49
    v_smfmac_f32_32x32x32_bf16 v[96:111], a[148:151], v[40:47], v2
    s_load_dwordx2 s[58:59], s[86:87], 8252
    v_exp_f32 v50, v50
    v_exp_f32 v51, v51
    v_exp_f32 v52, v52
    v_mfma_f32_32x32x16_bf16 v[64:79], a[40:43], v[128:131], v[64:79]
    v_exp_f32 v53, v53
    v_exp_f32 v54, v54
    v_exp_f32 v55, v55
    v_mfma_f32_32x32x16_bf16 v[80:95], a[44:47], v[128:131], v[80:95]
    s_load_dwordx2 s[58:59], s[86:87], 8764
    v_exp_f32 v56, v56
    v_exp_f32 v57, v57
    v_exp_f32 v58, v58
    v_smfmac_f32_32x32x32_bf16 v[96:111], a[152:155], v[48:55], v2
    s_waitcnt vmcnt(15)
    s_load_dwordx2 s[58:59], s[86:87], 9276
    v_exp_f32 v59, v59
    v_exp_f32 v60, v60
    v_exp_f32 v61, v61
    v_smfmac_f32_16x16x64_bf16 v[160:163], v[180:183], a[248:255], v3
    v_exp_f32 v62, v62
    v_exp_f32 v63, v63
    v_exp_f32 v64, v64
    v_exp_f32 v65, v65
    v_smfmac_f32_32x32x32_bf16 v[96:111], a[156:159], v[56:63], v2
    s_load_dwordx2 s[58:59], s[86:87], 9788
    v_exp_f32 v66, v66
    v_exp_f32 v67, v67
    v_exp_f32 v68, v68
    v_mfma_f32_32x32x4_2b_bf16 v[32:63], a[76:77], v[132:133], 0
    v_exp_f32 v69, v69
    v_exp_f32 v70, v70
    v_exp_f32 v71, v71
    v_exp_f32 v72, v72
    v_exp_f32 v73, v73
    v_exp_f32 v74, v74
    v_exp_f32 v75, v75
    v_exp_f32 v76, v76
    v_smfmac_f32_32x32x32_bf16 v[96:111], a[160:163], v[64:71], v2
    s_waitcnt vmcnt(13)
    s_load_dwordx2 s[58:59], s[86:87], 10300
    v_exp_f32 v77, v77
    v_exp_f32 v78, v78
    v_exp_f32 v79, v79
    v_smfmac_f32_16x16x64_bf16 v[164:167], v[180:183], v[208:215], v3
    v_exp_f32 v80, v80
    v_exp_f32 v81, v81
    v_smfmac_f32_32x32x32_bf16 v[96:111], a[164:167], v[72:79], v2
    v_exp_f32 v82, v82
    v_exp_f32 v83, v83
    v_exp_f32 v84, v84
    v_mfma_f32_32x32x16_bf16 v[32:47], a[48:51], v[128:131], v[32:47]
    v_exp_f32 v85, v85
    v_exp_f32 v86, v86
    v_exp_f32 v87, v87
    v_mfma_f32_32x32x16_bf16 v[48:63], a[52:55], v[128:131], v[48:63]
    v_exp_f32 v88, v88
    v_exp_f32 v89, v89
    v_exp_f32 v90, v90
    v_smfmac_f32_32x32x32_bf16 v[96:111], a[168:171], v[80:87], v2
    s_waitcnt vmcnt(11)
    v_exp_f32 v91, v91
    v_exp_f32 v92, v92
    v_exp_f32 v93, v93
    v_smfmac_f32_16x16x64_bf16 v[168:171], v[180:183], v[216:223], v3
    v_exp_f32 v94, v94
    v_exp_f32 v95, v95
    v_exp_f32 v32, v32
    v_exp_f32 v33, v33
    v_smfmac_f32_32x32x32_bf16 v[96:111], a[172:175], v[88:95], v2
    v_exp_f32 v34, v34
    v_exp_f32 v35, v35
    v_exp_f32 v36, v36
    v_mfma_f32_32x32x4_2b_bf16 v[64:95], a[78:79], v[132:133], 0
    v_exp_f32 v37, v37
    v_exp_f32 v38, v38
    v_exp_f32 v39, v39
    v_exp_f32 v40, v40
    v_exp_f32 v41, v41
    v_exp_f32 v42, v42
    v_exp_f32 v43, v43
    v_exp_f32 v44, v44
    v_smfmac_f32_32x32x32_bf16 v[96:111], a[176:179], v[32:39], v2
    s_waitcnt vmcnt(9)
    v_exp_f32 v45, v45
    v_exp_f32 v46, v46
    v_exp_f32 v47, v47
    v_smfmac_f32_16x16x64_bf16 v[172:175], v[180:183], v[224:231], v3
    buffer_load_dwordx4 v[248:251], v1, s[16:19], s50 offen offset:2048 sc1
    buffer_load_dwordx4 v[252:255], v1, s[16:19], s50 offen offset:3072 sc1
    v_exp_f32 v48, v48
    v_exp_f32 v49, v49
    v_smfmac_f32_32x32x32_bf16 v[96:111], a[180:183], v[40:47], v2
    s_add_u32 s50, s49, 86016
    v_exp_f32 v50, v50
    v_exp_f32 v51, v51
    v_exp_f32 v52, v52
    v_mfma_f32_32x32x16_bf16 v[64:79], a[56:59], v[128:131], v[64:79]
    v_exp_f32 v53, v53
    v_exp_f32 v54, v54
    v_exp_f32 v55, v55
    v_mfma_f32_32x32x16_bf16 v[80:95], a[60:63], v[128:131], v[80:95]
    v_exp_f32 v56, v56
    v_exp_f32 v57, v57
    v_exp_f32 v58, v58
    v_smfmac_f32_32x32x32_bf16 v[96:111], a[184:187], v[48:55], v2
    s_waitcnt vmcnt(9)
    v_exp_f32 v59, v59
    v_exp_f32 v60, v60
    v_exp_f32 v61, v61
    v_smfmac_f32_16x16x64_bf16 v[176:179], v[180:183], v[232:239], v3
    buffer_load_dwordx4 a[208:211], v1, s[16:19], s50 offen offset:0 sc1
    buffer_load_dwordx4 a[212:215], v1, s[16:19], s50 offen offset:1024 sc1
    v_exp_f32 v62, v62
    v_exp_f32 v63, v63
    v_exp_f32 v64, v64
    v_exp_f32 v65, v65
    v_smfmac_f32_32x32x32_bf16 v[96:111], a[188:191], v[56:63], v2
    s_waitcnt vmcnt(4)
    v_exp_f32 v66, v66
    v_exp_f32 v67, v67
    v_exp_f32 v68, v68
    v_mfma_f32_32x32x4_2b_bf16 v[32:63], a[64:65], v[138:139], 0
    v_exp_f32 v69, v69
    v_exp_f32 v70, v70
    v_exp_f32 v71, v71
    v_exp_f32 v72, v72
    v_exp_f32 v73, v73
    v_exp_f32 v74, v74
    v_exp_f32 v75, v75
    v_exp_f32 v76, v76
    v_smfmac_f32_32x32x32_bf16 v[96:111], a[192:195], v[64:71], v2
    buffer_load_dwordx4 a[216:219], v1, s[16:19], s50 offen offset:2048 sc1
    buffer_load_dwordx4 a[220:223], v1, s[16:19], s50 offen offset:3072 sc1
    v_exp_f32 v77, v77
    v_exp_f32 v78, v78
    v_exp_f32 v79, v79
    v_exp_f32 v80, v80
    v_exp_f32 v81, v81
    v_smfmac_f32_32x32x32_bf16 v[96:111], a[196:199], v[72:79], v2
    s_add_u32 s50, s49, 90112
    v_exp_f32 v82, v82
    v_exp_f32 v83, v83
    v_exp_f32 v84, v84
    v_mfma_f32_32x32x16_bf16 v[32:47], a[0:3], v[134:137], v[32:47]
    v_exp_f32 v85, v85
    v_exp_f32 v86, v86
    v_exp_f32 v87, v87
    v_mfma_f32_32x32x16_bf16 v[48:63], a[4:7], v[134:137], v[48:63]
    v_exp_f32 v88, v88
    v_exp_f32 v89, v89
    v_exp_f32 v90, v90
    v_smfmac_f32_32x32x32_bf16 v[96:111], a[200:203], v[80:87], v2
    buffer_load_dwordx4 a[224:227], v1, s[16:19], s50 offen offset:0 sc1
    buffer_load_dwordx4 a[228:231], v1, s[16:19], s50 offen offset:1024 sc1
    v_exp_f32 v91, v91
    v_exp_f32 v92, v92
    v_exp_f32 v93, v93
    v_exp_f32 v94, v94
    v_exp_f32 v95, v95
    v_exp_f32 v32, v32
    v_exp_f32 v33, v33
    v_smfmac_f32_32x32x32_bf16 v[96:111], a[204:207], v[88:95], v2
    v_exp_f32 v34, v34
    v_exp_f32 v35, v35
    v_exp_f32 v36, v36
    v_mfma_f32_32x32x4_2b_bf16 v[64:95], a[66:67], v[138:139], 0
    v_exp_f32 v37, v37
    v_exp_f32 v38, v38
    v_exp_f32 v39, v39
    v_exp_f32 v40, v40
    v_exp_f32 v41, v41
    v_exp_f32 v42, v42
    v_exp_f32 v43, v43
    v_exp_f32 v44, v44
    v_smfmac_f32_32x32x32_bf16 v[112:127], a[80:83], v[32:39], v2
    ds_write_b128 v6, v[96:99] offset:0
    buffer_load_dwordx4 a[232:235], v1, s[16:19], s50 offen offset:2048 sc1
    buffer_load_dwordx4 a[236:239], v1, s[16:19], s50 offen offset:3072 sc1
    v_exp_f32 v45, v45
    v_exp_f32 v46, v46
    v_exp_f32 v47, v47
    v_exp_f32 v48, v48
    v_exp_f32 v49, v49
    v_smfmac_f32_32x32x32_bf16 v[112:127], a[84:87], v[40:47], v2
    s_add_u32 s50, s49, 94208
    ds_write_b128 v6, v[100:103] offset:1024
    s_mov_b32 s45, 5120
    buffer_load_dwordx4 v[128:131], v11, s[16:19], s45 offen sc1
    buffer_load_dwordx2 v[132:133], v12, s[16:19], s45 offen offset:1024 sc1
    v_exp_f32 v50, v50
    v_exp_f32 v51, v51
    v_exp_f32 v52, v52
    v_mfma_f32_32x32x16_bf16 v[64:79], a[8:11], v[134:137], v[64:79]
    s_add_u32 m0, s64, 0
    s_mov_b32 s65, 0
    v_exp_f32 v53, v53
    v_exp_f32 v54, v54
    v_exp_f32 v55, v55
    v_mfma_f32_32x32x16_bf16 v[80:95], a[12:15], v[134:137], v[80:95]
    v_exp_f32 v56, v56
    v_exp_f32 v57, v57
    v_exp_f32 v58, v58
    v_smfmac_f32_32x32x32_bf16 v[112:127], a[88:91], v[48:55], v2
    ds_write_b128 v6, v[104:107] offset:2048
    buffer_load_dwordx4 a[240:243], v1, s[16:19], s50 offen offset:0 sc1
    buffer_load_dwordx4 a[244:247], v1, s[16:19], s50 offen offset:1024 sc1
    v_exp_f32 v59, v59
    v_exp_f32 v60, v60
    v_exp_f32 v61, v61
    buffer_load_dwordx4 v17, s[24:27], s65 offen offset:0 lds
    v_exp_f32 v62, v62
    v_exp_f32 v63, v63
    v_exp_f32 v64, v64
    v_exp_f32 v65, v65
    v_smfmac_f32_32x32x32_bf16 v[112:127], a[92:95], v[56:63], v2
    v_exp_f32 v66, v66
    v_exp_f32 v67, v67
    v_exp_f32 v68, v68
    v_mfma_f32_32x32x4_2b_bf16 v[32:63], a[68:69], v[138:139], 0
    v_exp_f32 v69, v69
    v_exp_f32 v70, v70
    v_exp_f32 v71, v71
    v_exp_f32 v72, v72
    v_exp_f32 v73, v73
    v_exp_f32 v74, v74
    v_exp_f32 v75, v75
    v_exp_f32 v76, v76
    v_smfmac_f32_32x32x32_bf16 v[112:127], a[96:99], v[64:71], v2
    s_waitcnt lgkmcnt(0)
    s_barrier
    buffer_load_dwordx4 a[248:251], v1, s[16:19], s50 offen offset:2048 sc1
    buffer_load_dwordx4 a[252:255], v1, s[16:19], s50 offen offset:3072 sc1
    v_exp_f32 v77, v77
    v_exp_f32 v78, v78
    v_exp_f32 v79, v79
    v_exp_f32 v80, v80
    v_exp_f32 v81, v81
    v_smfmac_f32_32x32x32_bf16 v[112:127], a[100:103], v[72:79], v2
    s_add_u32 s50, s49, 98304
    ds_read_b128 v[188:191], v7 offset:0
    v_exp_f32 v82, v82
    v_exp_f32 v83, v83
    v_exp_f32 v84, v84
    v_mfma_f32_32x32x16_bf16 v[32:47], a[16:19], v[134:137], v[32:47]
    ds_read_b128 v[192:195], v7 offset:3072
    s_mov_b32 s65, 23552
    v_exp_f32 v85, v85
    v_exp_f32 v86, v86
    v_exp_f32 v87, v87
    v_mfma_f32_32x32x16_bf16 v[48:63], a[20:23], v[134:137], v[48:63]
    ds_read_b128 v[196:199], v7 offset:6144
    v_exp_f32 v88, v88
    v_exp_f32 v89, v89
    v_exp_f32 v90, v90
    v_smfmac_f32_32x32x32_bf16 v[112:127], a[104:107], v[80:87], v2
    ds_read_b128 v[200:203], v7 offset:9216
    ds_read_b128 v[184:187], v1 offset:25600
    buffer_load_dwordx4 v[208:211], v1, s[16:19], s50 offen offset:0 sc1
    buffer_load_dwordx4 v[212:215], v1, s[16:19], s50 offen offset:1024 sc1
    v_exp_f32 v91, v91
    v_exp_f32 v92, v92
    v_exp_f32 v93, v93
    v_mfma_f32_32x32x8_bf16 v[96:111], v[4:5], v[4:5], 0
    buffer_load_dwordx4 v[216:219], v1, s[16:19], s50 offen offset:2048 sc1
    buffer_load_dwordx4 v[220:223], v1, s[16:19], s50 offen offset:3072 sc1
    buffer_load_dwordx4 v17, s[24:27], s65 offen offset:1024 lds
    v_exp_f32 v94, v94
    v_exp_f32 v95, v95
    v_exp_f32 v32, v32
    v_exp_f32 v33, v33
    v_smfmac_f32_32x32x32_bf16 v[112:127], a[108:111], v[88:95], v2
    s_add_u32 s50, s49, 163840
    v_exp_f32 v34, v34
    v_exp_f32 v35, v35
    v_exp_f32 v36, v36
    v_mfma_f32_32x32x4_2b_bf16 v[64:95], a[70:71], v[138:139], 0
    s_waitcnt lgkmcnt(0)
    v_exp_f32 v37, v37
    v_add_f32 v188, v188, v192
    v_exp_f32 v38, v38
    v_add_f32 v189, v189, v193
    v_exp_f32 v39, v39
    v_add_f32 v190, v190, v194
    v_exp_f32 v40, v40
    v_add_f32 v191, v191, v195
    v_exp_f32 v41, v41
    v_add_f32 v196, v196, v200
    v_exp_f32 v42, v42
    v_add_f32 v197, v197, v201
    v_exp_f32 v43, v43
    v_add_f32 v198, v198, v202
    v_exp_f32 v44, v44
    v_add_f32 v199, v199, v203
    v_smfmac_f32_32x32x32_bf16 v[112:127], a[112:115], v[32:39], v2
    v_exp_f32 v45, v45
    v_add_f32 v188, v188, v196
    v_exp_f32 v46, v46
    v_add_f32 v189, v189, v197
    v_exp_f32 v47, v47
    v_add_f32 v190, v190, v198
    v_smfmac_f32_16x16x64_bf16 v[140:143], v[184:187], v[240:247], v3
    buffer_load_dwordx4 v[224:227], v1, s[16:19], s50 offen offset:0 sc1
    buffer_load_dwordx4 v[228:231], v1, s[16:19], s50 offen offset:1024 sc1
    v_exp_f32 v48, v48
    v_rcp_f32_dpp v192, v188 quad_perm:[3,3,3,3] row_mask:0xf bank_mask:0xf
    v_exp_f32 v49, v49
    v_add_f32 v191, v191, v199
    v_smfmac_f32_32x32x32_bf16 v[112:127], a[116:119], v[40:47], v2
    v_exp_f32 v50, v50
    v_mul_f32 v188, v188, v192
    v_exp_f32 v51, v51
    v_mul_f32 v189, v189, v192
    v_exp_f32 v52, v52
    v_mul_f32 v190, v190, v192
    v_mfma_f32_32x32x16_bf16 v[64:79], a[24:27], v[134:137], v[64:79]
    s_mov_b32 s65, 47104
    v_exp_f32 v53, v53
    v_mul_f32 v191, v191, v192
    v_exp_f32 v54, v54
    v_cvt_pk_bf16_f32 v188, v188, v189
    v_exp_f32 v55, v55
    v_cvt_pk_bf16_f32 v189, v190, v191
    v_mfma_f32_32x32x16_bf16 v[80:95], a[28:31], v[134:137], v[80:95]
    v_exp_f32 v56, v56
    v_subrev_u32 v192, 528482304, v192
    v_exp_f32 v57, v57
    v_max_u32 v10, v10, v192
    v_exp_f32 v58, v58
    v_smfmac_f32_32x32x32_bf16 v[112:127], a[120:123], v[48:55], v2
    s_waitcnt vmcnt(22)
    ds_write2_b32 v8, v188, v189 offset0:0 offset1:32
    v_add_u32 v8, v9, v8
    v_exp_f32 v59, v59
    v_exp_f32 v60, v60
    v_exp_f32 v61, v61
    v_smfmac_f32_16x16x64_bf16 v[144:147], v[184:187], v[248:255], v3
    buffer_load_dwordx4 v[232:235], v1, s[16:19], s50 offen offset:2048 sc1
    buffer_load_dwordx4 v[236:239], v1, s[16:19], s50 offen offset:3072 sc1
    buffer_load_dwordx4 v17, s[24:27], s65 offen offset:2048 lds
    v_exp_f32 v62, v62
    v_exp_f32 v63, v63
    v_exp_f32 v64, v64
    v_exp_f32 v65, v65
    v_smfmac_f32_32x32x32_bf16 v[112:127], a[124:127], v[56:63], v2
    s_add_u32 s50, s49, 167936
    v_exp_f32 v66, v66
    v_exp_f32 v67, v67
    v_exp_f32 v68, v68
    v_mfma_f32_32x32x4_2b_bf16 v[32:63], a[72:73], v[138:139], 0
    v_exp_f32 v69, v69
    v_exp_f32 v70, v70
    v_exp_f32 v71, v71
    v_exp_f32 v72, v72
    v_exp_f32 v73, v73
    v_exp_f32 v74, v74
    v_exp_f32 v75, v75
    v_exp_f32 v76, v76
    v_smfmac_f32_32x32x32_bf16 v[112:127], a[128:131], v[64:71], v2
    s_waitcnt vmcnt(23)
    s_waitcnt lgkmcnt(0)
    s_barrier
    v_exp_f32 v77, v77
    v_exp_f32 v78, v78
    v_exp_f32 v79, v79
    v_smfmac_f32_16x16x64_bf16 v[148:151], v[184:187], a[208:215], v3
    buffer_load_dwordx4 v[240:243], v1, s[16:19], s50 offen offset:0 sc1
    buffer_load_dwordx4 v[244:247], v1, s[16:19], s50 offen offset:1024 sc1
    v_exp_f32 v80, v80
    v_exp_f32 v81, v81
    v_smfmac_f32_32x32x32_bf16 v[112:127], a[132:135], v[72:79], v2
    ds_read_b128 v[204:207], v1 offset:26624
    v_exp_f32 v82, v82
    v_exp_f32 v83, v83
    v_exp_f32 v84, v84
    v_mfma_f32_32x32x16_bf16 v[32:47], a[32:35], v[134:137], v[32:47]
    s_mov_b32 s65, 70656
    v_exp_f32 v85, v85
    v_exp_f32 v86, v86
    v_exp_f32 v87, v87
    v_mfma_f32_32x32x16_bf16 v[48:63], a[36:39], v[134:137], v[48:63]
    v_exp_f32 v88, v88
    v_exp_f32 v89, v89
    v_exp_f32 v90, v90
    v_smfmac_f32_32x32x32_bf16 v[112:127], a[136:139], v[80:87], v2
    s_waitcnt lgkmcnt(0)
    s_waitcnt vmcnt(23)
    v_exp_f32 v91, v91
    v_exp_f32 v92, v92
    v_exp_f32 v93, v93
    v_smfmac_f32_16x16x64_bf16 v[152:155], v[184:187], a[216:223], v3
    buffer_load_dwordx4 v[248:251], v1, s[16:19], s50 offen offset:2048 sc1
    buffer_load_dwordx4 v[252:255], v1, s[16:19], s50 offen offset:3072 sc1
    buffer_load_dwordx4 v17, s[24:27], s65 offen offset:3072 lds
    v_exp_f32 v94, v94
    v_exp_f32 v95, v95
    v_exp_f32 v32, v32
    v_exp_f32 v33, v33
    v_smfmac_f32_32x32x32_bf16 v[112:127], a[140:143], v[88:95], v2
    s_add_u32 s50, s49, 172032
    s_load_dwordx2 s[58:59], s[86:87], 10812
    v_exp_f32 v34, v34
    v_exp_f32 v35, v35
    v_exp_f32 v36, v36
    v_mfma_f32_32x32x4_2b_bf16 v[64:95], a[74:75], v[138:139], 0
    v_exp_f32 v37, v37
    v_exp_f32 v38, v38
    v_exp_f32 v39, v39
    v_exp_f32 v40, v40
    v_exp_f32 v41, v41
    v_exp_f32 v42, v42
    v_exp_f32 v43, v43
    v_exp_f32 v44, v44
    v_smfmac_f32_32x32x32_bf16 v[112:127], a[144:147], v[32:39], v2
    s_waitcnt vmcnt(24)
    s_load_dwordx2 s[58:59], s[86:87], 11324
    v_exp_f32 v45, v45
    v_exp_f32 v46, v46
    v_exp_f32 v47, v47
    v_smfmac_f32_16x16x64_bf16 v[156:159], v[184:187], a[224:231], v3
    buffer_load_dwordx4 a[208:211], v1, s[16:19], s50 offen offset:0 sc1
    buffer_load_dwordx4 a[212:215], v1, s[16:19], s50 offen offset:1024 sc1
    v_exp_f32 v48, v48
    v_exp_f32 v49, v49
    v_smfmac_f32_32x32x32_bf16 v[112:127], a[148:151], v[40:47], v2
    s_load_dwordx2 s[58:59], s[86:87], 11836
    v_exp_f32 v50, v50
    v_exp_f32 v51, v51
    v_exp_f32 v52, v52
    v_mfma_f32_32x32x16_bf16 v[64:79], a[40:43], v[134:137], v[64:79]
    s_add_u32 m0, s64, 4096
    s_mov_b32 s65, 98304
    v_exp_f32 v53, v53
    v_exp_f32 v54, v54
    v_exp_f32 v55, v55
    v_mfma_f32_32x32x16_bf16 v[80:95], a[44:47], v[134:137], v[80:95]
    s_load_dwordx2 s[58:59], s[86:87], 12348
    v_exp_f32 v56, v56
    v_exp_f32 v57, v57
    v_exp_f32 v58, v58
    v_smfmac_f32_32x32x32_bf16 v[112:127], a[152:155], v[48:55], v2
    s_waitcnt vmcnt(24)
    s_load_dwordx2 s[58:59], s[86:87], 12860
    v_exp_f32 v59, v59
    v_exp_f32 v60, v60
    v_exp_f32 v61, v61
    v_smfmac_f32_16x16x64_bf16 v[160:163], v[184:187], a[232:239], v3
    buffer_load_dwordx4 a[216:219], v1, s[16:19], s50 offen offset:2048 sc1
    buffer_load_dwordx4 a[220:223], v1, s[16:19], s50 offen offset:3072 sc1
    buffer_load_dwordx4 v17, s[24:27], s65 offen offset:0 lds
    v_exp_f32 v62, v62
    v_exp_f32 v63, v63
    v_exp_f32 v64, v64
    v_exp_f32 v65, v65
    v_smfmac_f32_32x32x32_bf16 v[112:127], a[156:159], v[56:63], v2
    s_add_u32 s50, s49, 176128
    s_load_dwordx2 s[58:59], s[86:87], 13372
    v_exp_f32 v66, v66
    v_exp_f32 v67, v67
    v_exp_f32 v68, v68
    v_mfma_f32_32x32x4_2b_bf16 v[32:63], a[76:77], v[138:139], 0
    v_exp_f32 v69, v69
    v_exp_f32 v70, v70
    v_exp_f32 v71, v71
    v_exp_f32 v72, v72
    v_exp_f32 v73, v73
    v_exp_f32 v74, v74
    v_exp_f32 v75, v75
    v_exp_f32 v76, v76
    v_smfmac_f32_32x32x32_bf16 v[112:127], a[160:163], v[64:71], v2
    s_waitcnt vmcnt(23)
    s_load_dwordx2 s[58:59], s[86:87], 13884
    v_exp_f32 v77, v77
    v_exp_f32 v78, v78
    v_exp_f32 v79, v79
    v_smfmac_f32_16x16x64_bf16 v[164:167], v[184:187], a[240:247], v3
    buffer_load_dwordx4 a[224:227], v1, s[16:19], s50 offen offset:0 sc1
    buffer_load_dwordx4 a[228:231], v1, s[16:19], s50 offen offset:1024 sc1
    v_exp_f32 v80, v80
    v_exp_f32 v81, v81
    v_smfmac_f32_32x32x32_bf16 v[112:127], a[164:167], v[72:79], v2
    v_exp_f32 v82, v82
    v_exp_f32 v83, v83
    v_exp_f32 v84, v84
    v_mfma_f32_32x32x16_bf16 v[32:47], a[48:51], v[134:137], v[32:47]
    s_mov_b32 s65, 121856
    v_exp_f32 v85, v85
    v_exp_f32 v86, v86
    v_exp_f32 v87, v87
    v_mfma_f32_32x32x16_bf16 v[48:63], a[52:55], v[134:137], v[48:63]
    v_exp_f32 v88, v88
    v_exp_f32 v89, v89
    v_exp_f32 v90, v90
    v_smfmac_f32_32x32x32_bf16 v[112:127], a[168:171], v[80:87], v2
    s_waitcnt vmcnt(22)
    v_exp_f32 v91, v91
    v_exp_f32 v92, v92
    v_exp_f32 v93, v93
    v_smfmac_f32_16x16x64_bf16 v[168:171], v[184:187], a[248:255], v3
    buffer_load_dwordx4 a[232:235], v1, s[16:19], s50 offen offset:2048 sc1
    buffer_load_dwordx4 a[236:239], v1, s[16:19], s50 offen offset:3072 sc1
    buffer_load_dwordx4 v17, s[24:27], s65 offen offset:1024 lds
    v_exp_f32 v94, v94
    v_exp_f32 v95, v95
    v_exp_f32 v32, v32
    v_exp_f32 v33, v33
    v_smfmac_f32_32x32x32_bf16 v[112:127], a[172:175], v[88:95], v2
    s_add_u32 s50, s49, 180224
    v_exp_f32 v34, v34
    v_exp_f32 v35, v35
    v_exp_f32 v36, v36
    v_mfma_f32_32x32x4_2b_bf16 v[64:95], a[78:79], v[138:139], 0
    v_exp_f32 v37, v37
    v_exp_f32 v38, v38
    v_exp_f32 v39, v39
    v_exp_f32 v40, v40
    v_exp_f32 v41, v41
    v_exp_f32 v42, v42
    v_exp_f32 v43, v43
    v_exp_f32 v44, v44
    v_smfmac_f32_32x32x32_bf16 v[112:127], a[176:179], v[32:39], v2
    s_waitcnt vmcnt(23)
    v_exp_f32 v45, v45
    v_exp_f32 v46, v46
    v_exp_f32 v47, v47
    v_smfmac_f32_16x16x64_bf16 v[172:175], v[184:187], v[208:215], v3
    buffer_load_dwordx4 a[240:243], v1, s[16:19], s50 offen offset:0 sc1
    buffer_load_dwordx4 a[244:247], v1, s[16:19], s50 offen offset:1024 sc1
    v_exp_f32 v48, v48
    v_exp_f32 v49, v49
    v_smfmac_f32_32x32x32_bf16 v[112:127], a[180:183], v[40:47], v2
    v_exp_f32 v50, v50
    v_exp_f32 v51, v51
    v_exp_f32 v52, v52
    v_mfma_f32_32x32x16_bf16 v[64:79], a[56:59], v[134:137], v[64:79]
L_hop3:
    s_cbranch_execz L_hop7
    s_mov_b32 s65, 145408
    v_exp_f32 v53, v53
    v_exp_f32 v54, v54
    v_exp_f32 v55, v55
    v_mfma_f32_32x32x16_bf16 v[80:95], a[60:63], v[134:137], v[80:95]
    v_exp_f32 v56, v56
    v_exp_f32 v57, v57
    v_exp_f32 v58, v58
    v_smfmac_f32_32x32x32_bf16 v[112:127], a[184:187], v[48:55], v2
    s_waitcnt vmcnt(23)
    v_exp_f32 v59, v59
    v_exp_f32 v60, v60
    v_exp_f32 v61, v61
    v_smfmac_f32_16x16x64_bf16 v[176:179], v[184:187], v[216:223], v3
    buffer_load_dwordx4 a[248:251], v1, s[16:19], s50 offen offset:2048 sc1
    buffer_load_dwordx4 a[252:255], v1, s[16:19], s50 offen offset:3072 sc1
    buffer_load_dwordx4 v17, s[24:27], s65 offen offset:2048 lds
    v_exp_f32 v62, v62
    v_exp_f32 v63, v63
    v_exp_f32 v64, v64
    v_exp_f32 v65, v65
    v_smfmac_f32_32x32x32_bf16 v[112:127], a[188:191], v[56:63], v2
    s_add_u32 s50, s49, 245760
    v_exp_f32 v66, v66
    v_exp_f32 v67, v67
    v_exp_f32 v68, v68
    v_mfma_f32_32x32x4_2b_bf16 v[32:63], a[64:65], v[132:133], 0
    v_exp_f32 v69, v69
    v_exp_f32 v70, v70
    v_exp_f32 v71, v71
    v_exp_f32 v72, v72
    v_exp_f32 v73, v73
    v_exp_f32 v74, v74
    v_exp_f32 v75, v75
    v_exp_f32 v76, v76
    v_smfmac_f32_32x32x32_bf16 v[112:127], a[192:195], v[64:71], v2
    s_waitcnt vmcnt(23)
    v_exp_f32 v77, v77
    v_exp_f32 v78, v78
    v_exp_f32 v79, v79
    v_smfmac_f32_16x16x64_bf16 v[140:143], v[204:207], v[224:231], v3
    buffer_load_dwordx4 v[208:211], v1, s[16:19], s50 offen offset:0 sc1
    buffer_load_dwordx4 v[212:215], v1, s[16:19], s50 offen offset:1024 sc1
    v_exp_f32 v80, v80
    v_exp_f32 v81, v81
    v_smfmac_f32_32x32x32_bf16 v[112:127], a[196:199], v[72:79], v2
    v_exp_f32 v82, v82
    v_exp_f32 v83, v83
    v_exp_f32 v84, v84
    v_mfma_f32_32x32x16_bf16 v[32:47], a[0:3], v[128:131], v[32:47]
    s_mov_b32 s65, 168960
    v_exp_f32 v85, v85
    v_exp_f32 v86, v86
    v_exp_f32 v87, v87
    v_mfma_f32_32x32x16_bf16 v[48:63], a[4:7], v[128:131], v[48:63]
    v_exp_f32 v88, v88
    v_exp_f32 v89, v89
    v_exp_f32 v90, v90
    v_smfmac_f32_32x32x32_bf16 v[112:127], a[200:203], v[80:87], v2
    s_waitcnt vmcnt(23)
    v_exp_f32 v91, v91
    v_exp_f32 v92, v92
    v_exp_f32 v93, v93
    v_smfmac_f32_16x16x64_bf16 v[144:147], v[204:207], v[232:239], v3
    buffer_load_dwordx4 v[216:219], v1, s[16:19], s50 offen offset:2048 sc1
    buffer_load_dwordx4 v[220:223], v1, s[16:19], s50 offen offset:3072 sc1
    buffer_load_dwordx4 v17, s[24:27], s65 offen offset:3072 lds
    v_exp_f32 v94, v94
    v_exp_f32 v95, v95
    v_exp_f32 v32, v32
    v_exp_f32 v33, v33
    v_smfmac_f32_32x32x32_bf16 v[112:127], a[204:207], v[88:95], v2
    s_add_u32 s50, s49, 249856
    v_exp_f32 v34, v34
    v_exp_f32 v35, v35
    v_exp_f32 v36, v36
    v_mfma_f32_32x32x4_2b_bf16 v[64:95], a[66:67], v[132:133], 0
    v_exp_f32 v37, v37
    v_exp_f32 v38, v38
    v_exp_f32 v39, v39
    v_exp_f32 v40, v40
    v_exp_f32 v41, v41
    v_exp_f32 v42, v42
    v_exp_f32 v43, v43
    v_exp_f32 v44, v44
    v_smfmac_f32_32x32x32_bf16 v[96:111], a[80:83], v[32:39], v2
    s_waitcnt vmcnt(23)
    ds_write_b128 v6, v[112:115] offset:12288
    v_exp_f32 v45, v45
    v_exp_f32 v46, v46
    v_exp_f32 v47, v47
    v_smfmac_f32_16x16x64_bf16 v[148:151], v[204:207], v[240:247], v3
    buffer_load_dwordx4 v[224:227], v1, s[16:19], s50 offen offset:0 sc1
    buffer_load_dwordx4 v[228:231], v1, s[16:19], s50 offen offset:1024 sc1
    s_mov_b32 s45, 6400
    buffer_load_dwordx4 v[134:137], v11, s[16:19], s45 offen sc1
    buffer_load_dwordx2 v[138:139], v12, s[16:19], s45 offen offset:1024 sc1
    v_exp_f32 v48, v48
    v_exp_f32 v49, v49
    v_smfmac_f32_32x32x32_bf16 v[96:111], a[84:87], v[40:47], v2
    ds_write_b128 v6, v[116:119] offset:13312
    v_exp_f32 v50, v50
    v_exp_f32 v51, v51
    v_exp_f32 v52, v52
    v_mfma_f32_32x32x16_bf16 v[64:79], a[8:11], v[128:131], v[64:79]
    s_add_u32 m0, s64, 8192
    s_mov_b32 s65, 196608
    v_exp_f32 v53, v53
    v_exp_f32 v54, v54
    v_exp_f32 v55, v55
    v_mfma_f32_32x32x16_bf16 v[80:95], a[12:15], v[128:131], v[80:95]
    v_exp_f32 v56, v56
    v_exp_f32 v57, v57
    v_exp_f32 v58, v58
    v_smfmac_f32_32x32x32_bf16 v[96:111], a[88:91], v[48:55], v2
    s_waitcnt vmcnt(25)
    ds_write_b128 v6, v[120:123] offset:14336
    v_exp_f32 v59, v59
    v_exp_f32 v60, v60
    v_exp_f32 v61, v61
    v_smfmac_f32_16x16x64_bf16 v[152:155], v[204:207], v[248:255], v3
    buffer_load_dwordx4 v[232:235], v1, s[16:19], s50 offen offset:2048 sc1
    buffer_load_dwordx4 v[236:239], v1, s[16:19], s50 offen offset:3072 sc1
    buffer_load_dwordx4 v17, s[24:27], s65 offen offset:0 lds
    v_exp_f32 v62, v62
    v_exp_f32 v63, v63
    v_exp_f32 v64, v64
    v_exp_f32 v65, v65
    v_smfmac_f32_32x32x32_bf16 v[96:111], a[92:95], v[56:63], v2
    s_add_u32 s50, s49, 253952
    v_exp_f32 v66, v66
    v_exp_f32 v67, v67
    v_exp_f32 v68, v68
    v_mfma_f32_32x32x4_2b_bf16 v[32:63], a[68:69], v[132:133], 0
    v_exp_f32 v69, v69
    v_exp_f32 v70, v70
    v_exp_f32 v71, v71
    v_exp_f32 v72, v72
    v_exp_f32 v73, v73
    v_exp_f32 v74, v74
    v_exp_f32 v75, v75
    v_exp_f32 v76, v76
    v_smfmac_f32_32x32x32_bf16 v[96:111], a[96:99], v[64:71], v2
    s_waitcnt vmcnt(25)
    s_waitcnt lgkmcnt(0)
    s_barrier
    v_exp_f32 v77, v77
    v_exp_f32 v78, v78
    v_exp_f32 v79, v79
    v_smfmac_f32_16x16x64_bf16 v[156:159], v[204:207], a[208:215], v3
    buffer_load_dwordx4 v[240:243], v1, s[16:19], s50 offen offset:0 sc1
    buffer_load_dwordx4 v[244:247], v1, s[16:19], s50 offen offset:1024 sc1
    v_exp_f32 v80, v80
    v_exp_f32 v81, v81
    v_smfmac_f32_32x32x32_bf16 v[96:111], a[100:103], v[72:79], v2
    ds_read_b128 v[188:191], v7 offset:12288
    v_exp_f32 v82, v82
    v_exp_f32 v83, v83
    v_exp_f32 v84, v84
    v_mfma_f32_32x32x16_bf16 v[32:47], a[16:19], v[128:131], v[32:47]
    ds_read_b128 v[192:195], v7 offset:15360
    s_mov_b32 s65, 220160
    v_exp_f32 v85, v85
    v_exp_f32 v86, v86
    v_exp_f32 v87, v87
    v_mfma_f32_32x32x16_bf16 v[48:63], a[20:23], v[128:131], v[48:63]
    ds_read_b128 v[196:199], v7 offset:18432
    v_exp_f32 v88, v88
    v_exp_f32 v89, v89
    v_exp_f32 v90, v90
    v_smfmac_f32_32x32x32_bf16 v[96:111], a[104:107], v[80:87], v2
    ds_read_b128 v[200:203], v7 offset:21504
    v_exp_f32 v91, v91
    v_exp_f32 v92, v92
    v_exp_f32 v93, v93
    v_mfma_f32_32x32x8_bf16 v[112:127], v[4:5], v[4:5], 0
    buffer_load_dwordx4 v[248:251], v1, s[16:19], s50 offen offset:2048 sc1
    buffer_load_dwordx4 v[252:255], v1, s[16:19], s50 offen offset:3072 sc1
    buffer_load_dwordx4 v17, s[24:27], s65 offen offset:1024 lds
    v_exp_f32 v94, v94
    v_exp_f32 v95, v95
    v_exp_f32 v32, v32
    v_exp_f32 v33, v33
    v_smfmac_f32_32x32x32_bf16 v[96:111], a[108:111], v[88:95], v2
    s_add_u32 s50, s49, 258048
    v_exp_f32 v34, v34
    v_exp_f32 v35, v35
    v_exp_f32 v36, v36
    v_mfma_f32_32x32x4_2b_bf16 v[64:95], a[70:71], v[132:133], 0
    s_waitcnt lgkmcnt(0)
    v_exp_f32 v37, v37
    v_add_f32 v188, v188, v192
    v_exp_f32 v38, v38
    v_add_f32 v189, v189, v193
    v_exp_f32 v39, v39
    v_add_f32 v190, v190, v194
    v_exp_f32 v40, v40
    v_add_f32 v191, v191, v195
    v_exp_f32 v41, v41
    v_add_f32 v196, v196, v200
    v_exp_f32 v42, v42
    v_add_f32 v197, v197, v201
    v_exp_f32 v43, v43
    v_add_f32 v198, v198, v202
    v_exp_f32 v44, v44
    v_add_f32 v199, v199, v203
    v_smfmac_f32_32x32x32_bf16 v[96:111], a[112:115], v[32:39], v2
    s_waitcnt vmcnt(28)
    v_exp_f32 v45, v45
    v_add_f32 v188, v188, v196
    v_exp_f32 v46, v46
    v_add_f32 v189, v189, v197
    v_exp_f32 v47, v47
    v_add_f32 v190, v190, v198
    v_smfmac_f32_16x16x64_bf16 v[160:163], v[204:207], a[216:223], v3
    buffer_load_dwordx4 a[208:211], v1, s[16:19], s50 offen offset:0 sc1
    buffer_load_dwordx4 a[212:215], v1, s[16:19], s50 offen offset:1024 sc1
    v_exp_f32 v48, v48
    v_rcp_f32_dpp v192, v188 quad_perm:[3,3,3,3] row_mask:0xf bank_mask:0xf
    v_exp_f32 v49, v49
    v_add_f32 v191, v191, v199
    v_smfmac_f32_32x32x32_bf16 v[96:111], a[116:119], v[40:47], v2
    v_exp_f32 v50, v50
    v_mul_f32 v188, v188, v192
    v_exp_f32 v51, v51
    v_mul_f32 v189, v189, v192
    v_exp_f32 v52, v52
    v_mul_f32 v190, v190, v192
    v_mfma_f32_32x32x16_bf16 v[64:79], a[24:27], v[128:131], v[64:79]
    s_mov_b32 s65, 243712
    v_exp_f32 v53, v53
    v_mul_f32 v191, v191, v192
    v_exp_f32 v54, v54
    v_cvt_pk_bf16_f32 v188, v188, v189
    v_exp_f32 v55, v55
    v_cvt_pk_bf16_f32 v189, v190, v191
    v_mfma_f32_32x32x16_bf16 v[80:95], a[28:31], v[128:131], v[80:95]
    v_exp_f32 v56, v56
    v_subrev_u32 v192, 528482304, v192
    v_exp_f32 v57, v57
    v_max_u32 v10, v10, v192
    v_exp_f32 v58, v58
    v_smfmac_f32_32x32x32_bf16 v[96:111], a[120:123], v[48:55], v2
    s_waitcnt vmcnt(27)
    ds_write2_b32 v8, v188, v189 offset0:0 offset1:32
    v_mad_i32_i24 v8, v9, -3, v8
    v_exp_f32 v59, v59
    v_exp_f32 v60, v60
    v_exp_f32 v61, v61
    v_smfmac_f32_16x16x64_bf16 v[164:167], v[204:207], a[224:231], v3
    buffer_load_dwordx4 a[216:219], v1, s[16:19], s50 offen offset:2048 sc1
    buffer_load_dwordx4 a[220:223], v1, s[16:19], s50 offen offset:3072 sc1
    buffer_load_dwordx4 v17, s[24:27], s65 offen offset:2048 lds
    v_exp_f32 v62, v62
    v_exp_f32 v63, v63
    v_exp_f32 v64, v64
    v_exp_f32 v65, v65
    v_smfmac_f32_32x32x32_bf16 v[96:111], a[124:127], v[56:63], v2
    s_add_u32 s50, s49, 262144
    v_exp_f32 v66, v66
    v_exp_f32 v67, v67
    v_exp_f32 v68, v68
    v_mfma_f32_32x32x4_2b_bf16 v[32:63], a[72:73], v[132:133], 0
    v_exp_f32 v69, v69
    v_exp_f32 v70, v70
    v_exp_f32 v71, v71
    v_exp_f32 v72, v72
    v_exp_f32 v73, v73
    v_exp_f32 v74, v74
    v_exp_f32 v75, v75
    v_exp_f32 v76, v76
    v_smfmac_f32_32x32x32_bf16 v[96:111], a[128:131], v[64:71], v2
    s_waitcnt vmcnt(28)
    s_waitcnt lgkmcnt(0)
    s_barrier
    v_exp_f32 v77, v77
    v_exp_f32 v78, v78
    v_exp_f32 v79, v79
    v_smfmac_f32_16x16x64_bf16 v[168:171], v[204:207], a[232:239], v3
    buffer_load_dwordx4 a[224:227], v1, s[16:19], s50 offen offset:0 sc1
    buffer_load_dwordx4 a[228:231], v1, s[16:19], s50 offen offset:1024 sc1
    v_exp_f32 v80, v80
    v_exp_f32 v81, v81
    v_smfmac_f32_32x32x32_bf16 v[96:111], a[132:135], v[72:79], v2
    ds_read_b128 v[180:183], v1 offset:27648
    ds_read_b128 v[184:187], v1 offset:28672
    v_exp_f32 v82, v82
    v_exp_f32 v83, v83
    v_exp_f32 v84, v84
    v_mfma_f32_32x32x16_bf16 v[32:47], a[32:35], v[128:131], v[32:47]
    s_mov_b32 s65, 267264
    v_exp_f32 v85, v85
    v_exp_f32 v86, v86
    v_exp_f32 v87, v87
    v_mfma_f32_32x32x16_bf16 v[48:63], a[36:39], v[128:131], v[48:63]
    v_exp_f32 v88, v88
    v_exp_f32 v89, v89
    v_exp_f32 v90, v90
    v_smfmac_f32_32x32x32_bf16 v[96:111], a[136:139], v[80:87], v2
    s_waitcnt lgkmcnt(0)
    s_waitcnt vmcnt(27)
    v_exp_f32 v91, v91
    v_exp_f32 v92, v92
    v_exp_f32 v93, v93
    v_smfmac_f32_16x16x64_bf16 v[172:175], v[204:207], a[240:247], v3
    buffer_load_dwordx4 a[232:235], v1, s[16:19], s50 offen offset:2048 sc1
    buffer_load_dwordx4 a[236:239], v1, s[16:19], s50 offen offset:3072 sc1
    buffer_load_dwordx4 v17, s[24:27], s65 offen offset:3072 lds
    v_exp_f32 v94, v94
    v_exp_f32 v95, v95
    v_exp_f32 v32, v32
    v_exp_f32 v33, v33
    v_smfmac_f32_32x32x32_bf16 v[96:111], a[140:143], v[88:95], v2
    s_add_u32 s50, s49, 327680
    s_load_dwordx2 s[58:59], s[86:87], 14396
    v_exp_f32 v34, v34
    v_exp_f32 v35, v35
    v_exp_f32 v36, v36
    v_mfma_f32_32x32x4_2b_bf16 v[64:95], a[74:75], v[132:133], 0
    v_exp_f32 v37, v37
    v_exp_f32 v38, v38
    v_exp_f32 v39, v39
    v_exp_f32 v40, v40
    v_exp_f32 v41, v41
    v_exp_f32 v42, v42
    v_exp_f32 v43, v43
    v_exp_f32 v44, v44
    v_smfmac_f32_32x32x32_bf16 v[96:111], a[144:147], v[32:39], v2
    s_waitcnt vmcnt(28)
    s_load_dwordx2 s[58:59], s[86:87], 14908
    v_exp_f32 v45, v45
    v_exp_f32 v46, v46
    v_exp_f32 v47, v47
    v_smfmac_f32_16x16x64_bf16 v[176:179], v[204:207], a[248:255], v3
    buffer_load_dwordx4 a[240:243], v1, s[16:19], s50 offen offset:0 sc1
    buffer_load_dwordx4 a[244:247], v1, s[16:19], s50 offen offset:1024 sc1
    v_exp_f32 v48, v48
    v_exp_f32 v49, v49
    v_smfmac_f32_32x32x32_bf16 v[96:111], a[148:151], v[40:47], v2
    s_load_dwordx2 s[58:59], s[86:87], 15420
    v_exp_f32 v50, v50
    v_exp_f32 v51, v51
    v_exp_f32 v52, v52
    v_mfma_f32_32x32x16_bf16 v[64:79], a[40:43], v[128:131], v[64:79]
    s_add_u32 m0, s64, 12288
    s_mov_b32 s65, 294912
    v_exp_f32 v53, v53
    v_exp_f32 v54, v54
    v_exp_f32 v55, v55
    v_mfma_f32_32x32x16_bf16 v[80:95], a[44:47], v[128:131], v[80:95]
    s_load_dwordx2 s[58:59], s[86:87], 15932
    v_exp_f32 v56, v56
    v_exp_f32 v57, v57
    v_exp_f32 v58, v58
    v_smfmac_f32_32x32x32_bf16 v[96:111], a[152:155], v[48:55], v2
    s_waitcnt vmcnt(27)
    s_load_dwordx2 s[58:59], s[86:87], 16444
    v_exp_f32 v59, v59
    v_exp_f32 v60, v60
    v_exp_f32 v61, v61
    v_smfmac_f32_16x16x64_bf16 v[140:143], v[180:183], v[208:215], v3
    buffer_load_dwordx4 a[248:251], v1, s[16:19], s50 offen offset:2048 sc1
    buffer_load_dwordx4 a[252:255], v1, s[16:19], s50 offen offset:3072 sc1
    buffer_load_dwordx4 v17, s[24:27], s65 offen offset:0 lds
    v_exp_f32 v62, v62
    v_exp_f32 v63, v63
    v_exp_f32 v64, v64
    v_exp_f32 v65, v65
    v_smfmac_f32_32x32x32_bf16 v[96:111], a[156:159], v[56:63], v2
    s_add_u32 s50, s49, 331776
    s_load_dwordx2 s[58:59], s[86:87], 16956
    v_exp_f32 v66, v66
    v_exp_f32 v67, v67
    v_exp_f32 v68, v68
    v_mfma_f32_32x32x4_2b_bf16 v[32:63], a[76:77], v[132:133], 0
    v_exp_f32 v69, v69
    v_exp_f32 v70, v70
    v_exp_f32 v71, v71
    v_exp_f32 v72, v72
    v_exp_f32 v73, v73
    v_exp_f32 v74, v74
    v_exp_f32 v75, v75
    v_exp_f32 v76, v76
    v_smfmac_f32_32x32x32_bf16 v[96:111], a[160:163], v[64:71], v2
    s_waitcnt vmcnt(28)
    s_load_dwordx2 s[58:59], s[86:87], 17468
    v_exp_f32 v77, v77
    v_exp_f32 v78, v78
    v_exp_f32 v79, v79
    v_smfmac_f32_16x16x64_bf16 v[144:147], v[180:183], v[216:223], v3
    buffer_load_dwordx4 v[208:211], v1, s[16:19], s50 offen offset:0 sc1
    buffer_load_dwordx4 v[212:215], v1, s[16:19], s50 offen offset:1024 sc1
    v_exp_f32 v80, v80
    v_exp_f32 v81, v81
    v_smfmac_f32_32x32x32_bf16 v[96:111], a[164:167], v[72:79], v2
    v_exp_f32 v82, v82
    v_exp_f32 v83, v83
    v_exp_f32 v84, v84
    v_mfma_f32_32x32x16_bf16 v[32:47], a[48:51], v[128:131], v[32:47]
    s_mov_b32 s65, 318464
    v_exp_f32 v85, v85
    v_exp_f32 v86, v86
    v_exp_f32 v87, v87
    v_mfma_f32_32x32x16_bf16 v[48:63], a[52:55], v[128:131], v[48:63]
    v_exp_f32 v88, v88
    v_exp_f32 v89, v89
    v_exp_f32 v90, v90
    v_smfmac_f32_32x32x32_bf16 v[96:111], a[168:171], v[80:87], v2
    s_waitcnt vmcnt(27)
    v_exp_f32 v91, v91
    v_exp_f32 v92, v92
    v_exp_f32 v93, v93
    v_smfmac_f32_16x16x64_bf16 v[148:151], v[180:183], v[224:231], v3
    buffer_load_dwordx4 v[216:219], v1, s[16:19], s50 offen offset:2048 sc1
    buffer_load_dwordx4 v[220:223], v1, s[16:19], s50 offen offset:3072 sc1
    buffer_load_dwordx4 v17, s[24:27], s65 offen offset:1024 lds
    v_exp_f32 v94, v94
    v_exp_f32 v95, v95
    v_exp_f32 v32, v32
    v_exp_f32 v33, v33
    v_smfmac_f32_32x32x32_bf16 v[96:111], a[172:175], v[88:95], v2
    s_add_u32 s50, s49, 335872
    v_exp_f32 v34, v34
    v_exp_f32 v35, v35
    v_exp_f32 v36, v36
    v_mfma_f32_32x32x4_2b_bf16 v[64:95], a[78:79], v[132:133], 0
    v_exp_f32 v37, v37
    v_exp_f32 v38, v38
    v_exp_f32 v39, v39
    v_exp_f32 v40, v40
    v_exp_f32 v41, v41
    v_exp_f32 v42, v42
    v_exp_f32 v43, v43
    v_exp_f32 v44, v44
    v_smfmac_f32_32x32x32_bf16 v[96:111], a[176:179], v[32:39], v2
    s_waitcnt vmcnt(26)
    v_exp_f32 v45, v45
    v_exp_f32 v46, v46
    v_exp_f32 v47, v47
    v_smfmac_f32_16x16x64_bf16 v[152:155], v[180:183], v[232:239], v3
    buffer_load_dwordx4 v[224:227], v1, s[16:19], s50 offen offset:0 sc1
    buffer_load_dwordx4 v[228:231], v1, s[16:19], s50 offen offset:1024 sc1
    v_exp_f32 v48, v48
    v_exp_f32 v49, v49
    v_smfmac_f32_32x32x32_bf16 v[96:111], a[180:183], v[40:47], v2
    v_exp_f32 v50, v50
    v_exp_f32 v51, v51
    v_exp_f32 v52, v52
    v_mfma_f32_32x32x16_bf16 v[64:79], a[56:59], v[128:131], v[64:79]
    s_mov_b32 s65, 342016
    v_exp_f32 v53, v53
    v_exp_f32 v54, v54
    v_exp_f32 v55, v55
    v_mfma_f32_32x32x16_bf16 v[80:95], a[60:63], v[128:131], v[80:95]
    v_exp_f32 v56, v56
    v_exp_f32 v57, v57
    v_exp_f32 v58, v58
    v_smfmac_f32_32x32x32_bf16 v[96:111], a[184:187], v[48:55], v2
    s_waitcnt vmcnt(25)
    v_exp_f32 v59, v59
    v_exp_f32 v60, v60
    v_exp_f32 v61, v61
    v_smfmac_f32_16x16x64_bf16 v[156:159], v[180:183], v[240:247], v3
    buffer_load_dwordx4 v[232:235], v1, s[16:19], s50 offen offset:2048 sc1
    buffer_load_dwordx4 v[236:239], v1, s[16:19], s50 offen offset:3072 sc1
    buffer_load_dwordx4 v17, s[24:27], s65 offen offset:2048 lds
    v_exp_f32 v62, v62
    v_exp_f32 v63, v63
    v_exp_f32 v64, v64
    v_exp_f32 v65, v65
    v_smfmac_f32_32x32x32_bf16 v[96:111], a[188:191], v[56:63], v2
    s_add_u32 s50, s49, 339968
    v_exp_f32 v66, v66
    v_exp_f32 v67, v67
    v_exp_f32 v68, v68
    v_mfma_f32_32x32x4_2b_bf16 v[32:63], a[64:65], v[138:139], 0
    v_exp_f32 v69, v69
    v_exp_f32 v70, v70
    v_exp_f32 v71, v71
    v_exp_f32 v72, v72
    v_exp_f32 v73, v73
    v_exp_f32 v74, v74
    v_exp_f32 v75, v75
    v_exp_f32 v76, v76
    v_smfmac_f32_32x32x32_bf16 v[96:111], a[192:195], v[64:71], v2
    s_waitcnt vmcnt(26)
    v_exp_f32 v77, v77
    v_exp_f32 v78, v78
    v_exp_f32 v79, v79
    v_smfmac_f32_16x16x64_bf16 v[160:163], v[180:183], v[248:255], v3
    buffer_load_dwordx4 v[240:243], v1, s[16:19], s50 offen offset:0 sc1
    buffer_load_dwordx4 v[244:247], v1, s[16:19], s50 offen offset:1024 sc1
    v_exp_f32 v80, v80
    v_exp_f32 v81, v81
    v_smfmac_f32_32x32x32_bf16 v[96:111], a[196:199], v[72:79], v2
    v_exp_f32 v82, v82
    v_exp_f32 v83, v83
    v_exp_f32 v84, v84
    v_mfma_f32_32x32x16_bf16 v[32:47], a[0:3], v[134:137], v[32:47]
    s_mov_b32 s65, 365568
    v_exp_f32 v85, v85
    v_exp_f32 v86, v86
    v_exp_f32 v87, v87
    v_mfma_f32_32x32x16_bf16 v[48:63], a[4:7], v[134:137], v[48:63]
    v_exp_f32 v88, v88
    v_exp_f32 v89, v89
    v_exp_f32 v90, v90
    v_smfmac_f32_32x32x32_bf16 v[96:111], a[200:203], v[80:87], v2
    s_waitcnt vmcnt(25)
    v_exp_f32 v91, v91
    v_exp_f32 v92, v92
    v_exp_f32 v93, v93
    v_smfmac_f32_16x16x64_bf16 v[164:167], v[180:183], a[208:215], v3
    buffer_load_dwordx4 v[248:251], v1, s[16:19], s50 offen offset:2048 sc1
    buffer_load_dwordx4 v[252:255], v1, s[16:19], s50 offen offset:3072 sc1
    buffer_load_dwordx4 v17, s[24:27], s65 offen offset:3072 lds
    v_exp_f32 v94, v94
    v_exp_f32 v95, v95
    v_exp_f32 v32, v32
    v_exp_f32 v33, v33
    v_smfmac_f32_32x32x32_bf16 v[96:111], a[204:207], v[88:95], v2
    s_add_u32 s50, s49, 344064
    v_exp_f32 v34, v34
    v_exp_f32 v35, v35
    v_exp_f32 v36, v36
    v_mfma_f32_32x32x4_2b_bf16 v[64:95], a[66:67], v[138:139], 0
    v_exp_f32 v37, v37
    v_exp_f32 v38, v38
    v_exp_f32 v39, v39
    v_exp_f32 v40, v40
    v_exp_f32 v41, v41
    v_exp_f32 v42, v42
    v_exp_f32 v43, v43
    v_exp_f32 v44, v44
    v_smfmac_f32_32x32x32_bf16 v[112:127], a[80:83], v[32:39], v2
    s_waitcnt vmcnt(26)
    ds_write_b128 v6, v[96:99] offset:0
    v_exp_f32 v45, v45
    v_exp_f32 v46, v46
    v_exp_f32 v47, v47
    v_smfmac_f32_16x16x64_bf16 v[168:171], v[180:183], a[216:223], v3
    buffer_load_dwordx4 a[208:211], v1, s[16:19], s50 offen offset:0 sc1
    buffer_load_dwordx4 a[212:215], v1, s[16:19], s50 offen offset:1024 sc1
    s_mov_b32 s45, 7680
    buffer_load_dwordx4 v[128:131], v11, s[16:19], s45 offen sc1
    buffer_load_dwordx2 v[132:133], v12, s[16:19], s45 offen offset:1024 sc1
    v_exp_f32 v48, v48
    v_exp_f32 v49, v49
    v_smfmac_f32_32x32x32_bf16 v[112:127], a[84:87], v[40:47], v2
    ds_write_b128 v6, v[100:103] offset:1024
    v_exp_f32 v50, v50
    v_exp_f32 v51, v51
    v_exp_f32 v52, v52
    v_mfma_f32_32x32x16_bf16 v[64:79], a[8:11], v[134:137], v[64:79]
    s_add_u32 m0, s64, 16384
    s_mov_b32 s65, 393216
    v_exp_f32 v53, v53
    v_exp_f32 v54, v54
    v_exp_f32 v55, v55
    v_mfma_f32_32x32x16_bf16 v[80:95], a[12:15], v[134:137], v[80:95]
    v_exp_f32 v56, v56
    v_exp_f32 v57, v57
    v_exp_f32 v58, v58
    v_smfmac_f32_32x32x32_bf16 v[112:127], a[88:91], v[48:55], v2
    s_waitcnt vmcnt(27)
    ds_write_b128 v6, v[104:107] offset:2048
    v_exp_f32 v59, v59
    v_exp_f32 v60, v60
    v_exp_f32 v61, v61
    v_smfmac_f32_16x16x64_bf16 v[172:175], v[180:183], a[224:231], v3
    buffer_load_dwordx4 a[216:219], v1, s[16:19], s50 offen offset:2048 sc1
    buffer_load_dwordx4 a[220:223], v1, s[16:19], s50 offen offset:3072 sc1
    buffer_load_dwordx4 v17, s[24:27], s65 offen offset:0 lds
    v_exp_f32 v62, v62
    v_exp_f32 v63, v63
    v_exp_f32 v64, v64
    v_exp_f32 v65, v65
    v_smfmac_f32_32x32x32_bf16 v[112:127], a[92:95], v[56:63], v2
    s_add_u32 s50, s49, 409600
    v_exp_f32 v66, v66
    v_exp_f32 v67, v67
    v_exp_f32 v68, v68
    v_mfma_f32_32x32x4_2b_bf16 v[32:63], a[68:69], v[138:139], 0
    v_exp_f32 v69, v69
    v_exp_f32 v70, v70
    v_exp_f32 v71, v71
    v_exp_f32 v72, v72
    v_exp_f32 v73, v73
    v_exp_f32 v74, v74
    v_exp_f32 v75, v75
    v_exp_f32 v76, v76
    v_smfmac_f32_32x32x32_bf16 v[112:127], a[96:99], v[64:71], v2
    s_waitcnt vmcnt(28)
    s_waitcnt lgkmcnt(0)
    s_barrier
    v_exp_f32 v77, v77
    v_exp_f32 v78, v78
    v_exp_f32 v79, v79
    v_smfmac_f32_16x16x64_bf16 v[176:179], v[180:183], a[232:239], v3
    buffer_load_dwordx4 a[224:227], v1, s[16:19], s50 offen offset:0 sc1
    buffer_load_dwordx4 a[228:231], v1, s[16:19], s50 offen offset:1024 sc1
    v_exp_f32 v80, v80
    v_exp_f32 v81, v81
    v_smfmac_f32_32x32x32_bf16 v[112:127], a[100:103], v[72:79], v2
    ds_read_b128 v[188:191], v7 offset:0
    v_exp_f32 v82, v82
    v_exp_f32 v83, v83
    v_exp_f32 v84, v84
    v_mfma_f32_32x32x16_bf16 v[32:47], a[16:19], v[134:137], v[32:47]
    ds_read_b128 v[192:195], v7 offset:3072
    s_mov_b32 s65, 416768
    v_exp_f32 v85, v85
    v_exp_f32 v86, v86
    v_exp_f32 v87, v87
    v_mfma_f32_32x32x16_bf16 v[48:63], a[20:23], v[134:137], v[48:63]
    ds_read_b128 v[196:199], v7 offset:6144
    v_exp_f32 v88, v88
    v_exp_f32 v89, v89
    v_exp_f32 v90, v90
    v_smfmac_f32_32x32x32_bf16 v[112:127], a[104:107], v[80:87], v2
    ds_read_b128 v[200:203], v7 offset:9216
    v_exp_f32 v91, v91
    v_exp_f32 v92, v92
    v_exp_f32 v93, v93
    v_mfma_f32_32x32x8_bf16 v[96:111], v[4:5], v[4:5], 0
    buffer_load_dwordx4 a[232:235], v1, s[16:19], s50 offen offset:2048 sc1
    buffer_load_dwordx4 a[236:239], v1, s[16:19], s50 offen offset:3072 sc1
    buffer_load_dwordx4 v17, s[24:27], s65 offen offset:1024 lds
    v_exp_f32 v94, v94
    v_exp_f32 v95, v95
    v_exp_f32 v32, v32
    v_exp_f32 v33, v33
    v_smfmac_f32_32x32x32_bf16 v[112:127], a[108:111], v[88:95], v2
    s_add_u32 s50, s49, 413696
    v_exp_f32 v34, v34
    v_exp_f32 v35, v35
    v_exp_f32 v36, v36
    v_mfma_f32_32x32x4_2b_bf16 v[64:95], a[70:71], v[138:139], 0
    s_waitcnt lgkmcnt(0)
    v_exp_f32 v37, v37
    v_add_f32 v188, v188, v192
    v_exp_f32 v38, v38
    v_add_f32 v189, v189, v193
    v_exp_f32 v39, v39
    v_add_f32 v190, v190, v194
    v_exp_f32 v40, v40
    v_add_f32 v191, v191, v195
    v_exp_f32 v41, v41
    v_add_f32 v196, v196, v200
    v_exp_f32 v42, v42
    v_add_f32 v197, v197, v201
    v_exp_f32 v43, v43
    v_add_f32 v198, v198, v202
    v_exp_f32 v44, v44
    v_add_f32 v199, v199, v203
    v_smfmac_f32_32x32x32_bf16 v[112:127], a[112:115], v[32:39], v2
    s_waitcnt vmcnt(30)
    v_exp_f32 v45, v45
    v_add_f32 v188, v188, v196
    v_exp_f32 v46, v46
    v_add_f32 v189, v189, v197
    v_exp_f32 v47, v47
    v_add_f32 v190, v190, v198
    v_smfmac_f32_16x16x64_bf16 v[140:143], v[184:187], a[240:247], v3
    buffer_load_dwordx4 a[240:243], v1, s[16:19], s50 offen offset:0 sc1
    buffer_load_dwordx4 a[244:247], v1, s[16:19], s50 offen offset:1024 sc1
    v_exp_f32 v48, v48
    v_rcp_f32_dpp v192, v188 quad_perm:[3,3,3,3] row_mask:0xf bank_mask:0xf
    v_exp_f32 v49, v49
    v_add_f32 v191, v191, v199
    v_smfmac_f32_32x32x32_bf16 v[112:127], a[116:119], v[40:47], v2
    v_exp_f32 v50, v50
    v_mul_f32 v188, v188, v192
    v_exp_f32 v51, v51
    v_mul_f32 v189, v189, v192
    v_exp_f32 v52, v52
    v_mul_f32 v190, v190, v192
    v_mfma_f32_32x32x16_bf16 v[64:79], a[24:27], v[134:137], v[64:79]
    s_mov_b32 s65, 440320
    v_exp_f32 v53, v53
    v_mul_f32 v191, v191, v192
    v_exp_f32 v54, v54
    v_cvt_pk_bf16_f32 v188, v188, v189
    v_exp_f32 v55, v55
    v_cvt_pk_bf16_f32 v189, v190, v191
    v_mfma_f32_32x32x16_bf16 v[80:95], a[28:31], v[134:137], v[80:95]
    v_exp_f32 v56, v56
    v_subrev_u32 v192, 528482304, v192
    v_exp_f32 v57, v57
    v_max_u32 v10, v10, v192
    v_exp_f32 v58, v58
    v_smfmac_f32_32x32x32_bf16 v[112:127], a[120:123], v[48:55], v2
    s_waitcnt vmcnt(30)
    ds_write2_b32 v8, v188, v189 offset0:0 offset1:32
    v_add_u32 v8, v9, v8
    v_exp_f32 v59, v59
    v_exp_f32 v60, v60
    v_exp_f32 v61, v61
    v_smfmac_f32_16x16x64_bf16 v[144:147], v[184:187], a[248:255], v3
    buffer_load_dwordx4 a[248:251], v1, s[16:19], s50 offen offset:2048 sc1
    buffer_load_dwordx4 a[252:255], v1, s[16:19], s50 offen offset:3072 sc1
    buffer_load_dwordx4 v17, s[24:27], s65 offen offset:2048 lds
    v_exp_f32 v62, v62
    v_exp_f32 v63, v63
    v_exp_f32 v64, v64
    v_exp_f32 v65, v65
    v_smfmac_f32_32x32x32_bf16 v[112:127], a[124:127], v[56:63], v2
    s_add_u32 s50, s49, 417792
    v_exp_f32 v66, v66
    v_exp_f32 v67, v67
    v_exp_f32 v68, v68
    v_mfma_f32_32x32x4_2b_bf16 v[32:63], a[72:73], v[138:139], 0
    v_exp_f32 v69, v69
    v_exp_f32 v70, v70
    v_exp_f32 v71, v71
    v_exp_f32 v72, v72
    v_exp_f32 v73, v73
    v_exp_f32 v74, v74
    v_exp_f32 v75, v75
    v_exp_f32 v76, v76
    v_smfmac_f32_32x32x32_bf16 v[112:127], a[128:131], v[64:71], v2
    s_waitcnt vmcnt(30)
    s_waitcnt lgkmcnt(0)
    s_barrier
    v_exp_f32 v77, v77
    v_exp_f32 v78, v78
    v_exp_f32 v79, v79
    v_smfmac_f32_16x16x64_bf16 v[148:151], v[184:187], v[208:215], v3
    buffer_load_dwordx4 v[208:211], v1, s[16:19], s50 offen offset:0 sc1
    buffer_load_dwordx4 v[212:215], v1, s[16:19], s50 offen offset:1024 sc1
    v_exp_f32 v80, v80
    v_exp_f32 v81, v81
    v_smfmac_f32_32x32x32_bf16 v[112:127], a[132:135], v[72:79], v2
    ds_read_b128 v[204:207], v1 offset:24576
    v_exp_f32 v82, v82
    v_exp_f32 v83, v83
    v_exp_f32 v84, v84
    v_mfma_f32_32x32x16_bf16 v[32:47], a[32:35], v[134:137], v[32:47]
    s_mov_b32 s65, 463872
    v_exp_f32 v85, v85
    v_exp_f32 v86, v86
    v_exp_f32 v87, v87
    v_mfma_f32_32x32x16_bf16 v[48:63], a[36:39], v[134:137], v[48:63]
    v_exp_f32 v88, v88
    v_exp_f32 v89, v89
    v_exp_f32 v90, v90
    v_smfmac_f32_32x32x32_bf16 v[112:127], a[136:139], v[80:87], v2
    s_waitcnt lgkmcnt(0)
    s_waitcnt vmcnt(30)
    v_exp_f32 v91, v91
    v_exp_f32 v92, v92
    v_exp_f32 v93, v93
    v_smfmac_f32_16x16x64_bf16 v[152:155], v[184:187], v[216:223], v3
    buffer_load_dwordx4 v[216:219], v1, s[16:19], s50 offen offset:2048 sc1
    buffer_load_dwordx4 v[220:223], v1, s[16:19], s50 offen offset:3072 sc1
    buffer_load_dwordx4 v17, s[24:27], s65 offen offset:3072 lds
    v_exp_f32 v94, v94
    v_exp_f32 v95, v95
    v_exp_f32 v32, v32
    v_exp_f32 v33, v33
    v_smfmac_f32_32x32x32_bf16 v[112:127], a[140:143], v[88:95], v2
L_hop4:
    s_cbranch_execz L_hop8
    s_add_u32 s50, s49, 421888
    s_load_dwordx2 s[58:59], s[86:87], 17980
    v_exp_f32 v34, v34
    v_exp_f32 v35, v35
    v_exp_f32 v36, v36
    v_mfma_f32_32x32x4_2b_bf16 v[64:95], a[74:75], v[138:139], 0
    v_exp_f32 v37, v37
    v_exp_f32 v38, v38
    v_exp_f32 v39, v39
    v_exp_f32 v40, v40
    v_exp_f32 v41, v41
    v_exp_f32 v42, v42
    v_exp_f32 v43, v43
    v_exp_f32 v44, v44
    v_smfmac_f32_32x32x32_bf16 v[112:127], a[144:147], v[32:39], v2
    s_waitcnt vmcnt(30)
    s_load_dwordx2 s[58:59], s[86:87], 18492
    v_exp_f32 v45, v45
    v_exp_f32 v46, v46
    v_exp_f32 v47, v47
    v_smfmac_f32_16x16x64_bf16 v[156:159], v[184:187], v[224:231], v3
    buffer_load_dwordx4 v[224:227], v1, s[16:19], s50 offen offset:0 sc1
    buffer_load_dwordx4 v[228:231], v1, s[16:19], s50 offen offset:1024 sc1
    v_exp_f32 v48, v48
    v_exp_f32 v49, v49
    v_smfmac_f32_32x32x32_bf16 v[112:127], a[148:151], v[40:47], v2
    s_load_dwordx2 s[58:59], s[86:87], 19004
    v_exp_f32 v50, v50
    v_exp_f32 v51, v51
    v_exp_f32 v52, v52
    v_mfma_f32_32x32x16_bf16 v[64:79], a[40:43], v[134:137], v[64:79]
    s_add_u32 m0, s64, 20480
    s_mov_b32 s65, 491520
    v_exp_f32 v53, v53
    v_exp_f32 v54, v54
    v_exp_f32 v55, v55
    v_mfma_f32_32x32x16_bf16 v[80:95], a[44:47], v[134:137], v[80:95]
    s_load_dwordx2 s[58:59], s[86:87], 19516
    v_exp_f32 v56, v56
    v_exp_f32 v57, v57
    v_exp_f32 v58, v58
    v_smfmac_f32_32x32x32_bf16 v[112:127], a[152:155], v[48:55], v2
    s_waitcnt vmcnt(30)
    s_load_dwordx2 s[58:59], s[86:87], 20028
    v_exp_f32 v59, v59
    v_exp_f32 v60, v60
    v_exp_f32 v61, v61
    v_smfmac_f32_16x16x64_bf16 v[160:163], v[184:187], v[232:239], v3
    buffer_load_dwordx4 v[232:235], v1, s[16:19], s50 offen offset:2048 sc1
    buffer_load_dwordx4 v[236:239], v1, s[16:19], s50 offen offset:3072 sc1
    buffer_load_dwordx4 v17, s[24:27], s65 offen offset:0 lds
    v_exp_f32 v62, v62
    v_exp_f32 v63, v63
    v_exp_f32 v64, v64
    v_exp_f32 v65, v65
    v_smfmac_f32_32x32x32_bf16 v[112:127], a[156:159], v[56:63], v2
    s_add_u32 s50, s49, 425984
    s_load_dwordx2 s[58:59], s[86:87], 20540
    v_exp_f32 v66, v66
    v_exp_f32 v67, v67
    v_exp_f32 v68, v68
    v_mfma_f32_32x32x4_2b_bf16 v[32:63], a[76:77], v[138:139], 0
    v_exp_f32 v69, v69
    v_exp_f32 v70, v70
    v_exp_f32 v71, v71
    v_exp_f32 v72, v72
    v_exp_f32 v73, v73
    v_exp_f32 v74, v74
    v_exp_f32 v75, v75
    v_exp_f32 v76, v76
    v_smfmac_f32_32x32x32_bf16 v[112:127], a[160:163], v[64:71], v2
    s_waitcnt vmcnt(30)
    s_load_dwordx2 s[58:59], s[86:87], 21052
    v_exp_f32 v77, v77
    v_exp_f32 v78, v78
    v_exp_f32 v79, v79
    v_smfmac_f32_16x16x64_bf16 v[164:167], v[184:187], v[240:247], v3
    buffer_load_dwordx4 v[240:243], v1, s[16:19], s50 offen offset:0 sc1
    buffer_load_dwordx4 v[244:247], v1, s[16:19], s50 offen offset:1024 sc1
    v_exp_f32 v80, v80
    v_exp_f32 v81, v81
    v_smfmac_f32_32x32x32_bf16 v[112:127], a[164:167], v[72:79], v2
    v_exp_f32 v82, v82
    v_exp_f32 v83, v83
    v_exp_f32 v84, v84
    v_mfma_f32_32x32x16_bf16 v[32:47], a[48:51], v[134:137], v[32:47]
    s_mov_b32 s65, 515072
    v_exp_f32 v85, v85
    v_exp_f32 v86, v86
    v_exp_f32 v87, v87
    v_mfma_f32_32x32x16_bf16 v[48:63], a[52:55], v[134:137], v[48:63]
    v_exp_f32 v88, v88
    v_exp_f32 v89, v89
    v_exp_f32 v90, v90
    v_smfmac_f32_32x32x32_bf16 v[112:127], a[168:171], v[80:87], v2
    s_waitcnt vmcnt(30)
    v_exp_f32 v91, v91
    v_exp_f32 v92, v92
    v_exp_f32 v93, v93
    v_smfmac_f32_16x16x64_bf16 v[168:171], v[184:187], v[248:255], v3
    buffer_load_dwordx4 v[248:251], v1, s[16:19], s50 offen offset:2048 sc1
    buffer_load_dwordx4 v[252:255], v1, s[16:19], s50 offen offset:3072 sc1
    buffer_load_dwordx4 v17, s[24:27], s65 offen offset:1024 lds
    v_exp_f32 v94, v94
    v_exp_f32 v95, v95
    v_exp_f32 v32, v32
    v_exp_f32 v33, v33
    v_smfmac_f32_32x32x32_bf16 v[112:127], a[172:175], v[88:95], v2
    s_add_u32 s50, s49, 491520
    v_exp_f32 v34, v34
    v_exp_f32 v35, v35
    v_exp_f32 v36, v36
    v_mfma_f32_32x32x4_2b_bf16 v[64:95], a[78:79], v[138:139], 0
    v_exp_f32 v37, v37
    v_exp_f32 v38, v38
    v_exp_f32 v39, v39
    v_exp_f32 v40, v40
    v_exp_f32 v41, v41
    v_exp_f32 v42, v42
    v_exp_f32 v43, v43
    v_exp_f32 v44, v44
    v_smfmac_f32_32x32x32_bf16 v[112:127], a[176:179], v[32:39], v2
    s_waitcnt vmcnt(30)
    v_exp_f32 v45, v45
    v_exp_f32 v46, v46
    v_exp_f32 v47, v47
    v_smfmac_f32_16x16x64_bf16 v[172:175], v[184:187], a[208:215], v3
    buffer_load_dwordx4 a[208:211], v1, s[16:19], s50 offen offset:0 sc1
    buffer_load_dwordx4 a[212:215], v1, s[16:19], s50 offen offset:1024 sc1
    v_exp_f32 v48, v48
    v_exp_f32 v49, v49
    v_smfmac_f32_32x32x32_bf16 v[112:127], a[180:183], v[40:47], v2
    v_exp_f32 v50, v50
    v_exp_f32 v51, v51
    v_exp_f32 v52, v52
    v_mfma_f32_32x32x16_bf16 v[64:79], a[56:59], v[134:137], v[64:79]
    s_mov_b32 s65, 538624
    v_exp_f32 v53, v53
    v_exp_f32 v54, v54
    v_exp_f32 v55, v55
    v_mfma_f32_32x32x16_bf16 v[80:95], a[60:63], v[134:137], v[80:95]
    v_exp_f32 v56, v56
    v_exp_f32 v57, v57
    v_exp_f32 v58, v58
    v_smfmac_f32_32x32x32_bf16 v[112:127], a[184:187], v[48:55], v2
    s_waitcnt vmcnt(28)
    v_exp_f32 v59, v59
    v_exp_f32 v60, v60
    v_exp_f32 v61, v61
    v_smfmac_f32_16x16x64_bf16 v[176:179], v[184:187], a[216:223], v3
    buffer_load_dwordx4 a[216:219], v1, s[16:19], s50 offen offset:2048 sc1
    buffer_load_dwordx4 a[220:223], v1, s[16:19], s50 offen offset:3072 sc1
    buffer_load_dwordx4 v17, s[24:27], s65 offen offset:2048 lds
    v_exp_f32 v62, v62
    v_exp_f32 v63, v63
    v_exp_f32 v64, v64
    v_exp_f32 v65, v65
    v_smfmac_f32_32x32x32_bf16 v[112:127], a[188:191], v[56:63], v2
    s_add_u32 s50, s49, 495616
    v_exp_f32 v66, v66
    v_exp_f32 v67, v67
    v_exp_f32 v68, v68
    v_mfma_f32_32x32x4_2b_bf16 v[32:63], a[64:65], v[132:133], 0
    v_exp_f32 v69, v69
    v_exp_f32 v70, v70
    v_exp_f32 v71, v71
    v_exp_f32 v72, v72
    v_exp_f32 v73, v73
    v_exp_f32 v74, v74
    v_exp_f32 v75, v75
    v_exp_f32 v76, v76
    v_smfmac_f32_32x32x32_bf16 v[112:127], a[192:195], v[64:71], v2
    s_waitcnt vmcnt(28)
    v_exp_f32 v77, v77
    v_exp_f32 v78, v78
    v_exp_f32 v79, v79
    v_smfmac_f32_16x16x64_bf16 v[140:143], v[204:207], a[224:231], v3
    buffer_load_dwordx4 a[224:227], v1, s[16:19], s50 offen offset:0 sc1
    buffer_load_dwordx4 a[228:231], v1, s[16:19], s50 offen offset:1024 sc1
    v_exp_f32 v80, v80
    v_exp_f32 v81, v81
    v_smfmac_f32_32x32x32_bf16 v[112:127], a[196:199], v[72:79], v2
    v_exp_f32 v82, v82
    v_exp_f32 v83, v83
    v_exp_f32 v84, v84
    v_mfma_f32_32x32x16_bf16 v[32:47], a[0:3], v[128:131], v[32:47]
    s_mov_b32 s65, 562176
    v_exp_f32 v85, v85
    v_exp_f32 v86, v86
    v_exp_f32 v87, v87
    v_mfma_f32_32x32x16_bf16 v[48:63], a[4:7], v[128:131], v[48:63]
    v_exp_f32 v88, v88
    v_exp_f32 v89, v89
    v_exp_f32 v90, v90
    v_smfmac_f32_32x32x32_bf16 v[112:127], a[200:203], v[80:87], v2
    s_waitcnt vmcnt(28)
    v_exp_f32 v91, v91
    v_exp_f32 v92, v92
    v_exp_f32 v93, v93
    v_smfmac_f32_16x16x64_bf16 v[144:147], v[204:207], a[232:239], v3
    buffer_load_dwordx4 a[232:235], v1, s[16:19], s50 offen offset:2048 sc1
    buffer_load_dwordx4 a[236:239], v1, s[16:19], s50 offen offset:3072 sc1
    buffer_load_dwordx4 v17, s[24:27], s65 offen offset:3072 lds
    v_exp_f32 v94, v94
    v_exp_f32 v95, v95
    v_exp_f32 v32, v32
    v_exp_f32 v33, v33
    v_smfmac_f32_32x32x32_bf16 v[112:127], a[204:207], v[88:95], v2
    s_add_u32 s50, s49, 499712
    v_exp_f32 v34, v34
    v_exp_f32 v35, v35
    v_exp_f32 v36, v36
    v_mfma_f32_32x32x4_2b_bf16 v[64:95], a[66:67], v[132:133], 0
    v_exp_f32 v37, v37
    v_exp_f32 v38, v38
    v_exp_f32 v39, v39
    v_exp_f32 v40, v40
    v_exp_f32 v41, v41
    v_exp_f32 v42, v42
    v_exp_f32 v43, v43
    v_exp_f32 v44, v44
    v_smfmac_f32_32x32x32_bf16 v[96:111], a[80:83], v[32:39], v2
    s_waitcnt vmcnt(28)
    ds_write_b128 v6, v[112:115] offset:12288
    v_exp_f32 v45, v45
    v_exp_f32 v46, v46
    v_exp_f32 v47, v47
    v_smfmac_f32_16x16x64_bf16 v[148:151], v[204:207], a[240:247], v3
    buffer_load_dwordx4 a[240:243], v1, s[16:19], s50 offen offset:0 sc1
    buffer_load_dwordx4 a[244:247], v1, s[16:19], s50 offen offset:1024 sc1
    s_mov_b32 s45, 8960
    buffer_load_dwordx4 v[134:137], v11, s[16:19], s45 offen sc1
    buffer_load_dwordx2 v[138:139], v12, s[16:19], s45 offen offset:1024 sc1
    v_exp_f32 v48, v48
    v_exp_f32 v49, v49
    v_smfmac_f32_32x32x32_bf16 v[96:111], a[84:87], v[40:47], v2
    ds_write_b128 v6, v[116:119] offset:13312
    v_exp_f32 v50, v50
    v_exp_f32 v51, v51
    v_exp_f32 v52, v52
    v_mfma_f32_32x32x16_bf16 v[64:79], a[8:11], v[128:131], v[64:79]
    s_add_u32 m0, s64, 24576
    s_mov_b32 s65, 589824
    v_exp_f32 v53, v53
    v_exp_f32 v54, v54
    v_exp_f32 v55, v55
    v_mfma_f32_32x32x16_bf16 v[80:95], a[12:15], v[128:131], v[80:95]
    v_exp_f32 v56, v56
    v_exp_f32 v57, v57
    v_exp_f32 v58, v58
    v_smfmac_f32_32x32x32_bf16 v[96:111], a[88:91], v[48:55], v2
    s_waitcnt vmcnt(30)
    ds_write_b128 v6, v[120:123] offset:14336
    v_exp_f32 v59, v59
    v_exp_f32 v60, v60
    v_exp_f32 v61, v61
    v_smfmac_f32_16x16x64_bf16 v[152:155], v[204:207], a[248:255], v3
    buffer_load_dwordx4 a[248:251], v1, s[16:19], s50 offen offset:2048 sc1
    buffer_load_dwordx4 a[252:255], v1, s[16:19], s50 offen offset:3072 sc1
    buffer_load_dwordx4 v17, s[24:27], s65 offen offset:0 lds
    v_exp_f32 v62, v62
    v_exp_f32 v63, v63
    v_exp_f32 v64, v64
    v_exp_f32 v65, v65
    v_smfmac_f32_32x32x32_bf16 v[96:111], a[92:95], v[56:63], v2
    s_add_u32 s50, s49, 503808
    v_exp_f32 v66, v66
    v_exp_f32 v67, v67
    v_exp_f32 v68, v68
    v_mfma_f32_32x32x4_2b_bf16 v[32:63], a[68:69], v[132:133], 0
    v_exp_f32 v69, v69
    v_exp_f32 v70, v70
    v_exp_f32 v71, v71
    v_exp_f32 v72, v72
    v_exp_f32 v73, v73
    v_exp_f32 v74, v74
    v_exp_f32 v75, v75
    v_exp_f32 v76, v76
    v_smfmac_f32_32x32x32_bf16 v[96:111], a[96:99], v[64:71], v2
    s_waitcnt vmcnt(30)
    s_waitcnt lgkmcnt(0)
    s_barrier
    v_exp_f32 v77, v77
    v_exp_f32 v78, v78
    v_exp_f32 v79, v79
    v_smfmac_f32_16x16x64_bf16 v[156:159], v[204:207], v[208:215], v3
    buffer_load_dwordx4 v[208:211], v1, s[16:19], s50 offen offset:0 sc1
    buffer_load_dwordx4 v[212:215], v1, s[16:19], s50 offen offset:1024 sc1
    v_exp_f32 v80, v80
    v_exp_f32 v81, v81
    v_smfmac_f32_32x32x32_bf16 v[96:111], a[100:103], v[72:79], v2
    ds_read_b128 v[188:191], v7 offset:12288
    v_exp_f32 v82, v82
    v_exp_f32 v83, v83
    v_exp_f32 v84, v84
    v_mfma_f32_32x32x16_bf16 v[32:47], a[16:19], v[128:131], v[32:47]
    ds_read_b128 v[192:195], v7 offset:15360
    s_mov_b32 s65, 613376
    v_exp_f32 v85, v85
    v_exp_f32 v86, v86
    v_exp_f32 v87, v87
    v_mfma_f32_32x32x16_bf16 v[48:63], a[20:23], v[128:131], v[48:63]
    ds_read_b128 v[196:199], v7 offset:18432
    v_exp_f32 v88, v88
    v_exp_f32 v89, v89
    v_exp_f32 v90, v90
    v_smfmac_f32_32x32x32_bf16 v[96:111], a[104:107], v[80:87], v2
    ds_read_b128 v[200:203], v7 offset:21504
    v_exp_f32 v91, v91
    v_exp_f32 v92, v92
    v_exp_f32 v93, v93
    v_mfma_f32_32x32x8_bf16 v[112:127], v[4:5], v[4:5], 0
    buffer_load_dwordx4 v17, s[24:27], s65 offen offset:1024 lds
    v_exp_f32 v94, v94
    v_exp_f32 v95, v95
    v_exp_f32 v32, v32
    v_exp_f32 v33, v33
    v_smfmac_f32_32x32x32_bf16 v[96:111], a[108:111], v[88:95], v2
    v_exp_f32 v34, v34
    v_exp_f32 v35, v35
    v_exp_f32 v36, v36
    v_mfma_f32_32x32x4_2b_bf16 v[64:95], a[70:71], v[132:133], 0
    s_waitcnt lgkmcnt(0)
    v_exp_f32 v37, v37
    v_add_f32 v188, v188, v192
    v_exp_f32 v38, v38
    v_add_f32 v189, v189, v193
    v_exp_f32 v39, v39
    v_add_f32 v190, v190, v194
    v_exp_f32 v40, v40
    v_add_f32 v191, v191, v195
    v_exp_f32 v41, v41
    v_add_f32 v196, v196, v200
    v_exp_f32 v42, v42
    v_add_f32 v197, v197, v201
    v_exp_f32 v43, v43
    v_add_f32 v198, v198, v202
    v_exp_f32 v44, v44
    v_add_f32 v199, v199, v203
    v_smfmac_f32_32x32x32_bf16 v[96:111], a[112:115], v[32:39], v2
    s_waitcnt vmcnt(31)
    v_exp_f32 v45, v45
    v_add_f32 v188, v188, v196
    v_exp_f32 v46, v46
    v_add_f32 v189, v189, v197
    v_exp_f32 v47, v47
    v_add_f32 v190, v190, v198
    v_smfmac_f32_16x16x64_bf16 v[160:163], v[204:207], v[216:223], v3
    buffer_load_dwordx4 v[216:219], v1, s[16:19], s50 offen offset:2048 sc1
    buffer_load_dwordx4 v[220:223], v1, s[16:19], s50 offen offset:3072 sc1
    v_exp_f32 v48, v48
    v_rcp_f32_dpp v192, v188 quad_perm:[3,3,3,3] row_mask:0xf bank_mask:0xf
    v_exp_f32 v49, v49
    v_add_f32 v191, v191, v199
    v_smfmac_f32_32x32x32_bf16 v[96:111], a[116:119], v[40:47], v2
    s_add_u32 s50, s49, 507904
    v_exp_f32 v50, v50
    v_mul_f32 v188, v188, v192
    v_exp_f32 v51, v51
    v_mul_f32 v189, v189, v192
    v_exp_f32 v52, v52
    v_mul_f32 v190, v190, v192
    v_mfma_f32_32x32x16_bf16 v[64:79], a[24:27], v[128:131], v[64:79]
    s_mov_b32 s65, 636928
    v_exp_f32 v53, v53
    v_mul_f32 v191, v191, v192
    v_exp_f32 v54, v54
    v_cvt_pk_bf16_f32 v188, v188, v189
    v_exp_f32 v55, v55
    v_cvt_pk_bf16_f32 v189, v190, v191
    v_mfma_f32_32x32x16_bf16 v[80:95], a[28:31], v[128:131], v[80:95]
    v_exp_f32 v56, v56
    v_subrev_u32 v192, 528482304, v192
    v_exp_f32 v57, v57
    v_max_u32 v10, v10, v192
    v_exp_f32 v58, v58
    v_smfmac_f32_32x32x32_bf16 v[96:111], a[120:123], v[48:55], v2
    s_waitcnt vmcnt(30)
    ds_write2_b32 v8, v188, v189 offset0:0 offset1:32
    v_add_u32 v8, v9, v8
    v_exp_f32 v59, v59
    v_exp_f32 v60, v60
    v_exp_f32 v61, v61
    v_smfmac_f32_16x16x64_bf16 v[164:167], v[204:207], v[224:231], v3
    buffer_load_dwordx4 v[224:227], v1, s[16:19], s50 offen offset:0 sc1
    buffer_load_dwordx4 v[228:231], v1, s[16:19], s50 offen offset:1024 sc1
    buffer_load_dwordx4 v17, s[24:27], s65 offen offset:2048 lds
    v_exp_f32 v62, v62
    v_exp_f32 v63, v63
    v_exp_f32 v64, v64
    v_exp_f32 v65, v65
    v_smfmac_f32_32x32x32_bf16 v[96:111], a[124:127], v[56:63], v2
    v_exp_f32 v66, v66
    v_exp_f32 v67, v67
    v_exp_f32 v68, v68
    v_mfma_f32_32x32x4_2b_bf16 v[32:63], a[72:73], v[132:133], 0
    v_exp_f32 v69, v69
    v_exp_f32 v70, v70
    v_exp_f32 v71, v71
    v_exp_f32 v72, v72
    v_exp_f32 v73, v73
    v_exp_f32 v74, v74
    v_exp_f32 v75, v75
    v_exp_f32 v76, v76
    v_smfmac_f32_32x32x32_bf16 v[96:111], a[128:131], v[64:71], v2
    s_waitcnt vmcnt(31)
    s_waitcnt lgkmcnt(0)
    s_barrier
    v_exp_f32 v77, v77
    v_exp_f32 v78, v78
    v_exp_f32 v79, v79
    v_smfmac_f32_16x16x64_bf16 v[168:171], v[204:207], v[232:239], v3
    buffer_load_dwordx4 v[232:235], v1, s[16:19], s50 offen offset:2048 sc1
    buffer_load_dwordx4 v[236:239], v1, s[16:19], s50 offen offset:3072 sc1
    v_exp_f32 v80, v80
    v_exp_f32 v81, v81
    v_smfmac_f32_32x32x32_bf16 v[96:111], a[132:135], v[72:79], v2
    s_add_u32 s50, s49, 573440
    ds_read_b128 v[180:183], v1 offset:25600
    v_exp_f32 v82, v82
    v_exp_f32 v83, v83
    v_exp_f32 v84, v84
    v_mfma_f32_32x32x16_bf16 v[32:47], a[32:35], v[128:131], v[32:47]
    s_mov_b32 s65, 660480
    v_exp_f32 v85, v85
    v_exp_f32 v86, v86
    v_exp_f32 v87, v87
    v_mfma_f32_32x32x16_bf16 v[48:63], a[36:39], v[128:131], v[48:63]
    v_exp_f32 v88, v88
    v_exp_f32 v89, v89
    v_exp_f32 v90, v90
    v_smfmac_f32_32x32x32_bf16 v[96:111], a[136:139], v[80:87], v2
    s_waitcnt lgkmcnt(0)
    s_waitcnt vmcnt(30)
    v_exp_f32 v91, v91
    v_exp_f32 v92, v92
    v_exp_f32 v93, v93
    v_smfmac_f32_16x16x64_bf16 v[172:175], v[204:207], v[240:247], v3
    buffer_load_dwordx4 v[240:243], v1, s[16:19], s50 offen offset:0 sc1
    buffer_load_dwordx4 v[244:247], v1, s[16:19], s50 offen offset:1024 sc1
    buffer_load_dwordx4 v17, s[24:27], s65 offen offset:3072 lds
    v_exp_f32 v94, v94
    v_exp_f32 v95, v95
    v_exp_f32 v32, v32
    v_exp_f32 v33, v33
    v_smfmac_f32_32x32x32_bf16 v[96:111], a[140:143], v[88:95], v2
    s_load_dwordx2 s[58:59], s[86:87], 21564
    v_exp_f32 v34, v34
    v_exp_f32 v35, v35
    v_exp_f32 v36, v36
    v_mfma_f32_32x32x4_2b_bf16 v[64:95], a[74:75], v[132:133], 0
    v_exp_f32 v37, v37
    v_exp_f32 v38, v38
    v_exp_f32 v39, v39
    v_exp_f32 v40, v40
    v_exp_f32 v41, v41
    v_exp_f32 v42, v42
    v_exp_f32 v43, v43
    v_exp_f32 v44, v44
    v_smfmac_f32_32x32x32_bf16 v[96:111], a[144:147], v[32:39], v2
    s_waitcnt vmcnt(31)
    s_load_dwordx2 s[58:59], s[86:87], 22076
    v_exp_f32 v45, v45
    v_exp_f32 v46, v46
    v_exp_f32 v47, v47
    v_smfmac_f32_16x16x64_bf16 v[176:179], v[204:207], v[248:255], v3
    buffer_load_dwordx4 v[248:251], v1, s[16:19], s50 offen offset:2048 sc1
    buffer_load_dwordx4 v[252:255], v1, s[16:19], s50 offen offset:3072 sc1
    v_exp_f32 v48, v48
    v_exp_f32 v49, v49
    v_smfmac_f32_32x32x32_bf16 v[96:111], a[148:151], v[40:47], v2
    s_add_u32 s50, s49, 577536
    s_load_dwordx2 s[58:59], s[86:87], 22588
    v_exp_f32 v50, v50
    v_exp_f32 v51, v51
    v_exp_f32 v52, v52
    v_mfma_f32_32x32x16_bf16 v[64:79], a[40:43], v[128:131], v[64:79]
    s_add_u32 m0, s64, 28672
    s_mov_b32 s65, 688128
    v_exp_f32 v53, v53
    v_exp_f32 v54, v54
    v_exp_f32 v55, v55
    v_mfma_f32_32x32x16_bf16 v[80:95], a[44:47], v[128:131], v[80:95]
    s_load_dwordx2 s[58:59], s[86:87], 23100
    v_exp_f32 v56, v56
    v_exp_f32 v57, v57
    v_exp_f32 v58, v58
    v_smfmac_f32_32x32x32_bf16 v[96:111], a[152:155], v[48:55], v2
    s_waitcnt vmcnt(30)
    s_load_dwordx2 s[58:59], s[86:87], 23612
    v_exp_f32 v59, v59
    v_exp_f32 v60, v60
    v_exp_f32 v61, v61
    v_smfmac_f32_16x16x64_bf16 v[140:143], v[180:183], a[208:215], v3
    buffer_load_dwordx4 a[208:211], v1, s[16:19], s50 offen offset:0 sc1
    buffer_load_dwordx4 a[212:215], v1, s[16:19], s50 offen offset:1024 sc1
    buffer_load_dwordx4 v17, s[24:27], s65 offen offset:0 lds
    v_exp_f32 v62, v62
    v_exp_f32 v63, v63
    v_exp_f32 v64, v64
    v_exp_f32 v65, v65
    v_smfmac_f32_32x32x32_bf16 v[96:111], a[156:159], v[56:63], v2
    s_load_dwordx2 s[58:59], s[86:87], 24124
    v_exp_f32 v66, v66
    v_exp_f32 v67, v67
    v_exp_f32 v68, v68
    v_mfma_f32_32x32x4_2b_bf16 v[32:63], a[76:77], v[132:133], 0
    v_exp_f32 v69, v69
    v_exp_f32 v70, v70
    v_exp_f32 v71, v71
    v_exp_f32 v72, v72
    v_exp_f32 v73, v73
    v_exp_f32 v74, v74
    v_exp_f32 v75, v75
    v_exp_f32 v76, v76
    v_smfmac_f32_32x32x32_bf16 v[96:111], a[160:163], v[64:71], v2
    s_waitcnt vmcnt(31)
    v_exp_f32 v77, v77
    v_exp_f32 v78, v78
    v_exp_f32 v79, v79
    v_smfmac_f32_16x16x64_bf16 v[144:147], v[180:183], a[216:223], v3
    buffer_load_dwordx4 a[216:219], v1, s[16:19], s50 offen offset:2048 sc1
    buffer_load_dwordx4 a[220:223], v1, s[16:19], s50 offen offset:3072 sc1
    v_exp_f32 v80, v80
    v_exp_f32 v81, v81
    v_smfmac_f32_32x32x32_bf16 v[96:111], a[164:167], v[72:79], v2
    s_add_u32 s50, s49, 581632
    v_exp_f32 v82, v82
    v_exp_f32 v83, v83
    v_exp_f32 v84, v84
    v_mfma_f32_32x32x16_bf16 v[32:47], a[48:51], v[128:131], v[32:47]
    s_mov_b32 s65, 711680
    v_exp_f32 v85, v85
    v_exp_f32 v86, v86
    v_exp_f32 v87, v87
    v_mfma_f32_32x32x16_bf16 v[48:63], a[52:55], v[128:131], v[48:63]
    v_exp_f32 v88, v88
    v_exp_f32 v89, v89
    v_exp_f32 v90, v90
    v_smfmac_f32_32x32x32_bf16 v[96:111], a[168:171], v[80:87], v2
    s_waitcnt vmcnt(30)
    v_exp_f32 v91, v91
    v_exp_f32 v92, v92
    v_exp_f32 v93, v93
    v_smfmac_f32_16x16x64_bf16 v[148:151], v[180:183], a[224:231], v3
    buffer_load_dwordx4 a[224:227], v1, s[16:19], s50 offen offset:0 sc1
    buffer_load_dwordx4 a[228:231], v1, s[16:19], s50 offen offset:1024 sc1
    buffer_load_dwordx4 v17, s[24:27], s65 offen offset:1024 lds
    v_exp_f32 v94, v94
    v_exp_f32 v95, v95
    v_exp_f32 v32, v32
    v_exp_f32 v33, v33
    v_smfmac_f32_32x32x32_bf16 v[96:111], a[172:175], v[88:95], v2
    v_exp_f32 v34, v34
    v_exp_f32 v35, v35
    v_exp_f32 v36, v36
    v_mfma_f32_32x32x4_2b_bf16 v[64:95], a[78:79], v[132:133], 0
    v_exp_f32 v37, v37
    v_exp_f32 v38, v38
    v_exp_f32 v39, v39
    v_exp_f32 v40, v40
    v_exp_f32 v41, v41
    v_exp_f32 v42, v42
    v_exp_f32 v43, v43
    v_exp_f32 v44, v44
    v_smfmac_f32_32x32x32_bf16 v[96:111], a[176:179], v[32:39], v2
    s_waitcnt vmcnt(31)
    v_exp_f32 v45, v45
    v_exp_f32 v46, v46
    v_exp_f32 v47, v47
    v_smfmac_f32_16x16x64_bf16 v[152:155], v[180:183], a[232:239], v3
    buffer_load_dwordx4 a[232:235], v1, s[16:19], s50 offen offset:2048 sc1
    buffer_load_dwordx4 a[236:239], v1, s[16:19], s50 offen offset:3072 sc1
    v_exp_f32 v48, v48
    v_exp_f32 v49, v49
    v_smfmac_f32_32x32x32_bf16 v[96:111], a[180:183], v[40:47], v2
    s_add_u32 s50, s49, 585728
    v_exp_f32 v50, v50
    v_exp_f32 v51, v51
    v_exp_f32 v52, v52
    v_mfma_f32_32x32x16_bf16 v[64:79], a[56:59], v[128:131], v[64:79]
    s_mov_b32 s65, 735232
    v_exp_f32 v53, v53
    v_exp_f32 v54, v54
    v_exp_f32 v55, v55
    v_mfma_f32_32x32x16_bf16 v[80:95], a[60:63], v[128:131], v[80:95]
    v_exp_f32 v56, v56
    v_exp_f32 v57, v57
    v_exp_f32 v58, v58
    v_smfmac_f32_32x32x32_bf16 v[96:111], a[184:187], v[48:55], v2
    s_waitcnt vmcnt(30)
    v_exp_f32 v59, v59
    v_exp_f32 v60, v60
    v_exp_f32 v61, v61
    v_smfmac_f32_16x16x64_bf16 v[156:159], v[180:183], a[240:247], v3
    buffer_load_dwordx4 a[240:243], v1, s[16:19], s50 offen offset:0 sc1
    buffer_load_dwordx4 a[244:247], v1, s[16:19], s50 offen offset:1024 sc1
    buffer_load_dwordx4 v17, s[24:27], s65 offen offset:2048 lds
    v_exp_f32 v62, v62
    v_exp_f32 v63, v63
    v_exp_f32 v64, v64
    v_exp_f32 v65, v65
    v_smfmac_f32_32x32x32_bf16 v[96:111], a[188:191], v[56:63], v2
    s_waitcnt vmcnt(31)
    v_exp_f32 v66, v66
    v_exp_f32 v67, v67
    v_exp_f32 v68, v68
    v_mfma_f32_32x32x4_2b_bf16 v[32:63], a[64:65], v[138:139], 0
    v_exp_f32 v69, v69
    v_exp_f32 v70, v70
    v_exp_f32 v71, v71
    v_exp_f32 v72, v72
    v_exp_f32 v73, v73
    v_exp_f32 v74, v74
    v_exp_f32 v75, v75
    v_exp_f32 v76, v76
    v_smfmac_f32_32x32x32_bf16 v[96:111], a[192:195], v[64:71], v2
    s_waitcnt vmcnt(29)
    v_exp_f32 v77, v77
    v_exp_f32 v78, v78
    v_exp_f32 v79, v79
    v_smfmac_f32_16x16x64_bf16 v[160:163], v[180:183], a[248:255], v3
    buffer_load_dwordx4 a[248:251], v1, s[16:19], s50 offen offset:2048 sc1
    buffer_load_dwordx4 a[252:255], v1, s[16:19], s50 offen offset:3072 sc1
    v_exp_f32 v80, v80
    v_exp_f32 v81, v81
    v_smfmac_f32_32x32x32_bf16 v[96:111], a[196:199], v[72:79], v2
    s_add_u32 s50, s49, 589824
    v_exp_f32 v82, v82
    v_exp_f32 v83, v83
    v_exp_f32 v84, v84
    v_mfma_f32_32x32x16_bf16 v[32:47], a[0:3], v[134:137], v[32:47]
    s_mov_b32 s65, 758784
    v_exp_f32 v85, v85
    v_exp_f32 v86, v86
    v_exp_f32 v87, v87
    v_mfma_f32_32x32x16_bf16 v[48:63], a[4:7], v[134:137], v[48:63]
    v_exp_f32 v88, v88
    v_exp_f32 v89, v89
    v_exp_f32 v90, v90
    v_smfmac_f32_32x32x32_bf16 v[96:111], a[200:203], v[80:87], v2
    s_waitcnt vmcnt(28)
    v_exp_f32 v91, v91
    v_exp_f32 v92, v92
    v_exp_f32 v93, v93
    v_smfmac_f32_16x16x64_bf16 v[164:167], v[180:183], v[208:215], v3
    buffer_load_dwordx4 v[208:211], v1, s[16:19], s50 offen offset:0 sc1
    buffer_load_dwordx4 v[212:215], v1, s[16:19], s50 offen offset:1024 sc1
    buffer_load_dwordx4 v17, s[24:27], s65 offen offset:3072 lds
    v_exp_f32 v94, v94
    v_exp_f32 v95, v95
    v_exp_f32 v32, v32
    v_exp_f32 v33, v33
    v_smfmac_f32_32x32x32_bf16 v[96:111], a[204:207], v[88:95], v2
    s_add_u32 s53, s49, 741376
    buffer_load_dwordx4 a[0:3], v1, s[16:19], s53 offen offset:0 sc1
    buffer_load_dwordx4 a[4:7], v1, s[16:19], s53 offen offset:1024 sc1
    v_exp_f32 v34, v34
    v_exp_f32 v35, v35
    v_exp_f32 v36, v36
    v_mfma_f32_32x32x4_2b_bf16 v[64:95], a[66:67], v[138:139], 0
    v_exp_f32 v37, v37
    v_exp_f32 v38, v38
    v_exp_f32 v39, v39
    v_exp_f32 v40, v40
    v_exp_f32 v41, v41
    v_exp_f32 v42, v42
    v_exp_f32 v43, v43
    v_exp_f32 v44, v44
    v_smfmac_f32_32x32x32_bf16 v[112:127], a[80:83], v[32:39], v2
    s_waitcnt vmcnt(30)
    ds_write_b128 v6, v[96:99] offset:0
    v_exp_f32 v45, v45
    v_exp_f32 v46, v46
    v_exp_f32 v47, v47
    v_smfmac_f32_16x16x64_bf16 v[168:171], v[180:183], v[216:223], v3
    buffer_load_dwordx4 v[216:219], v1, s[16:19], s50 offen offset:2048 sc1
    buffer_load_dwordx4 v[220:223], v1, s[16:19], s50 offen offset:3072 sc1
    v_exp_f32 v48, v48
    v_exp_f32 v49, v49
    v_smfmac_f32_32x32x32_bf16 v[112:127], a[84:87], v[40:47], v2
    s_add_u32 s50, s49, 655360
    ds_write_b128 v6, v[100:103] offset:1024
    v_exp_f32 v50, v50
    v_exp_f32 v51, v51
    v_exp_f32 v52, v52
    v_mfma_f32_32x32x16_bf16 v[64:79], a[8:11], v[134:137], v[64:79]
    v_exp_f32 v53, v53
    v_exp_f32 v54, v54
    v_exp_f32 v55, v55
    v_mfma_f32_32x32x16_bf16 v[80:95], a[12:15], v[134:137], v[80:95]
    v_exp_f32 v56, v56
    v_exp_f32 v57, v57
    v_exp_f32 v58, v58
    v_smfmac_f32_32x32x32_bf16 v[112:127], a[88:91], v[48:55], v2
    s_waitcnt vmcnt(30)
    ds_write_b128 v6, v[104:107] offset:2048
    v_exp_f32 v59, v59
    v_exp_f32 v60, v60
    v_exp_f32 v61, v61
    v_smfmac_f32_16x16x64_bf16 v[172:175], v[180:183], v[224:231], v3
    buffer_load_dwordx4 v[224:227], v1, s[16:19], s50 offen offset:0 sc1
    buffer_load_dwordx4 v[228:231], v1, s[16:19], s50 offen offset:1024 sc1
    v_exp_f32 v62, v62
    v_exp_f32 v63, v63
    v_exp_f32 v64, v64
    v_exp_f32 v65, v65
    v_smfmac_f32_32x32x32_bf16 v[112:127], a[92:95], v[56:63], v2
    buffer_load_dwordx4 a[8:11], v1, s[16:19], s53 offen offset:2048 sc1
    buffer_load_dwordx4 a[12:15], v1, s[16:19], s53 offen offset:3072 sc1
    v_exp_f32 v66, v66
    v_exp_f32 v67, v67
    v_exp_f32 v68, v68
    v_mfma_f32_32x32x4_2b_bf16 v[32:63], a[68:69], v[138:139], 0
    v_exp_f32 v69, v69
    v_exp_f32 v70, v70
    v_exp_f32 v71, v71
    v_exp_f32 v72, v72
    v_exp_f32 v73, v73
    v_exp_f32 v74, v74
    v_exp_f32 v75, v75
    v_exp_f32 v76, v76
    v_smfmac_f32_32x32x32_bf16 v[112:127], a[96:99], v[64:71], v2
    s_waitcnt vmcnt(31)
    s_waitcnt lgkmcnt(0)
    s_barrier
    ds_read_b64_tr_b16 a[80:81], v18 offset:0
    ds_read_b64_tr_b16 a[82:83], v18 offset:512
    v_exp_f32 v77, v77
    v_exp_f32 v78, v78
    v_exp_f32 v79, v79
    v_smfmac_f32_16x16x64_bf16 v[176:179], v[180:183], v[232:239], v3
    buffer_load_dwordx4 v[232:235], v1, s[16:19], s50 offen offset:2048 sc1
    buffer_load_dwordx4 v[236:239], v1, s[16:19], s50 offen offset:3072 sc1
    v_exp_f32 v80, v80
    v_exp_f32 v81, v81
    v_smfmac_f32_32x32x32_bf16 v[112:127], a[100:103], v[72:79], v2
    s_add_u32 s50, s49, 659456
    ds_read_b128 v[188:191], v7 offset:0
    ds_read_b64_tr_b16 a[84:85], v19 offset:0
    ds_read_b64_tr_b16 a[86:87], v19 offset:512
    v_exp_f32 v82, v82
    v_exp_f32 v83, v83
    v_exp_f32 v84, v84
    v_mfma_f32_32x32x16_bf16 v[32:47], a[16:19], v[134:137], v[32:47]
    ds_read_b128 v[192:195], v7 offset:3072
    v_exp_f32 v85, v85
    v_exp_f32 v86, v86
    v_exp_f32 v87, v87
    v_mfma_f32_32x32x16_bf16 v[48:63], a[20:23], v[134:137], v[48:63]
    ds_read_b128 v[196:199], v7 offset:6144
    ds_read_b64_tr_b16 a[88:89], v18 offset:2048
    ds_read_b64_tr_b16 a[90:91], v18 offset:2560
    v_exp_f32 v88, v88
    v_exp_f32 v89, v89
    v_exp_f32 v90, v90
    v_smfmac_f32_32x32x32_bf16 v[112:127], a[104:107], v[80:87], v2
    ds_read_b128 v[200:203], v7 offset:9216
L_hop5:
    s_cbranch_execz L_hop_back
    ds_read_b64_tr_b16 a[92:93], v19 offset:2048
    ds_read_b64_tr_b16 a[94:95], v19 offset:2560
    v_exp_f32 v91, v91
    v_exp_f32 v92, v92
    v_exp_f32 v93, v93
    v_exp_f32 v94, v94
    v_exp_f32 v95, v95
    v_exp_f32 v32, v32
    v_exp_f32 v33, v33
    v_smfmac_f32_32x32x32_bf16 v[112:127], a[108:111], v[88:95], v2
    s_add_u32 s53, s49, 745472
    buffer_load_dwordx4 a[16:19], v1, s[16:19], s53 offen offset:0 sc1
    buffer_load_dwordx4 a[20:23], v1, s[16:19], s53 offen offset:1024 sc1
    s_waitcnt lgkmcnt(7)
    s_add_u32 m0, s64, 0
    s_mov_b32 s65, 786432
    buffer_load_dwordx4 v17, s[24:27], s65 offen offset:0 lds
    s_mov_b32 s65, 809984
    buffer_load_dwordx4 v17, s[24:27], s65 offen offset:1024 lds
    v_exp_f32 v34, v34
    v_exp_f32 v35, v35
    v_exp_f32 v36, v36
    v_mfma_f32_32x32x4_2b_bf16 v[64:95], a[70:71], v[138:139], 0
    s_waitcnt lgkmcnt(0)
    v_exp_f32 v37, v37
    v_add_f32 v188, v188, v192
    v_exp_f32 v38, v38
    v_add_f32 v189, v189, v193
    v_exp_f32 v39, v39
    v_add_f32 v190, v190, v194
    v_exp_f32 v40, v40
    v_add_f32 v191, v191, v195
    v_exp_f32 v41, v41
    v_add_f32 v196, v196, v200
    v_exp_f32 v42, v42
    v_add_f32 v197, v197, v201
    v_exp_f32 v43, v43
    v_add_f32 v198, v198, v202
    v_exp_f32 v44, v44
    v_add_f32 v199, v199, v203
    v_smfmac_f32_32x32x32_bf16 v[112:127], a[112:115], v[32:39], v2
    ds_read_b64_tr_b16 a[96:97], v18 offset:4096
    ds_read_b64_tr_b16 a[98:99], v18 offset:4608
    v_exp_f32 v45, v45
    v_add_f32 v188, v188, v196
    v_exp_f32 v46, v46
    v_add_f32 v189, v189, v197
    v_exp_f32 v47, v47
    v_add_f32 v190, v190, v198
    v_exp_f32 v48, v48
    v_rcp_f32_dpp v192, v188 quad_perm:[3,3,3,3] row_mask:0xf bank_mask:0xf
    v_exp_f32 v49, v49
    v_add_f32 v191, v191, v199
    v_smfmac_f32_32x32x32_bf16 v[112:127], a[116:119], v[40:47], v2
    ds_read_b64_tr_b16 a[100:101], v19 offset:4096
    ds_read_b64_tr_b16 a[102:103], v19 offset:4608
    v_exp_f32 v50, v50
    v_mul_f32 v188, v188, v192
    v_exp_f32 v51, v51
    v_mul_f32 v189, v189, v192
    v_exp_f32 v52, v52
    v_mul_f32 v190, v190, v192
    v_mfma_f32_32x32x16_bf16 v[64:79], a[24:27], v[134:137], v[64:79]
    s_mov_b32 s65, 833536
    buffer_load_dwordx4 v17, s[24:27], s65 offen offset:2048 lds
    s_mov_b32 s65, 857088
    buffer_load_dwordx4 v17, s[24:27], s65 offen offset:3072 lds
    v_exp_f32 v53, v53
    v_mul_f32 v191, v191, v192
    v_exp_f32 v54, v54
    v_cvt_pk_bf16_f32 v188, v188, v189
    v_exp_f32 v55, v55
    v_cvt_pk_bf16_f32 v189, v190, v191
    v_mfma_f32_32x32x16_bf16 v[80:95], a[28:31], v[134:137], v[80:95]
    ds_read_b64_tr_b16 a[104:105], v18 offset:6144
    ds_read_b64_tr_b16 a[106:107], v18 offset:6656
    v_exp_f32 v56, v56
    v_subrev_u32 v192, 528482304, v192
    v_exp_f32 v57, v57
    v_max_u32 v10, v10, v192
    v_exp_f32 v58, v58
    v_smfmac_f32_32x32x32_bf16 v[112:127], a[120:123], v[48:55], v2
    ds_write2_b32 v8, v188, v189 offset0:0 offset1:32
    v_add_u32 v8, v9, v8
    ds_read_b64_tr_b16 a[108:109], v19 offset:6144
    ds_read_b64_tr_b16 a[110:111], v19 offset:6656
    v_exp_f32 v59, v59
    v_exp_f32 v60, v60
    v_exp_f32 v61, v61
    v_exp_f32 v62, v62
    v_exp_f32 v63, v63
    v_exp_f32 v64, v64
    v_exp_f32 v65, v65
    v_smfmac_f32_32x32x32_bf16 v[112:127], a[124:127], v[56:63], v2
    buffer_load_dwordx4 a[24:27], v1, s[16:19], s53 offen offset:2048 sc1
    buffer_load_dwordx4 a[28:31], v1, s[16:19], s53 offen offset:3072 sc1
    s_waitcnt lgkmcnt(5)
    s_add_u32 m0, s64, 4096
    s_mov_b32 s65, 884736
    buffer_load_dwordx4 v17, s[24:27], s65 offen offset:0 lds
    v_exp_f32 v66, v66
    v_exp_f32 v67, v67
    v_exp_f32 v68, v68
    v_mfma_f32_32x32x4_2b_bf16 v[32:63], a[72:73], v[138:139], 0
    v_exp_f32 v69, v69
    v_exp_f32 v70, v70
    v_exp_f32 v71, v71
    v_exp_f32 v72, v72
    v_exp_f32 v73, v73
    v_exp_f32 v74, v74
    v_exp_f32 v75, v75
    v_exp_f32 v76, v76
    v_smfmac_f32_32x32x32_bf16 v[112:127], a[128:131], v[64:71], v2
    s_waitcnt lgkmcnt(0)
    s_barrier
    ds_read_b64_tr_b16 a[112:113], v18 offset:8192
    ds_read_b64_tr_b16 a[114:115], v18 offset:8704
    v_exp_f32 v77, v77
    v_exp_f32 v78, v78
    v_exp_f32 v79, v79
    v_exp_f32 v80, v80
    v_exp_f32 v81, v81
    v_smfmac_f32_32x32x32_bf16 v[112:127], a[132:135], v[72:79], v2
    ds_read_b128 v[184:187], v1 offset:26624
    ds_read_b64_tr_b16 a[116:117], v19 offset:8192
    ds_read_b64_tr_b16 a[118:119], v19 offset:8704
    v_exp_f32 v82, v82
    v_exp_f32 v83, v83
    v_exp_f32 v84, v84
    v_mfma_f32_32x32x16_bf16 v[32:47], a[32:35], v[134:137], v[32:47]
    s_mov_b32 s65, 908288
    buffer_load_dwordx4 v17, s[24:27], s65 offen offset:1024 lds
    v_exp_f32 v85, v85
    v_exp_f32 v86, v86
    v_exp_f32 v87, v87
    v_mfma_f32_32x32x16_bf16 v[48:63], a[36:39], v[134:137], v[48:63]
    ds_read_b64_tr_b16 a[120:121], v18 offset:10240
    ds_read_b64_tr_b16 a[122:123], v18 offset:10752
    v_exp_f32 v88, v88
    v_exp_f32 v89, v89
    v_exp_f32 v90, v90
    v_smfmac_f32_32x32x32_bf16 v[112:127], a[136:139], v[80:87], v2
    s_waitcnt lgkmcnt(0)
    s_waitcnt vmcnt(41)
    ds_read_b64_tr_b16 a[124:125], v19 offset:10240
    ds_read_b64_tr_b16 a[126:127], v19 offset:10752
    v_exp_f32 v91, v91
    v_exp_f32 v92, v92
    v_exp_f32 v93, v93
    v_smfmac_f32_16x16x64_bf16 v[140:143], v[184:187], v[240:247], v3
    buffer_load_dwordx4 v[240:243], v1, s[16:19], s50 offen offset:0 sc1
    buffer_load_dwordx4 v[244:247], v1, s[16:19], s50 offen offset:1024 sc1
    v_exp_f32 v94, v94
    v_exp_f32 v95, v95
    v_exp_f32 v32, v32
    v_exp_f32 v33, v33
    v_smfmac_f32_32x32x32_bf16 v[112:127], a[140:143], v[88:95], v2
    s_add_u32 s53, s49, 749568
    buffer_load_dwordx4 a[32:35], v1, s[16:19], s53 offen offset:0 sc1
    buffer_load_dwordx4 a[36:39], v1, s[16:19], s53 offen offset:1024 sc1
    v_exp_f32 v34, v34
    v_exp_f32 v35, v35
    v_exp_f32 v36, v36
    v_mfma_f32_32x32x4_2b_bf16 v[64:95], a[74:75], v[138:139], 0
    v_exp_f32 v37, v37
    v_exp_f32 v38, v38
    v_exp_f32 v39, v39
    v_exp_f32 v40, v40
    v_exp_f32 v41, v41
    v_exp_f32 v42, v42
    v_exp_f32 v43, v43
    v_exp_f32 v44, v44
    v_smfmac_f32_32x32x32_bf16 v[112:127], a[144:147], v[32:39], v2
    s_waitcnt vmcnt(42)
    ds_read_b64_tr_b16 a[128:129], v18 offset:12288
    ds_read_b64_tr_b16 a[130:131], v18 offset:12800
    v_exp_f32 v45, v45
    v_exp_f32 v46, v46
    v_exp_f32 v47, v47
    v_smfmac_f32_16x16x64_bf16 v[144:147], v[184:187], v[248:255], v3
    buffer_load_dwordx4 v[248:251], v1, s[16:19], s50 offen offset:2048 sc1
    buffer_load_dwordx4 v[252:255], v1, s[16:19], s50 offen offset:3072 sc1
    v_exp_f32 v48, v48
    v_exp_f32 v49, v49
    v_smfmac_f32_32x32x32_bf16 v[112:127], a[148:151], v[40:47], v2
    s_add_u32 s50, s49, 663552
    ds_read_b64_tr_b16 a[132:133], v19 offset:12288
    ds_read_b64_tr_b16 a[134:135], v19 offset:12800
    v_exp_f32 v50, v50
    v_exp_f32 v51, v51
    v_exp_f32 v52, v52
    v_mfma_f32_32x32x16_bf16 v[64:79], a[40:43], v[134:137], v[64:79]
    v_exp_f32 v53, v53
    v_exp_f32 v54, v54
    v_exp_f32 v55, v55
    v_mfma_f32_32x32x16_bf16 v[80:95], a[44:47], v[134:137], v[80:95]
    ds_read_b64_tr_b16 a[136:137], v18 offset:14336
    ds_read_b64_tr_b16 a[138:139], v18 offset:14848
    v_exp_f32 v56, v56
    v_exp_f32 v57, v57
    v_exp_f32 v58, v58
    v_smfmac_f32_32x32x32_bf16 v[112:127], a[152:155], v[48:55], v2
    s_waitcnt vmcnt(42)
    ds_read_b64_tr_b16 a[140:141], v19 offset:14336
    ds_read_b64_tr_b16 a[142:143], v19 offset:14848
    v_exp_f32 v59, v59
    v_exp_f32 v60, v60
    v_exp_f32 v61, v61
    v_smfmac_f32_16x16x64_bf16 v[148:151], v[184:187], a[208:215], v3
    buffer_load_dwordx4 a[208:211], v1, s[16:19], s50 offen offset:0 sc1
    buffer_load_dwordx4 a[212:215], v1, s[16:19], s50 offen offset:1024 sc1
    v_exp_f32 v62, v62
    v_exp_f32 v63, v63
    v_exp_f32 v64, v64
    v_exp_f32 v65, v65
    v_smfmac_f32_32x32x32_bf16 v[112:127], a[156:159], v[56:63], v2
    buffer_load_dwordx4 a[40:43], v1, s[16:19], s53 offen offset:2048 sc1
    buffer_load_dwordx4 a[44:47], v1, s[16:19], s53 offen offset:3072 sc1
    v_exp_f32 v66, v66
    v_exp_f32 v67, v67
    v_exp_f32 v68, v68
    v_mfma_f32_32x32x4_2b_bf16 v[32:63], a[76:77], v[138:139], 0
    v_exp_f32 v69, v69
    v_exp_f32 v70, v70
    v_exp_f32 v71, v71
    v_exp_f32 v72, v72
    v_exp_f32 v73, v73
    v_exp_f32 v74, v74
    v_exp_f32 v75, v75
    v_exp_f32 v76, v76
    v_smfmac_f32_32x32x32_bf16 v[112:127], a[160:163], v[64:71], v2
    s_waitcnt vmcnt(43)
    ds_read_b64_tr_b16 a[144:145], v18 offset:16384
    ds_read_b64_tr_b16 a[146:147], v18 offset:16896
    v_exp_f32 v77, v77
    v_exp_f32 v78, v78
    v_exp_f32 v79, v79
    v_smfmac_f32_16x16x64_bf16 v[152:155], v[184:187], a[216:223], v3
    buffer_load_dwordx4 a[216:219], v1, s[16:19], s50 offen offset:2048 sc1
    buffer_load_dwordx4 a[220:223], v1, s[16:19], s50 offen offset:3072 sc1
    v_exp_f32 v80, v80
    v_exp_f32 v81, v81
    v_smfmac_f32_32x32x32_bf16 v[112:127], a[164:167], v[72:79], v2
    s_add_u32 s50, s49, 667648
    ds_read_b64_tr_b16 a[148:149], v19 offset:16384
    ds_read_b64_tr_b16 a[150:151], v19 offset:16896
    v_exp_f32 v82, v82
    v_exp_f32 v83, v83
    v_exp_f32 v84, v84
    v_mfma_f32_32x32x16_bf16 v[32:47], a[48:51], v[134:137], v[32:47]
    v_exp_f32 v85, v85
    v_exp_f32 v86, v86
    v_exp_f32 v87, v87
    v_mfma_f32_32x32x16_bf16 v[48:63], a[52:55], v[134:137], v[48:63]
    ds_read_b64_tr_b16 a[152:153], v18 offset:18432
    ds_read_b64_tr_b16 a[154:155], v18 offset:18944
    v_exp_f32 v88, v88
    v_exp_f32 v89, v89
    v_exp_f32 v90, v90
    v_smfmac_f32_32x32x32_bf16 v[112:127], a[168:171], v[80:87], v2
    s_waitcnt vmcnt(43)
    ds_read_b64_tr_b16 a[156:157], v19 offset:18432
    ds_read_b64_tr_b16 a[158:159], v19 offset:18944
    v_exp_f32 v91, v91
    v_exp_f32 v92, v92
    v_exp_f32 v93, v93
    v_smfmac_f32_16x16x64_bf16 v[156:159], v[184:187], a[224:231], v3
    buffer_load_dwordx4 a[224:227], v1, s[16:19], s50 offen offset:0 sc1
    buffer_load_dwordx4 a[228:231], v1, s[16:19], s50 offen offset:1024 sc1
    v_exp_f32 v94, v94
    v_exp_f32 v95, v95
    v_exp_f32 v32, v32
    v_exp_f32 v33, v33
    v_smfmac_f32_32x32x32_bf16 v[112:127], a[172:175], v[88:95], v2
    s_add_u32 s53, s49, 753664
    buffer_load_dwordx4 a[48:51], v1, s[16:19], s53 offen offset:0 sc1
    buffer_load_dwordx4 a[52:55], v1, s[16:19], s53 offen offset:1024 sc1
    v_exp_f32 v34, v34
    v_exp_f32 v35, v35
    v_exp_f32 v36, v36
    v_mfma_f32_32x32x4_2b_bf16 v[64:95], a[78:79], v[138:139], 0
    v_exp_f32 v37, v37
    v_exp_f32 v38, v38
    v_exp_f32 v39, v39
    v_exp_f32 v40, v40
    v_exp_f32 v41, v41
    v_exp_f32 v42, v42
    v_exp_f32 v43, v43
    v_exp_f32 v44, v44
    v_smfmac_f32_32x32x32_bf16 v[112:127], a[176:179], v[32:39], v2
    s_waitcnt vmcnt(44)
    ds_read_b64_tr_b16 a[160:161], v18 offset:20480
    ds_read_b64_tr_b16 a[162:163], v18 offset:20992
    v_exp_f32 v45, v45
    v_exp_f32 v46, v46
    v_exp_f32 v47, v47
    v_smfmac_f32_16x16x64_bf16 v[160:163], v[184:187], a[232:239], v3
    buffer_load_dwordx4 a[232:235], v1, s[16:19], s50 offen offset:2048 sc1
    buffer_load_dwordx4 a[236:239], v1, s[16:19], s50 offen offset:3072 sc1
    v_exp_f32 v48, v48
    v_exp_f32 v49, v49
    v_smfmac_f32_32x32x32_bf16 v[112:127], a[180:183], v[40:47], v2
    s_add_u32 s50, s49, 671744
    ds_read_b64_tr_b16 a[164:165], v19 offset:20480
    ds_read_b64_tr_b16 a[166:167], v19 offset:20992
    v_exp_f32 v50, v50
    v_exp_f32 v51, v51
    v_exp_f32 v52, v52
    v_mfma_f32_32x32x16_bf16 v[64:79], a[56:59], v[134:137], v[64:79]
    v_exp_f32 v53, v53
    v_exp_f32 v54, v54
    v_exp_f32 v55, v55
    v_mfma_f32_32x32x16_bf16 v[80:95], a[60:63], v[134:137], v[80:95]
    ds_read_b64_tr_b16 a[168:169], v18 offset:22528
    ds_read_b64_tr_b16 a[170:171], v18 offset:23040
    v_exp_f32 v56, v56
    v_exp_f32 v57, v57
    v_exp_f32 v58, v58
    v_smfmac_f32_32x32x32_bf16 v[112:127], a[184:187], v[48:55], v2
    s_waitcnt vmcnt(44)
    ds_read_b64_tr_b16 a[172:173], v19 offset:22528
    ds_read_b64_tr_b16 a[174:175], v19 offset:23040
    v_exp_f32 v59, v59
    v_exp_f32 v60, v60
    v_exp_f32 v61, v61
    v_smfmac_f32_16x16x64_bf16 v[164:167], v[184:187], a[240:247], v3
    buffer_load_dwordx4 a[240:243], v1, s[16:19], s50 offen offset:0 sc1
    buffer_load_dwordx4 a[244:247], v1, s[16:19], s50 offen offset:1024 sc1
    v_exp_f32 v62, v62
    v_exp_f32 v63, v63
    v_exp_f32 v64, v64
    v_exp_f32 v65, v65
    v_smfmac_f32_32x32x32_bf16 v[112:127], a[188:191], v[56:63], v2
    buffer_load_dwordx4 a[56:59], v1, s[16:19], s53 offen offset:2048 sc1
    buffer_load_dwordx4 a[60:63], v1, s[16:19], s53 offen offset:3072 sc1
    v_exp_f32 v66, v66
    v_exp_f32 v67, v67
    v_exp_f32 v68, v68
    v_exp_f32 v69, v69
    v_exp_f32 v70, v70
    v_exp_f32 v71, v71
    v_exp_f32 v72, v72
    v_exp_f32 v73, v73
    v_exp_f32 v74, v74
    v_exp_f32 v75, v75
    v_exp_f32 v76, v76
    v_smfmac_f32_32x32x32_bf16 v[112:127], a[192:195], v[64:71], v2
    s_waitcnt vmcnt(45)
    ds_read_b64_tr_b16 a[176:177], v18 offset:24576
    ds_read_b64_tr_b16 a[178:179], v18 offset:25088
    v_exp_f32 v77, v77
    v_exp_f32 v78, v78
    v_exp_f32 v79, v79
    v_smfmac_f32_16x16x64_bf16 v[168:171], v[184:187], a[248:255], v3
    buffer_load_dwordx4 a[248:251], v1, s[16:19], s50 offen offset:2048 sc1
    buffer_load_dwordx4 a[252:255], v1, s[16:19], s50 offen offset:3072 sc1
    v_exp_f32 v80, v80
    v_exp_f32 v81, v81
    v_smfmac_f32_32x32x32_bf16 v[112:127], a[196:199], v[72:79], v2
    s_add_u32 s50, s49, 737280
    ds_read_b64_tr_b16 a[180:181], v19 offset:24576
    ds_read_b64_tr_b16 a[182:183], v19 offset:25088
    v_exp_f32 v82, v82
    v_exp_f32 v83, v83
    v_exp_f32 v84, v84
    v_exp_f32 v85, v85
    v_exp_f32 v86, v86
    v_exp_f32 v87, v87
    ds_read_b64_tr_b16 a[184:185], v18 offset:26624
    ds_read_b64_tr_b16 a[186:187], v18 offset:27136
    v_exp_f32 v88, v88
    v_exp_f32 v89, v89
    v_exp_f32 v90, v90
    v_smfmac_f32_32x32x32_bf16 v[112:127], a[200:203], v[80:87], v2
    s_waitcnt vmcnt(45)
    ds_read_b64_tr_b16 a[188:189], v19 offset:26624
    ds_read_b64_tr_b16 a[190:191], v19 offset:27136
    v_exp_f32 v91, v91
    v_exp_f32 v92, v92
    v_exp_f32 v93, v93
    v_smfmac_f32_16x16x64_bf16 v[172:175], v[184:187], v[208:215], v3
    buffer_load_dwordx4 v[208:211], v1, s[16:19], s50 offen offset:0 sc1
    buffer_load_dwordx4 v[212:215], v1, s[16:19], s50 offen offset:1024 sc1
    v_exp_f32 v94, v94
    v_exp_f32 v95, v95
    s_nop 1
    v_smfmac_f32_32x32x32_bf16 v[112:127], a[204:207], v[88:95], v2
    s_waitcnt vmcnt(42)
    v_smfmac_f32_16x16x64_bf16 v[176:179], v[184:187], v[216:223], v3
    buffer_load_dwordx4 v[216:219], v1, s[16:19], s50 offen offset:2048 sc1
    buffer_load_dwordx4 v[220:223], v1, s[16:19], s50 offen offset:3072 sc1
    s_nop 7
    ds_write_b128 v6, v[112:115] offset:12288
    ds_write_b128 v6, v[116:119] offset:13312
    ds_write_b128 v6, v[120:123] offset:14336
    s_mov_b32 s65, 931840
    buffer_load_dwordx4 v17, s[24:27], s65 offen offset:2048 lds
    s_mov_b32 s65, 955392
    buffer_load_dwordx4 v17, s[24:27], s65 offen offset:3072 lds
    s_add_u32 m0, s64, 8192
    s_mov_b32 s65, 983040
    buffer_load_dwordx4 v17, s[24:27], s65 offen offset:0 lds
    s_mov_b32 s65, 1006592
    buffer_load_dwordx4 v17, s[24:27], s65 offen offset:1024 lds
    ds_read_b64_tr_b16 a[192:193], v18 offset:28672
    ds_read_b64_tr_b16 a[194:195], v18 offset:29184
    ds_read_b64_tr_b16 a[196:197], v19 offset:28672
    ds_read_b64_tr_b16 a[198:199], v19 offset:29184
    ds_read_b64_tr_b16 a[200:201], v18 offset:30720
    ds_read_b64_tr_b16 a[202:203], v18 offset:31232
    ds_read_b64_tr_b16 a[204:205], v19 offset:30720
    ds_read_b64_tr_b16 a[206:207], v19 offset:31232
    s_waitcnt lgkmcnt(8)
    s_barrier
    ds_read_b128 v[188:191], v7 offset:12288
    ds_read_b128 v[192:195], v7 offset:15360
    ds_read_b128 v[196:199], v7 offset:18432
    ds_read_b128 v[200:203], v7 offset:21504
    s_mov_b32 s65, 1030144
    buffer_load_dwordx4 v17, s[24:27], s65 offen offset:2048 lds
    s_mov_b32 s65, 1053696
    buffer_load_dwordx4 v17, s[24:27], s65 offen offset:3072 lds
    s_add_u32 m0, s64, 12288
    s_mov_b32 s65, 1081344
    buffer_load_dwordx4 v17, s[24:27], s65 offen offset:0 lds
    s_mov_b32 s65, 1104896
    buffer_load_dwordx4 v17, s[24:27], s65 offen offset:1024 lds
    s_waitcnt lgkmcnt(2)
    v_pk_add_f32 v[188:189], v[188:189], v[192:193]
    s_waitcnt lgkmcnt(0)
    v_pk_add_f32 v[196:197], v[196:197], v[200:201]
    v_pk_add_f32 v[188:189], v[188:189], v[196:197]
    v_pk_add_f32 v[190:191], v[190:191], v[194:195]
    v_pk_add_f32 v[198:199], v[198:199], v[202:203]
    v_rcp_f32_dpp v192, v188 quad_perm:[3,3,3,3] row_mask:0xf bank_mask:0xf
    v_pk_add_f32 v[190:191], v[190:191], v[198:199]
    v_pk_mul_f32 v[188:189], v[188:189], v[192:193] op_sel_hi:[1,0]
    v_pk_mul_f32 v[190:191], v[190:191], v[192:193] op_sel_hi:[1,0]
    v_cvt_pk_bf16_f32 v188, v188, v189
    v_cvt_pk_bf16_f32 v189, v190, v191
    v_subrev_u32 v192, 528482304, v192
    v_max_u32 v10, v10, v192
    ds_write2_b32 v8, v188, v189 offset0:0 offset1:32
    v_cmp_lt_u32 vcc, 1040187392, v10
    s_lshl_b32 s52, s40, 2
    v_mov_b32 v20, s52
    s_cmp_lg_u64 vcc, 0
    s_cselect_b32 s51, 1, 0
    v_mov_b32 v21, s51
    ds_write_b32 v20, v21 offset:30208
    s_mov_b32 s65, 1128448
    buffer_load_dwordx4 v17, s[24:27], s65 offen offset:2048 lds
    s_mov_b32 s65, 1152000
    buffer_load_dwordx4 v17, s[24:27], s65 offen offset:3072 lds
    s_add_u32 m0, s64, 16384
    s_mov_b32 s65, 1179648
    buffer_load_dwordx4 v17, s[24:27], s65 offen offset:0 lds
    s_mov_b32 s65, 1203200
    buffer_load_dwordx4 v17, s[24:27], s65 offen offset:1024 lds
    s_waitcnt lgkmcnt(0)
    s_barrier
    ds_read_b128 v[204:207], v1 offset:27648
    ds_read_b128 v[180:183], v1 offset:28672
    ds_read_b128 v[20:23], v4 offset:30208
    s_mov_b32 s65, 1226752
    buffer_load_dwordx4 v17, s[24:27], s65 offen offset:2048 lds
    s_mov_b32 s65, 1250304
    buffer_load_dwordx4 v17, s[24:27], s65 offen offset:3072 lds
    s_add_u32 m0, s64, 20480
    s_mov_b32 s65, 1277952
    buffer_load_dwordx4 v17, s[24:27], s65 offen offset:0 lds
    s_mov_b32 s65, 1301504
    buffer_load_dwordx4 v17, s[24:27], s65 offen offset:1024 lds
    s_waitcnt vmcnt(58)
    s_waitcnt lgkmcnt(2)
    v_smfmac_f32_16x16x64_bf16 v[140:143], v[204:207], v[224:231], v3
    s_waitcnt lgkmcnt(0)
    v_or3_b32 v20, v20, v21, v22
    s_waitcnt vmcnt(54)
    v_smfmac_f32_16x16x64_bf16 v[144:147], v[204:207], v[232:239], v3
    v_or_b32 v20, v20, v23
    s_nop 0
    s_waitcnt vmcnt(42)
    v_smfmac_f32_16x16x64_bf16 v[148:151], v[204:207], v[240:247], v3
    v_readfirstlane_b32 s51, v20
    s_waitcnt vmcnt(38)
    v_smfmac_f32_16x16x64_bf16 v[152:155], v[204:207], v[248:255], v3
    v_lshrrev_b32 v24, 5, v0
    s_waitcnt vmcnt(36)
    v_smfmac_f32_16x16x64_bf16 v[156:159], v[204:207], a[208:215], v3
    v_lshlrev_b32 v24, 8, v24
    s_waitcnt vmcnt(32)
    v_smfmac_f32_16x16x64_bf16 v[160:163], v[204:207], a[216:223], v3
    v_and_b32 v25, 15, v0
    s_waitcnt vmcnt(30)
    v_smfmac_f32_16x16x64_bf16 v[164:167], v[204:207], a[224:231], v3
    v_lshl_add_u32 v24, v25, 4, v24
    s_waitcnt vmcnt(26)
    v_smfmac_f32_16x16x64_bf16 v[168:171], v[204:207], a[232:239], v3
    v_bfe_u32 v25, v0, 4, 1
    s_waitcnt vmcnt(24)
    v_smfmac_f32_16x16x64_bf16 v[172:175], v[204:207], a[240:247], v3
    v_lshl_add_u32 v14, v25, 17, v24
    s_waitcnt vmcnt(20)
    v_smfmac_f32_16x16x64_bf16 v[176:179], v[204:207], a[248:255], v3
    v_lshl_add_u32 v26, v25, 3, v24
    s_mul_i32 s52, s40, 655360
    s_lshl_b32 s57, s41, 9
    s_add_u32 s52, s52, s57
    s_add_u32 s52, s52, 3620864
    s_waitcnt vmcnt(18)
    v_smfmac_f32_16x16x64_bf16 v[140:143], v[180:183], v[208:215], v3
    v_bfe_u32 v24, v0, 2, 3
    s_waitcnt vmcnt(16)
    v_smfmac_f32_16x16x64_bf16 v[144:147], v[180:183], v[216:223], v3
    v_lshlrev_b32 v24, 6, v24
    v_smfmac_f32_16x16x64_bf16 v[148:151], v[180:183], a[0:7], v3
    v_lshrrev_b32 v25, 5, v0
    s_lshl_b32 s57, s40, 4
    v_smfmac_f32_16x16x64_bf16 v[152:155], v[180:183], a[8:15], v3
    v_lshl_add_u32 v25, v25, 3, s57
    v_smfmac_f32_16x16x64_bf16 v[156:159], v[180:183], a[16:23], v3
    v_add_u32 v15, v24, v25
    v_smfmac_f32_16x16x64_bf16 v[160:163], v[180:183], a[24:31], v3
    v_and_b32 v25, 3, v0
    v_smfmac_f32_16x16x64_bf16 v[164:167], v[180:183], a[32:39], v3
    v_lshl_add_u32 v28, v25, 4, v24
    v_smfmac_f32_16x16x64_bf16 v[168:171], v[180:183], a[40:47], v3
    v_lshrrev_b32 v30, 3, v24
    s_lshl_b32 s57, s41, 6
    s_add_u32 s57, s57, 6242304
    v_smfmac_f32_16x16x64_bf16 v[172:175], v[180:183], a[48:55], v3
    v_smfmac_f32_16x16x64_bf16 v[176:179], v[180:183], a[56:63], v3
    s_cmp_lg_u32 s51, 0
    s_cbranch_scc1 L_p2_slow
L_p2_epi:
    v_permlane32_swap_b32 v140, v144
    v_permlane32_swap_b32 v141, v145
    v_permlane32_swap_b32 v142, v146
    v_permlane32_swap_b32 v143, v147
    v_pk_add_f32 v[140:141], v[140:141], v[144:145]
    v_pk_add_f32 v[142:143], v[142:143], v[146:147]
    v_permlane32_swap_b32 v148, v152
    v_permlane32_swap_b32 v149, v153
    v_permlane32_swap_b32 v150, v154
    v_permlane32_swap_b32 v151, v155
    v_pk_add_f32 v[148:149], v[148:149], v[152:153]
    v_pk_add_f32 v[150:151], v[150:151], v[154:155]
    v_permlane32_swap_b32 v156, v160
    v_permlane32_swap_b32 v157, v161
    v_permlane32_swap_b32 v158, v162
    v_permlane32_swap_b32 v159, v163
    v_pk_add_f32 v[156:157], v[156:157], v[160:161]
    v_pk_add_f32 v[158:159], v[158:159], v[162:163]
    v_permlane32_swap_b32 v164, v168
    v_permlane32_swap_b32 v165, v169
    v_permlane32_swap_b32 v166, v170
    v_permlane32_swap_b32 v167, v171
    v_pk_add_f32 v[164:165], v[164:165], v[168:169]
    v_pk_add_f32 v[166:167], v[166:167], v[170:171]
    v_permlane32_swap_b32 v172, v176
    v_permlane32_swap_b32 v173, v177
    v_permlane32_swap_b32 v174, v178
    v_permlane32_swap_b32 v175, v179
    v_pk_add_f32 v[172:173], v[172:173], v[176:177]
    v_pk_add_f32 v[174:175], v[174:175], v[178:179]
    v_pk_add_f32 v[32:33], v[140:141], v[148:149]
    v_pk_mul_f32 v[36:37], v[140:141], v[140:141]
    v_pk_add_f32 v[34:35], v[142:143], v[150:151]
    v_pk_mul_f32 v[38:39], v[142:143], v[142:143]
    v_pk_fma_f32 v[36:37], v[148:149], v[148:149], v[36:37]
    v_pk_fma_f32 v[38:39], v[150:151], v[150:151], v[38:39]
    v_pk_add_f32 v[32:33], v[32:33], v[156:157]
    v_pk_fma_f32 v[36:37], v[156:157], v[156:157], v[36:37]
    v_pk_add_f32 v[34:35], v[34:35], v[158:159]
    v_pk_fma_f32 v[38:39], v[158:159], v[158:159], v[38:39]
    v_pk_add_f32 v[32:33], v[32:33], v[164:165]
    v_pk_fma_f32 v[36:37], v[164:165], v[164:165], v[36:37]
    v_pk_add_f32 v[34:35], v[34:35], v[166:167]
    v_pk_fma_f32 v[38:39], v[166:167], v[166:167], v[38:39]
    v_pk_add_f32 v[32:33], v[32:33], v[172:173]
    v_pk_fma_f32 v[36:37], v[172:173], v[172:173], v[36:37]
    v_pk_add_f32 v[34:35], v[34:35], v[174:175]
    v_pk_fma_f32 v[38:39], v[174:175], v[174:175], v[38:39]
    v_add_f32_dpp v32, v32, v32 row_ror:8 row_mask:0xf bank_mask:0x3
    v_add_f32_dpp v33, v33, v33 row_ror:8 row_mask:0xf bank_mask:0x3
    v_add_f32_dpp v36, v36, v36 row_ror:8 row_mask:0xf bank_mask:0x3
    v_add_f32_dpp v37, v37, v37 row_ror:8 row_mask:0xf bank_mask:0x3
    v_add_f32_dpp v32, v34, v34 row_ror:8 row_mask:0xf bank_mask:0xc
    v_add_f32_dpp v33, v35, v35 row_ror:8 row_mask:0xf bank_mask:0xc
    v_add_f32_dpp v36, v38, v38 row_ror:8 row_mask:0xf bank_mask:0xc
    v_add_f32_dpp v37, v39, v39 row_ror:8 row_mask:0xf bank_mask:0xc
    v_add_f32_dpp v40, v32, v32 row_half_mirror row_mask:0xf bank_mask:0x5
    v_add_f32_dpp v41, v36, v36 row_half_mirror row_mask:0xf bank_mask:0x5
    s_nop 0
    v_add_f32_dpp v40, v33, v33 row_half_mirror row_mask:0xf bank_mask:0xa
    v_add_f32_dpp v41, v37, v37 row_half_mirror row_mask:0xf bank_mask:0xa
    s_nop 0
    v_add_f32_dpp v40, v40, v40 quad_perm:[1,0,3,2] row_mask:0xf bank_mask:0xf
    v_add_f32_dpp v41, v41, v41 quad_perm:[1,0,3,2] row_mask:0xf bank_mask:0xf
    s_nop 0
    v_add_f32_dpp v40, v40, v40 quad_perm:[2,3,0,1] row_mask:0xf bank_mask:0xf
    v_add_f32_dpp v41, v41, v41 quad_perm:[2,3,0,1] row_mask:0xf bank_mask:0xf
    ds_write_b64 v15, v[40:41] offset:29696
    s_mov_b32 s65, 1325056
    buffer_load_dwordx4 v17, s[24:27], s65 offen offset:2048 lds
    s_mov_b32 s65, 1348608
    buffer_load_dwordx4 v17, s[24:27], s65 offen offset:3072 lds
    s_add_u32 m0, s64, 24576
    s_mov_b32 s65, 1376256
    buffer_load_dwordx4 v17, s[24:27], s65 offen offset:0 lds
    s_mov_b32 s65, 1399808
    buffer_load_dwordx4 v17, s[24:27], s65 offen offset:1024 lds
    s_waitcnt lgkmcnt(0)
    s_barrier
    ds_read_b128 v[40:43], v28 offset:29696
    s_mov_b32 s65, 1423360
    buffer_load_dwordx4 v17, s[24:27], s65 offen offset:2048 lds
    s_mov_b32 s65, 1446912
    buffer_load_dwordx4 v17, s[24:27], s65 offen offset:3072 lds
    s_add_u32 m0, s64, 28672
    s_mov_b32 s65, 1474560
    buffer_load_dwordx4 v17, s[24:27], s65 offen offset:0 lds
    s_mov_b32 s65, 1498112
    buffer_load_dwordx4 v17, s[24:27], s65 offen offset:1024 lds
    s_waitcnt lgkmcnt(0)
    v_pk_add_f32 v[40:41], v[40:41], v[42:43]
    s_nop 1
    v_add_f32_dpp v40, v40, v40 quad_perm:[1,0,3,2] row_mask:0xf bank_mask:0xf
    v_add_f32_dpp v41, v41, v41 quad_perm:[1,0,3,2] row_mask:0xf bank_mask:0xf
    s_nop 0
    v_add_f32_dpp v40, v40, v40 quad_perm:[2,3,0,1] row_mask:0xf bank_mask:0xf
    v_add_f32_dpp v41, v41, v41 quad_perm:[2,3,0,1] row_mask:0xf bank_mask:0xf
    v_mul_f32 v52, 0x3acccccd, v40
    v_mul_f32 v41, 0x3acccccd, v41
    v_fma_f32 v41, -v52, v52, v41
    v_max_f32 v41, 0, v41
    v_add_f32 v42, 0x3727c5ac, v41
    v_fmac_f32 v41, 0x3727c5ac, v42
    v_rsq_f32 v42, v41
    v_sqrt_f32 v53, v41
    v_mul_f32 v40, -v52, v42
    v_mov_b32_dpp v44, v42 row_newbcast:0 row_mask:0xf bank_mask:0xf
    v_mov_b32_dpp v45, v42 row_newbcast:4 row_mask:0xf bank_mask:0xf
    v_mov_b32_dpp v46, v42 row_newbcast:8 row_mask:0xf bank_mask:0xf
    v_mov_b32_dpp v47, v42 row_newbcast:12 row_mask:0xf bank_mask:0xf
    v_mov_b32_dpp v48, v40 row_newbcast:0 row_mask:0xf bank_mask:0xf
    v_mov_b32_dpp v49, v40 row_newbcast:4 row_mask:0xf bank_mask:0xf
    v_mov_b32_dpp v50, v40 row_newbcast:8 row_mask:0xf bank_mask:0xf
    v_mov_b32_dpp v51, v40 row_newbcast:12 row_mask:0xf bank_mask:0xf
    v_pk_fma_f32 v[140:141], v[140:141], v[44:45], v[48:49]
    v_pk_fma_f32 v[142:143], v[142:143], v[46:47], v[50:51]
    v_pk_fma_f32 v[148:149], v[148:149], v[44:45], v[48:49]
    v_pk_fma_f32 v[150:151], v[150:151], v[46:47], v[50:51]
    v_pk_fma_f32 v[156:157], v[156:157], v[44:45], v[48:49]
    v_pk_fma_f32 v[158:159], v[158:159], v[46:47], v[50:51]
    v_pk_fma_f32 v[164:165], v[164:165], v[44:45], v[48:49]
    v_pk_fma_f32 v[166:167], v[166:167], v[46:47], v[50:51]
    v_pk_fma_f32 v[172:173], v[172:173], v[44:45], v[48:49]
    v_pk_fma_f32 v[174:175], v[174:175], v[46:47], v[50:51]
    v_cvt_pk_bf16_f32 v64, v140, v141
    v_cvt_pk_bf16_f32 v65, v142, v143
    v_cvt_pk_bf16_f32 v66, v148, v149
    v_cvt_pk_bf16_f32 v67, v150, v151
    v_cvt_pk_bf16_f32 v68, v156, v157
    v_cvt_pk_bf16_f32 v69, v158, v159
L_hop6:
    s_cbranch_execz L_hop_back
    v_cvt_pk_bf16_f32 v70, v164, v165
    v_cvt_pk_bf16_f32 v71, v166, v167
    v_cvt_pk_bf16_f32 v72, v172, v173
    v_cvt_pk_bf16_f32 v73, v174, v175
    v_permlane16_swap_b32 v64, v66
    v_permlane16_swap_b32 v65, v67
    buffer_store_dwordx4 v[64:67], v14, s[16:19], s52 offen sc1
    s_add_u32 s52, s52, 262144
    v_permlane16_swap_b32 v68, v70
    v_permlane16_swap_b32 v69, v71
    buffer_store_dwordx4 v[68:71], v14, s[16:19], s52 offen sc1
    s_add_u32 s52, s52, 262144
    buffer_store_dwordx2 v[72:73], v26, s[16:19], s52 offen sc1
    s_cmp_eq_u32 s40, 0
    s_cselect_b32 exec_lo, 0x11111111, 1
    s_mov_b32 exec_hi, 0
    buffer_store_dwordx2 v[52:53], v30, s[16:19], s57 offen sc1
    s_mov_b64 exec, -1
    s_lshl_b32 s56, s41, 5
    s_add_u32 s56, s56, 8224768
    v_mov_b32 v20, 1
    s_barrier
    buffer_store_dword v20, v29, s[16:19], s56 offen sc1
    v_lshrrev_b32 v20, 5, v0
    v_lshlrev_b32 v20, 4, v20
    s_lshl_b32 s50, s61, 7
    s_lshl_b32 s51, s40, 5
    s_add_u32 s50, s50, s51
    buffer_load_dwordx4 v[96:99], v20, s[32:35], s50 offen
    v_bfe_u32 v20, v0, 4, 1
    v_bfe_u32 v21, v0, 2, 2
    v_lshl_add_u32 v21, v20, 3, v21
    v_lshlrev_b32 v21, 12, v21
    v_lshlrev_b32 v20, 1, v20
    v_xor_b32 v20, v20, v0
    v_and_b32 v20, 3, v20
    v_lshl_add_u32 v21, v20, 4, v21
    v_lshrrev_b32 v20, 5, v0
    v_lshl_add_u32 v21, v20, 6, v21
    s_mul_i32 s50, s40, 1572864
    s_lshl_b32 s51, s63, 7
    s_add_u32 s50, s50, s51
    v_add_u32 v15, s50, v21
    s_mov_b32 s65, 1521664
    buffer_load_dwordx4 v17, s[24:27], s65 offen offset:2048 lds
    s_mov_b32 s65, 1545216
    buffer_load_dwordx4 v17, s[24:27], s65 offen offset:3072 lds
    ds_read_b64_tr_b16 a[208:209], v18 offset:0
    ds_read_b64_tr_b16 a[210:211], v18 offset:512
    ds_read_b64_tr_b16 a[212:213], v19 offset:0
    ds_read_b64_tr_b16 a[214:215], v19 offset:512
    ds_read_b64_tr_b16 a[216:217], v18 offset:2048
    ds_read_b64_tr_b16 a[218:219], v18 offset:2560
    ds_read_b64_tr_b16 a[220:221], v19 offset:2048
    ds_read_b64_tr_b16 a[222:223], v19 offset:2560
    ds_read_b64_tr_b16 a[224:225], v18 offset:4096
    ds_read_b64_tr_b16 a[226:227], v18 offset:4608
    ds_read_b64_tr_b16 a[228:229], v19 offset:4096
    ds_read_b64_tr_b16 a[230:231], v19 offset:4608
    s_waitcnt lgkmcnt(8)
    s_add_u32 m0, s64, 0
    s_mov_b32 s65, 0
    buffer_load_dwordx4 v15, s[28:31], s65 offen offset:0 lds
    s_mov_b32 s65, 15360
    buffer_load_dwordx4 v15, s[28:31], s65 offen offset:1024 lds
    s_waitcnt vmcnt(32)
    ds_read_b64_tr_b16 a[232:233], v18 offset:6144
    ds_read_b64_tr_b16 a[234:235], v18 offset:6656
    ds_read_b64_tr_b16 a[236:237], v19 offset:6144
    ds_read_b64_tr_b16 a[238:239], v19 offset:6656
    s_waitcnt lgkmcnt(8)
    s_mov_b32 s65, 63488
    buffer_load_dwordx4 v15, s[28:31], s65 offen offset:2048 lds
    s_mov_b32 s65, 78848
    buffer_load_dwordx4 v15, s[28:31], s65 offen offset:3072 lds
    s_waitcnt vmcnt(32)
    ds_read_b64_tr_b16 a[240:241], v18 offset:8192
    ds_read_b64_tr_b16 a[242:243], v18 offset:8704
    ds_read_b64_tr_b16 a[244:245], v19 offset:8192
    ds_read_b64_tr_b16 a[246:247], v19 offset:8704
    s_waitcnt lgkmcnt(8)
    s_add_u32 m0, s64, 4096
    s_mov_b32 s65, 131072
    buffer_load_dwordx4 v15, s[28:31], s65 offen offset:0 lds
    s_mov_b32 s65, 146432
    buffer_load_dwordx4 v15, s[28:31], s65 offen offset:1024 lds
    s_waitcnt vmcnt(32)
    ds_read_b64_tr_b16 a[248:249], v18 offset:10240
    ds_read_b64_tr_b16 a[250:251], v18 offset:10752
    ds_read_b64_tr_b16 a[252:253], v19 offset:10240
    ds_read_b64_tr_b16 a[254:255], v19 offset:10752
    s_waitcnt lgkmcnt(8)
    s_mov_b32 s65, 194560
    buffer_load_dwordx4 v15, s[28:31], s65 offen offset:2048 lds
    s_mov_b32 s65, 209920
    buffer_load_dwordx4 v15, s[28:31], s65 offen offset:3072 lds
    s_waitcnt vmcnt(32)
    ds_read_b64_tr_b16 a[0:1], v18 offset:12288
    ds_read_b64_tr_b16 a[2:3], v18 offset:12800
    ds_read_b64_tr_b16 a[4:5], v19 offset:12288
    ds_read_b64_tr_b16 a[6:7], v19 offset:12800
    s_waitcnt lgkmcnt(8)
    s_add_u32 m0, s64, 8192
    s_mov_b32 s65, 262144
    buffer_load_dwordx4 v15, s[28:31], s65 offen offset:0 lds
    s_mov_b32 s65, 277504
    buffer_load_dwordx4 v15, s[28:31], s65 offen offset:1024 lds
    s_waitcnt vmcnt(32)
    ds_read_b64_tr_b16 a[8:9], v18 offset:14336
    ds_read_b64_tr_b16 a[10:11], v18 offset:14848
    ds_read_b64_tr_b16 a[12:13], v19 offset:14336
    ds_read_b64_tr_b16 a[14:15], v19 offset:14848
    s_waitcnt lgkmcnt(8)
    s_mov_b32 s65, 325632
    buffer_load_dwordx4 v15, s[28:31], s65 offen offset:2048 lds
    s_mov_b32 s65, 340992
    buffer_load_dwordx4 v15, s[28:31], s65 offen offset:3072 lds
    s_waitcnt vmcnt(32)
    ds_read_b64_tr_b16 a[16:17], v18 offset:16384
    ds_read_b64_tr_b16 a[18:19], v18 offset:16896
    ds_read_b64_tr_b16 a[20:21], v19 offset:16384
    ds_read_b64_tr_b16 a[22:23], v19 offset:16896
    s_waitcnt lgkmcnt(8)
    s_add_u32 m0, s64, 12288
    s_mov_b32 s65, 393216
    buffer_load_dwordx4 v15, s[28:31], s65 offen offset:0 lds
    s_mov_b32 s65, 408576
    buffer_load_dwordx4 v15, s[28:31], s65 offen offset:1024 lds
    s_waitcnt vmcnt(32)
    ds_read_b64_tr_b16 a[24:25], v18 offset:18432
    ds_read_b64_tr_b16 a[26:27], v18 offset:18944
    ds_read_b64_tr_b16 a[28:29], v19 offset:18432
    ds_read_b64_tr_b16 a[30:31], v19 offset:18944
    s_waitcnt lgkmcnt(8)
    s_mov_b32 s65, 456704
    buffer_load_dwordx4 v15, s[28:31], s65 offen offset:2048 lds
    s_mov_b32 s65, 472064
    buffer_load_dwordx4 v15, s[28:31], s65 offen offset:3072 lds
    v_lshlrev_b32 v235, 5, v0
    s_and_b32 s55, s2, 3
    s_lshl_b32 s55, s55, 2
    s_add_u32 s55, s55, s40
    s_lshl_b32 s55, s55, 11
    s_add_u32 s55, s55, 8224768
    buffer_load_dword v24, v235, s[16:19], s55 offen sc1
    s_waitcnt vmcnt(33)
    ds_read_b64_tr_b16 a[32:33], v18 offset:20480
    ds_read_b64_tr_b16 a[34:35], v18 offset:20992
    ds_read_b64_tr_b16 a[36:37], v19 offset:20480
    ds_read_b64_tr_b16 a[38:39], v19 offset:20992
    s_waitcnt lgkmcnt(8)
    s_add_u32 m0, s64, 16384
    s_mov_b32 s65, 524288
    buffer_load_dwordx4 v15, s[28:31], s65 offen offset:0 lds
    s_mov_b32 s65, 539648
    buffer_load_dwordx4 v15, s[28:31], s65 offen offset:1024 lds
    s_waitcnt vmcnt(33)
    ds_read_b64_tr_b16 a[40:41], v18 offset:22528
    ds_read_b64_tr_b16 a[42:43], v18 offset:23040
    ds_read_b64_tr_b16 a[44:45], v19 offset:22528
    ds_read_b64_tr_b16 a[46:47], v19 offset:23040
    s_waitcnt lgkmcnt(8)
    s_mov_b32 s65, 587776
    buffer_load_dwordx4 v15, s[28:31], s65 offen offset:2048 lds
    s_mov_b32 s65, 603136
    buffer_load_dwordx4 v15, s[28:31], s65 offen offset:3072 lds
    s_waitcnt vmcnt(33)
    ds_read_b64_tr_b16 a[48:49], v18 offset:24576
    ds_read_b64_tr_b16 a[50:51], v18 offset:25088
    ds_read_b64_tr_b16 a[52:53], v19 offset:24576
    ds_read_b64_tr_b16 a[54:55], v19 offset:25088
    s_waitcnt lgkmcnt(8)
    s_add_u32 m0, s64, 20480
    s_mov_b32 s65, 655360
    buffer_load_dwordx4 v15, s[28:31], s65 offen offset:0 lds
    s_mov_b32 s65, 670720
    buffer_load_dwordx4 v15, s[28:31], s65 offen offset:1024 lds
    s_cmp_ge_u32 s2, 240
    s_cbranch_scc1 L_idle3
    s_lshl_b32 s71, s60, 18
    s_lshl_b32 s50, s40, 15
    s_add_u32 s71, s71, s50
    s_add_u32 s71, s71, 3620864
    s_waitcnt vmcnt(6)
    v_cmp_ne_u32 vcc, 1, v24
    s_nop 0
    s_cbranch_vccz L_s2_out
    s_mov_b32 s54, 0x40000
L_s2:
    buffer_load_dword v24, v235, s[16:19], s55 offen sc1
    s_waitcnt vmcnt(0)
    v_cmp_ne_u32 vcc, 1, v24
    s_sub_u32 s54, s54, 1
    s_cbranch_scc1 L_s2_x
    s_cbranch_vccnz L_s2
L_s2_x:
L_s2_end:
L_s2_out:
    s_add_u32 s50, s71, 0
    buffer_load_dwordx4 v[128:131], v1, s[16:19], s50 offen offset:0 sc1
    buffer_load_dwordx4 v[132:135], v1, s[16:19], s50 offen offset:1024 sc1
    buffer_load_dwordx4 v[136:139], v1, s[16:19], s50 offen offset:2048 sc1
    buffer_load_dwordx4 v[140:143], v1, s[16:19], s50 offen offset:3072 sc1
    s_add_u32 s50, s71, 4096
    buffer_load_dwordx4 v[144:147], v1, s[16:19], s50 offen offset:0 sc1
    buffer_load_dwordx4 v[148:151], v1, s[16:19], s50 offen offset:1024 sc1
    buffer_load_dwordx4 v[152:155], v1, s[16:19], s50 offen offset:2048 sc1
    buffer_load_dwordx4 v[156:159], v1, s[16:19], s50 offen offset:3072 sc1
    s_add_u32 s50, s71, 8192
    buffer_load_dwordx4 v[160:163], v1, s[16:19], s50 offen offset:0 sc1
    buffer_load_dwordx4 v[164:167], v1, s[16:19], s50 offen offset:1024 sc1
    s_waitcnt vmcnt(9)
    v_mfma_f32_32x32x16_bf16 v[32:47], a[80:83], v[128:131], 0
    v_mfma_f32_32x32x16_bf16 v[48:63], a[84:87], v[128:131], 0
    buffer_load_dwordx4 v[168:171], v1, s[16:19], s50 offen offset:2048 sc1
    s_waitcnt vmcnt(9)
    v_mfma_f32_32x32x16_bf16 v[32:47], a[88:91], v[132:135], v[32:47]
    v_mfma_f32_32x32x16_bf16 v[48:63], a[92:95], v[132:135], v[48:63]
    buffer_load_dwordx4 v[172:175], v1, s[16:19], s50 offen offset:3072 sc1
    s_waitcnt vmcnt(9)
    v_mfma_f32_32x32x16_bf16 v[32:47], a[96:99], v[136:139], v[32:47]
    ds_read_b64_tr_b16 a[56:57], v18 offset:26624
    ds_read_b64_tr_b16 a[58:59], v18 offset:27136
    ds_read_b64_tr_b16 a[60:61], v19 offset:26624
    ds_read_b64_tr_b16 a[62:63], v19 offset:27136
    v_mfma_f32_32x32x16_bf16 v[48:63], a[100:103], v[136:139], v[48:63]
    s_add_u32 s50, s71, 12288
    buffer_load_dwordx4 v[176:179], v1, s[16:19], s50 offen offset:0 sc1
    s_waitcnt vmcnt(9)
    v_mfma_f32_32x32x16_bf16 v[32:47], a[104:107], v[140:143], v[32:47]
    ds_read_b64_tr_b16 a[64:65], v18 offset:28672
    ds_read_b64_tr_b16 a[66:67], v18 offset:29184
    ds_read_b64_tr_b16 a[68:69], v19 offset:28672
    ds_read_b64_tr_b16 a[70:71], v19 offset:29184
    v_mfma_f32_32x32x16_bf16 v[48:63], a[108:111], v[140:143], v[48:63]
    buffer_load_dwordx4 v[180:183], v1, s[16:19], s50 offen offset:1024 sc1
    s_waitcnt vmcnt(9)
    v_mfma_f32_32x32x16_bf16 v[32:47], a[112:115], v[144:147], v[32:47]
    ds_read_b64_tr_b16 a[72:73], v18 offset:30720
    ds_read_b64_tr_b16 a[74:75], v18 offset:31232
    ds_read_b64_tr_b16 a[76:77], v19 offset:30720
    ds_read_b64_tr_b16 a[78:79], v19 offset:31232
    v_mfma_f32_32x32x16_bf16 v[48:63], a[116:119], v[144:147], v[48:63]
    buffer_load_dwordx4 v[184:187], v1, s[16:19], s50 offen offset:2048 sc1
    s_waitcnt vmcnt(9)
    v_mfma_f32_32x32x16_bf16 v[32:47], a[120:123], v[148:151], v[32:47]
    s_mul_i32 s56, s60, 24
    s_add_u32 s56, s56, s61
    s_cmp_ge_u32 s2, 240
    s_cselect_b32 s56, s2, s56
    s_lshl_b32 s56, s56, 5
    s_add_u32 s56, s56, 8257536
    v_mfma_f32_32x32x16_bf16 v[48:63], a[124:127], v[148:151], v[48:63]
    buffer_load_dwordx4 v[188:191], v1, s[16:19], s50 offen offset:3072 sc1
    v_mov_b32 v25, v29
    v_mov_b32 v26, 1
    s_lshl_b32 s51, s40, 2
    v_add_u32 v19, s51, v1
    v_min_u32 v20, 11, v0
    s_waitcnt vmcnt(9)
    v_mfma_f32_32x32x16_bf16 v[32:47], a[128:131], v[152:155], v[32:47]
    v_cmp_lt_u32 vcc, 5, v20
    v_add_u32 v21, 18, v20
    s_mul_i32 s57, s62, 5
    v_cndmask_b32 v20, v20, v21, vcc
    v_lshlrev_b32 v27, 5, v20
    v_mfma_f32_32x32x16_bf16 v[48:63], a[132:135], v[152:155], v[48:63]
    s_add_u32 s50, s71, 16384
    buffer_load_dwordx4 v[128:131], v1, s[16:19], s50 offen offset:0 sc1
    s_lshr_b32 s57, s57, 2
    s_mul_i32 s57, s57, 24
    s_mul_i32 s51, s40, 6
    s_add_u32 s57, s57, s51
    s_and_b32 s51, s2, 3
    s_waitcnt vmcnt(9)
    v_mfma_f32_32x32x16_bf16 v[32:47], a[136:139], v[156:159], v[32:47]
    s_lshl_b32 s51, s51, 8
    s_add_u32 s57, s57, s51
    s_lshl_b32 s57, s57, 5
    s_add_u32 s57, s57, 8257536
    s_lshl_b32 s68, s63, 3
    v_mfma_f32_32x32x16_bf16 v[48:63], a[140:143], v[156:159], v[48:63]
    buffer_load_dwordx4 v[132:135], v1, s[16:19], s50 offen offset:1024 sc1
    s_lshl_b32 s51, s40, 1
    s_add_u32 s68, s68, s51
    s_sub_u32 s52, 0, s62
    s_and_b32 s52, s52, 3
    s_mul_i32 s53, s62, 5
    s_waitcnt vmcnt(9)
    v_mfma_f32_32x32x16_bf16 v[32:47], a[144:147], v[160:163], v[32:47]
    s_add_u32 s52, s52, s53
    s_lshl_b32 s51, s52, 4
    v_lshrrev_b32 v20, 1, v0
    v_add_u32 v20, s51, v20
    v_lshrrev_b32 v21, 5, v20
    v_mfma_f32_32x32x16_bf16 v[48:63], a[148:151], v[160:163], v[48:63]
    buffer_load_dwordx4 v[136:139], v1, s[16:19], s50 offen offset:2048 sc1
    v_lshlrev_b32 v21, 17, v21
    v_and_b32 v20, 31, v20
    v_lshl_add_u32 v21, v20, 4, v21
    v_and_b32 v20, 1, v0
    v_lshl_add_u32 v253, v20, 9, v21
    s_waitcnt vmcnt(9)
    v_mfma_f32_32x32x16_bf16 v[32:47], a[152:155], v[164:167], v[32:47]
    s_sub_u32 s52, 2, s62
    s_and_b32 s52, s52, 3
    s_mul_i32 s53, s62, 5
    s_add_u32 s52, s52, s53
    s_lshl_b32 s51, s52, 4
    v_mfma_f32_32x32x16_bf16 v[48:63], a[156:159], v[164:167], v[48:63]
    buffer_load_dwordx4 v[140:143], v1, s[16:19], s50 offen offset:3072 sc1
    v_lshrrev_b32 v20, 1, v0
    v_add_u32 v20, s51, v20
    v_lshrrev_b32 v21, 5, v20
    v_lshlrev_b32 v21, 17, v21
    v_and_b32 v20, 31, v20
    s_waitcnt vmcnt(9)
    v_mfma_f32_32x32x16_bf16 v[32:47], a[160:163], v[168:171], v[32:47]
    v_lshl_add_u32 v21, v20, 4, v21
    v_and_b32 v20, 1, v0
    v_lshl_add_u32 v254, v20, 9, v21
    s_andn2_b32 s52, 1, s62
    s_lshl_b32 s52, s52, 2
    v_mfma_f32_32x32x16_bf16 v[48:63], a[164:167], v[168:171], v[48:63]
    s_add_u32 s50, s71, 20480
    buffer_load_dwordx4 v[144:147], v1, s[16:19], s50 offen offset:0 sc1
    s_mul_i32 s53, s62, 5
    s_add_u32 s52, s52, s53
    s_lshl_b32 s51, s52, 4
    v_lshrrev_b32 v20, 1, v0
    v_add_u32 v20, s51, v20
    s_waitcnt vmcnt(9)
    v_mfma_f32_32x32x16_bf16 v[32:47], a[168:171], v[172:175], v[32:47]
    v_lshrrev_b32 v21, 5, v20
    v_lshlrev_b32 v21, 17, v21
    v_and_b32 v20, 31, v20
    v_lshl_add_u32 v21, v20, 4, v21
    v_and_b32 v20, 1, v0
    v_mfma_f32_32x32x16_bf16 v[48:63], a[172:175], v[172:175], v[48:63]
    buffer_load_dwordx4 v[148:151], v1, s[16:19], s50 offen offset:1024 sc1
    v_lshl_add_u32 v255, v20, 9, v21
    s_lshl_b32 s51, s68, 4
    v_and_b32 v20, 15, v0
    v_lshlrev_b32 v21, 1, v20
    v_lshlrev_b32 v240, 3, v20
    s_waitcnt vmcnt(9)
    v_mfma_f32_32x32x16_bf16 v[32:47], a[176:179], v[176:179], v[32:47]
    buffer_load_ushort v252, v21, s[36:39], s51 offen
    s_lshl_b32 s69, s68, 6
    s_add_u32 s69, s69, 6242304
    s_lshl_b32 s68, s68, 9
    s_add_u32 s68, s68, 3620864
    v_mfma_f32_32x32x16_bf16 v[48:63], a[180:183], v[176:179], v[48:63]
    buffer_load_dwordx4 v[152:155], v1, s[16:19], s50 offen offset:2048 sc1
    v_lshrrev_b32 v20, 5, v0
    v_lshlrev_b32 v20, 11, v20
    v_bfe_u32 v21, v0, 2, 3
    v_lshl_add_u32 v20, v21, 6, v20
    v_bfe_u32 v21, v0, 4, 1
    s_waitcnt vmcnt(10)
    v_mfma_f32_32x32x16_bf16 v[32:47], a[184:187], v[180:183], v[32:47]
    v_lshl_add_u32 v20, v21, 5, v20
    v_and_b32 v21, 3, v0
    v_lshl_add_u32 v20, v21, 3, v20
    s_and_b32 s52, s40, 1
    s_lshl_b32 s52, s52, 5
    v_mfma_f32_32x32x16_bf16 v[48:63], a[188:191], v[180:183], v[48:63]
    buffer_load_dwordx4 v[156:159], v1, s[16:19], s50 offen offset:3072 sc1
    s_lshr_b32 s51, s40, 1
    s_lshl_b32 s51, s51, 9
    s_or_b32 s52, s52, s51
    s_or_b32 s52, s52, s64
    v_xor_b32 v28, s52, v20
    s_waitcnt vmcnt(10)
    v_mfma_f32_32x32x16_bf16 v[32:47], a[192:195], v[184:187], v[32:47]
    v_xor_b32 v29, 32, v28
    v_xor_b32 v30, 512, v28
    v_xor_b32 v31, 544, v28
    v_lshrrev_b32 v20, 5, v0
    v_lshl_add_u32 v20, v20, 2, v0
    v_mfma_f32_32x32x16_bf16 v[48:63], a[196:199], v[184:187], v[48:63]
    s_add_u32 s50, s71, 24576
    buffer_load_dwordx4 v[160:163], v1, s[16:19], s50 offen offset:0 sc1
    v_and_b32 v21, 48, v0
    v_and_or_b32 v20, v20, 15, v21
    v_lshl_add_u32 v192, v20, 4, s64
    v_xor_b32 v193, 128, v192
    v_lshrrev_b32 v20, 4, v0
    s_waitcnt vmcnt(10)
    v_mfma_f32_32x32x16_bf16 v[32:47], a[200:203], v[188:191], v[32:47]
    v_lshl_add_u32 v20, v20, 2, v0
    v_and_or_b32 v20, v20, 15, v21
    v_lshl_add_u32 v194, v20, 4, s64
    v_lshrrev_b32 v20, 2, v0
    v_lshl_add_u32 v20, v0, 2, v20
    v_mfma_f32_32x32x16_bf16 v[48:63], a[204:207], v[188:191], v[48:63]
    buffer_load_dwordx4 v[164:167], v1, s[16:19], s50 offen offset:1024 sc1
    v_and_b32 v20, 15, v20
    v_lshlrev_b32 v20, 4, v20
    v_and_b32 v21, 3, v0
    v_lshl_add_u32 v204, v21, 8, v20
    v_and_b32 v21, 1, v0
    s_waitcnt vmcnt(10)
    v_mfma_f32_32x32x16_bf16 v[32:47], a[208:211], v[128:131], v[32:47]
    v_lshl_add_u32 v20, v21, 9, v20
    v_bfe_u32 v21, v0, 1, 1
    v_lshl_add_u32 v20, v21, 12, v20
    s_xor_b32 s52, s40, 0
    s_lshl_b32 s52, s52, 15
    v_mfma_f32_32x32x16_bf16 v[48:63], a[212:215], v[128:131], v[48:63]
    buffer_load_dwordx4 v[168:171], v1, s[16:19], s50 offen offset:2048 sc1
    s_add_u32 s52, s52, 32768
    v_add_u32 v195, s52, v20
    v_add_u32 v199, s52, v204
    s_xor_b32 s52, s40, 1
    s_lshl_b32 s52, s52, 15
    s_waitcnt vmcnt(10)
    v_mfma_f32_32x32x16_bf16 v[32:47], a[216:219], v[132:135], v[32:47]
    s_add_u32 s52, s52, 33792
    v_add_u32 v196, s52, v20
    v_add_u32 v200, s52, v204
    s_xor_b32 s52, s40, 2
    s_lshl_b32 s52, s52, 15
    v_mfma_f32_32x32x16_bf16 v[48:63], a[220:223], v[132:135], v[48:63]
    buffer_load_dwordx4 v[172:175], v1, s[16:19], s50 offen offset:3072 sc1
    s_add_u32 s52, s52, 34816
    v_add_u32 v197, s52, v20
    v_add_u32 v201, s52, v204
    s_xor_b32 s52, s40, 3
    s_lshl_b32 s52, s52, 15
    s_waitcnt vmcnt(10)
    v_mfma_f32_32x32x16_bf16 v[32:47], a[224:227], v[136:139], v[32:47]
    s_add_u32 s52, s52, 35840
    v_add_u32 v198, s52, v20
    v_add_u32 v202, s52, v204
    v_lshrrev_b32 v20, 2, v0
    v_mul_u32_u24 v20, 1280, v20
    v_mfma_f32_32x32x16_bf16 v[48:63], a[228:231], v[136:139], v[48:63]
    s_add_u32 s50, s71, 28672
    buffer_load_dwordx4 v[176:179], v1, s[16:19], s50 offen offset:0 sc1
    v_and_b32 v21, 3, v0
    v_lshl_add_u32 v203, v21, 4, v20
    v_lshl_add_u32 v204, v21, 3, v20
    s_lshl_b32 s11, s63, 2
    s_add_u32 s11, s11, s40
    s_waitcnt vmcnt(10)
    v_mfma_f32_32x32x16_bf16 v[32:47], a[232:235], v[140:143], v[32:47]
    s_mul_i32 s11, s11, 20480
    s_mul_i32 s12, s40, 12288
    s_add_u32 s12, s12, 6258688
    s_andn2_b32 s52, 1, s62
    s_lshl_b32 s52, s52, 2
    v_mfma_f32_32x32x16_bf16 v[48:63], a[236:239], v[140:143], v[48:63]
    buffer_load_dwordx4 v[180:183], v1, s[16:19], s50 offen offset:1024 sc1
    s_mul_i32 s53, s62, 5
    s_add_u32 s52, s52, s53
    s_lshl_b32 s51, s52, 5
    s_add_u32 s6, s11, s51
    s_mul_i32 s51, s52, 49152
    s_waitcnt vmcnt(10)
    v_mfma_f32_32x32x16_bf16 v[32:47], a[240:243], v[144:147], v[32:47]
    s_add_u32 s9, s12, s51
    s_sub_u32 s52, 2, s62
    s_and_b32 s52, s52, 3
    s_mul_i32 s53, s62, 5
    s_add_u32 s52, s52, s53
    v_mfma_f32_32x32x16_bf16 v[48:63], a[244:247], v[144:147], v[48:63]
    buffer_load_dwordx4 v[184:187], v1, s[16:19], s50 offen offset:2048 sc1
    s_lshl_b32 s51, s52, 5
    s_add_u32 s5, s11, s51
    s_mul_i32 s51, s52, 49152
    s_add_u32 s8, s12, s51
    s_sub_u32 s52, 0, s62
    s_waitcnt vmcnt(10)
    v_mfma_f32_32x32x16_bf16 v[32:47], a[248:251], v[148:151], v[32:47]
    s_and_b32 s52, s52, 3
    s_mul_i32 s53, s62, 5
    s_add_u32 s52, s52, s53
    s_lshl_b32 s51, s52, 5
    s_add_u32 s4, s11, s51
    v_mfma_f32_32x32x16_bf16 v[48:63], a[252:255], v[148:151], v[48:63]
    buffer_load_dwordx4 v[188:191], v1, s[16:19], s50 offen offset:3072 sc1
    s_mul_i32 s51, s52, 49152
    s_add_u32 s7, s12, s51
    s_lshr_b32 s52, s52, 2
    s_mul_i32 s52, s52, 24
    s_mul_i32 s51, s40, 6
    s_waitcnt vmcnt(9)
    v_mfma_f32_32x32x16_bf16 v[32:47], a[0:3], v[152:155], v[32:47]
    s_add_u32 s52, s52, s51
    s_and_b32 s51, s2, 3
    s_lshl_b32 s51, s51, 8
    s_add_u32 s52, s52, s51
    s_lshl_b32 s52, s52, 5
    v_mfma_f32_32x32x16_bf16 v[48:63], a[4:7], v[152:155], v[48:63]
    s_add_u32 s50, s71, 131072
    buffer_load_dwordx4 v[128:131], v1, s[16:19], s50 offen offset:0 sc1
    s_add_u32 s10, s52, 8388608
    v_min_u32 v20, 5, v0
    v_lshlrev_b32 v205, 5, v20
    s_mov_b32 s66, 0xbdd2d3e8
    s_mov_b32 s67, s66
    s_waitcnt vmcnt(9)
    v_mfma_f32_32x32x16_bf16 v[32:47], a[8:11], v[156:159], v[32:47]
    v_mov_b32 v22, 0xc0135761
    v_mov_b32 v23, v22
    s_mul_i32 s52, s40, 6144
    v_add_u32 v10, s52, v1
    s_xor_b32 s52, s40, 1
    v_mfma_f32_32x32x16_bf16 v[48:63], a[12:15], v[156:159], v[48:63]
    buffer_load_dwordx4 v[132:135], v1, s[16:19], s50 offen offset:1024 sc1
    s_mul_i32 s52, s52, 6144
    v_add_u32 v11, s52, v1
    s_xor_b32 s52, s40, 2
    s_mul_i32 s52, s52, 6144
    v_add_u32 v12, s52, v1
    s_waitcnt vmcnt(9)
    v_mfma_f32_32x32x16_bf16 v[32:47], a[16:19], v[160:163], v[32:47]
    s_xor_b32 s52, s40, 3
    s_mul_i32 s52, s52, 6144
    v_add_u32 v13, s52, v1
    v_bfe_u32 v20, v0, 4, 1
    v_mul_u32_u24 v20, 49152, v20
    v_mfma_f32_32x32x16_bf16 v[48:63], a[20:23], v[160:163], v[48:63]
    buffer_load_dwordx4 v[136:139], v1, s[16:19], s50 offen offset:2048 sc1
    v_lshrrev_b32 v21, 5, v0
    v_lshl_add_u32 v20, v21, 8, v20
    v_and_b32 v21, 15, v0
    v_lshl_add_u32 v14, v21, 4, v20
    s_mul_i32 s70, s60, 196608
    s_waitcnt vmcnt(9)
    v_mfma_f32_32x32x16_bf16 v[32:47], a[24:27], v[164:167], v[32:47]
    s_lshl_b32 s52, s61, 11
    s_add_u32 s70, s70, s52
    s_lshl_b32 s52, s40, 9
    s_add_u32 s70, s70, s52
    s_add_u32 s70, s70, 6258688
    v_mfma_f32_32x32x16_bf16 v[48:63], a[28:31], v[164:167], v[48:63]
    buffer_load_dwordx4 v[140:143], v1, s[16:19], s50 offen offset:3072 sc1
    v_and_b32 v3, 0xffff0000, v96
    v_lshlrev_b32 v2, 16, v96
    v_and_b32 v5, 0xffff0000, v97
    v_lshlrev_b32 v4, 16, v97
    v_and_b32 v7, 0xffff0000, v98
    s_waitcnt vmcnt(9)
    v_mfma_f32_32x32x16_bf16 v[32:47], a[32:35], v[168:171], v[32:47]
    v_lshlrev_b32 v6, 16, v98
    v_and_b32 v9, 0xffff0000, v99
    v_lshlrev_b32 v8, 16, v99
    v_mfma_f32_32x32x16_bf16 v[48:63], a[36:39], v[168:171], v[48:63]
    s_add_u32 s50, s71, 135168
    buffer_load_dwordx4 v[144:147], v1, s[16:19], s50 offen offset:0 sc1
    s_waitcnt vmcnt(9)
    s_waitcnt lgkmcnt(15)
    v_mfma_f32_32x32x16_bf16 v[32:47], a[40:43], v[172:175], v[32:47]
    v_mfma_f32_32x32x16_bf16 v[48:63], a[44:47], v[172:175], v[48:63]
    buffer_load_dwordx4 v[148:151], v1, s[16:19], s50 offen offset:1024 sc1
    s_waitcnt vmcnt(9)
    s_waitcnt lgkmcnt(14)
    v_mfma_f32_32x32x16_bf16 v[32:47], a[48:51], v[176:179], v[32:47]
    s_waitcnt lgkmcnt(12)
    v_mfma_f32_32x32x16_bf16 v[48:63], a[52:55], v[176:179], v[48:63]
    buffer_load_dwordx4 v[152:155], v1, s[16:19], s50 offen offset:2048 sc1
    s_waitcnt vmcnt(9)
    s_waitcnt lgkmcnt(10)
    v_mfma_f32_32x32x16_bf16 v[32:47], a[56:59], v[180:183], v[32:47]
    s_waitcnt lgkmcnt(8)
    v_mfma_f32_32x32x16_bf16 v[48:63], a[60:63], v[180:183], v[48:63]
    buffer_load_dwordx4 v[156:159], v1, s[16:19], s50 offen offset:3072 sc1
    s_waitcnt vmcnt(9)
    s_waitcnt lgkmcnt(6)
    v_mfma_f32_32x32x16_bf16 v[32:47], a[64:67], v[184:187], v[32:47]
    s_waitcnt lgkmcnt(4)
    v_mfma_f32_32x32x16_bf16 v[48:63], a[68:71], v[184:187], v[48:63]
    s_add_u32 s50, s71, 139264
    buffer_load_dwordx4 v[160:163], v1, s[16:19], s50 offen offset:0 sc1
    s_waitcnt vmcnt(9)
    s_waitcnt lgkmcnt(2)
    v_mfma_f32_32x32x16_bf16 v[32:47], a[72:75], v[188:191], v[32:47]
    s_waitcnt lgkmcnt(0)
    v_mfma_f32_32x32x16_bf16 v[48:63], a[76:79], v[188:191], v[48:63]
    buffer_load_dwordx4 v[164:167], v1, s[16:19], s50 offen offset:1024 sc1
    s_waitcnt vmcnt(9)
    v_mfma_f32_32x32x16_bf16 v[64:79], a[80:83], v[128:131], 0
    v_mfma_f32_32x32x16_bf16 v[80:95], a[84:87], v[128:131], 0
    buffer_load_dwordx4 v[168:171], v1, s[16:19], s50 offen offset:2048 sc1
    s_waitcnt vmcnt(9)
    v_mfma_f32_32x32x16_bf16 v[64:79], a[88:91], v[132:135], v[64:79]
    v_mfma_f32_32x32x16_bf16 v[80:95], a[92:95], v[132:135], v[80:95]
    buffer_load_dwordx4 v[172:175], v1, s[16:19], s50 offen offset:3072 sc1
    s_waitcnt vmcnt(9)
    v_mfma_f32_32x32x16_bf16 v[64:79], a[96:99], v[136:139], v[64:79]
    ds_write_b128 v10, v[40:43] offset:0
    v_mfma_f32_32x32x16_bf16 v[80:95], a[100:103], v[136:139], v[80:95]
    s_add_u32 s50, s71, 143360
    buffer_load_dwordx4 v[176:179], v1, s[16:19], s50 offen offset:0 sc1
    ds_write_b128 v10, v[44:47] offset:1024
    s_waitcnt vmcnt(9)
    v_mfma_f32_32x32x16_bf16 v[64:79], a[104:107], v[140:143], v[64:79]
    ds_write_b128 v10, v[48:51] offset:2048
    v_mfma_f32_32x32x16_bf16 v[80:95], a[108:111], v[140:143], v[80:95]
    buffer_load_dwordx4 v[180:183], v1, s[16:19], s50 offen offset:1024 sc1
    ds_write_b128 v10, v[52:55] offset:3072
    s_waitcnt vmcnt(9)
    v_mfma_f32_32x32x16_bf16 v[64:79], a[112:115], v[144:147], v[64:79]
    ds_write_b128 v10, v[56:59] offset:4096
    v_mfma_f32_32x32x16_bf16 v[80:95], a[116:119], v[144:147], v[80:95]
    buffer_load_dwordx4 v[184:187], v1, s[16:19], s50 offen offset:2048 sc1
    ds_write_b128 v10, v[60:63] offset:5120
    s_waitcnt vmcnt(9)
    v_mfma_f32_32x32x16_bf16 v[64:79], a[120:123], v[148:151], v[64:79]
    v_mfma_f32_32x32x16_bf16 v[80:95], a[124:127], v[148:151], v[80:95]
    buffer_load_dwordx4 v[188:191], v1, s[16:19], s50 offen offset:3072 sc1
    s_waitcnt vmcnt(9)
    v_mfma_f32_32x32x16_bf16 v[64:79], a[128:131], v[152:155], v[64:79]
    s_waitcnt lgkmcnt(0)
    s_barrier
    ds_read_b128 v[96:99], v11 offset:0
    ds_read_b128 v[100:103], v11 offset:1024
    ds_read_b128 v[104:107], v12 offset:2048
    ds_read_b128 v[108:111], v12 offset:3072
    ds_read_b128 v[112:115], v13 offset:4096
    v_mfma_f32_32x32x16_bf16 v[80:95], a[132:135], v[152:155], v[80:95]
    s_add_u32 s50, s71, 147456
    buffer_load_dwordx4 v[128:131], v1, s[16:19], s50 offen offset:0 sc1
    ds_read_b128 v[116:119], v13 offset:5120
    s_add_u32 m0, s64, 29696
    s_nop 0
    buffer_load_dwordx4 v253, s[16:19], s68 offen sc1 lds
    s_waitcnt vmcnt(10)
    v_mfma_f32_32x32x16_bf16 v[64:79], a[136:139], v[156:159], v[64:79]
    v_mfma_f32_32x32x16_bf16 v[80:95], a[140:143], v[156:159], v[80:95]
    buffer_load_dwordx4 v[132:135], v1, s[16:19], s50 offen offset:1024 sc1
    s_waitcnt vmcnt(10)
    v_mfma_f32_32x32x16_bf16 v[64:79], a[144:147], v[160:163], v[64:79]
    v_add_f32 v32, v32, v2
    v_add_f32 v33, v33, v3
    v_add_f32 v34, v34, v4
    v_add_f32 v35, v35, v5
    v_add_f32 v36, v36, v6
    v_mfma_f32_32x32x16_bf16 v[80:95], a[148:151], v[160:163], v[80:95]
    buffer_load_dwordx4 v[136:139], v1, s[16:19], s50 offen offset:2048 sc1
    v_add_f32 v37, v37, v7
    v_add_f32 v38, v38, v8
    v_add_f32 v39, v39, v9
    s_waitcnt lgkmcnt(5)
    v_add_f32 v32, v32, v96
    v_add_f32 v33, v33, v97
    s_add_u32 m0, s64, 30720
    s_nop 0
    buffer_load_dwordx4 v254, s[16:19], s68 offen sc1 lds
    s_waitcnt vmcnt(11)
    v_mfma_f32_32x32x16_bf16 v[64:79], a[152:155], v[164:167], v[64:79]
    v_add_f32 v34, v34, v98
    v_add_f32 v35, v35, v99
    s_waitcnt lgkmcnt(4)
    v_add_f32 v36, v36, v100
    v_add_f32 v37, v37, v101
    v_add_f32 v38, v38, v102
    v_mfma_f32_32x32x16_bf16 v[80:95], a[156:159], v[164:167], v[80:95]
    buffer_load_dwordx4 v[140:143], v1, s[16:19], s50 offen offset:3072 sc1
    v_add_f32 v39, v39, v103
    s_waitcnt lgkmcnt(1)
    v_add_f32 v104, v104, v112
    v_add_f32 v105, v105, v113
    v_add_f32 v106, v106, v114
    v_add_f32 v107, v107, v115
    s_waitcnt vmcnt(11)
    v_mfma_f32_32x32x16_bf16 v[64:79], a[160:163], v[168:171], v[64:79]
L_hop7:
    s_cbranch_execz L_hop_back
    s_waitcnt lgkmcnt(0)
    v_add_f32 v108, v108, v116
    v_add_f32 v109, v109, v117
    v_add_f32 v110, v110, v118
    v_add_f32 v111, v111, v119
    v_add_f32 v32, v32, v104
    v_mfma_f32_32x32x16_bf16 v[80:95], a[164:167], v[168:171], v[80:95]
    s_add_u32 s50, s71, 151552
    buffer_load_dwordx4 v[144:147], v1, s[16:19], s50 offen offset:0 sc1
    v_add_f32 v33, v33, v105
    v_add_f32 v34, v34, v106
    v_add_f32 v35, v35, v107
    v_add_f32 v36, v36, v108
    v_add_f32 v37, v37, v109
    s_add_u32 m0, s64, 31744
    s_nop 0
    buffer_load_dwordx4 v255, s[16:19], s68 offen sc1 lds
    s_waitcnt vmcnt(12)
    v_mfma_f32_32x32x16_bf16 v[64:79], a[168:171], v[172:175], v[64:79]
    v_add_f32 v38, v38, v110
    v_add_f32 v39, v39, v111
    v_mul_f32 v120, v32, v32
    v_mul_f32 v121, v33, v33
    v_mul_f32 v122, v34, v34
    v_mfma_f32_32x32x16_bf16 v[80:95], a[172:175], v[172:175], v[80:95]
    buffer_load_dwordx4 v[148:151], v1, s[16:19], s50 offen offset:1024 sc1
    v_mul_f32 v123, v35, v35
    v_mul_f32 v124, v36, v36
    v_mul_f32 v125, v37, v37
    v_mul_f32 v126, v38, v38
    v_mul_f32 v127, v39, v39
    s_waitcnt vmcnt(12)
    v_mfma_f32_32x32x16_bf16 v[64:79], a[176:179], v[176:179], v[64:79]
    v_fma_f32 v120, v120, s66, v22
    v_fma_f32 v121, v121, s66, v22
    v_fma_f32 v122, v122, s66, v22
    v_fma_f32 v123, v123, s66, v22
    v_fma_f32 v124, v124, s66, v22
    v_mfma_f32_32x32x16_bf16 v[80:95], a[180:183], v[176:179], v[80:95]
    buffer_load_dwordx4 v[152:155], v1, s[16:19], s50 offen offset:2048 sc1
    v_fma_f32 v125, v125, s66, v22
    v_fma_f32 v126, v126, s66, v22
    v_fma_f32 v127, v127, s66, v22
    v_mul_f32 v120, v120, v32
    v_mul_f32 v121, v121, v33
    buffer_load_dwordx2 v[250:251], v240, s[16:19], s69 offen sc1
    v_lshl_add_u32 v253, v0, 3, s64
    s_waitcnt vmcnt(13)
    v_mfma_f32_32x32x16_bf16 v[64:79], a[184:187], v[180:183], v[64:79]
    v_mul_f32 v122, v122, v34
    v_mul_f32 v123, v123, v35
    v_mul_f32 v124, v124, v36
    v_mul_f32 v125, v125, v37
    v_mul_f32 v126, v126, v38
    v_mfma_f32_32x32x16_bf16 v[80:95], a[188:191], v[180:183], v[80:95]
    buffer_load_dwordx4 v[156:159], v1, s[16:19], s50 offen offset:3072 sc1
    v_mul_f32 v127, v127, v39
    v_exp_f32 v120, v120
    v_exp_f32 v121, v121
    s_waitcnt vmcnt(13)
    v_mfma_f32_32x32x16_bf16 v[64:79], a[192:195], v[184:187], v[64:79]
    v_exp_f32 v122, v122
    v_exp_f32 v123, v123
    v_exp_f32 v124, v124
    v_mfma_f32_32x32x16_bf16 v[80:95], a[196:199], v[184:187], v[80:95]
    s_add_u32 s50, s71, 155648
    buffer_load_dwordx4 v[160:163], v1, s[16:19], s50 offen offset:0 sc1
    v_exp_f32 v125, v125
    v_exp_f32 v126, v126
    v_exp_f32 v127, v127
    s_waitcnt vmcnt(13)
    v_mfma_f32_32x32x16_bf16 v[64:79], a[200:203], v[188:191], v[64:79]
    v_add_f32 v120, 1.0, v120
    v_add_f32 v121, 1.0, v121
    v_add_f32 v122, 1.0, v122
    v_add_f32 v123, 1.0, v123
    v_add_f32 v124, 1.0, v124
    v_mfma_f32_32x32x16_bf16 v[80:95], a[204:207], v[188:191], v[80:95]
    buffer_load_dwordx4 v[164:167], v1, s[16:19], s50 offen offset:1024 sc1
    v_add_f32 v125, 1.0, v125
    v_add_f32 v126, 1.0, v126
    v_add_f32 v127, 1.0, v127
    v_rcp_f32 v120, v120
    s_waitcnt vmcnt(13)
    v_mfma_f32_32x32x16_bf16 v[64:79], a[208:211], v[128:131], v[64:79]
    v_rcp_f32 v121, v121
    v_rcp_f32 v122, v122
    v_rcp_f32 v123, v123
    v_mfma_f32_32x32x16_bf16 v[80:95], a[212:215], v[128:131], v[80:95]
    buffer_load_dwordx4 v[168:171], v1, s[16:19], s50 offen offset:2048 sc1
    v_rcp_f32 v124, v124
    v_rcp_f32 v125, v125
    v_rcp_f32 v126, v126
    s_waitcnt vmcnt(12)
    v_mfma_f32_32x32x16_bf16 v[64:79], a[216:219], v[132:135], v[64:79]
    v_rcp_f32 v127, v127
    v_mul_f32 v32, v120, v32
    v_mul_f32 v33, v121, v33
    v_mul_f32 v34, v122, v34
    v_mfma_f32_32x32x16_bf16 v[80:95], a[220:223], v[132:135], v[80:95]
    buffer_load_dwordx4 v[172:175], v1, s[16:19], s50 offen offset:3072 sc1
    v_mul_f32 v35, v123, v35
    v_mul_f32 v36, v124, v36
    v_mul_f32 v37, v125, v37
    v_mul_f32 v38, v126, v38
    v_mul_f32 v39, v127, v39
    s_waitcnt vmcnt(12)
    v_mfma_f32_32x32x16_bf16 v[64:79], a[224:227], v[136:139], v[64:79]
    v_cvt_pk_bf16_f32 v120, v32, v33
    v_cvt_pk_bf16_f32 v121, v34, v35
    v_cvt_pk_bf16_f32 v122, v36, v37
    v_cvt_pk_bf16_f32 v123, v38, v39
    v_mfma_f32_32x32x16_bf16 v[80:95], a[228:231], v[136:139], v[80:95]
    s_add_u32 s50, s71, 159744
    buffer_load_dwordx4 v[176:179], v1, s[16:19], s50 offen offset:0 sc1
    s_waitcnt vmcnt(11)
    v_mfma_f32_32x32x16_bf16 v[64:79], a[232:235], v[140:143], v[64:79]
    v_mfma_f32_32x32x16_bf16 v[80:95], a[236:239], v[140:143], v[80:95]
    buffer_load_dwordx4 v[180:183], v1, s[16:19], s50 offen offset:1024 sc1
    s_waitcnt vmcnt(11)
    v_mfma_f32_32x32x16_bf16 v[64:79], a[240:243], v[144:147], v[64:79]
    v_mfma_f32_32x32x16_bf16 v[80:95], a[244:247], v[144:147], v[80:95]
    buffer_load_dwordx4 v[184:187], v1, s[16:19], s50 offen offset:2048 sc1
    s_waitcnt vmcnt(10)
    v_mfma_f32_32x32x16_bf16 v[64:79], a[248:251], v[148:151], v[64:79]
    v_mfma_f32_32x32x16_bf16 v[80:95], a[252:255], v[148:151], v[80:95]
    buffer_load_dwordx4 v[188:191], v1, s[16:19], s50 offen offset:3072 sc1
    s_waitcnt vmcnt(10)
    v_mfma_f32_32x32x16_bf16 v[64:79], a[0:3], v[152:155], v[64:79]
    buffer_store_dwordx4 v[120:123], v14, s[16:19], s70 offen sc1
    s_barrier
    s_add_u32 s51, s56, 131072
    buffer_store_dword v26, v25, s[16:19], s51 offen sc1
    ds_read_b64_tr_b16 v[240:241], v253 offset:29696
    ds_read_b64_tr_b16 v[242:243], v253 offset:30208
    v_mfma_f32_32x32x16_bf16 v[80:95], a[4:7], v[152:155], v[80:95]
    s_add_u32 m0, s64, 20480
    s_mov_b32 s65, 718848
    buffer_load_dwordx4 v15, s[28:31], s65 offen offset:2048 lds
    ds_read_b64_tr_b16 v[244:245], v253 offset:30720
    ds_read_b64_tr_b16 v[246:247], v253 offset:31232
    ds_read_b64_tr_b16 v[248:249], v253 offset:31744
    s_lshl_b32 s51, s41, 5
    s_add_u32 s51, s51, 8290304
    s_waitcnt vmcnt(11)
    v_mfma_f32_32x32x16_bf16 v[64:79], a[8:11], v[156:159], v[64:79]
    buffer_store_dword v26, v25, s[16:19], s51 offen sc1
    v_mfma_f32_32x32x16_bf16 v[80:95], a[12:15], v[156:159], v[80:95]
    s_mov_b32 s65, 734208
    buffer_load_dwordx4 v15, s[28:31], s65 offen offset:3072 lds
    v_lshlrev_b32 v252, 16, v252
    v_add_f32 v250, v250, v252
    s_waitcnt lgkmcnt(4)
    v_lshlrev_b32 v208, 16, v240
    v_and_b32 v209, 0xffff0000, v240
    v_lshlrev_b32 v210, 16, v241
    s_waitcnt vmcnt(12)
    v_mfma_f32_32x32x16_bf16 v[64:79], a[16:19], v[160:163], v[64:79]
    v_and_b32 v211, 0xffff0000, v241
    v_fma_f32 v208, v208, v251, v250
    v_fma_f32 v209, v209, v251, v250
    v_fma_f32 v210, v210, v251, v250
    v_fma_f32 v211, v211, v251, v250
    v_mfma_f32_32x32x16_bf16 v[80:95], a[20:23], v[160:163], v[80:95]
    s_add_u32 m0, s64, 24576
    s_mov_b32 s65, 786432
    buffer_load_dwordx4 v15, s[28:31], s65 offen offset:0 lds
    s_waitcnt lgkmcnt(3)
    v_lshlrev_b32 v212, 16, v242
    v_and_b32 v213, 0xffff0000, v242
    v_lshlrev_b32 v214, 16, v243
    v_and_b32 v215, 0xffff0000, v243
    v_fma_f32 v212, v212, v251, v250
    s_waitcnt vmcnt(12)
    v_mfma_f32_32x32x16_bf16 v[64:79], a[24:27], v[164:167], v[64:79]
    v_fma_f32 v213, v213, v251, v250
    v_fma_f32 v214, v214, v251, v250
    v_fma_f32 v215, v215, v251, v250
    s_waitcnt lgkmcnt(2)
    v_lshlrev_b32 v216, 16, v244
    v_and_b32 v217, 0xffff0000, v244
    v_mfma_f32_32x32x16_bf16 v[80:95], a[28:31], v[164:167], v[80:95]
    s_mov_b32 s65, 801792
    buffer_load_dwordx4 v15, s[28:31], s65 offen offset:1024 lds
    v_lshlrev_b32 v218, 16, v245
    v_and_b32 v219, 0xffff0000, v245
    v_fma_f32 v216, v216, v251, v250
    v_fma_f32 v217, v217, v251, v250
    v_fma_f32 v218, v218, v251, v250
    s_waitcnt vmcnt(12)
    v_mfma_f32_32x32x16_bf16 v[64:79], a[32:35], v[168:171], v[64:79]
    v_fma_f32 v219, v219, v251, v250
    s_waitcnt lgkmcnt(1)
    v_lshlrev_b32 v220, 16, v246
    v_and_b32 v221, 0xffff0000, v246
    v_lshlrev_b32 v222, 16, v247
    v_and_b32 v223, 0xffff0000, v247
    v_mfma_f32_32x32x16_bf16 v[80:95], a[36:39], v[168:171], v[80:95]
    s_mov_b32 s65, 849920
    buffer_load_dwordx4 v15, s[28:31], s65 offen offset:2048 lds
    v_fma_f32 v220, v220, v251, v250
    v_fma_f32 v221, v221, v251, v250
    v_fma_f32 v222, v222, v251, v250
    v_fma_f32 v223, v223, v251, v250
    s_waitcnt lgkmcnt(0)
    v_lshlrev_b32 v224, 16, v248
    s_waitcnt vmcnt(12)
    v_mfma_f32_32x32x16_bf16 v[64:79], a[40:43], v[172:175], v[64:79]
    v_and_b32 v225, 0xffff0000, v248
    v_lshlrev_b32 v226, 16, v249
    v_and_b32 v227, 0xffff0000, v249
    v_fma_f32 v224, v224, v251, v250
    v_fma_f32 v225, v225, v251, v250
    v_mfma_f32_32x32x16_bf16 v[80:95], a[44:47], v[172:175], v[80:95]
    s_mov_b32 s65, 865280
    buffer_load_dwordx4 v15, s[28:31], s65 offen offset:3072 lds
    v_fma_f32 v226, v226, v251, v250
    v_fma_f32 v227, v227, v251, v250
    s_waitcnt vmcnt(12)
    v_mfma_f32_32x32x16_bf16 v[64:79], a[48:51], v[176:179], v[64:79]
    v_mfma_f32_32x32x16_bf16 v[80:95], a[52:55], v[176:179], v[80:95]
    s_add_u32 m0, s64, 28672
    s_mov_b32 s65, 917504
    buffer_load_dwordx4 v15, s[28:31], s65 offen offset:0 lds
    s_waitcnt vmcnt(12)
    v_mfma_f32_32x32x16_bf16 v[64:79], a[56:59], v[180:183], v[64:79]
    v_mfma_f32_32x32x16_bf16 v[80:95], a[60:63], v[180:183], v[80:95]
    s_mov_b32 s65, 932864
    buffer_load_dwordx4 v15, s[28:31], s65 offen offset:1024 lds
    s_waitcnt vmcnt(12)
    v_mfma_f32_32x32x16_bf16 v[64:79], a[64:67], v[184:187], v[64:79]
    v_mfma_f32_32x32x16_bf16 v[80:95], a[68:71], v[184:187], v[80:95]
    s_mov_b32 s65, 980992
    buffer_load_dwordx4 v15, s[28:31], s65 offen offset:2048 lds
    s_waitcnt vmcnt(12)
    v_mfma_f32_32x32x16_bf16 v[64:79], a[72:75], v[188:191], v[64:79]
    v_mfma_f32_32x32x16_bf16 v[80:95], a[76:79], v[188:191], v[80:95]
    s_mov_b32 s65, 996352
    buffer_load_dwordx4 v15, s[28:31], s65 offen offset:3072 lds
    s_nop 8
    ds_write_b128 v10, v[72:75] offset:0
    ds_write_b128 v10, v[76:79] offset:1024
    ds_write_b128 v10, v[80:83] offset:2048
    ds_write_b128 v10, v[84:87] offset:3072
    ds_write_b128 v10, v[88:91] offset:4096
    ds_write_b128 v10, v[92:95] offset:5120
    v_add_f32 v20, v40, v72
    ds_write_b32 v19, v20 offset:24576
    s_waitcnt lgkmcnt(0)
    s_barrier
    ds_read_b128 v[236:239], v1 offset:24576
    ds_read_b128 v[96:99], v11 offset:0
    ds_read_b128 v[100:103], v11 offset:1024
    ds_read_b128 v[104:107], v12 offset:2048
    ds_read_b128 v[108:111], v12 offset:3072
    ds_read_b128 v[112:115], v13 offset:4096
    ds_read_b128 v[116:119], v13 offset:5120
    s_waitcnt lgkmcnt(6)
    v_cmp_u_f32 vcc, v236, v237
    v_cmp_u_f32 s[58:59], v238, v239
    s_nop 0
    s_or_b64 vcc, vcc, s[58:59]
    s_cbranch_vccnz L_redo3
L_t3:
    v_pk_add_f32 v[64:65], v[64:65], v[2:3]
    v_pk_add_f32 v[66:67], v[66:67], v[4:5]
    v_pk_add_f32 v[68:69], v[68:69], v[6:7]
    v_pk_add_f32 v[70:71], v[70:71], v[8:9]
    s_waitcnt lgkmcnt(5)
    v_pk_add_f32 v[64:65], v[64:65], v[96:97]
    ds_read_b64_tr_b16 a[0:1], v28 offset:0
    ds_read_b64_tr_b16 a[2:3], v28 offset:1024
    v_pk_add_f32 v[66:67], v[66:67], v[98:99]
    ds_read_b64_tr_b16 a[4:5], v29 offset:0
    ds_read_b64_tr_b16 a[6:7], v29 offset:1024
    s_waitcnt lgkmcnt(8)
    v_pk_add_f32 v[68:69], v[68:69], v[100:101]
    ds_read_b64_tr_b16 a[8:9], v30 offset:0
    ds_read_b64_tr_b16 a[10:11], v30 offset:1024
    v_pk_add_f32 v[70:71], v[70:71], v[102:103]
    ds_read_b64_tr_b16 a[12:13], v31 offset:0
    ds_read_b64_tr_b16 a[14:15], v31 offset:1024
    s_waitcnt lgkmcnt(9)
    v_pk_add_f32 v[104:105], v[104:105], v[112:113]
    ds_read_b64_tr_b16 a[16:17], v28 offset:4096
    ds_read_b64_tr_b16 a[18:19], v28 offset:5120
    v_pk_add_f32 v[106:107], v[106:107], v[114:115]
    ds_read_b64_tr_b16 a[20:21], v29 offset:4096
    ds_read_b64_tr_b16 a[22:23], v29 offset:5120
    s_waitcnt lgkmcnt(12)
    v_pk_add_f32 v[108:109], v[108:109], v[116:117]
    ds_read_b64_tr_b16 a[24:25], v30 offset:4096
    ds_read_b64_tr_b16 a[26:27], v30 offset:5120
    v_pk_add_f32 v[110:111], v[110:111], v[118:119]
    ds_read_b64_tr_b16 a[28:29], v31 offset:4096
    ds_read_b64_tr_b16 a[30:31], v31 offset:5120
    v_pk_add_f32 v[64:65], v[64:65], v[104:105]
    ds_read_b64_tr_b16 a[32:33], v28 offset:8192
    ds_read_b64_tr_b16 a[34:35], v28 offset:9216
    v_pk_add_f32 v[66:67], v[66:67], v[106:107]
    ds_read_b64_tr_b16 a[36:37], v29 offset:8192
    ds_read_b64_tr_b16 a[38:39], v29 offset:9216
    v_pk_add_f32 v[68:69], v[68:69], v[108:109]
    ds_read_b64_tr_b16 a[40:41], v30 offset:8192
    ds_read_b64_tr_b16 a[42:43], v30 offset:9216
    v_pk_add_f32 v[70:71], v[70:71], v[110:111]
    ds_read_b64_tr_b16 a[44:45], v31 offset:8192
    ds_read_b64_tr_b16 a[46:47], v31 offset:9216
    s_waitcnt lgkmcnt(15)
    s_add_u32 m0, s64, 0
    s_mov_b32 s65, 1048576
    buffer_load_dwordx4 v15, s[28:31], s65 offen offset:0 lds
    v_pk_mul_f32 v[120:121], v[64:65], v[64:65]
    ds_read_b64_tr_b16 a[48:49], v28 offset:12288
    ds_read_b64_tr_b16 a[50:51], v28 offset:13312
    v_pk_mul_f32 v[122:123], v[66:67], v[66:67]
    ds_read_b64_tr_b16 a[52:53], v29 offset:12288
    ds_read_b64_tr_b16 a[54:55], v29 offset:13312
    v_pk_mul_f32 v[124:125], v[68:69], v[68:69]
    ds_read_b64_tr_b16 a[56:57], v30 offset:12288
    ds_read_b64_tr_b16 a[58:59], v30 offset:13312
    s_mov_b32 s65, 1063936
    buffer_load_dwordx4 v15, s[28:31], s65 offen offset:1024 lds
    v_pk_mul_f32 v[126:127], v[70:71], v[70:71]
    ds_read_b64_tr_b16 a[60:61], v31 offset:12288
    ds_read_b64_tr_b16 a[62:63], v31 offset:13312
    v_pk_fma_f32 v[120:121], v[120:121], s[66:67], v[22:23]
    v_pk_fma_f32 v[122:123], v[122:123], s[66:67], v[22:23]
    s_mov_b32 s65, 1112064
    buffer_load_dwordx4 v15, s[28:31], s65 offen offset:2048 lds
    v_pk_fma_f32 v[124:125], v[124:125], s[66:67], v[22:23]
    v_pk_fma_f32 v[126:127], v[126:127], s[66:67], v[22:23]
    v_pk_mul_f32 v[120:121], v[120:121], v[64:65]
    s_mov_b32 s65, 1127424
    buffer_load_dwordx4 v15, s[28:31], s65 offen offset:3072 lds
    v_pk_mul_f32 v[122:123], v[122:123], v[66:67]
    v_pk_mul_f32 v[124:125], v[124:125], v[68:69]
    v_pk_mul_f32 v[126:127], v[126:127], v[70:71]
    s_waitcnt lgkmcnt(15)
    s_add_u32 m0, s64, 4096
    s_mov_b32 s65, 1179648
    buffer_load_dwordx4 v15, s[28:31], s65 offen offset:0 lds
    v_exp_f32 v120, v120
    v_exp_f32 v121, v121
    buffer_load_dword v206, v205, s[16:19], s10 offen sc1
    v_exp_f32 v122, v122
    s_mov_b32 s65, 1195008
    buffer_load_dwordx4 v15, s[28:31], s65 offen offset:1024 lds
    v_exp_f32 v123, v123
    v_exp_f32 v124, v124
    v_exp_f32 v125, v125
    s_mov_b32 s65, 1243136
    buffer_load_dwordx4 v15, s[28:31], s65 offen offset:2048 lds
    v_exp_f32 v126, v126
    v_exp_f32 v127, v127
    v_pk_add_f32 v[120:121], v[120:121], 1.0 op_sel_hi:[1,0]
    s_mov_b32 s65, 1258496
    buffer_load_dwordx4 v15, s[28:31], s65 offen offset:3072 lds
    v_pk_add_f32 v[122:123], v[122:123], 1.0 op_sel_hi:[1,0]
    v_pk_add_f32 v[124:125], v[124:125], 1.0 op_sel_hi:[1,0]
    v_pk_add_f32 v[126:127], v[126:127], 1.0 op_sel_hi:[1,0]
    v_rcp_f32 v120, v120
    v_rcp_f32 v121, v121
    v_rcp_f32 v122, v122
    v_rcp_f32 v123, v123
    v_rcp_f32 v124, v124
    v_rcp_f32 v125, v125
    v_rcp_f32 v126, v126
    v_rcp_f32 v127, v127
    v_pk_mul_f32 v[64:65], v[120:121], v[64:65]
    v_pk_mul_f32 v[66:67], v[122:123], v[66:67]
    v_pk_mul_f32 v[68:69], v[124:125], v[68:69]
    v_pk_mul_f32 v[70:71], v[126:127], v[70:71]
    v_cvt_pk_bf16_f32 v120, v64, v65
    v_cvt_pk_bf16_f32 v121, v66, v67
    v_cvt_pk_bf16_f32 v122, v68, v69
    v_cvt_pk_bf16_f32 v123, v70, v71
    s_add_u32 s70, s70, 98304
    buffer_store_dwordx4 v[120:123], v14, s[16:19], s70 offen sc1
L_join3:
    s_barrier
    buffer_store_dword v26, v25, s[16:19], s56 offen sc1
    s_waitcnt vmcnt(5)
    v_cmp_ne_u32 vcc, 1, v206
    s_nop 0
    s_cbranch_vccz L_s3a_end
    s_mov_b32 s54, 0x40000
L_s3a:
    buffer_load_dword v206, v205, s[16:19], s10 offen sc1
    s_waitcnt vmcnt(0)
    v_cmp_ne_u32 vcc, 1, v206
    s_sub_u32 s54, s54, 1
    s_cbranch_scc1 L_s3a_x
    s_cbranch_vccnz L_s3a
L_s3a_x:
L_s3a_end:
    s_waitcnt lgkmcnt(0)
    s_add_u32 s50, s7, 0
    buffer_load_dwordx4 v[128:131], v1, s[16:19], s50 offen offset:0 sc1
    buffer_load_dwordx4 v[132:135], v1, s[16:19], s50 offen offset:1024 sc1
    buffer_load_dwordx4 v[136:139], v1, s[16:19], s50 offen offset:2048 sc1
    buffer_load_dwordx4 v[140:143], v1, s[16:19], s50 offen offset:3072 sc1
    s_add_u32 s50, s7, 4096
    buffer_load_dwordx4 v[144:147], v1, s[16:19], s50 offen offset:0 sc1
    buffer_load_dwordx4 v[148:151], v1, s[16:19], s50 offen offset:1024 sc1
    buffer_load_dwordx4 v[152:155], v1, s[16:19], s50 offen offset:2048 sc1
    buffer_load_dwordx4 v[156:159], v1, s[16:19], s50 offen offset:3072 sc1
    s_add_u32 s50, s7, 49152
    buffer_load_dwordx4 v[160:163], v1, s[16:19], s50 offen offset:0 sc1
    buffer_load_dwordx4 v[164:167], v1, s[16:19], s50 offen offset:1024 sc1
    s_waitcnt vmcnt(9)
    v_mfma_f32_16x16x32_bf16 v[32:35], v[128:131], a[0:3], v[208:211]
    ds_read_b64_tr_b16 a[64:65], v28 offset:16384
    ds_read_b64_tr_b16 a[66:67], v28 offset:17408
    ds_read_b64_tr_b16 a[68:69], v29 offset:16384
    v_mfma_f32_16x16x32_bf16 v[36:39], v[128:131], a[4:7], 0
    s_add_u32 m0, s64, 8192
    s_mov_b32 s65, 1310720
    buffer_load_dwordx4 v15, s[28:31], s65 offen offset:0 lds
    ds_read_b64_tr_b16 a[70:71], v29 offset:17408
    ds_read_b64_tr_b16 a[72:73], v30 offset:16384
    ds_read_b64_tr_b16 a[74:75], v30 offset:17408
    v_mfma_f32_16x16x32_bf16 v[40:43], v[128:131], a[8:11], 0
    ds_read_b64_tr_b16 a[76:77], v31 offset:16384
    ds_read_b64_tr_b16 a[78:79], v31 offset:17408
    v_mfma_f32_16x16x32_bf16 v[44:47], v[128:131], a[12:15], 0
    s_mov_b32 s65, 1326080
    buffer_load_dwordx4 v15, s[28:31], s65 offen offset:1024 lds
    buffer_load_dwordx4 v[168:171], v1, s[16:19], s50 offen offset:2048 sc1
    s_waitcnt vmcnt(11)
    v_mfma_f32_16x16x32_bf16 v[32:35], v[132:135], a[16:19], v[32:35]
    ds_read_b64_tr_b16 a[80:81], v28 offset:20480
    ds_read_b64_tr_b16 a[82:83], v28 offset:21504
    ds_read_b64_tr_b16 a[84:85], v29 offset:20480
    v_mfma_f32_16x16x32_bf16 v[36:39], v[132:135], a[20:23], v[36:39]
    s_mov_b32 s65, 1374208
    buffer_load_dwordx4 v15, s[28:31], s65 offen offset:2048 lds
    ds_read_b64_tr_b16 a[86:87], v29 offset:21504
    ds_read_b64_tr_b16 a[88:89], v30 offset:20480
    ds_read_b64_tr_b16 a[90:91], v30 offset:21504
    v_mfma_f32_16x16x32_bf16 v[40:43], v[132:135], a[24:27], v[40:43]
    ds_read_b64_tr_b16 a[92:93], v31 offset:20480
    ds_read_b64_tr_b16 a[94:95], v31 offset:21504
    v_mfma_f32_16x16x32_bf16 v[44:47], v[132:135], a[28:31], v[44:47]
    s_mov_b32 s65, 1389568
    buffer_load_dwordx4 v15, s[28:31], s65 offen offset:3072 lds
    buffer_load_dwordx4 v[172:175], v1, s[16:19], s50 offen offset:3072 sc1
    s_waitcnt vmcnt(13)
    v_mfma_f32_16x16x32_bf16 v[32:35], v[136:139], a[32:35], v[32:35]
    ds_read_b64_tr_b16 a[96:97], v28 offset:24576
    ds_read_b64_tr_b16 a[98:99], v28 offset:25600
    ds_read_b64_tr_b16 a[100:101], v29 offset:24576
    v_mfma_f32_16x16x32_bf16 v[36:39], v[136:139], a[36:39], v[36:39]
    s_add_u32 m0, s64, 12288
    s_mov_b32 s65, 1441792
    buffer_load_dwordx4 v15, s[28:31], s65 offen offset:0 lds
    ds_read_b64_tr_b16 a[102:103], v29 offset:25600
    ds_read_b64_tr_b16 a[104:105], v30 offset:24576
    ds_read_b64_tr_b16 a[106:107], v30 offset:25600
    v_mfma_f32_16x16x32_bf16 v[40:43], v[136:139], a[40:43], v[40:43]
    ds_read_b64_tr_b16 a[108:109], v31 offset:24576
    ds_read_b64_tr_b16 a[110:111], v31 offset:25600
    v_mfma_f32_16x16x32_bf16 v[44:47], v[136:139], a[44:47], v[44:47]
    s_mov_b32 s65, 1457152
    buffer_load_dwordx4 v15, s[28:31], s65 offen offset:1024 lds
    s_add_u32 s50, s7, 53248
    buffer_load_dwordx4 v[176:179], v1, s[16:19], s50 offen offset:0 sc1
    s_waitcnt vmcnt(15)
    v_mfma_f32_16x16x32_bf16 v[32:35], v[140:143], a[48:51], v[32:35]
    ds_read_b64_tr_b16 a[112:113], v28 offset:28672
    ds_read_b64_tr_b16 a[114:115], v28 offset:29696
    ds_read_b64_tr_b16 a[116:117], v29 offset:28672
    v_mfma_f32_16x16x32_bf16 v[36:39], v[140:143], a[52:55], v[36:39]
    s_mov_b32 s65, 1505280
    buffer_load_dwordx4 v15, s[28:31], s65 offen offset:2048 lds
    ds_read_b64_tr_b16 a[118:119], v29 offset:29696
    ds_read_b64_tr_b16 a[120:121], v30 offset:28672
    ds_read_b64_tr_b16 a[122:123], v30 offset:29696
    v_mfma_f32_16x16x32_bf16 v[40:43], v[140:143], a[56:59], v[40:43]
    ds_read_b64_tr_b16 a[124:125], v31 offset:28672
    ds_read_b64_tr_b16 a[126:127], v31 offset:29696
    v_mfma_f32_16x16x32_bf16 v[44:47], v[140:143], a[60:63], v[44:47]
    s_mov_b32 s65, 1520640
    buffer_load_dwordx4 v15, s[28:31], s65 offen offset:3072 lds
    buffer_load_dwordx4 v[180:183], v1, s[16:19], s50 offen offset:1024 sc1
    s_waitcnt vmcnt(17)
    s_waitcnt lgkmcnt(15)
    v_mfma_f32_16x16x32_bf16 v[32:35], v[144:147], a[64:67], v[32:35]
    v_mfma_f32_16x16x32_bf16 v[36:39], v[144:147], a[68:71], v[36:39]
    v_mfma_f32_16x16x32_bf16 v[40:43], v[144:147], a[72:75], v[40:43]
    v_mfma_f32_16x16x32_bf16 v[44:47], v[144:147], a[76:79], v[44:47]
    buffer_load_dwordx4 v[184:187], v1, s[16:19], s50 offen offset:2048 sc1
    buffer_load_dword v24, v27, s[16:19], s57 offen sc1
    s_waitcnt vmcnt(18)
    v_mfma_f32_16x16x32_bf16 v[32:35], v[148:151], a[80:83], v[32:35]
    v_mfma_f32_16x16x32_bf16 v[36:39], v[148:151], a[84:87], v[36:39]
    v_mfma_f32_16x16x32_bf16 v[40:43], v[148:151], a[88:91], v[40:43]
    v_mfma_f32_16x16x32_bf16 v[44:47], v[148:151], a[92:95], v[44:47]
    buffer_load_dwordx4 v[188:191], v1, s[16:19], s50 offen offset:3072 sc1
    s_waitcnt vmcnt(18)
    s_waitcnt lgkmcnt(14)
    v_mfma_f32_16x16x32_bf16 v[32:35], v[152:155], a[96:99], v[32:35]
    s_waitcnt lgkmcnt(12)
    v_mfma_f32_16x16x32_bf16 v[36:39], v[152:155], a[100:103], v[36:39]
    s_waitcnt lgkmcnt(10)
    v_mfma_f32_16x16x32_bf16 v[40:43], v[152:155], a[104:107], v[40:43]
    s_waitcnt lgkmcnt(8)
    v_mfma_f32_16x16x32_bf16 v[44:47], v[152:155], a[108:111], v[44:47]
    s_add_u32 s50, s7, 8192
    buffer_load_dwordx4 v[128:131], v1, s[16:19], s50 offen offset:0 sc1
    s_waitcnt vmcnt(18)
    s_waitcnt lgkmcnt(6)
    v_mfma_f32_16x16x32_bf16 v[32:35], v[156:159], a[112:115], v[32:35]
    s_waitcnt lgkmcnt(4)
    v_mfma_f32_16x16x32_bf16 v[36:39], v[156:159], a[116:119], v[36:39]
    s_waitcnt lgkmcnt(2)
    v_mfma_f32_16x16x32_bf16 v[40:43], v[156:159], a[120:123], v[40:43]
    s_waitcnt lgkmcnt(0)
    v_mfma_f32_16x16x32_bf16 v[44:47], v[156:159], a[124:127], v[44:47]
    buffer_load_dwordx4 v[132:135], v1, s[16:19], s50 offen offset:1024 sc1
    s_waitcnt vmcnt(18)
    v_mfma_f32_16x16x32_bf16 v[48:51], v[160:163], a[0:3], v[212:215]
    v_mfma_f32_16x16x32_bf16 v[52:55], v[160:163], a[4:7], 0
    v_mfma_f32_16x16x32_bf16 v[56:59], v[160:163], a[8:11], 0
    v_mfma_f32_16x16x32_bf16 v[60:63], v[160:163], a[12:15], 0
    buffer_load_dwordx4 v[136:139], v1, s[16:19], s50 offen offset:2048 sc1
    s_waitcnt vmcnt(18)
    v_mfma_f32_16x16x32_bf16 v[48:51], v[164:167], a[16:19], v[48:51]
    v_mfma_f32_16x16x32_bf16 v[52:55], v[164:167], a[20:23], v[52:55]
    v_mfma_f32_16x16x32_bf16 v[56:59], v[164:167], a[24:27], v[56:59]
    v_mfma_f32_16x16x32_bf16 v[60:63], v[164:167], a[28:31], v[60:63]
    buffer_load_dwordx4 v[140:143], v1, s[16:19], s50 offen offset:3072 sc1
    s_waitcnt vmcnt(16)
    v_mfma_f32_16x16x32_bf16 v[48:51], v[168:171], a[32:35], v[48:51]
    v_mfma_f32_16x16x32_bf16 v[52:55], v[168:171], a[36:39], v[52:55]
    v_mfma_f32_16x16x32_bf16 v[56:59], v[168:171], a[40:43], v[56:59]
    v_mfma_f32_16x16x32_bf16 v[60:63], v[168:171], a[44:47], v[60:63]
    s_add_u32 s50, s7, 57344
    buffer_load_dwordx4 v[144:147], v1, s[16:19], s50 offen offset:0 sc1
    s_waitcnt vmcnt(14)
    v_mfma_f32_16x16x32_bf16 v[48:51], v[172:175], a[48:51], v[48:51]
    v_mfma_f32_16x16x32_bf16 v[52:55], v[172:175], a[52:55], v[52:55]
    v_mfma_f32_16x16x32_bf16 v[56:59], v[172:175], a[56:59], v[56:59]
    v_mfma_f32_16x16x32_bf16 v[60:63], v[172:175], a[60:63], v[60:63]
    buffer_load_dwordx4 v[148:151], v1, s[16:19], s50 offen offset:1024 sc1
    s_waitcnt vmcnt(12)
    v_mfma_f32_16x16x32_bf16 v[48:51], v[176:179], a[64:67], v[48:51]
    ds_read_b64_tr_b16 a[128:129], v28 offset:0
    ds_read_b64_tr_b16 a[130:131], v28 offset:1024
    v_mfma_f32_16x16x32_bf16 v[52:55], v[176:179], a[68:71], v[52:55]
    ds_read_b64_tr_b16 a[132:133], v29 offset:0
    ds_read_b64_tr_b16 a[134:135], v29 offset:1024
    v_mfma_f32_16x16x32_bf16 v[56:59], v[176:179], a[72:75], v[56:59]
    ds_read_b64_tr_b16 a[136:137], v30 offset:0
    ds_read_b64_tr_b16 a[138:139], v30 offset:1024
    v_mfma_f32_16x16x32_bf16 v[60:63], v[176:179], a[76:79], v[60:63]
    buffer_load_dwordx4 v[152:155], v1, s[16:19], s50 offen offset:2048 sc1
    s_waitcnt vmcnt(10)
    v_mfma_f32_16x16x32_bf16 v[48:51], v[180:183], a[80:83], v[48:51]
    ds_read_b64_tr_b16 a[140:141], v31 offset:0
    ds_read_b64_tr_b16 a[142:143], v31 offset:1024
    v_mfma_f32_16x16x32_bf16 v[52:55], v[180:183], a[84:87], v[52:55]
    ds_read_b64_tr_b16 a[144:145], v28 offset:4096
    ds_read_b64_tr_b16 a[146:147], v28 offset:5120
    v_mfma_f32_16x16x32_bf16 v[56:59], v[180:183], a[88:91], v[56:59]
    ds_read_b64_tr_b16 a[148:149], v29 offset:4096
    ds_read_b64_tr_b16 a[150:151], v29 offset:5120
    v_mfma_f32_16x16x32_bf16 v[60:63], v[180:183], a[92:95], v[60:63]
    buffer_load_dwordx4 v[156:159], v1, s[16:19], s50 offen offset:3072 sc1
    s_waitcnt vmcnt(10)
    v_mfma_f32_16x16x32_bf16 v[48:51], v[184:187], a[96:99], v[48:51]
    ds_read_b64_tr_b16 a[152:153], v30 offset:4096
    ds_read_b64_tr_b16 a[154:155], v30 offset:5120
    v_mfma_f32_16x16x32_bf16 v[52:55], v[184:187], a[100:103], v[52:55]
    ds_read_b64_tr_b16 a[156:157], v31 offset:4096
    ds_read_b64_tr_b16 a[158:159], v31 offset:5120
    v_mfma_f32_16x16x32_bf16 v[56:59], v[184:187], a[104:107], v[56:59]
    ds_read_b64_tr_b16 a[160:161], v28 offset:8192
    ds_read_b64_tr_b16 a[162:163], v28 offset:9216
    v_mfma_f32_16x16x32_bf16 v[60:63], v[184:187], a[108:111], v[60:63]
    s_waitcnt vmcnt(9)
    v_cmp_ne_u32 vcc, 1, v24
    s_nop 0
    s_cbranch_vccz L_s3_end
    s_mov_b32 s54, 0x40000
L_s3:
    buffer_load_dword v24, v27, s[16:19], s57 offen sc1
    s_waitcnt vmcnt(0)
    v_cmp_ne_u32 vcc, 1, v24
    s_sub_u32 s54, s54, 1
    s_cbranch_scc1 L_s3_x
    s_cbranch_vccnz L_s3
L_s3_x:
L_s3_end:
    s_add_u32 s50, s8, 0
    buffer_load_dwordx4 v[160:163], v1, s[16:19], s50 offen offset:0 sc1
    s_waitcnt vmcnt(9)
    v_mfma_f32_16x16x32_bf16 v[48:51], v[188:191], a[112:115], v[48:51]
    ds_read_b64_tr_b16 a[164:165], v29 offset:8192
    ds_read_b64_tr_b16 a[166:167], v29 offset:9216
    v_mfma_f32_16x16x32_bf16 v[52:55], v[188:191], a[116:119], v[52:55]
    ds_read_b64_tr_b16 a[168:169], v30 offset:8192
    ds_read_b64_tr_b16 a[170:171], v30 offset:9216
    v_mfma_f32_16x16x32_bf16 v[56:59], v[188:191], a[120:123], v[56:59]
    ds_read_b64_tr_b16 a[172:173], v31 offset:8192
    ds_read_b64_tr_b16 a[174:175], v31 offset:9216
    v_mfma_f32_16x16x32_bf16 v[60:63], v[188:191], a[124:127], v[60:63]
L_hop8:
    s_cbranch_execz L_hop_back
    buffer_load_dwordx4 v[164:167], v1, s[16:19], s50 offen offset:1024 sc1
    s_waitcnt vmcnt(9)
    s_waitcnt lgkmcnt(15)
    v_mfma_f32_16x16x32_bf16 v[32:35], v[128:131], a[128:131], v[32:35]
    ds_read_b64_tr_b16 a[176:177], v28 offset:12288
    ds_read_b64_tr_b16 a[178:179], v28 offset:13312
    v_mfma_f32_16x16x32_bf16 v[36:39], v[128:131], a[132:135], v[36:39]
    ds_read_b64_tr_b16 a[180:181], v29 offset:12288
    ds_read_b64_tr_b16 a[182:183], v29 offset:13312
    v_mfma_f32_16x16x32_bf16 v[40:43], v[128:131], a[136:139], v[40:43]
    ds_read_b64_tr_b16 a[184:185], v30 offset:12288
    ds_read_b64_tr_b16 a[186:187], v30 offset:13312
    v_mfma_f32_16x16x32_bf16 v[44:47], v[128:131], a[140:143], v[44:47]
    buffer_load_dwordx4 v[168:171], v1, s[16:19], s50 offen offset:2048 sc1
    s_waitcnt vmcnt(9)
    s_waitcnt lgkmcnt(15)
    v_mfma_f32_16x16x32_bf16 v[32:35], v[132:135], a[144:147], v[32:35]
    ds_read_b64_tr_b16 a[188:189], v31 offset:12288
    ds_read_b64_tr_b16 a[190:191], v31 offset:13312
    v_mfma_f32_16x16x32_bf16 v[36:39], v[132:135], a[148:151], v[36:39]
    v_mfma_f32_16x16x32_bf16 v[40:43], v[132:135], a[152:155], v[40:43]
    s_waitcnt lgkmcnt(15)
    v_mfma_f32_16x16x32_bf16 v[44:47], v[132:135], a[156:159], v[44:47]
    buffer_load_dwordx4 v[172:175], v1, s[16:19], s50 offen offset:3072 sc1
    s_waitcnt vmcnt(9)
    s_waitcnt lgkmcnt(14)
    v_mfma_f32_16x16x32_bf16 v[32:35], v[136:139], a[160:163], v[32:35]
    s_waitcnt lgkmcnt(12)
    v_mfma_f32_16x16x32_bf16 v[36:39], v[136:139], a[164:167], v[36:39]
    s_waitcnt lgkmcnt(10)
    v_mfma_f32_16x16x32_bf16 v[40:43], v[136:139], a[168:171], v[40:43]
    s_waitcnt lgkmcnt(8)
    v_mfma_f32_16x16x32_bf16 v[44:47], v[136:139], a[172:175], v[44:47]
    s_add_u32 s50, s8, 4096
    buffer_load_dwordx4 v[176:179], v1, s[16:19], s50 offen offset:0 sc1
    s_waitcnt vmcnt(9)
    s_waitcnt lgkmcnt(6)
    v_mfma_f32_16x16x32_bf16 v[32:35], v[140:143], a[176:179], v[32:35]
    s_waitcnt lgkmcnt(4)
    v_mfma_f32_16x16x32_bf16 v[36:39], v[140:143], a[180:183], v[36:39]
    s_waitcnt lgkmcnt(2)
    v_mfma_f32_16x16x32_bf16 v[40:43], v[140:143], a[184:187], v[40:43]
    s_waitcnt lgkmcnt(0)
    v_mfma_f32_16x16x32_bf16 v[44:47], v[140:143], a[188:191], v[44:47]
    buffer_load_dwordx4 v[180:183], v1, s[16:19], s50 offen offset:1024 sc1
    s_waitcnt vmcnt(9)
    v_mfma_f32_16x16x32_bf16 v[48:51], v[144:147], a[128:131], v[48:51]
    v_mfma_f32_16x16x32_bf16 v[52:55], v[144:147], a[132:135], v[52:55]
    v_mfma_f32_16x16x32_bf16 v[56:59], v[144:147], a[136:139], v[56:59]
    v_mfma_f32_16x16x32_bf16 v[60:63], v[144:147], a[140:143], v[60:63]
    buffer_load_dwordx4 v[184:187], v1, s[16:19], s50 offen offset:2048 sc1
    s_waitcnt vmcnt(9)
    v_mfma_f32_16x16x32_bf16 v[48:51], v[148:151], a[144:147], v[48:51]
    ds_write_b128 v192, v[32:35] offset:0
    v_mfma_f32_16x16x32_bf16 v[52:55], v[148:151], a[148:151], v[52:55]
    v_mfma_f32_16x16x32_bf16 v[56:59], v[148:151], a[152:155], v[56:59]
    ds_write_b128 v192, v[36:39] offset:1024
    v_mfma_f32_16x16x32_bf16 v[60:63], v[148:151], a[156:159], v[60:63]
    buffer_load_dwordx4 v[188:191], v1, s[16:19], s50 offen offset:3072 sc1
    s_waitcnt vmcnt(9)
    v_mfma_f32_16x16x32_bf16 v[48:51], v[152:155], a[160:163], v[48:51]
    v_mfma_f32_16x16x32_bf16 v[52:55], v[152:155], a[164:167], v[52:55]
    ds_write_b128 v192, v[40:43] offset:2048
    v_mfma_f32_16x16x32_bf16 v[56:59], v[152:155], a[168:171], v[56:59]
    v_mfma_f32_16x16x32_bf16 v[60:63], v[152:155], a[172:175], v[60:63]
    s_add_u32 s50, s8, 8192
    buffer_load_dwordx4 v[128:131], v1, s[16:19], s50 offen offset:0 sc1
    s_waitcnt vmcnt(9)
    v_mfma_f32_16x16x32_bf16 v[48:51], v[156:159], a[176:179], v[48:51]
    ds_write_b128 v192, v[44:47] offset:3072
    v_mfma_f32_16x16x32_bf16 v[52:55], v[156:159], a[180:183], v[52:55]
    v_mfma_f32_16x16x32_bf16 v[56:59], v[156:159], a[184:187], v[56:59]
    v_add_f32 v17, v32, v33
    v_add_f32 v17, v17, v34
    v_mfma_f32_16x16x32_bf16 v[60:63], v[156:159], a[188:191], v[60:63]
    buffer_load_dwordx4 v[132:135], v1, s[16:19], s50 offen offset:1024 sc1
    s_waitcnt vmcnt(9)
    v_mfma_f32_16x16x32_bf16 v[64:67], v[160:163], a[0:3], v[216:219]
    v_add_f32 v17, v17, v35
    v_mfma_f32_16x16x32_bf16 v[68:71], v[160:163], a[4:7], 0
    v_mfma_f32_16x16x32_bf16 v[72:75], v[160:163], a[8:11], 0
    v_mfma_f32_16x16x32_bf16 v[76:79], v[160:163], a[12:15], 0
    buffer_load_dwordx4 v[136:139], v1, s[16:19], s50 offen offset:2048 sc1
    s_waitcnt vmcnt(9)
    v_mfma_f32_16x16x32_bf16 v[64:67], v[164:167], a[16:19], v[64:67]
    ds_write_b128 v193, v[48:51] offset:4096
    v_mfma_f32_16x16x32_bf16 v[68:71], v[164:167], a[20:23], v[68:71]
    v_mfma_f32_16x16x32_bf16 v[72:75], v[164:167], a[24:27], v[72:75]
    ds_write_b128 v193, v[52:55] offset:5120
    v_mfma_f32_16x16x32_bf16 v[76:79], v[164:167], a[28:31], v[76:79]
    buffer_load_dwordx4 v[140:143], v1, s[16:19], s50 offen offset:3072 sc1
    s_waitcnt vmcnt(9)
    v_mfma_f32_16x16x32_bf16 v[64:67], v[168:171], a[32:35], v[64:67]
    v_mfma_f32_16x16x32_bf16 v[68:71], v[168:171], a[36:39], v[68:71]
    ds_write_b128 v193, v[56:59] offset:6144
    v_mfma_f32_16x16x32_bf16 v[72:75], v[168:171], a[40:43], v[72:75]
    v_mfma_f32_16x16x32_bf16 v[76:79], v[168:171], a[44:47], v[76:79]
    s_add_u32 s50, s8, 49152
    buffer_load_dwordx4 v[144:147], v1, s[16:19], s50 offen offset:0 sc1
    s_waitcnt vmcnt(9)
    v_mfma_f32_16x16x32_bf16 v[64:67], v[172:175], a[48:51], v[64:67]
    ds_write_b128 v193, v[60:63] offset:7168
    v_mfma_f32_16x16x32_bf16 v[68:71], v[172:175], a[52:55], v[68:71]
    v_mfma_f32_16x16x32_bf16 v[72:75], v[172:175], a[56:59], v[72:75]
    v_add_f32 v17, v17, v48
    v_add_f32 v17, v17, v49
    v_mfma_f32_16x16x32_bf16 v[76:79], v[172:175], a[60:63], v[76:79]
    buffer_load_dwordx4 v[148:151], v1, s[16:19], s50 offen offset:1024 sc1
    s_waitcnt vmcnt(9)
    v_mfma_f32_16x16x32_bf16 v[64:67], v[176:179], a[64:67], v[64:67]
    v_add_f32 v17, v17, v50
    v_add_f32 v17, v17, v51
    v_mfma_f32_16x16x32_bf16 v[68:71], v[176:179], a[68:71], v[68:71]
    s_waitcnt lgkmcnt(0)
    s_barrier
    ds_read_b128 v[32:35], v195 offset:0
    ds_read_b128 v[36:39], v195 offset:256
    v_mfma_f32_16x16x32_bf16 v[72:75], v[176:179], a[72:75], v[72:75]
    ds_read_b128 v[40:43], v196 offset:0
    ds_read_b128 v[44:47], v196 offset:256
    v_mfma_f32_16x16x32_bf16 v[76:79], v[176:179], a[76:79], v[76:79]
    buffer_load_dwordx4 v[152:155], v1, s[16:19], s50 offen offset:2048 sc1
    s_waitcnt vmcnt(9)
    v_mfma_f32_16x16x32_bf16 v[64:67], v[180:183], a[80:83], v[64:67]
    ds_read_b128 v[48:51], v197 offset:0
    ds_read_b128 v[52:55], v197 offset:256
    v_mfma_f32_16x16x32_bf16 v[68:71], v[180:183], a[84:87], v[68:71]
    ds_read_b128 v[56:59], v198 offset:0
    ds_read_b128 v[60:63], v198 offset:256
    v_mfma_f32_16x16x32_bf16 v[72:75], v[180:183], a[88:91], v[72:75]
    v_mfma_f32_16x16x32_bf16 v[76:79], v[180:183], a[92:95], v[76:79]
    buffer_load_dwordx4 v[156:159], v1, s[16:19], s50 offen offset:3072 sc1
    s_waitcnt vmcnt(9)
    v_mfma_f32_16x16x32_bf16 v[64:67], v[184:187], a[96:99], v[64:67]
    v_mfma_f32_16x16x32_bf16 v[68:71], v[184:187], a[100:103], v[68:71]
    v_mfma_f32_16x16x32_bf16 v[72:75], v[184:187], a[104:107], v[72:75]
    v_mfma_f32_16x16x32_bf16 v[76:79], v[184:187], a[108:111], v[76:79]
    s_add_u32 s50, s8, 53248
    buffer_load_dwordx4 v[160:163], v1, s[16:19], s50 offen offset:0 sc1
    s_waitcnt vmcnt(9)
    v_mfma_f32_16x16x32_bf16 v[64:67], v[188:191], a[112:115], v[64:67]
    v_mfma_f32_16x16x32_bf16 v[68:71], v[188:191], a[116:119], v[68:71]
    s_waitcnt lgkmcnt(5)
    v_add_f32 v32, v32, v40
    v_add_f32 v33, v33, v41
    v_mfma_f32_16x16x32_bf16 v[72:75], v[188:191], a[120:123], v[72:75]
    v_add_f32 v34, v34, v42
    v_add_f32 v35, v35, v43
    v_mfma_f32_16x16x32_bf16 v[76:79], v[188:191], a[124:127], v[76:79]
    buffer_load_dwordx4 v[164:167], v1, s[16:19], s50 offen offset:1024 sc1
    s_waitcnt vmcnt(9)
    v_mfma_f32_16x16x32_bf16 v[64:67], v[128:131], a[128:131], v[64:67]
    s_waitcnt lgkmcnt(4)
    v_add_f32 v36, v36, v44
    v_add_f32 v37, v37, v45
    v_mfma_f32_16x16x32_bf16 v[68:71], v[128:131], a[132:135], v[68:71]
    v_add_f32 v38, v38, v46
    v_add_f32 v39, v39, v47
    v_mfma_f32_16x16x32_bf16 v[72:75], v[128:131], a[136:139], v[72:75]
    s_waitcnt lgkmcnt(1)
    v_add_f32 v48, v48, v56
    v_add_f32 v49, v49, v57
    v_mfma_f32_16x16x32_bf16 v[76:79], v[128:131], a[140:143], v[76:79]
    buffer_load_dwordx4 v[168:171], v1, s[16:19], s50 offen offset:2048 sc1
    s_waitcnt vmcnt(9)
    v_mfma_f32_16x16x32_bf16 v[64:67], v[132:135], a[144:147], v[64:67]
    v_add_f32 v50, v50, v58
    v_add_f32 v51, v51, v59
    v_mfma_f32_16x16x32_bf16 v[68:71], v[132:135], a[148:151], v[68:71]
    s_waitcnt lgkmcnt(0)
    v_add_f32 v52, v52, v60
    v_add_f32 v53, v53, v61
    v_mfma_f32_16x16x32_bf16 v[72:75], v[132:135], a[152:155], v[72:75]
    v_add_f32 v54, v54, v62
    v_add_f32 v55, v55, v63
    v_mfma_f32_16x16x32_bf16 v[76:79], v[132:135], a[156:159], v[76:79]
    buffer_load_dwordx4 v[172:175], v1, s[16:19], s50 offen offset:3072 sc1
    s_waitcnt vmcnt(9)
    v_mfma_f32_16x16x32_bf16 v[64:67], v[136:139], a[160:163], v[64:67]
    v_add_f32 v32, v32, v48
    v_add_f32 v33, v33, v49
    v_mfma_f32_16x16x32_bf16 v[68:71], v[136:139], a[164:167], v[68:71]
    v_add_f32 v34, v34, v50
    v_add_f32 v35, v35, v51
    v_mfma_f32_16x16x32_bf16 v[72:75], v[136:139], a[168:171], v[72:75]
    v_add_f32 v36, v36, v52
    v_add_f32 v37, v37, v53
    v_mfma_f32_16x16x32_bf16 v[76:79], v[136:139], a[172:175], v[76:79]
    s_add_u32 s50, s8, 57344
    buffer_load_dwordx4 v[176:179], v1, s[16:19], s50 offen offset:0 sc1
    s_waitcnt vmcnt(9)
    v_mfma_f32_16x16x32_bf16 v[64:67], v[140:143], a[176:179], v[64:67]
    v_add_f32 v38, v38, v54
    v_add_f32 v39, v39, v55
    v_mfma_f32_16x16x32_bf16 v[68:71], v[140:143], a[180:183], v[68:71]
    v_cvt_pk_bf16_f32 v40, v32, v33
    v_cvt_pk_bf16_f32 v41, v34, v35
    v_mfma_f32_16x16x32_bf16 v[72:75], v[140:143], a[184:187], v[72:75]
    v_cvt_pk_bf16_f32 v42, v36, v37
    v_cvt_pk_bf16_f32 v43, v38, v39
    v_mfma_f32_16x16x32_bf16 v[76:79], v[140:143], a[188:191], v[76:79]
    buffer_load_dwordx4 v[180:183], v1, s[16:19], s50 offen offset:1024 sc1
    s_waitcnt vmcnt(9)
    v_mfma_f32_16x16x32_bf16 v[80:83], v[144:147], a[0:3], v[220:223]
    buffer_store_dwordx4 v[40:43], v203, s[72:75], s4 offen
    v_mfma_f32_16x16x32_bf16 v[84:87], v[144:147], a[4:7], 0
    v_mfma_f32_16x16x32_bf16 v[88:91], v[144:147], a[8:11], 0
    v_mfma_f32_16x16x32_bf16 v[92:95], v[144:147], a[12:15], 0
    buffer_load_dwordx4 v[184:187], v1, s[16:19], s50 offen offset:2048 sc1
    s_waitcnt vmcnt(10)
    v_mfma_f32_16x16x32_bf16 v[80:83], v[148:151], a[16:19], v[80:83]
    ds_write_b128 v192, v[64:67] offset:8192
    v_mfma_f32_16x16x32_bf16 v[84:87], v[148:151], a[20:23], v[84:87]
    v_mfma_f32_16x16x32_bf16 v[88:91], v[148:151], a[24:27], v[88:91]
    ds_write_b128 v192, v[68:71] offset:9216
    v_mfma_f32_16x16x32_bf16 v[92:95], v[148:151], a[28:31], v[92:95]
    buffer_load_dwordx4 v[188:191], v1, s[16:19], s50 offen offset:3072 sc1
    s_waitcnt vmcnt(10)
    v_mfma_f32_16x16x32_bf16 v[80:83], v[152:155], a[32:35], v[80:83]
    v_mfma_f32_16x16x32_bf16 v[84:87], v[152:155], a[36:39], v[84:87]
    ds_write_b128 v192, v[72:75] offset:10240
    v_mfma_f32_16x16x32_bf16 v[88:91], v[152:155], a[40:43], v[88:91]
    v_mfma_f32_16x16x32_bf16 v[92:95], v[152:155], a[44:47], v[92:95]
    s_add_u32 s50, s9, 0
    buffer_load_dwordx4 v[128:131], v1, s[16:19], s50 offen offset:0 sc1
    s_waitcnt vmcnt(10)
    v_mfma_f32_16x16x32_bf16 v[80:83], v[156:159], a[48:51], v[80:83]
    ds_write_b128 v192, v[76:79] offset:11264
    v_mfma_f32_16x16x32_bf16 v[84:87], v[156:159], a[52:55], v[84:87]
    v_mfma_f32_16x16x32_bf16 v[88:91], v[156:159], a[56:59], v[88:91]
    v_add_f32 v17, v17, v64
    v_add_f32 v17, v17, v65
    v_mfma_f32_16x16x32_bf16 v[92:95], v[156:159], a[60:63], v[92:95]
    buffer_load_dwordx4 v[132:135], v1, s[16:19], s50 offen offset:1024 sc1
    s_waitcnt vmcnt(10)
    v_mfma_f32_16x16x32_bf16 v[80:83], v[160:163], a[64:67], v[80:83]
    v_add_f32 v17, v17, v66
    v_add_f32 v17, v17, v67
    v_mfma_f32_16x16x32_bf16 v[84:87], v[160:163], a[68:71], v[84:87]
    v_mfma_f32_16x16x32_bf16 v[88:91], v[160:163], a[72:75], v[88:91]
    v_mfma_f32_16x16x32_bf16 v[92:95], v[160:163], a[76:79], v[92:95]
    buffer_load_dwordx4 v[136:139], v1, s[16:19], s50 offen offset:2048 sc1
    s_waitcnt vmcnt(10)
    v_mfma_f32_16x16x32_bf16 v[80:83], v[164:167], a[80:83], v[80:83]
    v_mfma_f32_16x16x32_bf16 v[84:87], v[164:167], a[84:87], v[84:87]
    v_mfma_f32_16x16x32_bf16 v[88:91], v[164:167], a[88:91], v[88:91]
    v_mfma_f32_16x16x32_bf16 v[92:95], v[164:167], a[92:95], v[92:95]
    buffer_load_dwordx4 v[140:143], v1, s[16:19], s50 offen offset:3072 sc1
    s_waitcnt vmcnt(10)
    v_mfma_f32_16x16x32_bf16 v[80:83], v[168:171], a[96:99], v[80:83]
    v_mfma_f32_16x16x32_bf16 v[84:87], v[168:171], a[100:103], v[84:87]
    v_mfma_f32_16x16x32_bf16 v[88:91], v[168:171], a[104:107], v[88:91]
    v_mfma_f32_16x16x32_bf16 v[92:95], v[168:171], a[108:111], v[92:95]
    s_add_u32 s50, s9, 4096
    buffer_load_dwordx4 v[144:147], v1, s[16:19], s50 offen offset:0 sc1
    s_waitcnt vmcnt(10)
    v_mfma_f32_16x16x32_bf16 v[80:83], v[172:175], a[112:115], v[80:83]
    v_mfma_f32_16x16x32_bf16 v[84:87], v[172:175], a[116:119], v[84:87]
    v_mfma_f32_16x16x32_bf16 v[88:91], v[172:175], a[120:123], v[88:91]
    v_mfma_f32_16x16x32_bf16 v[92:95], v[172:175], a[124:127], v[92:95]
    buffer_load_dwordx4 v[148:151], v1, s[16:19], s50 offen offset:1024 sc1
    s_waitcnt vmcnt(10)
    v_mfma_f32_16x16x32_bf16 v[80:83], v[176:179], a[128:131], v[80:83]
    v_mfma_f32_16x16x32_bf16 v[84:87], v[176:179], a[132:135], v[84:87]
    v_mfma_f32_16x16x32_bf16 v[88:91], v[176:179], a[136:139], v[88:91]
    v_mfma_f32_16x16x32_bf16 v[92:95], v[176:179], a[140:143], v[92:95]
    buffer_load_dwordx4 v[152:155], v1, s[16:19], s50 offen offset:2048 sc1
    s_waitcnt vmcnt(10)
    v_mfma_f32_16x16x32_bf16 v[80:83], v[180:183], a[144:147], v[80:83]
    v_mfma_f32_16x16x32_bf16 v[84:87], v[180:183], a[148:151], v[84:87]
    v_mfma_f32_16x16x32_bf16 v[88:91], v[180:183], a[152:155], v[88:91]
    v_mfma_f32_16x16x32_bf16 v[92:95], v[180:183], a[156:159], v[92:95]
    buffer_load_dwordx4 v[156:159], v1, s[16:19], s50 offen offset:3072 sc1
    s_waitcnt vmcnt(9)
    v_mfma_f32_16x16x32_bf16 v[80:83], v[184:187], a[160:163], v[80:83]
    v_mfma_f32_16x16x32_bf16 v[84:87], v[184:187], a[164:167], v[84:87]
    v_mfma_f32_16x16x32_bf16 v[88:91], v[184:187], a[168:171], v[88:91]
    v_mfma_f32_16x16x32_bf16 v[92:95], v[184:187], a[172:175], v[92:95]
    s_add_u32 s50, s9, 8192
    buffer_load_dwordx4 v[160:163], v1, s[16:19], s50 offen offset:0 sc1
    s_waitcnt vmcnt(9)
    v_mfma_f32_16x16x32_bf16 v[80:83], v[188:191], a[176:179], v[80:83]
    v_mfma_f32_16x16x32_bf16 v[84:87], v[188:191], a[180:183], v[84:87]
    v_mfma_f32_16x16x32_bf16 v[88:91], v[188:191], a[184:187], v[88:91]
    v_mfma_f32_16x16x32_bf16 v[92:95], v[188:191], a[188:191], v[92:95]
    buffer_load_dwordx4 v[164:167], v1, s[16:19], s50 offen offset:1024 sc1
    s_waitcnt vmcnt(9)
    v_mfma_f32_16x16x32_bf16 v[96:99], v[128:131], a[0:3], v[224:227]
    v_mfma_f32_16x16x32_bf16 v[100:103], v[128:131], a[4:7], 0
    v_mfma_f32_16x16x32_bf16 v[104:107], v[128:131], a[8:11], 0
    v_mfma_f32_16x16x32_bf16 v[108:111], v[128:131], a[12:15], 0
    buffer_load_dwordx4 v[168:171], v1, s[16:19], s50 offen offset:2048 sc1
    s_waitcnt vmcnt(9)
    v_mfma_f32_16x16x32_bf16 v[96:99], v[132:135], a[16:19], v[96:99]
    ds_write_b128 v193, v[80:83] offset:12288
    v_mfma_f32_16x16x32_bf16 v[100:103], v[132:135], a[20:23], v[100:103]
    v_mfma_f32_16x16x32_bf16 v[104:107], v[132:135], a[24:27], v[104:107]
    ds_write_b128 v193, v[84:87] offset:13312
    v_mfma_f32_16x16x32_bf16 v[108:111], v[132:135], a[28:31], v[108:111]
    buffer_load_dwordx4 v[172:175], v1, s[16:19], s50 offen offset:3072 sc1
    s_waitcnt vmcnt(9)
    v_mfma_f32_16x16x32_bf16 v[96:99], v[136:139], a[32:35], v[96:99]
    v_mfma_f32_16x16x32_bf16 v[100:103], v[136:139], a[36:39], v[100:103]
    ds_write_b128 v193, v[88:91] offset:14336
    v_mfma_f32_16x16x32_bf16 v[104:107], v[136:139], a[40:43], v[104:107]
    v_mfma_f32_16x16x32_bf16 v[108:111], v[136:139], a[44:47], v[108:111]
    ds_write_b128 v193, v[92:95] offset:15360
    s_add_u32 s56, s56, 65536
    buffer_store_dword v26, v25, s[16:19], s56 offen sc1
    s_waitcnt vmcnt(9)
    v_mfma_f32_16x16x32_bf16 v[96:99], v[140:143], a[48:51], v[96:99]
    v_mfma_f32_16x16x32_bf16 v[100:103], v[140:143], a[52:55], v[100:103]
    v_add_f32 v17, v17, v80
    v_add_f32 v17, v17, v81
    v_mfma_f32_16x16x32_bf16 v[104:107], v[140:143], a[56:59], v[104:107]
    v_add_f32 v17, v17, v82
    v_add_f32 v17, v17, v83
    v_mfma_f32_16x16x32_bf16 v[108:111], v[140:143], a[60:63], v[108:111]
    s_waitcnt vmcnt(8)
    v_mfma_f32_16x16x32_bf16 v[96:99], v[144:147], a[64:67], v[96:99]
    s_waitcnt lgkmcnt(0)
    s_barrier
    ds_read_b128 v[64:67], v195 offset:8192
    ds_read_b128 v[68:71], v195 offset:8448
    v_mfma_f32_16x16x32_bf16 v[100:103], v[144:147], a[68:71], v[100:103]
    ds_read_b128 v[72:75], v196 offset:8192
    ds_read_b128 v[76:79], v196 offset:8448
    v_mfma_f32_16x16x32_bf16 v[104:107], v[144:147], a[72:75], v[104:107]
    ds_read_b128 v[80:83], v197 offset:8192
    ds_read_b128 v[84:87], v197 offset:8448
    v_mfma_f32_16x16x32_bf16 v[108:111], v[144:147], a[76:79], v[108:111]
    ds_read_b128 v[88:91], v198 offset:8192
    ds_read_b128 v[92:95], v198 offset:8448
    s_waitcnt vmcnt(7)
    v_mfma_f32_16x16x32_bf16 v[96:99], v[148:151], a[80:83], v[96:99]
    v_mfma_f32_16x16x32_bf16 v[100:103], v[148:151], a[84:87], v[100:103]
    v_mfma_f32_16x16x32_bf16 v[104:107], v[148:151], a[88:91], v[104:107]
    v_mfma_f32_16x16x32_bf16 v[108:111], v[148:151], a[92:95], v[108:111]
    s_waitcnt vmcnt(6)
    v_mfma_f32_16x16x32_bf16 v[96:99], v[152:155], a[96:99], v[96:99]
    v_mfma_f32_16x16x32_bf16 v[100:103], v[152:155], a[100:103], v[100:103]
    s_waitcnt lgkmcnt(5)
    v_add_f32 v64, v64, v72
    v_add_f32 v65, v65, v73
    v_mfma_f32_16x16x32_bf16 v[104:107], v[152:155], a[104:107], v[104:107]
    v_add_f32 v66, v66, v74
    v_add_f32 v67, v67, v75
    v_mfma_f32_16x16x32_bf16 v[108:111], v[152:155], a[108:111], v[108:111]
    s_waitcnt lgkmcnt(4)
    v_add_f32 v68, v68, v76
    v_add_f32 v69, v69, v77
    s_waitcnt vmcnt(5)
    v_mfma_f32_16x16x32_bf16 v[96:99], v[156:159], a[112:115], v[96:99]
    v_add_f32 v70, v70, v78
    v_add_f32 v71, v71, v79
    v_mfma_f32_16x16x32_bf16 v[100:103], v[156:159], a[116:119], v[100:103]
    s_waitcnt lgkmcnt(1)
    v_add_f32 v80, v80, v88
    v_add_f32 v81, v81, v89
    v_mfma_f32_16x16x32_bf16 v[104:107], v[156:159], a[120:123], v[104:107]
    v_add_f32 v82, v82, v90
    v_add_f32 v83, v83, v91
    v_mfma_f32_16x16x32_bf16 v[108:111], v[156:159], a[124:127], v[108:111]
    s_waitcnt lgkmcnt(0)
    v_add_f32 v84, v84, v92
    v_add_f32 v85, v85, v93
    s_waitcnt vmcnt(4)
    v_mfma_f32_16x16x32_bf16 v[96:99], v[160:163], a[128:131], v[96:99]
    v_add_f32 v86, v86, v94
    v_add_f32 v87, v87, v95
    v_mfma_f32_16x16x32_bf16 v[100:103], v[160:163], a[132:135], v[100:103]
    v_add_f32 v64, v64, v80
    v_add_f32 v65, v65, v81
    v_mfma_f32_16x16x32_bf16 v[104:107], v[160:163], a[136:139], v[104:107]
    v_add_f32 v66, v66, v82
    v_add_f32 v67, v67, v83
    v_mfma_f32_16x16x32_bf16 v[108:111], v[160:163], a[140:143], v[108:111]
    v_add_f32 v68, v68, v84
    v_add_f32 v69, v69, v85
    s_waitcnt vmcnt(3)
    v_mfma_f32_16x16x32_bf16 v[96:99], v[164:167], a[144:147], v[96:99]
    v_add_f32 v70, v70, v86
    v_add_f32 v71, v71, v87
    v_mfma_f32_16x16x32_bf16 v[100:103], v[164:167], a[148:151], v[100:103]
    v_cvt_pk_bf16_f32 v72, v64, v65
    v_cvt_pk_bf16_f32 v73, v66, v67
    v_mfma_f32_16x16x32_bf16 v[104:107], v[164:167], a[152:155], v[104:107]
    v_cvt_pk_bf16_f32 v74, v68, v69
    v_cvt_pk_bf16_f32 v75, v70, v71
    v_mfma_f32_16x16x32_bf16 v[108:111], v[164:167], a[156:159], v[108:111]
    buffer_store_dwordx4 v[72:75], v203, s[72:75], s5 offen
    s_waitcnt vmcnt(3)
    v_mfma_f32_16x16x32_bf16 v[96:99], v[168:171], a[160:163], v[96:99]
    v_mfma_f32_16x16x32_bf16 v[100:103], v[168:171], a[164:167], v[100:103]
    v_mfma_f32_16x16x32_bf16 v[104:107], v[168:171], a[168:171], v[104:107]
    v_mfma_f32_16x16x32_bf16 v[108:111], v[168:171], a[172:175], v[108:111]
    s_waitcnt vmcnt(2)
    v_mfma_f32_16x16x32_bf16 v[96:99], v[172:175], a[176:179], v[96:99]
    v_mfma_f32_16x16x32_bf16 v[100:103], v[172:175], a[180:183], v[100:103]
    v_mfma_f32_16x16x32_bf16 v[104:107], v[172:175], a[184:187], v[104:107]
    v_mfma_f32_16x16x32_bf16 v[108:111], v[172:175], a[188:191], v[108:111]
    s_nop 4
    ds_write_b128 v194, v[96:99] offset:16384
    ds_write_b128 v194, v[100:103] offset:17408
    ds_write_b128 v194, v[104:107] offset:18432
    ds_write_b128 v194, v[108:111] offset:19456
    v_add_f32 v17, v17, v96
    v_add_f32 v17, v17, v97
    v_add_f32 v17, v17, v98
    v_add_f32 v17, v17, v99
    ds_write_b32 v19, v17 offset:24576
    s_waitcnt lgkmcnt(0)
    s_barrier
    ds_read_b128 v[96:99], v199 offset:16384
    ds_read_b128 v[100:103], v200 offset:16384
    ds_read_b128 v[104:107], v201 offset:16384
    ds_read_b128 v[108:111], v202 offset:16384
    ds_read_b128 v[236:239], v1 offset:24576
    s_waitcnt lgkmcnt(3)
    v_pk_add_f32 v[96:97], v[96:97], v[100:101]
    v_pk_add_f32 v[98:99], v[98:99], v[102:103]
    s_waitcnt lgkmcnt(1)
    v_pk_add_f32 v[104:105], v[104:105], v[108:109]
    v_pk_add_f32 v[106:107], v[106:107], v[110:111]
    v_pk_add_f32 v[96:97], v[96:97], v[104:105]
    v_pk_add_f32 v[98:99], v[98:99], v[106:107]
    v_cvt_pk_bf16_f32 v100, v96, v97
    v_cvt_pk_bf16_f32 v101, v98, v99
    buffer_store_dwordx2 v[100:101], v204, s[72:75], s6 offen
    s_waitcnt lgkmcnt(0)
    v_cmp_u_f32 vcc, v236, v237
    v_cmp_u_f32 s[58:59], v238, v239
    s_nop 0
    s_or_b64 vcc, vcc, s[58:59]
    s_cbranch_vccnz L_redo4
L_fin:
    s_endpgm
L_hot_end:
L_idle3:
    s_mov_b32 s54, 0x40000
L_s2i:
    buffer_load_dword v24, v235, s[16:19], s55 offen sc1
    s_waitcnt vmcnt(0)
    v_cmp_ne_u32 vcc, 1, v24
    s_sub_u32 s54, s54, 1
    s_cbranch_scc1 L_s2i_x
    s_cbranch_vccnz L_s2i
L_s2i_x:
L_s2i_end:
    s_waitcnt vmcnt(0) lgkmcnt(0)
    s_nop 15
    s_nop 3
    s_barrier
    s_mul_i32 s56, s60, 24
    s_add_u32 s56, s56, s61
    s_cmp_ge_u32 s2, 240
    s_cselect_b32 s56, s2, s56
    s_lshl_b32 s56, s56, 5
    s_add_u32 s56, s56, 8257536
    v_mov_b32 v25, v29
    v_mov_b32 v26, 1
    s_lshl_b32 s51, s40, 2
    v_add_u32 v19, s51, v1
    v_min_u32 v20, 11, v0
    v_cmp_lt_u32 vcc, 5, v20
    v_add_u32 v21, 18, v20
    s_mul_i32 s57, s62, 5
    v_cndmask_b32 v20, v20, v21, vcc
    v_lshlrev_b32 v27, 5, v20
    s_lshr_b32 s57, s57, 2
    s_mul_i32 s57, s57, 24
    s_mul_i32 s51, s40, 6
    s_add_u32 s57, s57, s51
    s_and_b32 s51, s2, 3
    s_lshl_b32 s51, s51, 8
    s_add_u32 s57, s57, s51
    s_lshl_b32 s57, s57, 5
    s_add_u32 s57, s57, 8257536
    s_lshl_b32 s68, s63, 3
    s_lshl_b32 s51, s40, 1
    s_add_u32 s68, s68, s51
    s_sub_u32 s52, 0, s62
    s_and_b32 s52, s52, 3
    s_mul_i32 s53, s62, 5
    s_add_u32 s52, s52, s53
    s_lshl_b32 s51, s52, 4
    v_lshrrev_b32 v20, 1, v0
    v_add_u32 v20, s51, v20
    v_lshrrev_b32 v21, 5, v20
    v_lshlrev_b32 v21, 17, v21
    v_and_b32 v20, 31, v20
    v_lshl_add_u32 v21, v20, 4, v21
    v_and_b32 v20, 1, v0
    v_lshl_add_u32 v253, v20, 9, v21
    s_sub_u32 s52, 2, s62
    s_and_b32 s52, s52, 3
    s_mul_i32 s53, s62, 5
    s_add_u32 s52, s52, s53
    s_lshl_b32 s51, s52, 4
    v_lshrrev_b32 v20, 1, v0
    v_add_u32 v20, s51, v20
    v_lshrrev_b32 v21, 5, v20
    v_lshlrev_b32 v21, 17, v21
    v_and_b32 v20, 31, v20
    v_lshl_add_u32 v21, v20, 4, v21
    v_and_b32 v20, 1, v0
    v_lshl_add_u32 v254, v20, 9, v21
    s_andn2_b32 s52, 1, s62
    s_lshl_b32 s52, s52, 2
    s_mul_i32 s53, s62, 5
    s_add_u32 s52, s52, s53
    s_lshl_b32 s51, s52, 4
    v_lshrrev_b32 v20, 1, v0
    v_add_u32 v20, s51, v20
    v_lshrrev_b32 v21, 5, v20
    v_lshlrev_b32 v21, 17, v21
    v_and_b32 v20, 31, v20
    v_lshl_add_u32 v21, v20, 4, v21
    v_and_b32 v20, 1, v0
    v_lshl_add_u32 v255, v20, 9, v21
    s_lshl_b32 s51, s68, 4
    v_and_b32 v20, 15, v0
    v_lshlrev_b32 v21, 1, v20
    v_lshlrev_b32 v240, 3, v20
    buffer_load_ushort v252, v21, s[36:39], s51 offen
    s_lshl_b32 s69, s68, 6
    s_add_u32 s69, s69, 6242304
    s_lshl_b32 s68, s68, 9
    s_add_u32 s68, s68, 3620864
    v_lshrrev_b32 v20, 5, v0
    v_lshlrev_b32 v20, 11, v20
    v_bfe_u32 v21, v0, 2, 3
    v_lshl_add_u32 v20, v21, 6, v20
    v_bfe_u32 v21, v0, 4, 1
    v_lshl_add_u32 v20, v21, 5, v20
    v_and_b32 v21, 3, v0
    v_lshl_add_u32 v20, v21, 3, v20
    s_and_b32 s52, s40, 1
    s_lshl_b32 s52, s52, 5
    s_lshr_b32 s51, s40, 1
    s_lshl_b32 s51, s51, 9
    s_or_b32 s52, s52, s51
    s_or_b32 s52, s52, s64
    v_xor_b32 v28, s52, v20
    v_xor_b32 v29, 32, v28
    v_xor_b32 v30, 512, v28
    v_xor_b32 v31, 544, v28
    v_lshrrev_b32 v20, 5, v0
    v_lshl_add_u32 v20, v20, 2, v0
    v_and_b32 v21, 48, v0
    v_and_or_b32 v20, v20, 15, v21
    v_lshl_add_u32 v192, v20, 4, s64
    v_xor_b32 v193, 128, v192
    v_lshrrev_b32 v20, 4, v0
    v_lshl_add_u32 v20, v20, 2, v0
    v_and_or_b32 v20, v20, 15, v21
    v_lshl_add_u32 v194, v20, 4, s64
    v_lshrrev_b32 v20, 2, v0
    v_lshl_add_u32 v20, v0, 2, v20
    v_and_b32 v20, 15, v20
    v_lshlrev_b32 v20, 4, v20
    v_and_b32 v21, 3, v0
    v_lshl_add_u32 v204, v21, 8, v20
    v_and_b32 v21, 1, v0
    v_lshl_add_u32 v20, v21, 9, v20
    v_bfe_u32 v21, v0, 1, 1
    v_lshl_add_u32 v20, v21, 12, v20
    s_xor_b32 s52, s40, 0
    s_lshl_b32 s52, s52, 15
    s_add_u32 s52, s52, 32768
    v_add_u32 v195, s52, v20
    v_add_u32 v199, s52, v204
    s_xor_b32 s52, s40, 1
    s_lshl_b32 s52, s52, 15
    s_add_u32 s52, s52, 33792
    v_add_u32 v196, s52, v20
    v_add_u32 v200, s52, v204
    s_xor_b32 s52, s40, 2
    s_lshl_b32 s52, s52, 15
    s_add_u32 s52, s52, 34816
    v_add_u32 v197, s52, v20
    v_add_u32 v201, s52, v204
    s_xor_b32 s52, s40, 3
    s_lshl_b32 s52, s52, 15
    s_add_u32 s52, s52, 35840
    v_add_u32 v198, s52, v20
    v_add_u32 v202, s52, v204
    v_lshrrev_b32 v20, 2, v0
    v_mul_u32_u24 v20, 1280, v20
    v_and_b32 v21, 3, v0
    v_lshl_add_u32 v203, v21, 4, v20
    v_lshl_add_u32 v204, v21, 3, v20
    s_lshl_b32 s11, s63, 2
    s_add_u32 s11, s11, s40
    s_mul_i32 s11, s11, 20480
    s_mul_i32 s12, s40, 12288
    s_add_u32 s12, s12, 6258688
    s_andn2_b32 s52, 1, s62
    s_lshl_b32 s52, s52, 2
    s_mul_i32 s53, s62, 5
    s_add_u32 s52, s52, s53
    s_lshl_b32 s51, s52, 5
    s_add_u32 s6, s11, s51
    s_mul_i32 s51, s52, 49152
    s_add_u32 s9, s12, s51
    s_sub_u32 s52, 2, s62
    s_and_b32 s52, s52, 3
    s_mul_i32 s53, s62, 5
    s_add_u32 s52, s52, s53
    s_lshl_b32 s51, s52, 5
    s_add_u32 s5, s11, s51
    s_mul_i32 s51, s52, 49152
    s_add_u32 s8, s12, s51
    s_sub_u32 s52, 0, s62
    s_and_b32 s52, s52, 3
    s_mul_i32 s53, s62, 5
    s_add_u32 s52, s52, s53
    s_lshl_b32 s51, s52, 5
    s_add_u32 s4, s11, s51
    s_mul_i32 s51, s52, 49152
    s_add_u32 s7, s12, s51
    s_lshr_b32 s52, s52, 2
    s_mul_i32 s52, s52, 24
    s_mul_i32 s51, s40, 6
    s_add_u32 s52, s52, s51
    s_and_b32 s51, s2, 3
    s_lshl_b32 s51, s51, 8
    s_add_u32 s52, s52, s51
    s_lshl_b32 s52, s52, 5
    s_add_u32 s10, s52, 8388608
    v_min_u32 v20, 5, v0
    v_lshlrev_b32 v205, 5, v20
    s_lshl_b32 s51, s41, 5
    s_add_u32 s51, s51, 8290304
    buffer_store_dword v26, v25, s[16:19], s51 offen sc1
    s_add_u32 m0, s64, 29696
    s_nop 0
    buffer_load_dwordx4 v253, s[16:19], s68 offen sc1 lds
    s_add_u32 m0, s64, 30720
    s_nop 0
    buffer_load_dwordx4 v254, s[16:19], s68 offen sc1 lds
    s_add_u32 m0, s64, 31744
    s_nop 0
    buffer_load_dwordx4 v255, s[16:19], s68 offen sc1 lds
    buffer_load_dwordx2 v[250:251], v240, s[16:19], s69 offen sc1
    v_lshl_add_u32 v253, v0, 3, s64
    s_waitcnt vmcnt(0) lgkmcnt(0)
    ds_read_b64_tr_b16 v[240:241], v253 offset:29696
    ds_read_b64_tr_b16 v[242:243], v253 offset:30208
    ds_read_b64_tr_b16 v[244:245], v253 offset:30720
    ds_read_b64_tr_b16 v[246:247], v253 offset:31232
    ds_read_b64_tr_b16 v[248:249], v253 offset:31744
    v_lshlrev_b32 v252, 16, v252
    v_add_f32 v250, v250, v252
    s_waitcnt lgkmcnt(4)
    v_lshlrev_b32 v208, 16, v240
    v_and_b32 v209, 0xffff0000, v240
    v_lshlrev_b32 v210, 16, v241
    v_and_b32 v211, 0xffff0000, v241
    v_fma_f32 v208, v208, v251, v250
    v_fma_f32 v209, v209, v251, v250
    v_fma_f32 v210, v210, v251, v250
    v_fma_f32 v211, v211, v251, v250
    s_waitcnt lgkmcnt(3)
    v_lshlrev_b32 v212, 16, v242
    v_and_b32 v213, 0xffff0000, v242
    v_lshlrev_b32 v214, 16, v243
    v_and_b32 v215, 0xffff0000, v243
    v_fma_f32 v212, v212, v251, v250
    v_fma_f32 v213, v213, v251, v250
    v_fma_f32 v214, v214, v251, v250
    v_fma_f32 v215, v215, v251, v250
    s_waitcnt lgkmcnt(2)
    v_lshlrev_b32 v216, 16, v244
    v_and_b32 v217, 0xffff0000, v244
    v_lshlrev_b32 v218, 16, v245
    v_and_b32 v219, 0xffff0000, v245
    v_fma_f32 v216, v216, v251, v250
    v_fma_f32 v217, v217, v251, v250
    v_fma_f32 v218, v218, v251, v250
    v_fma_f32 v219, v219, v251, v250
    s_waitcnt lgkmcnt(1)
    v_lshlrev_b32 v220, 16, v246
    v_and_b32 v221, 0xffff0000, v246
    v_lshlrev_b32 v222, 16, v247
    v_and_b32 v223, 0xffff0000, v247
    v_fma_f32 v220, v220, v251, v250
    v_fma_f32 v221, v221, v251, v250
    v_fma_f32 v222, v222, v251, v250
    v_fma_f32 v223, v223, v251, v250
    s_waitcnt lgkmcnt(0)
    v_lshlrev_b32 v224, 16, v248
    v_and_b32 v225, 0xffff0000, v248
    v_lshlrev_b32 v226, 16, v249
    v_and_b32 v227, 0xffff0000, v249
    v_fma_f32 v224, v224, v251, v250
    v_fma_f32 v225, v225, v251, v250
    v_fma_f32 v226, v226, v251, v250
    v_fma_f32 v227, v227, v251, v250
    s_add_u32 m0, s64, 20480
    s_mov_b32 s65, 718848
    buffer_load_dwordx4 v15, s[28:31], s65 offen offset:2048 lds
    s_mov_b32 s65, 734208
    buffer_load_dwordx4 v15, s[28:31], s65 offen offset:3072 lds
    s_add_u32 m0, s64, 24576
    s_mov_b32 s65, 786432
    buffer_load_dwordx4 v15, s[28:31], s65 offen offset:0 lds
    s_mov_b32 s65, 801792
    buffer_load_dwordx4 v15, s[28:31], s65 offen offset:1024 lds
    s_mov_b32 s65, 849920
    buffer_load_dwordx4 v15, s[28:31], s65 offen offset:2048 lds
    s_mov_b32 s65, 865280
    buffer_load_dwordx4 v15, s[28:31], s65 offen offset:3072 lds
    s_add_u32 m0, s64, 28672
    s_mov_b32 s65, 917504
    buffer_load_dwordx4 v15, s[28:31], s65 offen offset:0 lds
    s_mov_b32 s65, 932864
    buffer_load_dwordx4 v15, s[28:31], s65 offen offset:1024 lds
    s_mov_b32 s65, 980992
    buffer_load_dwordx4 v15, s[28:31], s65 offen offset:2048 lds
    s_mov_b32 s65, 996352
    buffer_load_dwordx4 v15, s[28:31], s65 offen offset:3072 lds
    s_waitcnt vmcnt(0) lgkmcnt(0)
    ds_read_b64_tr_b16 a[0:1], v28 offset:0
    ds_read_b64_tr_b16 a[2:3], v28 offset:1024
    ds_read_b64_tr_b16 a[4:5], v29 offset:0
    ds_read_b64_tr_b16 a[6:7], v29 offset:1024
    ds_read_b64_tr_b16 a[8:9], v30 offset:0
    ds_read_b64_tr_b16 a[10:11], v30 offset:1024
    ds_read_b64_tr_b16 a[12:13], v31 offset:0
    ds_read_b64_tr_b16 a[14:15], v31 offset:1024
    ds_read_b64_tr_b16 a[16:17], v28 offset:4096
    ds_read_b64_tr_b16 a[18:19], v28 offset:5120
    ds_read_b64_tr_b16 a[20:21], v29 offset:4096
    ds_read_b64_tr_b16 a[22:23], v29 offset:5120
    ds_read_b64_tr_b16 a[24:25], v30 offset:4096
    ds_read_b64_tr_b16 a[26:27], v30 offset:5120
    ds_read_b64_tr_b16 a[28:29], v31 offset:4096
    ds_read_b64_tr_b16 a[30:31], v31 offset:5120
    ds_read_b64_tr_b16 a[32:33], v28 offset:8192
    ds_read_b64_tr_b16 a[34:35], v28 offset:9216
    ds_read_b64_tr_b16 a[36:37], v29 offset:8192
    ds_read_b64_tr_b16 a[38:39], v29 offset:9216
    ds_read_b64_tr_b16 a[40:41], v30 offset:8192
    ds_read_b64_tr_b16 a[42:43], v30 offset:9216
    ds_read_b64_tr_b16 a[44:45], v31 offset:8192
    ds_read_b64_tr_b16 a[46:47], v31 offset:9216
    ds_read_b64_tr_b16 a[48:49], v28 offset:12288
    ds_read_b64_tr_b16 a[50:51], v28 offset:13312
    ds_read_b64_tr_b16 a[52:53], v29 offset:12288
    ds_read_b64_tr_b16 a[54:55], v29 offset:13312
    ds_read_b64_tr_b16 a[56:57], v30 offset:12288
    ds_read_b64_tr_b16 a[58:59], v30 offset:13312
    ds_read_b64_tr_b16 a[60:61], v31 offset:12288
    ds_read_b64_tr_b16 a[62:63], v31 offset:13312
    s_waitcnt vmcnt(0) lgkmcnt(0)
    s_add_u32 m0, s64, 0
    s_mov_b32 s65, 1048576
    buffer_load_dwordx4 v15, s[28:31], s65 offen offset:0 lds
    s_mov_b32 s65, 1063936
    buffer_load_dwordx4 v15, s[28:31], s65 offen offset:1024 lds
    s_mov_b32 s65, 1112064
    buffer_load_dwordx4 v15, s[28:31], s65 offen offset:2048 lds
    s_mov_b32 s65, 1127424
    buffer_load_dwordx4 v15, s[28:31], s65 offen offset:3072 lds
    s_add_u32 m0, s64, 4096
    s_mov_b32 s65, 1179648
    buffer_load_dwordx4 v15, s[28:31], s65 offen offset:0 lds
    s_mov_b32 s65, 1195008
    buffer_load_dwordx4 v15, s[28:31], s65 offen offset:1024 lds
    s_mov_b32 s65, 1243136
    buffer_load_dwordx4 v15, s[28:31], s65 offen offset:2048 lds
    s_mov_b32 s65, 1258496
    buffer_load_dwordx4 v15, s[28:31], s65 offen offset:3072 lds
    v_mov_b32 v206, 0
    s_waitcnt vmcnt(0) lgkmcnt(0)
    s_nop 15
    s_nop 3
    s_branch L_join3
L_redo3:
    s_waitcnt vmcnt(0) lgkmcnt(0)
    s_nop 15
    s_nop 3
    v_lshlrev_b32 v235, 5, v0
    s_and_b32 s55, s2, 3
    s_lshl_b32 s55, s55, 2
    s_add_u32 s55, s55, s40
    s_lshl_b32 s55, s55, 11
    s_add_u32 s55, s55, 8290304
    s_mov_b32 s54, 0x40000
L_d2:
    buffer_load_dword v24, v235, s[16:19], s55 offen sc1
    s_waitcnt vmcnt(0)
    v_cmp_ne_u32 vcc, 1, v24
    s_sub_u32 s54, s54, 1
    s_cbranch_scc1 L_d2_x
    s_cbranch_vccnz L_d2
L_d2_x:
L_d2_end:
    s_barrier
    s_lshl_b32 s71, s60, 18
    s_lshl_b32 s50, s40, 15
    s_add_u32 s71, s71, s50
    s_add_u32 s71, s71, 3620864
    s_add_u32 s50, s71, 0
    buffer_load_dwordx4 v[128:131], v1, s[16:19], s50 offen offset:0 sc1
    buffer_load_dwordx4 v[132:135], v1, s[16:19], s50 offen offset:1024 sc1
    buffer_load_dwordx4 v[136:139], v1, s[16:19], s50 offen offset:2048 sc1
    buffer_load_dwordx4 v[140:143], v1, s[16:19], s50 offen offset:3072 sc1
    s_add_u32 s50, s71, 4096
    buffer_load_dwordx4 v[144:147], v1, s[16:19], s50 offen offset:0 sc1
    buffer_load_dwordx4 v[148:151], v1, s[16:19], s50 offen offset:1024 sc1
    buffer_load_dwordx4 v[152:155], v1, s[16:19], s50 offen offset:2048 sc1
    buffer_load_dwordx4 v[156:159], v1, s[16:19], s50 offen offset:3072 sc1
    s_add_u32 s50, s71, 8192
    buffer_load_dwordx4 v[160:163], v1, s[16:19], s50 offen offset:0 sc1
    buffer_load_dwordx4 v[164:167], v1, s[16:19], s50 offen offset:1024 sc1
    s_waitcnt vmcnt(9)
    v_mfma_f32_32x32x16_bf16 v[32:47], a[80:83], v[128:131], 0
    v_mfma_f32_32x32x16_bf16 v[48:63], a[84:87], v[128:131], 0
    buffer_load_dwordx4 v[168:171], v1, s[16:19], s50 offen offset:2048 sc1
    s_waitcnt vmcnt(9)
    v_mfma_f32_32x32x16_bf16 v[32:47], a[88:91], v[132:135], v[32:47]
    v_mfma_f32_32x32x16_bf16 v[48:63], a[92:95], v[132:135], v[48:63]
    buffer_load_dwordx4 v[172:175], v1, s[16:19], s50 offen offset:3072 sc1
    s_waitcnt vmcnt(9)
    v_mfma_f32_32x32x16_bf16 v[32:47], a[96:99], v[136:139], v[32:47]
    v_mfma_f32_32x32x16_bf16 v[48:63], a[100:103], v[136:139], v[48:63]
    s_add_u32 s50, s71, 12288
    buffer_load_dwordx4 v[176:179], v1, s[16:19], s50 offen offset:0 sc1
    s_waitcnt vmcnt(9)
    v_mfma_f32_32x32x16_bf16 v[32:47], a[104:107], v[140:143], v[32:47]
    v_mfma_f32_32x32x16_bf16 v[48:63], a[108:111], v[140:143], v[48:63]
    buffer_load_dwordx4 v[180:183], v1, s[16:19], s50 offen offset:1024 sc1
    s_waitcnt vmcnt(9)
    v_mfma_f32_32x32x16_bf16 v[32:47], a[112:115], v[144:147], v[32:47]
    v_mfma_f32_32x32x16_bf16 v[48:63], a[116:119], v[144:147], v[48:63]
    buffer_load_dwordx4 v[184:187], v1, s[16:19], s50 offen offset:2048 sc1
    s_waitcnt vmcnt(9)
    v_mfma_f32_32x32x16_bf16 v[32:47], a[120:123], v[148:151], v[32:47]
    v_mfma_f32_32x32x16_bf16 v[48:63], a[124:127], v[148:151], v[48:63]
    buffer_load_dwordx4 v[188:191], v1, s[16:19], s50 offen offset:3072 sc1
    s_waitcnt vmcnt(9)
    v_mfma_f32_32x32x16_bf16 v[32:47], a[128:131], v[152:155], v[32:47]
    v_mfma_f32_32x32x16_bf16 v[48:63], a[132:135], v[152:155], v[48:63]
    s_add_u32 s50, s71, 16384
    buffer_load_dwordx4 v[128:131], v1, s[16:19], s50 offen offset:0 sc1
    s_waitcnt vmcnt(9)
    v_mfma_f32_32x32x16_bf16 v[32:47], a[136:139], v[156:159], v[32:47]
    v_mfma_f32_32x32x16_bf16 v[48:63], a[140:143], v[156:159], v[48:63]
    buffer_load_dwordx4 v[132:135], v1, s[16:19], s50 offen offset:1024 sc1
    s_waitcnt vmcnt(9)
    v_mfma_f32_32x32x16_bf16 v[32:47], a[144:147], v[160:163], v[32:47]
    v_mfma_f32_32x32x16_bf16 v[48:63], a[148:151], v[160:163], v[48:63]
    buffer_load_dwordx4 v[136:139], v1, s[16:19], s50 offen offset:2048 sc1
    s_waitcnt vmcnt(9)
    v_mfma_f32_32x32x16_bf16 v[32:47], a[152:155], v[164:167], v[32:47]
    v_mfma_f32_32x32x16_bf16 v[48:63], a[156:159], v[164:167], v[48:63]
    buffer_load_dwordx4 v[140:143], v1, s[16:19], s50 offen offset:3072 sc1
    s_waitcnt vmcnt(9)
    v_mfma_f32_32x32x16_bf16 v[32:47], a[160:163], v[168:171], v[32:47]
    v_mfma_f32_32x32x16_bf16 v[48:63], a[164:167], v[168:171], v[48:63]
    s_add_u32 s50, s71, 20480
    buffer_load_dwordx4 v[144:147], v1, s[16:19], s50 offen offset:0 sc1
    s_waitcnt vmcnt(9)
    v_mfma_f32_32x32x16_bf16 v[32:47], a[168:171], v[172:175], v[32:47]
    v_mfma_f32_32x32x16_bf16 v[48:63], a[172:175], v[172:175], v[48:63]
    buffer_load_dwordx4 v[148:151], v1, s[16:19], s50 offen offset:1024 sc1
    s_waitcnt vmcnt(9)
    v_mfma_f32_32x32x16_bf16 v[32:47], a[176:179], v[176:179], v[32:47]
    v_mfma_f32_32x32x16_bf16 v[48:63], a[180:183], v[176:179], v[48:63]
    buffer_load_dwordx4 v[152:155], v1, s[16:19], s50 offen offset:2048 sc1
    s_waitcnt vmcnt(9)
    v_mfma_f32_32x32x16_bf16 v[32:47], a[184:187], v[180:183], v[32:47]
    v_mfma_f32_32x32x16_bf16 v[48:63], a[188:191], v[180:183], v[48:63]
    buffer_load_dwordx4 v[156:159], v1, s[16:19], s50 offen offset:3072 sc1
    s_waitcnt vmcnt(9)
    v_mfma_f32_32x32x16_bf16 v[32:47], a[192:195], v[184:187], v[32:47]
    v_mfma_f32_32x32x16_bf16 v[48:63], a[196:199], v[184:187], v[48:63]
    s_add_u32 s50, s71, 24576
    buffer_load_dwordx4 v[160:163], v1, s[16:19], s50 offen offset:0 sc1
    s_waitcnt vmcnt(9)
    v_mfma_f32_32x32x16_bf16 v[32:47], a[200:203], v[188:191], v[32:47]
    v_mfma_f32_32x32x16_bf16 v[48:63], a[204:207], v[188:191], v[48:63]
    buffer_load_dwordx4 v[164:167], v1, s[16:19], s50 offen offset:1024 sc1
    s_waitcnt vmcnt(9)
    v_mfma_f32_32x32x16_bf16 v[32:47], a[208:211], v[128:131], v[32:47]
    v_mfma_f32_32x32x16_bf16 v[48:63], a[212:215], v[128:131], v[48:63]
    buffer_load_dwordx4 v[168:171], v1, s[16:19], s50 offen offset:2048 sc1
    s_waitcnt vmcnt(9)
    v_mfma_f32_32x32x16_bf16 v[32:47], a[216:219], v[132:135], v[32:47]
    v_mfma_f32_32x32x16_bf16 v[48:63], a[220:223], v[132:135], v[48:63]
    buffer_load_dwordx4 v[172:175], v1, s[16:19], s50 offen offset:3072 sc1
    s_waitcnt vmcnt(9)
    v_mfma_f32_32x32x16_bf16 v[32:47], a[224:227], v[136:139], v[32:47]
    v_mfma_f32_32x32x16_bf16 v[48:63], a[228:231], v[136:139], v[48:63]
    s_add_u32 s50, s71, 28672
    buffer_load_dwordx4 v[176:179], v1, s[16:19], s50 offen offset:0 sc1
    s_waitcnt vmcnt(9)
    v_mfma_f32_32x32x16_bf16 v[32:47], a[232:235], v[140:143], v[32:47]
    v_mfma_f32_32x32x16_bf16 v[48:63], a[236:239], v[140:143], v[48:63]
    buffer_load_dwordx4 v[180:183], v1, s[16:19], s50 offen offset:1024 sc1
    s_waitcnt vmcnt(9)
    v_mfma_f32_32x32x16_bf16 v[32:47], a[240:243], v[144:147], v[32:47]
    v_mfma_f32_32x32x16_bf16 v[48:63], a[244:247], v[144:147], v[48:63]
    buffer_load_dwordx4 v[184:187], v1, s[16:19], s50 offen offset:2048 sc1
    s_waitcnt vmcnt(9)
    v_mfma_f32_32x32x16_bf16 v[32:47], a[248:251], v[148:151], v[32:47]
    v_mfma_f32_32x32x16_bf16 v[48:63], a[252:255], v[148:151], v[48:63]
    buffer_load_dwordx4 v[188:191], v1, s[16:19], s50 offen offset:3072 sc1
    s_waitcnt vmcnt(9)
    v_mfma_f32_32x32x16_bf16 v[32:47], a[0:3], v[152:155], v[32:47]
    v_mfma_f32_32x32x16_bf16 v[48:63], a[4:7], v[152:155], v[48:63]
    s_add_u32 s50, s71, 131072
    buffer_load_dwordx4 v[128:131], v1, s[16:19], s50 offen offset:0 sc1
    s_waitcnt vmcnt(9)
    v_mfma_f32_32x32x16_bf16 v[32:47], a[8:11], v[156:159], v[32:47]
    v_mfma_f32_32x32x16_bf16 v[48:63], a[12:15], v[156:159], v[48:63]
    buffer_load_dwordx4 v[132:135], v1, s[16:19], s50 offen offset:1024 sc1
    s_waitcnt vmcnt(9)
    v_mfma_f32_32x32x16_bf16 v[32:47], a[16:19], v[160:163], v[32:47]
    v_mfma_f32_32x32x16_bf16 v[48:63], a[20:23], v[160:163], v[48:63]
    buffer_load_dwordx4 v[136:139], v1, s[16:19], s50 offen offset:2048 sc1
    s_waitcnt vmcnt(9)
    v_mfma_f32_32x32x16_bf16 v[32:47], a[24:27], v[164:167], v[32:47]
    v_mfma_f32_32x32x16_bf16 v[48:63], a[28:31], v[164:167], v[48:63]
    buffer_load_dwordx4 v[140:143], v1, s[16:19], s50 offen offset:3072 sc1
    s_waitcnt vmcnt(9)
    v_mfma_f32_32x32x16_bf16 v[32:47], a[32:35], v[168:171], v[32:47]
    v_mfma_f32_32x32x16_bf16 v[48:63], a[36:39], v[168:171], v[48:63]
    s_add_u32 s50, s71, 135168
    buffer_load_dwordx4 v[144:147], v1, s[16:19], s50 offen offset:0 sc1
    s_waitcnt vmcnt(9)
    v_mfma_f32_32x32x16_bf16 v[32:47], a[40:43], v[172:175], v[32:47]
    v_mfma_f32_32x32x16_bf16 v[48:63], a[44:47], v[172:175], v[48:63]
    buffer_load_dwordx4 v[148:151], v1, s[16:19], s50 offen offset:1024 sc1
    s_waitcnt vmcnt(9)
    v_mfma_f32_32x32x16_bf16 v[32:47], a[48:51], v[176:179], v[32:47]
    v_mfma_f32_32x32x16_bf16 v[48:63], a[52:55], v[176:179], v[48:63]
    buffer_load_dwordx4 v[152:155], v1, s[16:19], s50 offen offset:2048 sc1
    s_waitcnt vmcnt(9)
    v_mfma_f32_32x32x16_bf16 v[32:47], a[56:59], v[180:183], v[32:47]
    v_mfma_f32_32x32x16_bf16 v[48:63], a[60:63], v[180:183], v[48:63]
    buffer_load_dwordx4 v[156:159], v1, s[16:19], s50 offen offset:3072 sc1
    s_waitcnt vmcnt(9)
    v_mfma_f32_32x32x16_bf16 v[32:47], a[64:67], v[184:187], v[32:47]
    v_mfma_f32_32x32x16_bf16 v[48:63], a[68:71], v[184:187], v[48:63]
    s_add_u32 s50, s71, 139264
    buffer_load_dwordx4 v[160:163], v1, s[16:19], s50 offen offset:0 sc1
    s_waitcnt vmcnt(9)
    v_mfma_f32_32x32x16_bf16 v[32:47], a[72:75], v[188:191], v[32:47]
    v_mfma_f32_32x32x16_bf16 v[48:63], a[76:79], v[188:191], v[48:63]
    buffer_load_dwordx4 v[164:167], v1, s[16:19], s50 offen offset:1024 sc1
    s_waitcnt vmcnt(9)
    v_mfma_f32_32x32x16_bf16 v[64:79], a[80:83], v[128:131], 0
    v_mfma_f32_32x32x16_bf16 v[80:95], a[84:87], v[128:131], 0
    buffer_load_dwordx4 v[168:171], v1, s[16:19], s50 offen offset:2048 sc1
    s_waitcnt vmcnt(9)
    v_mfma_f32_32x32x16_bf16 v[64:79], a[88:91], v[132:135], v[64:79]
    v_mfma_f32_32x32x16_bf16 v[80:95], a[92:95], v[132:135], v[80:95]
    buffer_load_dwordx4 v[172:175], v1, s[16:19], s50 offen offset:3072 sc1
    s_waitcnt vmcnt(9)
    v_mfma_f32_32x32x16_bf16 v[64:79], a[96:99], v[136:139], v[64:79]
    ds_write_b128 v10, v[40:43] offset:0
    v_mfma_f32_32x32x16_bf16 v[80:95], a[100:103], v[136:139], v[80:95]
    s_add_u32 s50, s71, 143360
    buffer_load_dwordx4 v[176:179], v1, s[16:19], s50 offen offset:0 sc1
    ds_write_b128 v10, v[44:47] offset:1024
    s_waitcnt vmcnt(9)
    v_mfma_f32_32x32x16_bf16 v[64:79], a[104:107], v[140:143], v[64:79]
    ds_write_b128 v10, v[48:51] offset:2048
    v_mfma_f32_32x32x16_bf16 v[80:95], a[108:111], v[140:143], v[80:95]
    buffer_load_dwordx4 v[180:183], v1, s[16:19], s50 offen offset:1024 sc1
    ds_write_b128 v10, v[52:55] offset:3072
    s_waitcnt vmcnt(9)
    v_mfma_f32_32x32x16_bf16 v[64:79], a[112:115], v[144:147], v[64:79]
    ds_write_b128 v10, v[56:59] offset:4096
    v_mfma_f32_32x32x16_bf16 v[80:95], a[116:119], v[144:147], v[80:95]
    buffer_load_dwordx4 v[184:187], v1, s[16:19], s50 offen offset:2048 sc1
    ds_write_b128 v10, v[60:63] offset:5120
    s_waitcnt vmcnt(9)
    v_mfma_f32_32x32x16_bf16 v[64:79], a[120:123], v[148:151], v[64:79]
    v_mfma_f32_32x32x16_bf16 v[80:95], a[124:127], v[148:151], v[80:95]
    buffer_load_dwordx4 v[188:191], v1, s[16:19], s50 offen offset:3072 sc1
    s_waitcnt vmcnt(9)
    v_mfma_f32_32x32x16_bf16 v[64:79], a[128:131], v[152:155], v[64:79]
    s_waitcnt lgkmcnt(0)
    s_barrier
    ds_read_b128 v[96:99], v11 offset:0
    ds_read_b128 v[100:103], v11 offset:1024
    ds_read_b128 v[104:107], v12 offset:2048
    ds_read_b128 v[108:111], v12 offset:3072
    ds_read_b128 v[112:115], v13 offset:4096
    v_mfma_f32_32x32x16_bf16 v[80:95], a[132:135], v[152:155], v[80:95]
    s_add_u32 s50, s71, 147456
    buffer_load_dwordx4 v[128:131], v1, s[16:19], s50 offen offset:0 sc1
    ds_read_b128 v[116:119], v13 offset:5120
    s_waitcnt vmcnt(9)
    v_mfma_f32_32x32x16_bf16 v[64:79], a[136:139], v[156:159], v[64:79]
    v_mfma_f32_32x32x16_bf16 v[80:95], a[140:143], v[156:159], v[80:95]
    buffer_load_dwordx4 v[132:135], v1, s[16:19], s50 offen offset:1024 sc1
    s_waitcnt vmcnt(9)
    v_mfma_f32_32x32x16_bf16 v[64:79], a[144:147], v[160:163], v[64:79]
    v_add_f32 v32, v32, v2
    v_add_f32 v33, v33, v3
    v_add_f32 v34, v34, v4
    v_add_f32 v35, v35, v5
    v_add_f32 v36, v36, v6
    v_mfma_f32_32x32x16_bf16 v[80:95], a[148:151], v[160:163], v[80:95]
    buffer_load_dwordx4 v[136:139], v1, s[16:19], s50 offen offset:2048 sc1
    v_add_f32 v37, v37, v7
    v_add_f32 v38, v38, v8
    v_add_f32 v39, v39, v9
    s_waitcnt lgkmcnt(5)
    v_add_f32 v32, v32, v96
    v_add_f32 v33, v33, v97
    s_waitcnt vmcnt(9)
    v_mfma_f32_32x32x16_bf16 v[64:79], a[152:155], v[164:167], v[64:79]
    v_add_f32 v34, v34, v98
    v_add_f32 v35, v35, v99
    s_waitcnt lgkmcnt(4)
    v_add_f32 v36, v36, v100
    v_add_f32 v37, v37, v101
    v_add_f32 v38, v38, v102
    v_mfma_f32_32x32x16_bf16 v[80:95], a[156:159], v[164:167], v[80:95]
    buffer_load_dwordx4 v[140:143], v1, s[16:19], s50 offen offset:3072 sc1
    v_add_f32 v39, v39, v103
    s_waitcnt lgkmcnt(1)
    v_add_f32 v104, v104, v112
    v_add_f32 v105, v105, v113
    v_add_f32 v106, v106, v114
    v_add_f32 v107, v107, v115
    s_waitcnt vmcnt(9)
    v_mfma_f32_32x32x16_bf16 v[64:79], a[160:163], v[168:171], v[64:79]
    s_waitcnt lgkmcnt(0)
    v_add_f32 v108, v108, v116
    v_add_f32 v109, v109, v117
    v_add_f32 v110, v110, v118
    v_add_f32 v111, v111, v119
    v_add_f32 v32, v32, v104
    v_mfma_f32_32x32x16_bf16 v[80:95], a[164:167], v[168:171], v[80:95]
    s_add_u32 s50, s71, 151552
    buffer_load_dwordx4 v[144:147], v1, s[16:19], s50 offen offset:0 sc1
    v_add_f32 v33, v33, v105
    v_add_f32 v34, v34, v106
    v_add_f32 v35, v35, v107
    v_add_f32 v36, v36, v108
    v_add_f32 v37, v37, v109
    s_waitcnt vmcnt(9)
    v_mfma_f32_32x32x16_bf16 v[64:79], a[168:171], v[172:175], v[64:79]
    v_add_f32 v38, v38, v110
    v_add_f32 v39, v39, v111
    v_mul_f32 v120, v32, v32
    v_mul_f32 v121, v33, v33
    v_mul_f32 v122, v34, v34
    v_mfma_f32_32x32x16_bf16 v[80:95], a[172:175], v[172:175], v[80:95]
    buffer_load_dwordx4 v[148:151], v1, s[16:19], s50 offen offset:1024 sc1
    v_mul_f32 v123, v35, v35
    v_mul_f32 v124, v36, v36
    v_mul_f32 v125, v37, v37
    v_mul_f32 v126, v38, v38
    v_mul_f32 v127, v39, v39
    s_waitcnt vmcnt(9)
    v_mfma_f32_32x32x16_bf16 v[64:79], a[176:179], v[176:179], v[64:79]
    v_fma_f32 v120, v120, s66, v22
    v_fma_f32 v121, v121, s66, v22
    v_fma_f32 v122, v122, s66, v22
    v_fma_f32 v123, v123, s66, v22
    v_fma_f32 v124, v124, s66, v22
    v_mfma_f32_32x32x16_bf16 v[80:95], a[180:183], v[176:179], v[80:95]
    buffer_load_dwordx4 v[152:155], v1, s[16:19], s50 offen offset:2048 sc1
    v_fma_f32 v125, v125, s66, v22
    v_fma_f32 v126, v126, s66, v22
    v_fma_f32 v127, v127, s66, v22
    v_mul_f32 v120, v120, v32
    v_mul_f32 v121, v121, v33
    s_waitcnt vmcnt(9)
    v_mfma_f32_32x32x16_bf16 v[64:79], a[184:187], v[180:183], v[64:79]
    v_mul_f32 v122, v122, v34
    v_mul_f32 v123, v123, v35
    v_mul_f32 v124, v124, v36
    v_mul_f32 v125, v125, v37
    v_mul_f32 v126, v126, v38
    v_mfma_f32_32x32x16_bf16 v[80:95], a[188:191], v[180:183], v[80:95]
    buffer_load_dwordx4 v[156:159], v1, s[16:19], s50 offen offset:3072 sc1
    v_mul_f32 v127, v127, v39
    v_exp_f32 v120, v120
    v_exp_f32 v121, v121
    s_waitcnt vmcnt(9)
    v_mfma_f32_32x32x16_bf16 v[64:79], a[192:195], v[184:187], v[64:79]
    v_exp_f32 v122, v122
    v_exp_f32 v123, v123
    v_exp_f32 v124, v124
    v_mfma_f32_32x32x16_bf16 v[80:95], a[196:199], v[184:187], v[80:95]
    s_add_u32 s50, s71, 155648
    buffer_load_dwordx4 v[160:163], v1, s[16:19], s50 offen offset:0 sc1
    v_exp_f32 v125, v125
    v_exp_f32 v126, v126
    v_exp_f32 v127, v127
    s_waitcnt vmcnt(9)
    v_mfma_f32_32x32x16_bf16 v[64:79], a[200:203], v[188:191], v[64:79]
    v_add_f32 v120, 1.0, v120
    v_add_f32 v121, 1.0, v121
    v_add_f32 v122, 1.0, v122
    v_add_f32 v123, 1.0, v123
    v_add_f32 v124, 1.0, v124
    v_mfma_f32_32x32x16_bf16 v[80:95], a[204:207], v[188:191], v[80:95]
    buffer_load_dwordx4 v[164:167], v1, s[16:19], s50 offen offset:1024 sc1
    v_add_f32 v125, 1.0, v125
    v_add_f32 v126, 1.0, v126
    v_add_f32 v127, 1.0, v127
    v_rcp_f32 v120, v120
    s_waitcnt vmcnt(9)
    v_mfma_f32_32x32x16_bf16 v[64:79], a[208:211], v[128:131], v[64:79]
    v_rcp_f32 v121, v121
    v_rcp_f32 v122, v122
    v_rcp_f32 v123, v123
    v_mfma_f32_32x32x16_bf16 v[80:95], a[212:215], v[128:131], v[80:95]
    buffer_load_dwordx4 v[168:171], v1, s[16:19], s50 offen offset:2048 sc1
    v_rcp_f32 v124, v124
    v_rcp_f32 v125, v125
    v_rcp_f32 v126, v126
    s_waitcnt vmcnt(9)
    v_mfma_f32_32x32x16_bf16 v[64:79], a[216:219], v[132:135], v[64:79]
    v_rcp_f32 v127, v127
    v_mul_f32 v32, v120, v32
    v_mul_f32 v33, v121, v33
    v_mul_f32 v34, v122, v34
    v_mfma_f32_32x32x16_bf16 v[80:95], a[220:223], v[132:135], v[80:95]
    buffer_load_dwordx4 v[172:175], v1, s[16:19], s50 offen offset:3072 sc1
    v_mul_f32 v35, v123, v35
    v_mul_f32 v36, v124, v36
    v_mul_f32 v37, v125, v37
    v_mul_f32 v38, v126, v38
    v_mul_f32 v39, v127, v39
    s_waitcnt vmcnt(9)
    v_mfma_f32_32x32x16_bf16 v[64:79], a[224:227], v[136:139], v[64:79]
    v_cvt_pk_bf16_f32 v120, v32, v33
    v_cvt_pk_bf16_f32 v121, v34, v35
    v_cvt_pk_bf16_f32 v122, v36, v37
    v_cvt_pk_bf16_f32 v123, v38, v39
    v_mfma_f32_32x32x16_bf16 v[80:95], a[228:231], v[136:139], v[80:95]
    s_add_u32 s50, s71, 159744
    buffer_load_dwordx4 v[176:179], v1, s[16:19], s50 offen offset:0 sc1
    s_waitcnt vmcnt(9)
    v_mfma_f32_32x32x16_bf16 v[64:79], a[232:235], v[140:143], v[64:79]
    v_mfma_f32_32x32x16_bf16 v[80:95], a[236:239], v[140:143], v[80:95]
    buffer_load_dwordx4 v[180:183], v1, s[16:19], s50 offen offset:1024 sc1
    s_waitcnt vmcnt(9)
    v_mfma_f32_32x32x16_bf16 v[64:79], a[240:243], v[144:147], v[64:79]
    v_mfma_f32_32x32x16_bf16 v[80:95], a[244:247], v[144:147], v[80:95]
    buffer_load_dwordx4 v[184:187], v1, s[16:19], s50 offen offset:2048 sc1
    s_waitcnt vmcnt(9)
    v_mfma_f32_32x32x16_bf16 v[64:79], a[248:251], v[148:151], v[64:79]
    v_mfma_f32_32x32x16_bf16 v[80:95], a[252:255], v[148:151], v[80:95]
    buffer_load_dwordx4 v[188:191], v1, s[16:19], s50 offen offset:3072 sc1
    s_waitcnt vmcnt(9)
    v_mfma_f32_32x32x16_bf16 v[64:79], a[0:3], v[152:155], v[64:79]
    buffer_store_dwordx4 v[120:123], v14, s[16:19], s70 offen sc1
    s_barrier
    v_mfma_f32_32x32x16_bf16 v[80:95], a[4:7], v[152:155], v[80:95]
    s_waitcnt vmcnt(9)
    v_mfma_f32_32x32x16_bf16 v[64:79], a[8:11], v[156:159], v[64:79]
    v_mfma_f32_32x32x16_bf16 v[80:95], a[12:15], v[156:159], v[80:95]
    s_waitcnt vmcnt(8)
    v_mfma_f32_32x32x16_bf16 v[64:79], a[16:19], v[160:163], v[64:79]
    v_mfma_f32_32x32x16_bf16 v[80:95], a[20:23], v[160:163], v[80:95]
    s_waitcnt vmcnt(7)
    v_mfma_f32_32x32x16_bf16 v[64:79], a[24:27], v[164:167], v[64:79]
    v_mfma_f32_32x32x16_bf16 v[80:95], a[28:31], v[164:167], v[80:95]
    s_waitcnt vmcnt(6)
    v_mfma_f32_32x32x16_bf16 v[64:79], a[32:35], v[168:171], v[64:79]
    v_mfma_f32_32x32x16_bf16 v[80:95], a[36:39], v[168:171], v[80:95]
    s_waitcnt vmcnt(5)
    v_mfma_f32_32x32x16_bf16 v[64:79], a[40:43], v[172:175], v[64:79]
    v_mfma_f32_32x32x16_bf16 v[80:95], a[44:47], v[172:175], v[80:95]
    s_waitcnt vmcnt(4)
    v_mfma_f32_32x32x16_bf16 v[64:79], a[48:51], v[176:179], v[64:79]
    v_mfma_f32_32x32x16_bf16 v[80:95], a[52:55], v[176:179], v[80:95]
    s_waitcnt vmcnt(3)
    v_mfma_f32_32x32x16_bf16 v[64:79], a[56:59], v[180:183], v[64:79]
    v_mfma_f32_32x32x16_bf16 v[80:95], a[60:63], v[180:183], v[80:95]
    s_waitcnt vmcnt(2)
    v_mfma_f32_32x32x16_bf16 v[64:79], a[64:67], v[184:187], v[64:79]
    v_mfma_f32_32x32x16_bf16 v[80:95], a[68:71], v[184:187], v[80:95]
    s_waitcnt vmcnt(1)
    v_mfma_f32_32x32x16_bf16 v[64:79], a[72:75], v[188:191], v[64:79]
    v_mfma_f32_32x32x16_bf16 v[80:95], a[76:79], v[188:191], v[80:95]
    s_nop 10
    ds_write_b128 v10, v[72:75] offset:0
    ds_write_b128 v10, v[76:79] offset:1024
    ds_write_b128 v10, v[80:83] offset:2048
    ds_write_b128 v10, v[84:87] offset:3072
    ds_write_b128 v10, v[88:91] offset:4096
    ds_write_b128 v10, v[92:95] offset:5120
    s_waitcnt lgkmcnt(0)
    s_barrier
    ds_read_b128 v[96:99], v11 offset:0
    ds_read_b128 v[100:103], v11 offset:1024
    ds_read_b128 v[104:107], v12 offset:2048
    ds_read_b128 v[108:111], v12 offset:3072
    ds_read_b128 v[112:115], v13 offset:4096
    ds_read_b128 v[116:119], v13 offset:5120
    s_waitcnt vmcnt(0) lgkmcnt(0)
    s_nop 15
    s_nop 3
    s_branch L_t3
L_redo4:
    s_waitcnt vmcnt(0) lgkmcnt(0)
    s_nop 15
    s_nop 3
    v_lshlrev_b32 v235, 5, v0
    s_and_b32 s55, s2, 3
    s_lshl_b32 s55, s55, 2
    s_add_u32 s55, s55, s40
    s_lshl_b32 s55, s55, 11
    s_add_u32 s55, s55, 8290304
    s_mov_b32 s54, 0x40000
L_d2b:
    buffer_load_dword v24, v235, s[16:19], s55 offen sc1
    s_waitcnt vmcnt(0)
    v_cmp_ne_u32 vcc, 1, v24
    s_sub_u32 s54, s54, 1
    s_cbranch_scc1 L_d2b_x
    s_cbranch_vccnz L_d2b
L_d2b_x:
L_d2b_end:
    s_add_u32 s57, s57, 65536
    s_mov_b32 s54, 0x40000
L_d3:
    buffer_load_dword v24, v27, s[16:19], s57 offen sc1
    s_waitcnt vmcnt(0)
    v_cmp_ne_u32 vcc, 1, v24
    s_sub_u32 s54, s54, 1
    s_cbranch_scc1 L_d3_x
    s_cbranch_vccnz L_d3
L_d3_x:
L_d3_end:
    s_barrier
    s_lshl_b32 s68, s63, 3
    s_lshl_b32 s51, s40, 1
    s_add_u32 s68, s68, s51
    s_sub_u32 s52, 0, s62
    s_and_b32 s52, s52, 3
    s_mul_i32 s53, s62, 5
    s_add_u32 s52, s52, s53
    s_lshl_b32 s51, s52, 4
    v_lshrrev_b32 v20, 1, v0
    v_add_u32 v20, s51, v20
    v_lshrrev_b32 v21, 5, v20
    v_lshlrev_b32 v21, 17, v21
    v_and_b32 v20, 31, v20
    v_lshl_add_u32 v21, v20, 4, v21
    v_and_b32 v20, 1, v0
    v_lshl_add_u32 v253, v20, 9, v21
    s_sub_u32 s52, 2, s62
    s_and_b32 s52, s52, 3
    s_mul_i32 s53, s62, 5
    s_add_u32 s52, s52, s53
    s_lshl_b32 s51, s52, 4
    v_lshrrev_b32 v20, 1, v0
    v_add_u32 v20, s51, v20
    v_lshrrev_b32 v21, 5, v20
    v_lshlrev_b32 v21, 17, v21
    v_and_b32 v20, 31, v20
    v_lshl_add_u32 v21, v20, 4, v21
    v_and_b32 v20, 1, v0
    v_lshl_add_u32 v254, v20, 9, v21
    s_andn2_b32 s52, 1, s62
    s_lshl_b32 s52, s52, 2
    s_mul_i32 s53, s62, 5
    s_add_u32 s52, s52, s53
    s_lshl_b32 s51, s52, 4
    v_lshrrev_b32 v20, 1, v0
    v_add_u32 v20, s51, v20
    v_lshrrev_b32 v21, 5, v20
    v_lshlrev_b32 v21, 17, v21
    v_and_b32 v20, 31, v20
    v_lshl_add_u32 v21, v20, 4, v21
    v_and_b32 v20, 1, v0
    v_lshl_add_u32 v255, v20, 9, v21
    s_lshl_b32 s51, s68, 4
    v_and_b32 v20, 15, v0
    v_lshlrev_b32 v21, 1, v20
    v_lshlrev_b32 v240, 3, v20
    buffer_load_ushort v252, v21, s[36:39], s51 offen
    s_lshl_b32 s69, s68, 6
    s_add_u32 s69, s69, 6242304
    s_lshl_b32 s68, s68, 9
    s_add_u32 s68, s68, 3620864
    s_add_u32 m0, s64, 29696
    s_nop 0
    buffer_load_dwordx4 v253, s[16:19], s68 offen sc1 lds
    s_add_u32 m0, s64, 30720
    s_nop 0
    buffer_load_dwordx4 v254, s[16:19], s68 offen sc1 lds
    s_add_u32 m0, s64, 31744
    s_nop 0
    buffer_load_dwordx4 v255, s[16:19], s68 offen sc1 lds
    buffer_load_dwordx2 v[250:251], v240, s[16:19], s69 offen sc1
    v_lshl_add_u32 v253, v0, 3, s64
    s_waitcnt vmcnt(0) lgkmcnt(0)
    ds_read_b64_tr_b16 v[240:241], v253 offset:29696
    ds_read_b64_tr_b16 v[242:243], v253 offset:30208
    ds_read_b64_tr_b16 v[244:245], v253 offset:30720
    ds_read_b64_tr_b16 v[246:247], v253 offset:31232
    ds_read_b64_tr_b16 v[248:249], v253 offset:31744
    v_lshlrev_b32 v252, 16, v252
    v_add_f32 v250, v250, v252
    s_waitcnt lgkmcnt(4)
    v_lshlrev_b32 v208, 16, v240
    v_and_b32 v209, 0xffff0000, v240
    v_lshlrev_b32 v210, 16, v241
    v_and_b32 v211, 0xffff0000, v241
    v_fma_f32 v208, v208, v251, v250
    v_fma_f32 v209, v209, v251, v250
    v_fma_f32 v210, v210, v251, v250
    v_fma_f32 v211, v211, v251, v250
    s_waitcnt lgkmcnt(3)
    v_lshlrev_b32 v212, 16, v242
    v_and_b32 v213, 0xffff0000, v242
    v_lshlrev_b32 v214, 16, v243
    v_and_b32 v215, 0xffff0000, v243
    v_fma_f32 v212, v212, v251, v250
    v_fma_f32 v213, v213, v251, v250
    v_fma_f32 v214, v214, v251, v250
    v_fma_f32 v215, v215, v251, v250
    s_waitcnt lgkmcnt(2)
    v_lshlrev_b32 v216, 16, v244
    v_and_b32 v217, 0xffff0000, v244
    v_lshlrev_b32 v218, 16, v245
    v_and_b32 v219, 0xffff0000, v245
    v_fma_f32 v216, v216, v251, v250
    v_fma_f32 v217, v217, v251, v250
    v_fma_f32 v218, v218, v251, v250
    v_fma_f32 v219, v219, v251, v250
    s_waitcnt lgkmcnt(1)
    v_lshlrev_b32 v220, 16, v246
    v_and_b32 v221, 0xffff0000, v246
    v_lshlrev_b32 v222, 16, v247
    v_and_b32 v223, 0xffff0000, v247
    v_fma_f32 v220, v220, v251, v250
    v_fma_f32 v221, v221, v251, v250
    v_fma_f32 v222, v222, v251, v250
    v_fma_f32 v223, v223, v251, v250
    s_waitcnt lgkmcnt(0)
    v_lshlrev_b32 v224, 16, v248
    v_and_b32 v225, 0xffff0000, v248
    v_lshlrev_b32 v226, 16, v249
    v_and_b32 v227, 0xffff0000, v249
    v_fma_f32 v224, v224, v251, v250
    v_fma_f32 v225, v225, v251, v250
    v_fma_f32 v226, v226, v251, v250
    v_fma_f32 v227, v227, v251, v250
    s_add_u32 s50, s7, 0
    buffer_load_dwordx4 v[128:131], v1, s[16:19], s50 offen offset:0 sc1
    buffer_load_dwordx4 v[132:135], v1, s[16:19], s50 offen offset:1024 sc1
    buffer_load_dwordx4 v[136:139], v1, s[16:19], s50 offen offset:2048 sc1
    buffer_load_dwordx4 v[140:143], v1, s[16:19], s50 offen offset:3072 sc1
    s_add_u32 s50, s7, 4096
    buffer_load_dwordx4 v[144:147], v1, s[16:19], s50 offen offset:0 sc1
    buffer_load_dwordx4 v[148:151], v1, s[16:19], s50 offen offset:1024 sc1
    buffer_load_dwordx4 v[152:155], v1, s[16:19], s50 offen offset:2048 sc1
    buffer_load_dwordx4 v[156:159], v1, s[16:19], s50 offen offset:3072 sc1
    s_add_u32 s50, s7, 49152
    buffer_load_dwordx4 v[160:163], v1, s[16:19], s50 offen offset:0 sc1
    buffer_load_dwordx4 v[164:167], v1, s[16:19], s50 offen offset:1024 sc1
    s_waitcnt vmcnt(9)
    v_mfma_f32_16x16x32_bf16 v[32:35], v[128:131], a[0:3], v[208:211]
    v_mfma_f32_16x16x32_bf16 v[36:39], v[128:131], a[4:7], 0
    v_mfma_f32_16x16x32_bf16 v[40:43], v[128:131], a[8:11], 0
    v_mfma_f32_16x16x32_bf16 v[44:47], v[128:131], a[12:15], 0
    buffer_load_dwordx4 v[168:171], v1, s[16:19], s50 offen offset:2048 sc1
    s_waitcnt vmcnt(9)
    v_mfma_f32_16x16x32_bf16 v[32:35], v[132:135], a[16:19], v[32:35]
    v_mfma_f32_16x16x32_bf16 v[36:39], v[132:135], a[20:23], v[36:39]
    v_mfma_f32_16x16x32_bf16 v[40:43], v[132:135], a[24:27], v[40:43]
    v_mfma_f32_16x16x32_bf16 v[44:47], v[132:135], a[28:31], v[44:47]
    buffer_load_dwordx4 v[172:175], v1, s[16:19], s50 offen offset:3072 sc1
    s_waitcnt vmcnt(9)
    v_mfma_f32_16x16x32_bf16 v[32:35], v[136:139], a[32:35], v[32:35]
    v_mfma_f32_16x16x32_bf16 v[36:39], v[136:139], a[36:39], v[36:39]
    v_mfma_f32_16x16x32_bf16 v[40:43], v[136:139], a[40:43], v[40:43]
    v_mfma_f32_16x16x32_bf16 v[44:47], v[136:139], a[44:47], v[44:47]
    s_add_u32 s50, s7, 53248
    buffer_load_dwordx4 v[176:179], v1, s[16:19], s50 offen offset:0 sc1
    s_waitcnt vmcnt(9)
    v_mfma_f32_16x16x32_bf16 v[32:35], v[140:143], a[48:51], v[32:35]
    v_mfma_f32_16x16x32_bf16 v[36:39], v[140:143], a[52:55], v[36:39]
    v_mfma_f32_16x16x32_bf16 v[40:43], v[140:143], a[56:59], v[40:43]
    v_mfma_f32_16x16x32_bf16 v[44:47], v[140:143], a[60:63], v[44:47]
    buffer_load_dwordx4 v[180:183], v1, s[16:19], s50 offen offset:1024 sc1
    s_waitcnt vmcnt(9)
    v_mfma_f32_16x16x32_bf16 v[32:35], v[144:147], a[64:67], v[32:35]
    v_mfma_f32_16x16x32_bf16 v[36:39], v[144:147], a[68:71], v[36:39]
    v_mfma_f32_16x16x32_bf16 v[40:43], v[144:147], a[72:75], v[40:43]
    v_mfma_f32_16x16x32_bf16 v[44:47], v[144:147], a[76:79], v[44:47]
    buffer_load_dwordx4 v[184:187], v1, s[16:19], s50 offen offset:2048 sc1
    s_waitcnt vmcnt(9)
    v_mfma_f32_16x16x32_bf16 v[32:35], v[148:151], a[80:83], v[32:35]
    v_mfma_f32_16x16x32_bf16 v[36:39], v[148:151], a[84:87], v[36:39]
    v_mfma_f32_16x16x32_bf16 v[40:43], v[148:151], a[88:91], v[40:43]
    v_mfma_f32_16x16x32_bf16 v[44:47], v[148:151], a[92:95], v[44:47]
    buffer_load_dwordx4 v[188:191], v1, s[16:19], s50 offen offset:3072 sc1
    s_waitcnt vmcnt(9)
    v_mfma_f32_16x16x32_bf16 v[32:35], v[152:155], a[96:99], v[32:35]
    v_mfma_f32_16x16x32_bf16 v[36:39], v[152:155], a[100:103], v[36:39]
    v_mfma_f32_16x16x32_bf16 v[40:43], v[152:155], a[104:107], v[40:43]
    v_mfma_f32_16x16x32_bf16 v[44:47], v[152:155], a[108:111], v[44:47]
    s_add_u32 s50, s7, 8192
    buffer_load_dwordx4 v[128:131], v1, s[16:19], s50 offen offset:0 sc1
    s_waitcnt vmcnt(9)
    v_mfma_f32_16x16x32_bf16 v[32:35], v[156:159], a[112:115], v[32:35]
    v_mfma_f32_16x16x32_bf16 v[36:39], v[156:159], a[116:119], v[36:39]
    v_mfma_f32_16x16x32_bf16 v[40:43], v[156:159], a[120:123], v[40:43]
    v_mfma_f32_16x16x32_bf16 v[44:47], v[156:159], a[124:127], v[44:47]
    buffer_load_dwordx4 v[132:135], v1, s[16:19], s50 offen offset:1024 sc1
    s_waitcnt vmcnt(9)
    v_mfma_f32_16x16x32_bf16 v[48:51], v[160:163], a[0:3], v[212:215]
    v_mfma_f32_16x16x32_bf16 v[52:55], v[160:163], a[4:7], 0
    v_mfma_f32_16x16x32_bf16 v[56:59], v[160:163], a[8:11], 0
    v_mfma_f32_16x16x32_bf16 v[60:63], v[160:163], a[12:15], 0
    buffer_load_dwordx4 v[136:139], v1, s[16:19], s50 offen offset:2048 sc1
    s_waitcnt vmcnt(9)
    v_mfma_f32_16x16x32_bf16 v[48:51], v[164:167], a[16:19], v[48:51]
    v_mfma_f32_16x16x32_bf16 v[52:55], v[164:167], a[20:23], v[52:55]
    v_mfma_f32_16x16x32_bf16 v[56:59], v[164:167], a[24:27], v[56:59]
    v_mfma_f32_16x16x32_bf16 v[60:63], v[164:167], a[28:31], v[60:63]
    buffer_load_dwordx4 v[140:143], v1, s[16:19], s50 offen offset:3072 sc1
    s_waitcnt vmcnt(9)
    v_mfma_f32_16x16x32_bf16 v[48:51], v[168:171], a[32:35], v[48:51]
    v_mfma_f32_16x16x32_bf16 v[52:55], v[168:171], a[36:39], v[52:55]
    v_mfma_f32_16x16x32_bf16 v[56:59], v[168:171], a[40:43], v[56:59]
    v_mfma_f32_16x16x32_bf16 v[60:63], v[168:171], a[44:47], v[60:63]
    s_add_u32 s50, s7, 57344
    buffer_load_dwordx4 v[144:147], v1, s[16:19], s50 offen offset:0 sc1
    s_waitcnt vmcnt(9)
    v_mfma_f32_16x16x32_bf16 v[48:51], v[172:175], a[48:51], v[48:51]
    v_mfma_f32_16x16x32_bf16 v[52:55], v[172:175], a[52:55], v[52:55]
    v_mfma_f32_16x16x32_bf16 v[56:59], v[172:175], a[56:59], v[56:59]
    v_mfma_f32_16x16x32_bf16 v[60:63], v[172:175], a[60:63], v[60:63]
    buffer_load_dwordx4 v[148:151], v1, s[16:19], s50 offen offset:1024 sc1
    s_waitcnt vmcnt(9)
    v_mfma_f32_16x16x32_bf16 v[48:51], v[176:179], a[64:67], v[48:51]
    v_mfma_f32_16x16x32_bf16 v[52:55], v[176:179], a[68:71], v[52:55]
    v_mfma_f32_16x16x32_bf16 v[56:59], v[176:179], a[72:75], v[56:59]
    v_mfma_f32_16x16x32_bf16 v[60:63], v[176:179], a[76:79], v[60:63]
    buffer_load_dwordx4 v[152:155], v1, s[16:19], s50 offen offset:2048 sc1
    s_waitcnt vmcnt(9)
    v_mfma_f32_16x16x32_bf16 v[48:51], v[180:183], a[80:83], v[48:51]
    v_mfma_f32_16x16x32_bf16 v[52:55], v[180:183], a[84:87], v[52:55]
    v_mfma_f32_16x16x32_bf16 v[56:59], v[180:183], a[88:91], v[56:59]
    v_mfma_f32_16x16x32_bf16 v[60:63], v[180:183], a[92:95], v[60:63]
    buffer_load_dwordx4 v[156:159], v1, s[16:19], s50 offen offset:3072 sc1
    s_waitcnt vmcnt(9)
    v_mfma_f32_16x16x32_bf16 v[48:51], v[184:187], a[96:99], v[48:51]
    v_mfma_f32_16x16x32_bf16 v[52:55], v[184:187], a[100:103], v[52:55]
    v_mfma_f32_16x16x32_bf16 v[56:59], v[184:187], a[104:107], v[56:59]
    v_mfma_f32_16x16x32_bf16 v[60:63], v[184:187], a[108:111], v[60:63]
    s_add_u32 s50, s8, 0
    buffer_load_dwordx4 v[160:163], v1, s[16:19], s50 offen offset:0 sc1
    s_waitcnt vmcnt(9)
    v_mfma_f32_16x16x32_bf16 v[48:51], v[188:191], a[112:115], v[48:51]
    v_mfma_f32_16x16x32_bf16 v[52:55], v[188:191], a[116:119], v[52:55]
    v_mfma_f32_16x16x32_bf16 v[56:59], v[188:191], a[120:123], v[56:59]
    v_mfma_f32_16x16x32_bf16 v[60:63], v[188:191], a[124:127], v[60:63]
    buffer_load_dwordx4 v[164:167], v1, s[16:19], s50 offen offset:1024 sc1
    s_waitcnt vmcnt(9)
    v_mfma_f32_16x16x32_bf16 v[32:35], v[128:131], a[128:131], v[32:35]
    v_mfma_f32_16x16x32_bf16 v[36:39], v[128:131], a[132:135], v[36:39]
    v_mfma_f32_16x16x32_bf16 v[40:43], v[128:131], a[136:139], v[40:43]
    v_mfma_f32_16x16x32_bf16 v[44:47], v[128:131], a[140:143], v[44:47]
    buffer_load_dwordx4 v[168:171], v1, s[16:19], s50 offen offset:2048 sc1
    s_waitcnt vmcnt(9)
    v_mfma_f32_16x16x32_bf16 v[32:35], v[132:135], a[144:147], v[32:35]
    v_mfma_f32_16x16x32_bf16 v[36:39], v[132:135], a[148:151], v[36:39]
    v_mfma_f32_16x16x32_bf16 v[40:43], v[132:135], a[152:155], v[40:43]
    v_mfma_f32_16x16x32_bf16 v[44:47], v[132:135], a[156:159], v[44:47]
    buffer_load_dwordx4 v[172:175], v1, s[16:19], s50 offen offset:3072 sc1
    s_waitcnt vmcnt(9)
    v_mfma_f32_16x16x32_bf16 v[32:35], v[136:139], a[160:163], v[32:35]
    v_mfma_f32_16x16x32_bf16 v[36:39], v[136:139], a[164:167], v[36:39]
    v_mfma_f32_16x16x32_bf16 v[40:43], v[136:139], a[168:171], v[40:43]
    v_mfma_f32_16x16x32_bf16 v[44:47], v[136:139], a[172:175], v[44:47]
    s_add_u32 s50, s8, 4096
    buffer_load_dwordx4 v[176:179], v1, s[16:19], s50 offen offset:0 sc1
    s_waitcnt vmcnt(9)
    v_mfma_f32_16x16x32_bf16 v[32:35], v[140:143], a[176:179], v[32:35]
    v_mfma_f32_16x16x32_bf16 v[36:39], v[140:143], a[180:183], v[36:39]
    v_mfma_f32_16x16x32_bf16 v[40:43], v[140:143], a[184:187], v[40:43]
    v_mfma_f32_16x16x32_bf16 v[44:47], v[140:143], a[188:191], v[44:47]
    buffer_load_dwordx4 v[180:183], v1, s[16:19], s50 offen offset:1024 sc1
    s_waitcnt vmcnt(9)
    v_mfma_f32_16x16x32_bf16 v[48:51], v[144:147], a[128:131], v[48:51]
    v_mfma_f32_16x16x32_bf16 v[52:55], v[144:147], a[132:135], v[52:55]
    v_mfma_f32_16x16x32_bf16 v[56:59], v[144:147], a[136:139], v[56:59]
    v_mfma_f32_16x16x32_bf16 v[60:63], v[144:147], a[140:143], v[60:63]
    buffer_load_dwordx4 v[184:187], v1, s[16:19], s50 offen offset:2048 sc1
    s_waitcnt vmcnt(9)
    v_mfma_f32_16x16x32_bf16 v[48:51], v[148:151], a[144:147], v[48:51]
    ds_write_b128 v192, v[32:35] offset:0
    v_mfma_f32_16x16x32_bf16 v[52:55], v[148:151], a[148:151], v[52:55]
    v_mfma_f32_16x16x32_bf16 v[56:59], v[148:151], a[152:155], v[56:59]
    ds_write_b128 v192, v[36:39] offset:1024
    v_mfma_f32_16x16x32_bf16 v[60:63], v[148:151], a[156:159], v[60:63]
    buffer_load_dwordx4 v[188:191], v1, s[16:19], s50 offen offset:3072 sc1
    s_waitcnt vmcnt(9)
    v_mfma_f32_16x16x32_bf16 v[48:51], v[152:155], a[160:163], v[48:51]
    v_mfma_f32_16x16x32_bf16 v[52:55], v[152:155], a[164:167], v[52:55]
    ds_write_b128 v192, v[40:43] offset:2048
    v_mfma_f32_16x16x32_bf16 v[56:59], v[152:155], a[168:171], v[56:59]
    v_mfma_f32_16x16x32_bf16 v[60:63], v[152:155], a[172:175], v[60:63]
    s_add_u32 s50, s8, 8192
    buffer_load_dwordx4 v[128:131], v1, s[16:19], s50 offen offset:0 sc1
    s_waitcnt vmcnt(9)
    v_mfma_f32_16x16x32_bf16 v[48:51], v[156:159], a[176:179], v[48:51]
    ds_write_b128 v192, v[44:47] offset:3072
    v_mfma_f32_16x16x32_bf16 v[52:55], v[156:159], a[180:183], v[52:55]
    v_mfma_f32_16x16x32_bf16 v[56:59], v[156:159], a[184:187], v[56:59]
    v_mfma_f32_16x16x32_bf16 v[60:63], v[156:159], a[188:191], v[60:63]
    buffer_load_dwordx4 v[132:135], v1, s[16:19], s50 offen offset:1024 sc1
    s_waitcnt vmcnt(9)
    v_mfma_f32_16x16x32_bf16 v[64:67], v[160:163], a[0:3], v[216:219]
    v_mfma_f32_16x16x32_bf16 v[68:71], v[160:163], a[4:7], 0
    v_mfma_f32_16x16x32_bf16 v[72:75], v[160:163], a[8:11], 0
    v_mfma_f32_16x16x32_bf16 v[76:79], v[160:163], a[12:15], 0
    buffer_load_dwordx4 v[136:139], v1, s[16:19], s50 offen offset:2048 sc1
    s_waitcnt vmcnt(9)
    v_mfma_f32_16x16x32_bf16 v[64:67], v[164:167], a[16:19], v[64:67]
    ds_write_b128 v193, v[48:51] offset:4096
    v_mfma_f32_16x16x32_bf16 v[68:71], v[164:167], a[20:23], v[68:71]
    v_mfma_f32_16x16x32_bf16 v[72:75], v[164:167], a[24:27], v[72:75]
    ds_write_b128 v193, v[52:55] offset:5120
    v_mfma_f32_16x16x32_bf16 v[76:79], v[164:167], a[28:31], v[76:79]
    buffer_load_dwordx4 v[140:143], v1, s[16:19], s50 offen offset:3072 sc1
    s_waitcnt vmcnt(9)
    v_mfma_f32_16x16x32_bf16 v[64:67], v[168:171], a[32:35], v[64:67]
    v_mfma_f32_16x16x32_bf16 v[68:71], v[168:171], a[36:39], v[68:71]
    ds_write_b128 v193, v[56:59] offset:6144
    v_mfma_f32_16x16x32_bf16 v[72:75], v[168:171], a[40:43], v[72:75]
    v_mfma_f32_16x16x32_bf16 v[76:79], v[168:171], a[44:47], v[76:79]
    s_add_u32 s50, s8, 49152
    buffer_load_dwordx4 v[144:147], v1, s[16:19], s50 offen offset:0 sc1
    s_waitcnt vmcnt(9)
    v_mfma_f32_16x16x32_bf16 v[64:67], v[172:175], a[48:51], v[64:67]
    ds_write_b128 v193, v[60:63] offset:7168
    v_mfma_f32_16x16x32_bf16 v[68:71], v[172:175], a[52:55], v[68:71]
    v_mfma_f32_16x16x32_bf16 v[72:75], v[172:175], a[56:59], v[72:75]
    v_mfma_f32_16x16x32_bf16 v[76:79], v[172:175], a[60:63], v[76:79]
    buffer_load_dwordx4 v[148:151], v1, s[16:19], s50 offen offset:1024 sc1
    s_waitcnt vmcnt(9)
    v_mfma_f32_16x16x32_bf16 v[64:67], v[176:179], a[64:67], v[64:67]
    s_waitcnt lgkmcnt(0)
    s_barrier
    ds_read_b128 v[32:35], v195 offset:0
    ds_read_b128 v[36:39], v195 offset:256
    v_mfma_f32_16x16x32_bf16 v[68:71], v[176:179], a[68:71], v[68:71]
    ds_read_b128 v[40:43], v196 offset:0
    ds_read_b128 v[44:47], v196 offset:256
    v_mfma_f32_16x16x32_bf16 v[72:75], v[176:179], a[72:75], v[72:75]
    ds_read_b128 v[48:51], v197 offset:0
    ds_read_b128 v[52:55], v197 offset:256
    v_mfma_f32_16x16x32_bf16 v[76:79], v[176:179], a[76:79], v[76:79]
    buffer_load_dwordx4 v[152:155], v1, s[16:19], s50 offen offset:2048 sc1
    s_waitcnt vmcnt(9)
    v_mfma_f32_16x16x32_bf16 v[64:67], v[180:183], a[80:83], v[64:67]
    ds_read_b128 v[56:59], v198 offset:0
    ds_read_b128 v[60:63], v198 offset:256
    v_mfma_f32_16x16x32_bf16 v[68:71], v[180:183], a[84:87], v[68:71]
    v_mfma_f32_16x16x32_bf16 v[72:75], v[180:183], a[88:91], v[72:75]
    v_mfma_f32_16x16x32_bf16 v[76:79], v[180:183], a[92:95], v[76:79]
    buffer_load_dwordx4 v[156:159], v1, s[16:19], s50 offen offset:3072 sc1
    s_waitcnt vmcnt(9)
    v_mfma_f32_16x16x32_bf16 v[64:67], v[184:187], a[96:99], v[64:67]
    v_mfma_f32_16x16x32_bf16 v[68:71], v[184:187], a[100:103], v[68:71]
    v_mfma_f32_16x16x32_bf16 v[72:75], v[184:187], a[104:107], v[72:75]
    v_mfma_f32_16x16x32_bf16 v[76:79], v[184:187], a[108:111], v[76:79]
    s_add_u32 s50, s8, 53248
    buffer_load_dwordx4 v[160:163], v1, s[16:19], s50 offen offset:0 sc1
    s_waitcnt vmcnt(9)
    v_mfma_f32_16x16x32_bf16 v[64:67], v[188:191], a[112:115], v[64:67]
    s_waitcnt lgkmcnt(5)
    v_add_f32 v32, v32, v40
    v_add_f32 v33, v33, v41
    v_mfma_f32_16x16x32_bf16 v[68:71], v[188:191], a[116:119], v[68:71]
    v_add_f32 v34, v34, v42
    v_add_f32 v35, v35, v43
    v_mfma_f32_16x16x32_bf16 v[72:75], v[188:191], a[120:123], v[72:75]
    s_waitcnt lgkmcnt(4)
    v_add_f32 v36, v36, v44
    v_add_f32 v37, v37, v45
    v_mfma_f32_16x16x32_bf16 v[76:79], v[188:191], a[124:127], v[76:79]
    buffer_load_dwordx4 v[164:167], v1, s[16:19], s50 offen offset:1024 sc1
    s_waitcnt vmcnt(9)
    v_mfma_f32_16x16x32_bf16 v[64:67], v[128:131], a[128:131], v[64:67]
    v_add_f32 v38, v38, v46
    v_add_f32 v39, v39, v47
    v_mfma_f32_16x16x32_bf16 v[68:71], v[128:131], a[132:135], v[68:71]
    s_waitcnt lgkmcnt(1)
    v_add_f32 v48, v48, v56
    v_add_f32 v49, v49, v57
    v_mfma_f32_16x16x32_bf16 v[72:75], v[128:131], a[136:139], v[72:75]
    v_add_f32 v50, v50, v58
    v_add_f32 v51, v51, v59
    v_mfma_f32_16x16x32_bf16 v[76:79], v[128:131], a[140:143], v[76:79]
    buffer_load_dwordx4 v[168:171], v1, s[16:19], s50 offen offset:2048 sc1
    s_waitcnt vmcnt(9)
    v_mfma_f32_16x16x32_bf16 v[64:67], v[132:135], a[144:147], v[64:67]
    s_waitcnt lgkmcnt(0)
    v_add_f32 v52, v52, v60
    v_add_f32 v53, v53, v61
    v_mfma_f32_16x16x32_bf16 v[68:71], v[132:135], a[148:151], v[68:71]
    v_add_f32 v54, v54, v62
    v_add_f32 v55, v55, v63
    v_mfma_f32_16x16x32_bf16 v[72:75], v[132:135], a[152:155], v[72:75]
    v_add_f32 v32, v32, v48
    v_add_f32 v33, v33, v49
    v_mfma_f32_16x16x32_bf16 v[76:79], v[132:135], a[156:159], v[76:79]
    buffer_load_dwordx4 v[172:175], v1, s[16:19], s50 offen offset:3072 sc1
    s_waitcnt vmcnt(9)
    v_mfma_f32_16x16x32_bf16 v[64:67], v[136:139], a[160:163], v[64:67]
    v_add_f32 v34, v34, v50
    v_add_f32 v35, v35, v51
    v_mfma_f32_16x16x32_bf16 v[68:71], v[136:139], a[164:167], v[68:71]
    v_add_f32 v36, v36, v52
    v_add_f32 v37, v37, v53
    v_mfma_f32_16x16x32_bf16 v[72:75], v[136:139], a[168:171], v[72:75]
    v_add_f32 v38, v38, v54
    v_add_f32 v39, v39, v55
    v_mfma_f32_16x16x32_bf16 v[76:79], v[136:139], a[172:175], v[76:79]
    s_add_u32 s50, s8, 57344
    buffer_load_dwordx4 v[176:179], v1, s[16:19], s50 offen offset:0 sc1
    s_waitcnt vmcnt(9)
    v_mfma_f32_16x16x32_bf16 v[64:67], v[140:143], a[176:179], v[64:67]
    v_cvt_pk_bf16_f32 v40, v32, v33
    v_cvt_pk_bf16_f32 v41, v34, v35
    v_mfma_f32_16x16x32_bf16 v[68:71], v[140:143], a[180:183], v[68:71]
    v_cvt_pk_bf16_f32 v42, v36, v37
    v_cvt_pk_bf16_f32 v43, v38, v39
    v_mfma_f32_16x16x32_bf16 v[72:75], v[140:143], a[184:187], v[72:75]
    buffer_store_dwordx4 v[40:43], v203, s[72:75], s4 offen
    v_mfma_f32_16x16x32_bf16 v[76:79], v[140:143], a[188:191], v[76:79]
    buffer_load_dwordx4 v[180:183], v1, s[16:19], s50 offen offset:1024 sc1
    s_waitcnt vmcnt(10)
    v_mfma_f32_16x16x32_bf16 v[80:83], v[144:147], a[0:3], v[220:223]
    v_mfma_f32_16x16x32_bf16 v[84:87], v[144:147], a[4:7], 0
    v_mfma_f32_16x16x32_bf16 v[88:91], v[144:147], a[8:11], 0
    v_mfma_f32_16x16x32_bf16 v[92:95], v[144:147], a[12:15], 0
    buffer_load_dwordx4 v[184:187], v1, s[16:19], s50 offen offset:2048 sc1
    s_waitcnt vmcnt(10)
    v_mfma_f32_16x16x32_bf16 v[80:83], v[148:151], a[16:19], v[80:83]
    ds_write_b128 v192, v[64:67] offset:8192
    v_mfma_f32_16x16x32_bf16 v[84:87], v[148:151], a[20:23], v[84:87]
    v_mfma_f32_16x16x32_bf16 v[88:91], v[148:151], a[24:27], v[88:91]
    ds_write_b128 v192, v[68:71] offset:9216
    v_mfma_f32_16x16x32_bf16 v[92:95], v[148:151], a[28:31], v[92:95]
    buffer_load_dwordx4 v[188:191], v1, s[16:19], s50 offen offset:3072 sc1
    s_waitcnt vmcnt(10)
    v_mfma_f32_16x16x32_bf16 v[80:83], v[152:155], a[32:35], v[80:83]
    v_mfma_f32_16x16x32_bf16 v[84:87], v[152:155], a[36:39], v[84:87]
    ds_write_b128 v192, v[72:75] offset:10240
    v_mfma_f32_16x16x32_bf16 v[88:91], v[152:155], a[40:43], v[88:91]
    v_mfma_f32_16x16x32_bf16 v[92:95], v[152:155], a[44:47], v[92:95]
    s_add_u32 s50, s9, 0
    buffer_load_dwordx4 v[128:131], v1, s[16:19], s50 offen offset:0 sc1
    s_waitcnt vmcnt(10)
    v_mfma_f32_16x16x32_bf16 v[80:83], v[156:159], a[48:51], v[80:83]
    ds_write_b128 v192, v[76:79] offset:11264
    v_mfma_f32_16x16x32_bf16 v[84:87], v[156:159], a[52:55], v[84:87]
    v_mfma_f32_16x16x32_bf16 v[88:91], v[156:159], a[56:59], v[88:91]
    v_mfma_f32_16x16x32_bf16 v[92:95], v[156:159], a[60:63], v[92:95]
    buffer_load_dwordx4 v[132:135], v1, s[16:19], s50 offen offset:1024 sc1
    s_waitcnt vmcnt(10)
    v_mfma_f32_16x16x32_bf16 v[80:83], v[160:163], a[64:67], v[80:83]
    v_mfma_f32_16x16x32_bf16 v[84:87], v[160:163], a[68:71], v[84:87]
    v_mfma_f32_16x16x32_bf16 v[88:91], v[160:163], a[72:75], v[88:91]
    v_mfma_f32_16x16x32_bf16 v[92:95], v[160:163], a[76:79], v[92:95]
    buffer_load_dwordx4 v[136:139], v1, s[16:19], s50 offen offset:2048 sc1
    s_waitcnt vmcnt(10)
    v_mfma_f32_16x16x32_bf16 v[80:83], v[164:167], a[80:83], v[80:83]
    v_mfma_f32_16x16x32_bf16 v[84:87], v[164:167], a[84:87], v[84:87]
    v_mfma_f32_16x16x32_bf16 v[88:91], v[164:167], a[88:91], v[88:91]
    v_mfma_f32_16x16x32_bf16 v[92:95], v[164:167], a[92:95], v[92:95]
    buffer_load_dwordx4 v[140:143], v1, s[16:19], s50 offen offset:3072 sc1
    s_waitcnt vmcnt(10)
    v_mfma_f32_16x16x32_bf16 v[80:83], v[168:171], a[96:99], v[80:83]
    v_mfma_f32_16x16x32_bf16 v[84:87], v[168:171], a[100:103], v[84:87]
    v_mfma_f32_16x16x32_bf16 v[88:91], v[168:171], a[104:107], v[88:91]
    v_mfma_f32_16x16x32_bf16 v[92:95], v[168:171], a[108:111], v[92:95]
    s_add_u32 s50, s9, 4096
    buffer_load_dwordx4 v[144:147], v1, s[16:19], s50 offen offset:0 sc1
    s_waitcnt vmcnt(10)
    v_mfma_f32_16x16x32_bf16 v[80:83], v[172:175], a[112:115], v[80:83]
    v_mfma_f32_16x16x32_bf16 v[84:87], v[172:175], a[116:119], v[84:87]
    v_mfma_f32_16x16x32_bf16 v[88:91], v[172:175], a[120:123], v[88:91]
    v_mfma_f32_16x16x32_bf16 v[92:95], v[172:175], a[124:127], v[92:95]
    buffer_load_dwordx4 v[148:151], v1, s[16:19], s50 offen offset:1024 sc1
    s_waitcnt vmcnt(10)
    v_mfma_f32_16x16x32_bf16 v[80:83], v[176:179], a[128:131], v[80:83]
    v_mfma_f32_16x16x32_bf16 v[84:87], v[176:179], a[132:135], v[84:87]
    v_mfma_f32_16x16x32_bf16 v[88:91], v[176:179], a[136:139], v[88:91]
    v_mfma_f32_16x16x32_bf16 v[92:95], v[176:179], a[140:143], v[92:95]
    buffer_load_dwordx4 v[152:155], v1, s[16:19], s50 offen offset:2048 sc1
    s_waitcnt vmcnt(9)
    v_mfma_f32_16x16x32_bf16 v[80:83], v[180:183], a[144:147], v[80:83]
    v_mfma_f32_16x16x32_bf16 v[84:87], v[180:183], a[148:151], v[84:87]
    v_mfma_f32_16x16x32_bf16 v[88:91], v[180:183], a[152:155], v[88:91]
    v_mfma_f32_16x16x32_bf16 v[92:95], v[180:183], a[156:159], v[92:95]
    buffer_load_dwordx4 v[156:159], v1, s[16:19], s50 offen offset:3072 sc1
    s_waitcnt vmcnt(9)
    v_mfma_f32_16x16x32_bf16 v[80:83], v[184:187], a[160:163], v[80:83]
    v_mfma_f32_16x16x32_bf16 v[84:87], v[184:187], a[164:167], v[84:87]
    v_mfma_f32_16x16x32_bf16 v[88:91], v[184:187], a[168:171], v[88:91]
    v_mfma_f32_16x16x32_bf16 v[92:95], v[184:187], a[172:175], v[92:95]
    s_add_u32 s50, s9, 8192
    buffer_load_dwordx4 v[160:163], v1, s[16:19], s50 offen offset:0 sc1
    s_waitcnt vmcnt(9)
    v_mfma_f32_16x16x32_bf16 v[80:83], v[188:191], a[176:179], v[80:83]
    v_mfma_f32_16x16x32_bf16 v[84:87], v[188:191], a[180:183], v[84:87]
    v_mfma_f32_16x16x32_bf16 v[88:91], v[188:191], a[184:187], v[88:91]
    v_mfma_f32_16x16x32_bf16 v[92:95], v[188:191], a[188:191], v[92:95]
    buffer_load_dwordx4 v[164:167], v1, s[16:19], s50 offen offset:1024 sc1
    s_waitcnt vmcnt(9)
    v_mfma_f32_16x16x32_bf16 v[96:99], v[128:131], a[0:3], v[224:227]
    v_mfma_f32_16x16x32_bf16 v[100:103], v[128:131], a[4:7], 0
    v_mfma_f32_16x16x32_bf16 v[104:107], v[128:131], a[8:11], 0
    v_mfma_f32_16x16x32_bf16 v[108:111], v[128:131], a[12:15], 0
    buffer_load_dwordx4 v[168:171], v1, s[16:19], s50 offen offset:2048 sc1
    s_waitcnt vmcnt(9)
    v_mfma_f32_16x16x32_bf16 v[96:99], v[132:135], a[16:19], v[96:99]
    ds_write_b128 v193, v[80:83] offset:12288
    v_mfma_f32_16x16x32_bf16 v[100:103], v[132:135], a[20:23], v[100:103]
    v_mfma_f32_16x16x32_bf16 v[104:107], v[132:135], a[24:27], v[104:107]
    ds_write_b128 v193, v[84:87] offset:13312
    v_mfma_f32_16x16x32_bf16 v[108:111], v[132:135], a[28:31], v[108:111]
    buffer_load_dwordx4 v[172:175], v1, s[16:19], s50 offen offset:3072 sc1
    s_waitcnt vmcnt(9)
    v_mfma_f32_16x16x32_bf16 v[96:99], v[136:139], a[32:35], v[96:99]
    v_mfma_f32_16x16x32_bf16 v[100:103], v[136:139], a[36:39], v[100:103]
    ds_write_b128 v193, v[88:91] offset:14336
    v_mfma_f32_16x16x32_bf16 v[104:107], v[136:139], a[40:43], v[104:107]
    v_mfma_f32_16x16x32_bf16 v[108:111], v[136:139], a[44:47], v[108:111]
    ds_write_b128 v193, v[92:95] offset:15360
    s_waitcnt vmcnt(8)
    v_mfma_f32_16x16x32_bf16 v[96:99], v[140:143], a[48:51], v[96:99]
    v_mfma_f32_16x16x32_bf16 v[100:103], v[140:143], a[52:55], v[100:103]
    v_mfma_f32_16x16x32_bf16 v[104:107], v[140:143], a[56:59], v[104:107]
    v_mfma_f32_16x16x32_bf16 v[108:111], v[140:143], a[60:63], v[108:111]
    s_waitcnt vmcnt(7)
    v_mfma_f32_16x16x32_bf16 v[96:99], v[144:147], a[64:67], v[96:99]
    s_waitcnt lgkmcnt(0)
    s_barrier
    ds_read_b128 v[64:67], v195 offset:8192
    ds_read_b128 v[68:71], v195 offset:8448
    v_mfma_f32_16x16x32_bf16 v[100:103], v[144:147], a[68:71], v[100:103]
    ds_read_b128 v[72:75], v196 offset:8192
    ds_read_b128 v[76:79], v196 offset:8448
    v_mfma_f32_16x16x32_bf16 v[104:107], v[144:147], a[72:75], v[104:107]
    ds_read_b128 v[80:83], v197 offset:8192
    ds_read_b128 v[84:87], v197 offset:8448
    v_mfma_f32_16x16x32_bf16 v[108:111], v[144:147], a[76:79], v[108:111]
    ds_read_b128 v[88:91], v198 offset:8192
    ds_read_b128 v[92:95], v198 offset:8448
    s_waitcnt vmcnt(6)
    v_mfma_f32_16x16x32_bf16 v[96:99], v[148:151], a[80:83], v[96:99]
    v_mfma_f32_16x16x32_bf16 v[100:103], v[148:151], a[84:87], v[100:103]
    v_mfma_f32_16x16x32_bf16 v[104:107], v[148:151], a[88:91], v[104:107]
    v_mfma_f32_16x16x32_bf16 v[108:111], v[148:151], a[92:95], v[108:111]
    s_waitcnt vmcnt(5)
    v_mfma_f32_16x16x32_bf16 v[96:99], v[152:155], a[96:99], v[96:99]
    v_mfma_f32_16x16x32_bf16 v[100:103], v[152:155], a[100:103], v[100:103]
    s_waitcnt lgkmcnt(5)
    v_add_f32 v64, v64, v72
    v_add_f32 v65, v65, v73
    v_mfma_f32_16x16x32_bf16 v[104:107], v[152:155], a[104:107], v[104:107]
    v_add_f32 v66, v66, v74
    v_add_f32 v67, v67, v75
    v_mfma_f32_16x16x32_bf16 v[108:111], v[152:155], a[108:111], v[108:111]
    s_waitcnt lgkmcnt(4)
    v_add_f32 v68, v68, v76
    v_add_f32 v69, v69, v77
    s_waitcnt vmcnt(4)
    v_mfma_f32_16x16x32_bf16 v[96:99], v[156:159], a[112:115], v[96:99]
    v_add_f32 v70, v70, v78
    v_add_f32 v71, v71, v79
    v_mfma_f32_16x16x32_bf16 v[100:103], v[156:159], a[116:119], v[100:103]
    s_waitcnt lgkmcnt(1)
    v_add_f32 v80, v80, v88
    v_add_f32 v81, v81, v89
    v_mfma_f32_16x16x32_bf16 v[104:107], v[156:159], a[120:123], v[104:107]
    v_add_f32 v82, v82, v90
    v_add_f32 v83, v83, v91
    v_mfma_f32_16x16x32_bf16 v[108:111], v[156:159], a[124:127], v[108:111]
    s_waitcnt lgkmcnt(0)
    v_add_f32 v84, v84, v92
    v_add_f32 v85, v85, v93
    s_waitcnt vmcnt(3)
    v_mfma_f32_16x16x32_bf16 v[96:99], v[160:163], a[128:131], v[96:99]
    v_add_f32 v86, v86, v94
    v_add_f32 v87, v87, v95
    v_mfma_f32_16x16x32_bf16 v[100:103], v[160:163], a[132:135], v[100:103]
    v_add_f32 v64, v64, v80
    v_add_f32 v65, v65, v81
    v_mfma_f32_16x16x32_bf16 v[104:107], v[160:163], a[136:139], v[104:107]
    v_add_f32 v66, v66, v82
    v_add_f32 v67, v67, v83
    v_mfma_f32_16x16x32_bf16 v[108:111], v[160:163], a[140:143], v[108:111]
    v_add_f32 v68, v68, v84
    v_add_f32 v69, v69, v85
    s_waitcnt vmcnt(2)
    v_mfma_f32_16x16x32_bf16 v[96:99], v[164:167], a[144:147], v[96:99]
    v_add_f32 v70, v70, v86
    v_add_f32 v71, v71, v87
    v_mfma_f32_16x16x32_bf16 v[100:103], v[164:167], a[148:151], v[100:103]
    v_cvt_pk_bf16_f32 v72, v64, v65
    v_cvt_pk_bf16_f32 v73, v66, v67
    v_mfma_f32_16x16x32_bf16 v[104:107], v[164:167], a[152:155], v[104:107]
    v_cvt_pk_bf16_f32 v74, v68, v69
    v_cvt_pk_bf16_f32 v75, v70, v71
    v_mfma_f32_16x16x32_bf16 v[108:111], v[164:167], a[156:159], v[108:111]
    buffer_store_dwordx4 v[72:75], v203, s[72:75], s5 offen
    s_waitcnt vmcnt(2)
    v_mfma_f32_16x16x32_bf16 v[96:99], v[168:171], a[160:163], v[96:99]
    v_mfma_f32_16x16x32_bf16 v[100:103], v[168:171], a[164:167], v[100:103]
    v_mfma_f32_16x16x32_bf16 v[104:107], v[168:171], a[168:171], v[104:107]
    v_mfma_f32_16x16x32_bf16 v[108:111], v[168:171], a[172:175], v[108:111]
    s_waitcnt vmcnt(1)
    v_mfma_f32_16x16x32_bf16 v[96:99], v[172:175], a[176:179], v[96:99]
    v_mfma_f32_16x16x32_bf16 v[100:103], v[172:175], a[180:183], v[100:103]
    v_mfma_f32_16x16x32_bf16 v[104:107], v[172:175], a[184:187], v[104:107]
    v_mfma_f32_16x16x32_bf16 v[108:111], v[172:175], a[188:191], v[108:111]
    s_nop 4
    ds_write_b128 v194, v[96:99] offset:16384
    ds_write_b128 v194, v[100:103] offset:17408
    ds_write_b128 v194, v[104:107] offset:18432
    ds_write_b128 v194, v[108:111] offset:19456
    s_waitcnt lgkmcnt(0)
    s_barrier
    ds_read_b128 v[96:99], v199 offset:16384
    ds_read_b128 v[100:103], v200 offset:16384
    ds_read_b128 v[104:107], v201 offset:16384
    ds_read_b128 v[108:111], v202 offset:16384
    s_waitcnt lgkmcnt(2)
    v_pk_add_f32 v[96:97], v[96:97], v[100:101]
    v_pk_add_f32 v[98:99], v[98:99], v[102:103]
    s_waitcnt lgkmcnt(0)
    v_pk_add_f32 v[104:105], v[104:105], v[108:109]
    v_pk_add_f32 v[106:107], v[106:107], v[110:111]
    v_pk_add_f32 v[96:97], v[96:97], v[104:105]
    v_pk_add_f32 v[98:99], v[98:99], v[106:107]
    v_cvt_pk_bf16_f32 v100, v96, v97
    v_cvt_pk_bf16_f32 v101, v98, v99
    buffer_store_dwordx2 v[100:101], v204, s[72:75], s6 offen
    s_waitcnt vmcnt(0) lgkmcnt(0)
    s_nop 15
    s_nop 3
    s_branch L_fin
L_p2_slow:
    s_waitcnt vmcnt(0) lgkmcnt(0)
    s_nop 15
    s_nop 3
    s_barrier
    s_mul_i32 s44, s40, 320
    s_add_u32 s44, s44, s42
    v_add_u32 v20, 0, v0
    v_mul_u32_u24 v21, 205, v20
    v_lshrrev_b32 v21, 12, v21
    v_mul_u32_u24 v21, 960, v21
    v_lshl_add_u32 v24, v0, 4, v21
    v_add_u32 v20, 64, v0
    v_mul_u32_u24 v21, 205, v20
    v_lshrrev_b32 v21, 12, v21
    v_mul_u32_u24 v21, 960, v21
    v_lshl_add_u32 v25, v0, 4, v21
    v_add_u32 v20, 128, v0
    v_mul_u32_u24 v21, 205, v20
    v_lshrrev_b32 v21, 12, v21
    v_mul_u32_u24 v21, 960, v21
    v_lshl_add_u32 v26, v0, 4, v21
    s_add_u32 m0, s43, 0
    s_nop 0
    buffer_load_dwordx4 v24, s[20:23], s44 offen offset:0 lds
    buffer_load_dwordx4 v25, s[20:23], s44 offen offset:1024 lds
    buffer_load_dwordx4 v26, s[20:23], s44 offen offset:2048 lds
    v_and_b32 v20, 7, v0
    v_lshlrev_b32 v21, 2, v20
    v_mov_b32 v22, 0x54435210
    v_lshrrev_b32 v21, v21, v22
    v_and_b32 v21, 7, v21
    v_lshrrev_b32 v22, 3, v0
    s_mul_i32 s44, s40, 5
    v_add_u32 v21, s44, v21
    v_lshrrev_b32 v23, 2, v21
    v_lshlrev_b32 v23, 8, v23
    v_and_b32 v21, 3, v21
    v_lshl_add_u32 v23, v21, 2, v23
    v_lshl_add_u32 v23, v22, 4, v23
    v_add_u32 v23, 24576, v23
    v_mov_b32 v21, 0x37
    v_lshrrev_b32 v21, v20, v21
    v_and_b32 v21, 1, v21
    v_cmp_eq_u32 vcc, 1, v21
    v_mov_b32 v22, 30272
    s_nop 0
    v_cndmask_b32 v8, v22, v23, vcc
    v_mul_u32_u24 v9, 1280, v21
    v_mov_b32 v10, 0
    s_lshl_b32 s46, s40, 14
    s_add_u32 s46, s46, 2621440
    s_lshl_b32 s47, s40, 12
    s_add_u32 s47, s47, 2686976
    s_mul_i32 s48, s40, 24576
    s_add_u32 s48, s48, 2703360
    s_mul_i32 s49, s40, 20480
    s_add_u32 s49, s49, 2801664
    s_add_u32 s44, s43, 0
    v_bfe_u32 v20, v0, 2, 3
    v_mul_u32_u24 v20, 320, v20
    v_and_b32 v21, 3, v0
    v_lshl_add_u32 v20, v21, 3, v20
    v_add_u32 v20, s44, v20
    v_cmp_gt_u32 vcc, 32, v0
    v_mov_b32 v21, 0xffff0000
    v_mov_b32 v22, 0x0c0c0c0c
    v_mov_b32 v23, 0x01000c0c
    v_cndmask_b32 v21, 0, v21, vcc
    v_cndmask_b32 v22, v22, v23, vcc
    s_mov_b32 s45, 0
    buffer_load_dwordx4 v[128:131], v11, s[16:19], s45 offen sc1
    buffer_load_dwordx2 v[132:133], v12, s[16:19], s45 offen offset:1024 sc1
    buffer_load_dwordx4 a[64:67], v1, s[16:19], s47 offen offset:0 sc1
    buffer_load_dwordx4 a[0:3], v1, s[16:19], s46 offen offset:0 sc1
    buffer_load_dwordx4 a[4:7], v1, s[16:19], s46 offen offset:1024 sc1
    buffer_load_dwordx4 a[80:83], v13, s[16:19], s48 offen offset:0 sc1
    buffer_load_dwordx4 a[84:87], v13, s[16:19], s48 offen offset:768 sc1
    buffer_load_dwordx4 a[88:91], v13, s[16:19], s48 offen offset:1536 sc1
    buffer_load_dwordx4 a[92:95], v13, s[16:19], s48 offen offset:2304 sc1
    s_add_u32 s48, s48, 3072
    buffer_load_dwordx4 a[8:11], v1, s[16:19], s46 offen offset:2048 sc1
    buffer_load_dwordx4 a[12:15], v1, s[16:19], s46 offen offset:3072 sc1
    s_add_u32 s46, s46, 4096
    buffer_load_dwordx4 a[96:99], v13, s[16:19], s48 offen offset:0 sc1
    buffer_load_dwordx4 a[100:103], v13, s[16:19], s48 offen offset:768 sc1
    buffer_load_dwordx4 a[104:107], v13, s[16:19], s48 offen offset:1536 sc1
    buffer_load_dwordx4 a[108:111], v13, s[16:19], s48 offen offset:2304 sc1
    s_add_u32 s48, s48, 3072
    buffer_load_dwordx4 a[68:71], v1, s[16:19], s47 offen offset:1024 sc1
    buffer_load_dwordx4 a[16:19], v1, s[16:19], s46 offen offset:0 sc1
    buffer_load_dwordx4 a[20:23], v1, s[16:19], s46 offen offset:1024 sc1
    buffer_load_dwordx4 a[112:115], v13, s[16:19], s48 offen offset:0 sc1
    buffer_load_dwordx4 a[116:119], v13, s[16:19], s48 offen offset:768 sc1
    buffer_load_dwordx4 a[120:123], v13, s[16:19], s48 offen offset:1536 sc1
    buffer_load_dwordx4 a[124:127], v13, s[16:19], s48 offen offset:2304 sc1
    s_add_u32 s48, s48, 3072
    buffer_load_dwordx4 a[24:27], v1, s[16:19], s46 offen offset:2048 sc1
    buffer_load_dwordx4 a[28:31], v1, s[16:19], s46 offen offset:3072 sc1
    s_add_u32 s46, s46, 4096
    buffer_load_dwordx4 a[128:131], v13, s[16:19], s48 offen offset:0 sc1
    buffer_load_dwordx4 a[132:135], v13, s[16:19], s48 offen offset:768 sc1
    buffer_load_dwordx4 a[136:139], v13, s[16:19], s48 offen offset:1536 sc1
    buffer_load_dwordx4 a[140:143], v13, s[16:19], s48 offen offset:2304 sc1
    s_add_u32 s48, s48, 3072
    buffer_load_dwordx4 a[72:75], v1, s[16:19], s47 offen offset:2048 sc1
    buffer_load_dwordx4 a[32:35], v1, s[16:19], s46 offen offset:0 sc1
    buffer_load_dwordx4 a[36:39], v1, s[16:19], s46 offen offset:1024 sc1
    buffer_load_dwordx4 a[144:147], v13, s[16:19], s48 offen offset:0 sc1
    buffer_load_dwordx4 a[148:151], v13, s[16:19], s48 offen offset:768 sc1
    buffer_load_dwordx4 a[152:155], v13, s[16:19], s48 offen offset:1536 sc1
    buffer_load_dwordx4 a[156:159], v13, s[16:19], s48 offen offset:2304 sc1
    s_add_u32 s48, s48, 3072
    buffer_load_dwordx4 a[40:43], v1, s[16:19], s46 offen offset:2048 sc1
    buffer_load_dwordx4 a[44:47], v1, s[16:19], s46 offen offset:3072 sc1
    s_add_u32 s46, s46, 4096
    buffer_load_dwordx4 a[160:163], v13, s[16:19], s48 offen offset:0 sc1
    buffer_load_dwordx4 a[164:167], v13, s[16:19], s48 offen offset:768 sc1
    buffer_load_dwordx4 a[168:171], v13, s[16:19], s48 offen offset:1536 sc1
    buffer_load_dwordx4 a[172:175], v13, s[16:19], s48 offen offset:2304 sc1
    s_add_u32 s48, s48, 3072
    buffer_load_dwordx4 a[76:79], v1, s[16:19], s47 offen offset:3072 sc1
    buffer_load_dwordx4 a[48:51], v1, s[16:19], s46 offen offset:0 sc1
    buffer_load_dwordx4 a[52:55], v1, s[16:19], s46 offen offset:1024 sc1
    buffer_load_dwordx4 a[176:179], v13, s[16:19], s48 offen offset:0 sc1
    buffer_load_dwordx4 a[180:183], v13, s[16:19], s48 offen offset:768 sc1
    buffer_load_dwordx4 a[184:187], v13, s[16:19], s48 offen offset:1536 sc1
    buffer_load_dwordx4 a[188:191], v13, s[16:19], s48 offen offset:2304 sc1
    s_add_u32 s48, s48, 3072
    buffer_load_dwordx4 a[56:59], v1, s[16:19], s46 offen offset:2048 sc1
    buffer_load_dwordx4 a[60:63], v1, s[16:19], s46 offen offset:3072 sc1
    s_add_u32 s46, s46, 4096
    buffer_load_dwordx4 a[192:195], v13, s[16:19], s48 offen offset:0 sc1
    buffer_load_dwordx4 a[196:199], v13, s[16:19], s48 offen offset:768 sc1
    buffer_load_dwordx4 a[200:203], v13, s[16:19], s48 offen offset:1536 sc1
    buffer_load_dwordx4 a[204:207], v13, s[16:19], s48 offen offset:2304 sc1
    s_add_u32 s48, s48, 3072
    s_waitcnt vmcnt(54)
    ds_read_b64_tr_b16 v[64:65], v20 offset:0
    ds_read_b64_tr_b16 v[66:67], v20 offset:32
    ds_read_b64_tr_b16 v[68:69], v20 offset:64
    ds_read_b64_tr_b16 v[70:71], v20 offset:96
    ds_read_b64_tr_b16 v[72:73], v20 offset:128
    ds_read_b64_tr_b16 v[74:75], v20 offset:160
    ds_read_b64_tr_b16 v[76:77], v20 offset:192
    ds_read_b64_tr_b16 v[78:79], v20 offset:224
    ds_read_b64_tr_b16 v[80:81], v20 offset:256
    ds_read_b64_tr_b16 v[82:83], v20 offset:288
    s_waitcnt lgkmcnt(9)
    v_perm_b32 v140, v64, v64, v22
    v_and_b32 v141, v21, v64
    v_perm_b32 v142, v65, v65, v22
    v_and_b32 v143, v21, v65
    s_waitcnt lgkmcnt(8)
    v_perm_b32 v144, v66, v66, v22
    v_and_b32 v145, v21, v66
    v_perm_b32 v146, v67, v67, v22
    v_and_b32 v147, v21, v67
    s_waitcnt lgkmcnt(7)
    v_perm_b32 v148, v68, v68, v22
    v_and_b32 v149, v21, v68
    v_perm_b32 v150, v69, v69, v22
    v_and_b32 v151, v21, v69
    s_waitcnt lgkmcnt(6)
    v_perm_b32 v152, v70, v70, v22
    v_and_b32 v153, v21, v70
    v_perm_b32 v154, v71, v71, v22
    v_and_b32 v155, v21, v71
    s_waitcnt lgkmcnt(5)
    v_perm_b32 v156, v72, v72, v22
    v_and_b32 v157, v21, v72
    v_perm_b32 v158, v73, v73, v22
    v_and_b32 v159, v21, v73
    s_waitcnt lgkmcnt(4)
    v_perm_b32 v160, v74, v74, v22
    v_and_b32 v161, v21, v74
    v_perm_b32 v162, v75, v75, v22
    v_and_b32 v163, v21, v75
    s_waitcnt lgkmcnt(3)
    v_perm_b32 v164, v76, v76, v22
    v_and_b32 v165, v21, v76
    v_perm_b32 v166, v77, v77, v22
    v_and_b32 v167, v21, v77
    s_waitcnt lgkmcnt(2)
    v_perm_b32 v168, v78, v78, v22
    v_and_b32 v169, v21, v78
    v_perm_b32 v170, v79, v79, v22
    v_and_b32 v171, v21, v79
    s_waitcnt lgkmcnt(1)
    v_perm_b32 v172, v80, v80, v22
    v_and_b32 v173, v21, v80
    v_perm_b32 v174, v81, v81, v22
    v_and_b32 v175, v21, v81
    s_waitcnt lgkmcnt(0)
    v_perm_b32 v176, v82, v82, v22
    v_and_b32 v177, v21, v82
    v_perm_b32 v178, v83, v83, v22
    v_and_b32 v179, v21, v83
    v_mfma_f32_32x32x8_bf16 v[96:111], v[4:5], v[4:5], 0
    s_waitcnt vmcnt(51)
    v_mfma_f32_32x32x4_2b_bf16 v[32:63], a[64:65], v[132:133], 0
    s_waitcnt vmcnt(50)
    s_nop 15
    s_nop 0
    v_mfma_f32_32x32x16_bf16 v[32:47], a[0:3], v[128:131], v[32:47]
    s_waitcnt vmcnt(49)
    v_mfma_f32_32x32x16_bf16 v[48:63], a[4:7], v[128:131], v[48:63]
    s_nop 9
    v_mov_b32 v24, v32
    v_max3_f32 v24, v24, v32, v33
    v_max3_f32 v24, v24, v34, v35
    v_max3_f32 v24, v24, v36, v37
    v_max3_f32 v24, v24, v38, v39
    v_max3_f32 v24, v24, v40, v41
    v_max3_f32 v24, v24, v42, v43
    v_max3_f32 v24, v24, v44, v45
    v_max3_f32 v24, v24, v46, v47
    v_max3_f32 v24, v24, v48, v49
    v_max3_f32 v24, v24, v50, v51
    v_max3_f32 v24, v24, v52, v53
    v_max3_f32 v24, v24, v54, v55
    v_max3_f32 v24, v24, v56, v57
    v_max3_f32 v24, v24, v58, v59
    v_max3_f32 v24, v24, v60, v61
    v_max3_f32 v24, v24, v62, v63
    v_mfma_f32_32x32x4_2b_bf16 v[32:63], a[66:67], v[132:133], 0
    s_waitcnt vmcnt(44)
    s_nop 15
    s_nop 0
    v_mfma_f32_32x32x16_bf16 v[32:47], a[8:11], v[128:131], v[32:47]
    s_waitcnt vmcnt(43)
    v_mfma_f32_32x32x16_bf16 v[48:63], a[12:15], v[128:131], v[48:63]
    s_nop 9
    v_max3_f32 v24, v24, v32, v33
    v_max3_f32 v24, v24, v34, v35
    v_max3_f32 v24, v24, v36, v37
    v_max3_f32 v24, v24, v38, v39
    v_max3_f32 v24, v24, v40, v41
    v_max3_f32 v24, v24, v42, v43
    v_max3_f32 v24, v24, v44, v45
    v_max3_f32 v24, v24, v46, v47
    v_max3_f32 v24, v24, v48, v49
    v_max3_f32 v24, v24, v50, v51
    v_max3_f32 v24, v24, v52, v53
    v_max3_f32 v24, v24, v54, v55
    v_max3_f32 v24, v24, v56, v57
    v_max3_f32 v24, v24, v58, v59
    v_max3_f32 v24, v24, v60, v61
    v_max3_f32 v24, v24, v62, v63
    s_waitcnt vmcnt(38)
    v_mfma_f32_32x32x4_2b_bf16 v[32:63], a[68:69], v[132:133], 0
    s_waitcnt vmcnt(37)
    s_nop 15
    s_nop 0
    v_mfma_f32_32x32x16_bf16 v[32:47], a[16:19], v[128:131], v[32:47]
    s_waitcnt vmcnt(36)
    v_mfma_f32_32x32x16_bf16 v[48:63], a[20:23], v[128:131], v[48:63]
    s_nop 9
    v_max3_f32 v24, v24, v32, v33
    v_max3_f32 v24, v24, v34, v35
    v_max3_f32 v24, v24, v36, v37
    v_max3_f32 v24, v24, v38, v39
    v_max3_f32 v24, v24, v40, v41
    v_max3_f32 v24, v24, v42, v43
    v_max3_f32 v24, v24, v44, v45
    v_max3_f32 v24, v24, v46, v47
    v_max3_f32 v24, v24, v48, v49
    v_max3_f32 v24, v24, v50, v51
    v_max3_f32 v24, v24, v52, v53
    v_max3_f32 v24, v24, v54, v55
    v_max3_f32 v24, v24, v56, v57
    v_max3_f32 v24, v24, v58, v59
    v_max3_f32 v24, v24, v60, v61
    v_max3_f32 v24, v24, v62, v63
    v_mfma_f32_32x32x4_2b_bf16 v[32:63], a[70:71], v[132:133], 0
    s_waitcnt vmcnt(31)
    s_nop 15
    s_nop 0
    v_mfma_f32_32x32x16_bf16 v[32:47], a[24:27], v[128:131], v[32:47]
    s_waitcnt vmcnt(30)
    v_mfma_f32_32x32x16_bf16 v[48:63], a[28:31], v[128:131], v[48:63]
    s_nop 9
    v_max3_f32 v24, v24, v32, v33
    v_max3_f32 v24, v24, v34, v35
    v_max3_f32 v24, v24, v36, v37
    v_max3_f32 v24, v24, v38, v39
    v_max3_f32 v24, v24, v40, v41
    v_max3_f32 v24, v24, v42, v43
    v_max3_f32 v24, v24, v44, v45
    v_max3_f32 v24, v24, v46, v47
    v_max3_f32 v24, v24, v48, v49
    v_max3_f32 v24, v24, v50, v51
    v_max3_f32 v24, v24, v52, v53
    v_max3_f32 v24, v24, v54, v55
    v_max3_f32 v24, v24, v56, v57
    v_max3_f32 v24, v24, v58, v59
    v_max3_f32 v24, v24, v60, v61
    v_max3_f32 v24, v24, v62, v63
    s_waitcnt vmcnt(25)
    v_mfma_f32_32x32x4_2b_bf16 v[32:63], a[72:73], v[132:133], 0
    s_waitcnt vmcnt(24)
    s_nop 15
    s_nop 0
    v_mfma_f32_32x32x16_bf16 v[32:47], a[32:35], v[128:131], v[32:47]
    s_waitcnt vmcnt(23)
    v_mfma_f32_32x32x16_bf16 v[48:63], a[36:39], v[128:131], v[48:63]
    s_nop 9
    v_max3_f32 v24, v24, v32, v33
    v_max3_f32 v24, v24, v34, v35
    v_max3_f32 v24, v24, v36, v37
    v_max3_f32 v24, v24, v38, v39
    v_max3_f32 v24, v24, v40, v41
    v_max3_f32 v24, v24, v42, v43
    v_max3_f32 v24, v24, v44, v45
    v_max3_f32 v24, v24, v46, v47
    v_max3_f32 v24, v24, v48, v49
    v_max3_f32 v24, v24, v50, v51
    v_max3_f32 v24, v24, v52, v53
    v_max3_f32 v24, v24, v54, v55
    v_max3_f32 v24, v24, v56, v57
    v_max3_f32 v24, v24, v58, v59
    v_max3_f32 v24, v24, v60, v61
    v_max3_f32 v24, v24, v62, v63
    v_mfma_f32_32x32x4_2b_bf16 v[32:63], a[74:75], v[132:133], 0
    s_waitcnt vmcnt(18)
    s_nop 15
    s_nop 0
    v_mfma_f32_32x32x16_bf16 v[32:47], a[40:43], v[128:131], v[32:47]
    s_waitcnt vmcnt(17)
    v_mfma_f32_32x32x16_bf16 v[48:63], a[44:47], v[128:131], v[48:63]
    s_nop 9
    v_max3_f32 v24, v24, v32, v33
    v_max3_f32 v24, v24, v34, v35
    v_max3_f32 v24, v24, v36, v37
    v_max3_f32 v24, v24, v38, v39
    v_max3_f32 v24, v24, v40, v41
    v_max3_f32 v24, v24, v42, v43
    v_max3_f32 v24, v24, v44, v45
    v_max3_f32 v24, v24, v46, v47
    v_max3_f32 v24, v24, v48, v49
    v_max3_f32 v24, v24, v50, v51
    v_max3_f32 v24, v24, v52, v53
    v_max3_f32 v24, v24, v54, v55
    v_max3_f32 v24, v24, v56, v57
    v_max3_f32 v24, v24, v58, v59
    v_max3_f32 v24, v24, v60, v61
    v_max3_f32 v24, v24, v62, v63
    s_waitcnt vmcnt(12)
    v_mfma_f32_32x32x4_2b_bf16 v[32:63], a[76:77], v[132:133], 0
    s_waitcnt vmcnt(11)
    s_nop 15
    s_nop 0
    v_mfma_f32_32x32x16_bf16 v[32:47], a[48:51], v[128:131], v[32:47]
    s_waitcnt vmcnt(10)
    v_mfma_f32_32x32x16_bf16 v[48:63], a[52:55], v[128:131], v[48:63]
    s_nop 9
    v_max3_f32 v24, v24, v32, v33
    v_max3_f32 v24, v24, v34, v35
    v_max3_f32 v24, v24, v36, v37
    v_max3_f32 v24, v24, v38, v39
    v_max3_f32 v24, v24, v40, v41
    v_max3_f32 v24, v24, v42, v43
    v_max3_f32 v24, v24, v44, v45
    v_max3_f32 v24, v24, v46, v47
    v_max3_f32 v24, v24, v48, v49
    v_max3_f32 v24, v24, v50, v51
    v_max3_f32 v24, v24, v52, v53
    v_max3_f32 v24, v24, v54, v55
    v_max3_f32 v24, v24, v56, v57
    v_max3_f32 v24, v24, v58, v59
    v_max3_f32 v24, v24, v60, v61
    v_max3_f32 v24, v24, v62, v63
    v_mfma_f32_32x32x4_2b_bf16 v[32:63], a[78:79], v[132:133], 0
    s_waitcnt vmcnt(5)
    s_nop 15
    s_nop 0
    v_mfma_f32_32x32x16_bf16 v[32:47], a[56:59], v[128:131], v[32:47]
    s_waitcnt vmcnt(4)
    v_mfma_f32_32x32x16_bf16 v[48:63], a[60:63], v[128:131], v[48:63]
    s_nop 9
    v_max3_f32 v24, v24, v32, v33
    v_max3_f32 v24, v24, v34, v35
    v_max3_f32 v24, v24, v36, v37
    v_max3_f32 v24, v24, v38, v39
    v_max3_f32 v24, v24, v40, v41
    v_max3_f32 v24, v24, v42, v43
    v_max3_f32 v24, v24, v44, v45
    v_max3_f32 v24, v24, v46, v47
    v_max3_f32 v24, v24, v48, v49
    v_max3_f32 v24, v24, v50, v51
    v_max3_f32 v24, v24, v52, v53
    v_max3_f32 v24, v24, v54, v55
    v_max3_f32 v24, v24, v56, v57
    v_max3_f32 v24, v24, v58, v59
    v_max3_f32 v24, v24, v60, v61
    v_max3_f32 v24, v24, v62, v63
    v_mov_b32 v25, v24
    s_nop 1
    v_permlane32_swap_b32 v24, v25
    v_max_f32 v24, v24, v25
    s_lshl_b32 s51, s40, 2
    v_add_u32 v25, s51, v1
    s_barrier
    ds_write_b32 v25, v24 offset:30720
    s_waitcnt lgkmcnt(0)
    s_barrier
    ds_read_b128 v[24:27], v1 offset:30720
    s_waitcnt lgkmcnt(0)
    v_max3_f32 v24, v24, v25, v26
    v_max_f32 v24, v24, v27
    v_sub_f32 v208, 0, v24
    v_sub_f32 v209, 0, v24
    v_sub_f32 v210, 0, v24
    v_sub_f32 v211, 0, v24
    v_sub_f32 v212, 0, v24
    v_sub_f32 v213, 0, v24
    v_sub_f32 v214, 0, v24
    v_sub_f32 v215, 0, v24
    v_sub_f32 v216, 0, v24
    v_sub_f32 v217, 0, v24
    v_sub_f32 v218, 0, v24
    v_sub_f32 v219, 0, v24
    v_sub_f32 v220, 0, v24
    v_sub_f32 v221, 0, v24
    v_sub_f32 v222, 0, v24
    v_sub_f32 v223, 0, v24
    v_sub_f32 v224, 0, v24
    v_sub_f32 v225, 0, v24
    v_sub_f32 v226, 0, v24
    v_sub_f32 v227, 0, v24
    v_sub_f32 v228, 0, v24
    v_sub_f32 v229, 0, v24
    v_sub_f32 v230, 0, v24
    v_sub_f32 v231, 0, v24
    v_sub_f32 v232, 0, v24
    v_sub_f32 v233, 0, v24
    v_sub_f32 v234, 0, v24
    v_sub_f32 v235, 0, v24
    v_sub_f32 v236, 0, v24
    v_sub_f32 v237, 0, v24
    v_sub_f32 v238, 0, v24
    v_sub_f32 v239, 0, v24
    s_nop 1
    v_mfma_f32_32x32x4_2b_bf16 v[32:63], a[64:65], v[132:133], v[208:239]
    s_nop 15
    s_nop 1
    v_mfma_f32_32x32x16_bf16 v[32:47], a[0:3], v[128:131], v[32:47]
    v_mfma_f32_32x32x16_bf16 v[48:63], a[4:7], v[128:131], v[48:63]
    s_nop 10
    v_exp_f32 v32, v32
    v_exp_f32 v33, v33
    s_add_u32 s50, s49, 0
    v_exp_f32 v34, v34
    v_exp_f32 v35, v35
    v_exp_f32 v36, v36
    v_mfma_f32_32x32x4_2b_bf16 v[64:95], a[66:67], v[132:133], v[208:239]
    v_exp_f32 v37, v37
    v_exp_f32 v38, v38
    v_exp_f32 v39, v39
    v_exp_f32 v40, v40
    v_exp_f32 v41, v41
    v_exp_f32 v42, v42
    v_exp_f32 v43, v43
    v_exp_f32 v44, v44
    v_smfmac_f32_32x32x32_bf16 v[96:111], a[80:83], v[32:39], v2
    v_exp_f32 v45, v45
    v_exp_f32 v46, v46
    v_exp_f32 v47, v47
    v_exp_f32 v48, v48
    v_exp_f32 v49, v49
    v_smfmac_f32_32x32x32_bf16 v[96:111], a[84:87], v[40:47], v2
    v_exp_f32 v50, v50
    v_exp_f32 v51, v51
    v_exp_f32 v52, v52
    v_mfma_f32_32x32x16_bf16 v[64:79], a[8:11], v[128:131], v[64:79]
    v_exp_f32 v53, v53
    v_exp_f32 v54, v54
    v_exp_f32 v55, v55
    v_mfma_f32_32x32x16_bf16 v[80:95], a[12:15], v[128:131], v[80:95]
    v_exp_f32 v56, v56
    v_exp_f32 v57, v57
    v_exp_f32 v58, v58
    v_smfmac_f32_32x32x32_bf16 v[96:111], a[88:91], v[48:55], v2
    v_exp_f32 v59, v59
    v_exp_f32 v60, v60
    v_exp_f32 v61, v61
    v_exp_f32 v62, v62
    v_exp_f32 v63, v63
    v_exp_f32 v64, v64
    v_exp_f32 v65, v65
    v_smfmac_f32_32x32x32_bf16 v[96:111], a[92:95], v[56:63], v2
    v_exp_f32 v66, v66
    v_exp_f32 v67, v67
    v_exp_f32 v68, v68
    v_mfma_f32_32x32x4_2b_bf16 v[32:63], a[68:69], v[132:133], v[208:239]
    v_exp_f32 v69, v69
    v_exp_f32 v70, v70
    v_exp_f32 v71, v71
    v_exp_f32 v72, v72
    v_exp_f32 v73, v73
    v_exp_f32 v74, v74
    v_exp_f32 v75, v75
    v_exp_f32 v76, v76
    v_smfmac_f32_32x32x32_bf16 v[96:111], a[96:99], v[64:71], v2
    v_exp_f32 v77, v77
    v_exp_f32 v78, v78
    v_exp_f32 v79, v79
    v_exp_f32 v80, v80
    v_exp_f32 v81, v81
    v_smfmac_f32_32x32x32_bf16 v[96:111], a[100:103], v[72:79], v2
    v_exp_f32 v82, v82
    v_exp_f32 v83, v83
    v_exp_f32 v84, v84
    v_mfma_f32_32x32x16_bf16 v[32:47], a[16:19], v[128:131], v[32:47]
    v_exp_f32 v85, v85
    v_exp_f32 v86, v86
    v_exp_f32 v87, v87
    v_mfma_f32_32x32x16_bf16 v[48:63], a[20:23], v[128:131], v[48:63]
    v_exp_f32 v88, v88
    v_exp_f32 v89, v89
    v_exp_f32 v90, v90
    v_smfmac_f32_32x32x32_bf16 v[96:111], a[104:107], v[80:87], v2
    v_exp_f32 v91, v91
    v_exp_f32 v92, v92
    v_exp_f32 v93, v93
    v_mfma_f32_32x32x8_bf16 v[112:127], v[4:5], v[4:5], 0
    v_exp_f32 v94, v94
    v_exp_f32 v95, v95
    v_exp_f32 v32, v32
    v_exp_f32 v33, v33
    v_smfmac_f32_32x32x32_bf16 v[96:111], a[108:111], v[88:95], v2
    v_exp_f32 v34, v34
    v_exp_f32 v35, v35
    v_exp_f32 v36, v36
    v_mfma_f32_32x32x4_2b_bf16 v[64:95], a[70:71], v[132:133], v[208:239]
    v_exp_f32 v37, v37
    v_exp_f32 v38, v38
    v_exp_f32 v39, v39
    v_exp_f32 v40, v40
    v_exp_f32 v41, v41
    v_exp_f32 v42, v42
    v_exp_f32 v43, v43
    v_exp_f32 v44, v44
    v_smfmac_f32_32x32x32_bf16 v[96:111], a[112:115], v[32:39], v2
    v_exp_f32 v45, v45
    v_exp_f32 v46, v46
    v_exp_f32 v47, v47
    v_exp_f32 v48, v48
    v_exp_f32 v49, v49
    v_smfmac_f32_32x32x32_bf16 v[96:111], a[116:119], v[40:47], v2
    v_exp_f32 v50, v50
    v_exp_f32 v51, v51
    v_exp_f32 v52, v52
    v_mfma_f32_32x32x16_bf16 v[64:79], a[24:27], v[128:131], v[64:79]
    v_exp_f32 v53, v53
    v_exp_f32 v54, v54
    v_exp_f32 v55, v55
    v_mfma_f32_32x32x16_bf16 v[80:95], a[28:31], v[128:131], v[80:95]
    v_exp_f32 v56, v56
    v_exp_f32 v57, v57
    v_exp_f32 v58, v58
    v_smfmac_f32_32x32x32_bf16 v[96:111], a[120:123], v[48:55], v2
    v_exp_f32 v59, v59
    v_exp_f32 v60, v60
    v_exp_f32 v61, v61
    v_exp_f32 v62, v62
    v_exp_f32 v63, v63
    v_exp_f32 v64, v64
    v_exp_f32 v65, v65
    v_smfmac_f32_32x32x32_bf16 v[96:111], a[124:127], v[56:63], v2
    v_exp_f32 v66, v66
    v_exp_f32 v67, v67
    v_exp_f32 v68, v68
    v_mfma_f32_32x32x4_2b_bf16 v[32:63], a[72:73], v[132:133], v[208:239]
    v_exp_f32 v69, v69
    v_exp_f32 v70, v70
    v_exp_f32 v71, v71
    v_exp_f32 v72, v72
    v_exp_f32 v73, v73
    v_exp_f32 v74, v74
    v_exp_f32 v75, v75
    v_exp_f32 v76, v76
    v_smfmac_f32_32x32x32_bf16 v[96:111], a[128:131], v[64:71], v2
    v_exp_f32 v77, v77
    v_exp_f32 v78, v78
    v_exp_f32 v79, v79
    v_exp_f32 v80, v80
    v_exp_f32 v81, v81
    v_smfmac_f32_32x32x32_bf16 v[96:111], a[132:135], v[72:79], v2
    v_exp_f32 v82, v82
    v_exp_f32 v83, v83
    v_exp_f32 v84, v84
    v_mfma_f32_32x32x16_bf16 v[32:47], a[32:35], v[128:131], v[32:47]
    v_exp_f32 v85, v85
    v_exp_f32 v86, v86
    v_exp_f32 v87, v87
    v_mfma_f32_32x32x16_bf16 v[48:63], a[36:39], v[128:131], v[48:63]
    v_exp_f32 v88, v88
    v_exp_f32 v89, v89
    v_exp_f32 v90, v90
    v_smfmac_f32_32x32x32_bf16 v[96:111], a[136:139], v[80:87], v2
    v_exp_f32 v91, v91
    v_exp_f32 v92, v92
    v_exp_f32 v93, v93
    v_exp_f32 v94, v94
    v_exp_f32 v95, v95
    v_exp_f32 v32, v32
    v_exp_f32 v33, v33
    v_smfmac_f32_32x32x32_bf16 v[96:111], a[140:143], v[88:95], v2
    s_mov_b32 s45, 1280
    buffer_load_dwordx4 v[134:137], v11, s[16:19], s45 offen sc1
    buffer_load_dwordx2 v[138:139], v12, s[16:19], s45 offen offset:1024 sc1
    v_exp_f32 v34, v34
    v_exp_f32 v35, v35
    v_exp_f32 v36, v36
    v_mfma_f32_32x32x4_2b_bf16 v[64:95], a[74:75], v[132:133], v[208:239]
    v_exp_f32 v37, v37
    v_exp_f32 v38, v38
    v_exp_f32 v39, v39
    v_exp_f32 v40, v40
    v_exp_f32 v41, v41
    v_exp_f32 v42, v42
    v_exp_f32 v43, v43
    v_exp_f32 v44, v44
    v_smfmac_f32_32x32x32_bf16 v[96:111], a[144:147], v[32:39], v2
    v_exp_f32 v45, v45
    v_exp_f32 v46, v46
    v_exp_f32 v47, v47
    v_exp_f32 v48, v48
    v_exp_f32 v49, v49
    v_smfmac_f32_32x32x32_bf16 v[96:111], a[148:151], v[40:47], v2
    v_exp_f32 v50, v50
    v_exp_f32 v51, v51
    v_exp_f32 v52, v52
    v_mfma_f32_32x32x16_bf16 v[64:79], a[40:43], v[128:131], v[64:79]
    v_exp_f32 v53, v53
    v_exp_f32 v54, v54
    v_exp_f32 v55, v55
    v_mfma_f32_32x32x16_bf16 v[80:95], a[44:47], v[128:131], v[80:95]
    v_exp_f32 v56, v56
    v_exp_f32 v57, v57
    v_exp_f32 v58, v58
    v_smfmac_f32_32x32x32_bf16 v[96:111], a[152:155], v[48:55], v2
    v_exp_f32 v59, v59
    v_exp_f32 v60, v60
    v_exp_f32 v61, v61
    v_exp_f32 v62, v62
    v_exp_f32 v63, v63
    v_exp_f32 v64, v64
    v_exp_f32 v65, v65
    v_smfmac_f32_32x32x32_bf16 v[96:111], a[156:159], v[56:63], v2
    v_exp_f32 v66, v66
    v_exp_f32 v67, v67
    v_exp_f32 v68, v68
    v_mfma_f32_32x32x4_2b_bf16 v[32:63], a[76:77], v[132:133], v[208:239]
    v_exp_f32 v69, v69
    v_exp_f32 v70, v70
    v_exp_f32 v71, v71
    v_exp_f32 v72, v72
    v_exp_f32 v73, v73
    v_exp_f32 v74, v74
    v_exp_f32 v75, v75
    v_exp_f32 v76, v76
    v_smfmac_f32_32x32x32_bf16 v[96:111], a[160:163], v[64:71], v2
    v_exp_f32 v77, v77
    v_exp_f32 v78, v78
    v_exp_f32 v79, v79
    v_exp_f32 v80, v80
    v_exp_f32 v81, v81
    v_smfmac_f32_32x32x32_bf16 v[96:111], a[164:167], v[72:79], v2
    v_exp_f32 v82, v82
    v_exp_f32 v83, v83
    v_exp_f32 v84, v84
    v_mfma_f32_32x32x16_bf16 v[32:47], a[48:51], v[128:131], v[32:47]
    v_exp_f32 v85, v85
    v_exp_f32 v86, v86
    v_exp_f32 v87, v87
    v_mfma_f32_32x32x16_bf16 v[48:63], a[52:55], v[128:131], v[48:63]
    v_exp_f32 v88, v88
    v_exp_f32 v89, v89
    v_exp_f32 v90, v90
    v_smfmac_f32_32x32x32_bf16 v[96:111], a[168:171], v[80:87], v2
    v_exp_f32 v91, v91
    v_exp_f32 v92, v92
    v_exp_f32 v93, v93
    v_exp_f32 v94, v94
    v_exp_f32 v95, v95
    v_exp_f32 v32, v32
    v_exp_f32 v33, v33
    v_smfmac_f32_32x32x32_bf16 v[96:111], a[172:175], v[88:95], v2
    v_exp_f32 v34, v34
    v_exp_f32 v35, v35
    v_exp_f32 v36, v36
    v_mfma_f32_32x32x4_2b_bf16 v[64:95], a[78:79], v[132:133], v[208:239]
    v_exp_f32 v37, v37
    v_exp_f32 v38, v38
    v_exp_f32 v39, v39
    v_exp_f32 v40, v40
    v_exp_f32 v41, v41
    v_exp_f32 v42, v42
    v_exp_f32 v43, v43
    v_exp_f32 v44, v44
    v_smfmac_f32_32x32x32_bf16 v[96:111], a[176:179], v[32:39], v2
    buffer_load_dwordx4 a[208:211], v1, s[16:19], s50 offen offset:0 sc1
    buffer_load_dwordx4 a[212:215], v1, s[16:19], s50 offen offset:1024 sc1
    v_exp_f32 v45, v45
    v_exp_f32 v46, v46
    v_exp_f32 v47, v47
    v_exp_f32 v48, v48
    v_exp_f32 v49, v49
    v_smfmac_f32_32x32x32_bf16 v[96:111], a[180:183], v[40:47], v2
    v_exp_f32 v50, v50
    v_exp_f32 v51, v51
    v_exp_f32 v52, v52
    v_mfma_f32_32x32x16_bf16 v[64:79], a[56:59], v[128:131], v[64:79]
    v_exp_f32 v53, v53
    v_exp_f32 v54, v54
    v_exp_f32 v55, v55
    v_mfma_f32_32x32x16_bf16 v[80:95], a[60:63], v[128:131], v[80:95]
    v_exp_f32 v56, v56
    v_exp_f32 v57, v57
    v_exp_f32 v58, v58
    v_smfmac_f32_32x32x32_bf16 v[96:111], a[184:187], v[48:55], v2
    buffer_load_dwordx4 a[216:219], v1, s[16:19], s50 offen offset:2048 sc1
    buffer_load_dwordx4 a[220:223], v1, s[16:19], s50 offen offset:3072 sc1
    v_exp_f32 v59, v59
    v_exp_f32 v60, v60
    v_exp_f32 v61, v61
    v_exp_f32 v62, v62
    v_exp_f32 v63, v63
    v_exp_f32 v64, v64
    v_exp_f32 v65, v65
    v_smfmac_f32_32x32x32_bf16 v[96:111], a[188:191], v[56:63], v2
    s_waitcnt vmcnt(4)
    s_add_u32 s50, s49, 4096
    v_exp_f32 v66, v66
    v_exp_f32 v67, v67
    v_exp_f32 v68, v68
    v_mfma_f32_32x32x4_2b_bf16 v[32:63], a[64:65], v[138:139], 0
    s_nop 15
    s_nop 1
    v_mfma_f32_32x32x16_bf16 v[32:47], a[0:3], v[134:137], v[32:47]
    v_mfma_f32_32x32x16_bf16 v[48:63], a[4:7], v[134:137], v[48:63]
    s_nop 10
    v_mov_b32 v24, v32
    v_max3_f32 v24, v24, v32, v33
    v_max3_f32 v24, v24, v34, v35
    v_max3_f32 v24, v24, v36, v37
    v_max3_f32 v24, v24, v38, v39
    v_max3_f32 v24, v24, v40, v41
    v_max3_f32 v24, v24, v42, v43
    v_max3_f32 v24, v24, v44, v45
    v_max3_f32 v24, v24, v46, v47
    v_max3_f32 v24, v24, v48, v49
    v_max3_f32 v24, v24, v50, v51
    v_max3_f32 v24, v24, v52, v53
    v_max3_f32 v24, v24, v54, v55
    v_max3_f32 v24, v24, v56, v57
    v_max3_f32 v24, v24, v58, v59
    v_max3_f32 v24, v24, v60, v61
    v_max3_f32 v24, v24, v62, v63
    v_mfma_f32_32x32x4_2b_bf16 v[32:63], a[66:67], v[138:139], 0
    s_nop 15
    s_nop 1
    v_mfma_f32_32x32x16_bf16 v[32:47], a[8:11], v[134:137], v[32:47]
    v_mfma_f32_32x32x16_bf16 v[48:63], a[12:15], v[134:137], v[48:63]
    s_nop 10
    v_max3_f32 v24, v24, v32, v33
    v_max3_f32 v24, v24, v34, v35
    v_max3_f32 v24, v24, v36, v37
    v_max3_f32 v24, v24, v38, v39
    v_max3_f32 v24, v24, v40, v41
    v_max3_f32 v24, v24, v42, v43
    v_max3_f32 v24, v24, v44, v45
    v_max3_f32 v24, v24, v46, v47
    v_max3_f32 v24, v24, v48, v49
    v_max3_f32 v24, v24, v50, v51
    v_max3_f32 v24, v24, v52, v53
    v_max3_f32 v24, v24, v54, v55
    v_max3_f32 v24, v24, v56, v57
    v_max3_f32 v24, v24, v58, v59
    v_max3_f32 v24, v24, v60, v61
    v_max3_f32 v24, v24, v62, v63
    v_mfma_f32_32x32x4_2b_bf16 v[32:63], a[68:69], v[138:139], 0
    s_nop 15
    s_nop 1
    v_mfma_f32_32x32x16_bf16 v[32:47], a[16:19], v[134:137], v[32:47]
    v_mfma_f32_32x32x16_bf16 v[48:63], a[20:23], v[134:137], v[48:63]
    s_nop 10
    v_max3_f32 v24, v24, v32, v33
    v_max3_f32 v24, v24, v34, v35
    v_max3_f32 v24, v24, v36, v37
    v_max3_f32 v24, v24, v38, v39
    v_max3_f32 v24, v24, v40, v41
    v_max3_f32 v24, v24, v42, v43
    v_max3_f32 v24, v24, v44, v45
    v_max3_f32 v24, v24, v46, v47
    v_max3_f32 v24, v24, v48, v49
    v_max3_f32 v24, v24, v50, v51
    v_max3_f32 v24, v24, v52, v53
    v_max3_f32 v24, v24, v54, v55
    v_max3_f32 v24, v24, v56, v57
    v_max3_f32 v24, v24, v58, v59
    v_max3_f32 v24, v24, v60, v61
    v_max3_f32 v24, v24, v62, v63
    v_mfma_f32_32x32x4_2b_bf16 v[32:63], a[70:71], v[138:139], 0
    s_nop 15
    s_nop 1
    v_mfma_f32_32x32x16_bf16 v[32:47], a[24:27], v[134:137], v[32:47]
    v_mfma_f32_32x32x16_bf16 v[48:63], a[28:31], v[134:137], v[48:63]
    s_nop 10
    v_max3_f32 v24, v24, v32, v33
    v_max3_f32 v24, v24, v34, v35
    v_max3_f32 v24, v24, v36, v37
    v_max3_f32 v24, v24, v38, v39
    v_max3_f32 v24, v24, v40, v41
    v_max3_f32 v24, v24, v42, v43
    v_max3_f32 v24, v24, v44, v45
    v_max3_f32 v24, v24, v46, v47
    v_max3_f32 v24, v24, v48, v49
    v_max3_f32 v24, v24, v50, v51
    v_max3_f32 v24, v24, v52, v53
    v_max3_f32 v24, v24, v54, v55
    v_max3_f32 v24, v24, v56, v57
    v_max3_f32 v24, v24, v58, v59
    v_max3_f32 v24, v24, v60, v61
    v_max3_f32 v24, v24, v62, v63
    v_mfma_f32_32x32x4_2b_bf16 v[32:63], a[72:73], v[138:139], 0
    s_nop 15
    s_nop 1
    v_mfma_f32_32x32x16_bf16 v[32:47], a[32:35], v[134:137], v[32:47]
    v_mfma_f32_32x32x16_bf16 v[48:63], a[36:39], v[134:137], v[48:63]
    s_nop 10
    v_max3_f32 v24, v24, v32, v33
    v_max3_f32 v24, v24, v34, v35
    v_max3_f32 v24, v24, v36, v37
    v_max3_f32 v24, v24, v38, v39
    v_max3_f32 v24, v24, v40, v41
    v_max3_f32 v24, v24, v42, v43
    v_max3_f32 v24, v24, v44, v45
    v_max3_f32 v24, v24, v46, v47
    v_max3_f32 v24, v24, v48, v49
    v_max3_f32 v24, v24, v50, v51
    v_max3_f32 v24, v24, v52, v53
    v_max3_f32 v24, v24, v54, v55
    v_max3_f32 v24, v24, v56, v57
    v_max3_f32 v24, v24, v58, v59
    v_max3_f32 v24, v24, v60, v61
    v_max3_f32 v24, v24, v62, v63
    v_mfma_f32_32x32x4_2b_bf16 v[32:63], a[74:75], v[138:139], 0
    s_nop 15
    s_nop 1
    v_mfma_f32_32x32x16_bf16 v[32:47], a[40:43], v[134:137], v[32:47]
    v_mfma_f32_32x32x16_bf16 v[48:63], a[44:47], v[134:137], v[48:63]
    s_nop 10
    v_max3_f32 v24, v24, v32, v33
    v_max3_f32 v24, v24, v34, v35
    v_max3_f32 v24, v24, v36, v37
    v_max3_f32 v24, v24, v38, v39
    v_max3_f32 v24, v24, v40, v41
    v_max3_f32 v24, v24, v42, v43
    v_max3_f32 v24, v24, v44, v45
    v_max3_f32 v24, v24, v46, v47
    v_max3_f32 v24, v24, v48, v49
    v_max3_f32 v24, v24, v50, v51
    v_max3_f32 v24, v24, v52, v53
    v_max3_f32 v24, v24, v54, v55
    v_max3_f32 v24, v24, v56, v57
    v_max3_f32 v24, v24, v58, v59
    v_max3_f32 v24, v24, v60, v61
    v_max3_f32 v24, v24, v62, v63
    v_mfma_f32_32x32x4_2b_bf16 v[32:63], a[76:77], v[138:139], 0
    s_nop 15
    s_nop 1
    v_mfma_f32_32x32x16_bf16 v[32:47], a[48:51], v[134:137], v[32:47]
    v_mfma_f32_32x32x16_bf16 v[48:63], a[52:55], v[134:137], v[48:63]
    s_nop 10
    v_max3_f32 v24, v24, v32, v33
    v_max3_f32 v24, v24, v34, v35
    v_max3_f32 v24, v24, v36, v37
    v_max3_f32 v24, v24, v38, v39
    v_max3_f32 v24, v24, v40, v41
    v_max3_f32 v24, v24, v42, v43
    v_max3_f32 v24, v24, v44, v45
    v_max3_f32 v24, v24, v46, v47
    v_max3_f32 v24, v24, v48, v49
    v_max3_f32 v24, v24, v50, v51
    v_max3_f32 v24, v24, v52, v53
    v_max3_f32 v24, v24, v54, v55
    v_max3_f32 v24, v24, v56, v57
    v_max3_f32 v24, v24, v58, v59
    v_max3_f32 v24, v24, v60, v61
    v_max3_f32 v24, v24, v62, v63
    v_mfma_f32_32x32x4_2b_bf16 v[32:63], a[78:79], v[138:139], 0
    s_nop 15
    s_nop 1
    v_mfma_f32_32x32x16_bf16 v[32:47], a[56:59], v[134:137], v[32:47]
    v_mfma_f32_32x32x16_bf16 v[48:63], a[60:63], v[134:137], v[48:63]
    s_nop 10
    v_max3_f32 v24, v24, v32, v33
    v_max3_f32 v24, v24, v34, v35
    v_max3_f32 v24, v24, v36, v37
    v_max3_f32 v24, v24, v38, v39
    v_max3_f32 v24, v24, v40, v41
    v_max3_f32 v24, v24, v42, v43
    v_max3_f32 v24, v24, v44, v45
    v_max3_f32 v24, v24, v46, v47
    v_max3_f32 v24, v24, v48, v49
    v_max3_f32 v24, v24, v50, v51
    v_max3_f32 v24, v24, v52, v53
    v_max3_f32 v24, v24, v54, v55
    v_max3_f32 v24, v24, v56, v57
    v_max3_f32 v24, v24, v58, v59
    v_max3_f32 v24, v24, v60, v61
    v_max3_f32 v24, v24, v62, v63
    v_mov_b32 v25, v24
    s_nop 1
    v_permlane32_swap_b32 v24, v25
    v_max_f32 v24, v24, v25
    s_lshl_b32 s51, s40, 2
    v_add_u32 v25, s51, v1
    s_barrier
    ds_write_b32 v25, v24 offset:30720
    s_waitcnt lgkmcnt(0)
    s_barrier
    ds_read_b128 v[24:27], v1 offset:30720
    s_waitcnt lgkmcnt(0)
    v_max3_f32 v24, v24, v25, v26
    v_max_f32 v24, v24, v27
    v_sub_f32 v208, 0, v24
    v_sub_f32 v209, 0, v24
    v_sub_f32 v210, 0, v24
    v_sub_f32 v211, 0, v24
    v_sub_f32 v212, 0, v24
    v_sub_f32 v213, 0, v24
    v_sub_f32 v214, 0, v24
    v_sub_f32 v215, 0, v24
    v_sub_f32 v216, 0, v24
    v_sub_f32 v217, 0, v24
    v_sub_f32 v218, 0, v24
    v_sub_f32 v219, 0, v24
    v_sub_f32 v220, 0, v24
    v_sub_f32 v221, 0, v24
    v_sub_f32 v222, 0, v24
    v_sub_f32 v223, 0, v24
    v_sub_f32 v224, 0, v24
    v_sub_f32 v225, 0, v24
    v_sub_f32 v226, 0, v24
    v_sub_f32 v227, 0, v24
    v_sub_f32 v228, 0, v24
    v_sub_f32 v229, 0, v24
    v_sub_f32 v230, 0, v24
    v_sub_f32 v231, 0, v24
    v_sub_f32 v232, 0, v24
    v_sub_f32 v233, 0, v24
    v_sub_f32 v234, 0, v24
    v_sub_f32 v235, 0, v24
    v_sub_f32 v236, 0, v24
    v_sub_f32 v237, 0, v24
    v_sub_f32 v238, 0, v24
    v_sub_f32 v239, 0, v24
    s_nop 1
    v_mfma_f32_32x32x4_2b_bf16 v[32:63], a[64:65], v[138:139], v[208:239]
    v_exp_f32 v69, v69
    v_exp_f32 v70, v70
    v_exp_f32 v71, v71
    v_exp_f32 v72, v72
    v_exp_f32 v73, v73
    v_exp_f32 v74, v74
    v_exp_f32 v75, v75
    v_exp_f32 v76, v76
    v_smfmac_f32_32x32x32_bf16 v[96:111], a[192:195], v[64:71], v2
    buffer_load_dwordx4 a[224:227], v1, s[16:19], s50 offen offset:0 sc1
    buffer_load_dwordx4 a[228:231], v1, s[16:19], s50 offen offset:1024 sc1
    v_exp_f32 v77, v77
    v_exp_f32 v78, v78
    v_exp_f32 v79, v79
    v_exp_f32 v80, v80
    v_exp_f32 v81, v81
    v_smfmac_f32_32x32x32_bf16 v[96:111], a[196:199], v[72:79], v2
    v_exp_f32 v82, v82
    v_exp_f32 v83, v83
    v_exp_f32 v84, v84
    v_mfma_f32_32x32x16_bf16 v[32:47], a[0:3], v[134:137], v[32:47]
    v_exp_f32 v85, v85
    v_exp_f32 v86, v86
    v_exp_f32 v87, v87
    v_mfma_f32_32x32x16_bf16 v[48:63], a[4:7], v[134:137], v[48:63]
    v_exp_f32 v88, v88
    v_exp_f32 v89, v89
    v_exp_f32 v90, v90
    v_smfmac_f32_32x32x32_bf16 v[96:111], a[200:203], v[80:87], v2
    buffer_load_dwordx4 a[232:235], v1, s[16:19], s50 offen offset:2048 sc1
    buffer_load_dwordx4 a[236:239], v1, s[16:19], s50 offen offset:3072 sc1
    v_exp_f32 v91, v91
    v_exp_f32 v92, v92
    v_exp_f32 v93, v93
    v_exp_f32 v94, v94
    v_exp_f32 v95, v95
    v_exp_f32 v32, v32
    v_exp_f32 v33, v33
    v_smfmac_f32_32x32x32_bf16 v[96:111], a[204:207], v[88:95], v2
    s_add_u32 s50, s49, 8192
    v_exp_f32 v34, v34
    v_exp_f32 v35, v35
    v_exp_f32 v36, v36
    v_mfma_f32_32x32x4_2b_bf16 v[64:95], a[66:67], v[138:139], v[208:239]
    v_exp_f32 v37, v37
    v_exp_f32 v38, v38
    v_exp_f32 v39, v39
    v_exp_f32 v40, v40
    v_exp_f32 v41, v41
    v_exp_f32 v42, v42
    v_exp_f32 v43, v43
    v_exp_f32 v44, v44
    v_smfmac_f32_32x32x32_bf16 v[112:127], a[80:83], v[32:39], v2
    ds_write_b128 v6, v[96:99] offset:0
    buffer_load_dwordx4 a[240:243], v1, s[16:19], s50 offen offset:0 sc1
    buffer_load_dwordx4 a[244:247], v1, s[16:19], s50 offen offset:1024 sc1
    v_exp_f32 v45, v45
    v_exp_f32 v46, v46
    v_exp_f32 v47, v47
    v_exp_f32 v48, v48
    v_exp_f32 v49, v49
    v_smfmac_f32_32x32x32_bf16 v[112:127], a[84:87], v[40:47], v2
    ds_write_b128 v6, v[100:103] offset:1024
    s_mov_b32 s45, 2560
    buffer_load_dwordx4 v[128:131], v11, s[16:19], s45 offen sc1
    buffer_load_dwordx2 v[132:133], v12, s[16:19], s45 offen offset:1024 sc1
    v_exp_f32 v50, v50
    v_exp_f32 v51, v51
    v_exp_f32 v52, v52
    v_mfma_f32_32x32x16_bf16 v[64:79], a[8:11], v[134:137], v[64:79]
    v_exp_f32 v53, v53
    v_exp_f32 v54, v54
    v_exp_f32 v55, v55
    v_mfma_f32_32x32x16_bf16 v[80:95], a[12:15], v[134:137], v[80:95]
    v_exp_f32 v56, v56
    v_exp_f32 v57, v57
    v_exp_f32 v58, v58
    v_smfmac_f32_32x32x32_bf16 v[112:127], a[88:91], v[48:55], v2
    ds_write_b128 v6, v[104:107] offset:2048
    v_exp_f32 v59, v59
    v_exp_f32 v60, v60
    v_exp_f32 v61, v61
    v_exp_f32 v62, v62
    v_exp_f32 v63, v63
    v_exp_f32 v64, v64
    v_exp_f32 v65, v65
    v_smfmac_f32_32x32x32_bf16 v[112:127], a[92:95], v[56:63], v2
    v_exp_f32 v66, v66
    v_exp_f32 v67, v67
    v_exp_f32 v68, v68
    v_mfma_f32_32x32x4_2b_bf16 v[32:63], a[68:69], v[138:139], v[208:239]
    v_exp_f32 v69, v69
    v_exp_f32 v70, v70
    v_exp_f32 v71, v71
    v_exp_f32 v72, v72
    v_exp_f32 v73, v73
    v_exp_f32 v74, v74
    v_exp_f32 v75, v75
    v_exp_f32 v76, v76
    v_smfmac_f32_32x32x32_bf16 v[112:127], a[96:99], v[64:71], v2
    s_waitcnt lgkmcnt(0)
    s_barrier
    v_exp_f32 v77, v77
    v_exp_f32 v78, v78
    v_exp_f32 v79, v79
    v_exp_f32 v80, v80
    v_exp_f32 v81, v81
    v_smfmac_f32_32x32x32_bf16 v[112:127], a[100:103], v[72:79], v2
    ds_read_b128 v[188:191], v7 offset:0
    v_exp_f32 v82, v82
    v_exp_f32 v83, v83
    v_exp_f32 v84, v84
    v_mfma_f32_32x32x16_bf16 v[32:47], a[16:19], v[134:137], v[32:47]
    ds_read_b128 v[192:195], v7 offset:3072
    v_exp_f32 v85, v85
    v_exp_f32 v86, v86
    v_exp_f32 v87, v87
    v_mfma_f32_32x32x16_bf16 v[48:63], a[20:23], v[134:137], v[48:63]
    ds_read_b128 v[196:199], v7 offset:6144
    v_exp_f32 v88, v88
    v_exp_f32 v89, v89
    v_exp_f32 v90, v90
    v_smfmac_f32_32x32x32_bf16 v[112:127], a[104:107], v[80:87], v2
    ds_read_b128 v[200:203], v7 offset:9216
    v_exp_f32 v91, v91
    v_exp_f32 v92, v92
    v_exp_f32 v93, v93
    v_mfma_f32_32x32x8_bf16 v[96:111], v[4:5], v[4:5], 0
    buffer_load_dwordx4 a[248:251], v1, s[16:19], s50 offen offset:2048 sc1
    buffer_load_dwordx4 a[252:255], v1, s[16:19], s50 offen offset:3072 sc1
    v_exp_f32 v94, v94
    v_exp_f32 v95, v95
    v_exp_f32 v32, v32
    v_exp_f32 v33, v33
    v_smfmac_f32_32x32x32_bf16 v[112:127], a[108:111], v[88:95], v2
    s_add_u32 s50, s49, 12288
    v_exp_f32 v34, v34
    v_exp_f32 v35, v35
    v_exp_f32 v36, v36
    v_mfma_f32_32x32x4_2b_bf16 v[64:95], a[70:71], v[138:139], v[208:239]
    s_waitcnt lgkmcnt(0)
    v_exp_f32 v37, v37
    v_add_f32 v188, v188, v192
    v_exp_f32 v38, v38
    v_add_f32 v189, v189, v193
    v_exp_f32 v39, v39
    v_add_f32 v190, v190, v194
    v_exp_f32 v40, v40
    v_add_f32 v191, v191, v195
    v_exp_f32 v41, v41
    v_add_f32 v196, v196, v200
    v_exp_f32 v42, v42
    v_add_f32 v197, v197, v201
    v_exp_f32 v43, v43
    v_add_f32 v198, v198, v202
    v_exp_f32 v44, v44
    v_add_f32 v199, v199, v203
    v_smfmac_f32_32x32x32_bf16 v[112:127], a[112:115], v[32:39], v2
    v_exp_f32 v45, v45
    v_add_f32 v188, v188, v196
    v_exp_f32 v46, v46
    v_add_f32 v189, v189, v197
    v_exp_f32 v47, v47
    v_add_f32 v190, v190, v198
    v_exp_f32 v48, v48
    v_rcp_f32_dpp v192, v188 quad_perm:[3,3,3,3] row_mask:0xf bank_mask:0xf
    v_exp_f32 v49, v49
    v_add_f32 v191, v191, v199
    v_smfmac_f32_32x32x32_bf16 v[112:127], a[116:119], v[40:47], v2
    v_exp_f32 v50, v50
    v_mul_f32 v188, v188, v192
    v_exp_f32 v51, v51
    v_mul_f32 v189, v189, v192
    v_exp_f32 v52, v52
    v_mul_f32 v190, v190, v192
    v_mfma_f32_32x32x16_bf16 v[64:79], a[24:27], v[134:137], v[64:79]
    v_exp_f32 v53, v53
    v_mul_f32 v191, v191, v192
    v_exp_f32 v54, v54
    v_cvt_pk_bf16_f32 v188, v188, v189
    v_exp_f32 v55, v55
    v_cvt_pk_bf16_f32 v189, v190, v191
    v_mfma_f32_32x32x16_bf16 v[80:95], a[28:31], v[134:137], v[80:95]
    v_exp_f32 v56, v56
    v_subrev_u32 v192, 528482304, v192
    v_exp_f32 v57, v57
    v_max_u32 v10, v10, v192
    v_exp_f32 v58, v58
    v_smfmac_f32_32x32x32_bf16 v[112:127], a[120:123], v[48:55], v2
    ds_write2_b32 v8, v188, v189 offset0:0 offset1:32
    v_add_u32 v8, v9, v8
    v_exp_f32 v59, v59
    v_exp_f32 v60, v60
    v_exp_f32 v61, v61
    v_exp_f32 v62, v62
    v_exp_f32 v63, v63
    v_exp_f32 v64, v64
    v_exp_f32 v65, v65
    v_smfmac_f32_32x32x32_bf16 v[112:127], a[124:127], v[56:63], v2
    v_exp_f32 v66, v66
    v_exp_f32 v67, v67
    v_exp_f32 v68, v68
    v_mfma_f32_32x32x4_2b_bf16 v[32:63], a[72:73], v[138:139], v[208:239]
    v_exp_f32 v69, v69
    v_exp_f32 v70, v70
    v_exp_f32 v71, v71
    v_exp_f32 v72, v72
    v_exp_f32 v73, v73
    v_exp_f32 v74, v74
    v_exp_f32 v75, v75
    v_exp_f32 v76, v76
    v_smfmac_f32_32x32x32_bf16 v[112:127], a[128:131], v[64:71], v2
    v_exp_f32 v77, v77
    v_exp_f32 v78, v78
    v_exp_f32 v79, v79
    v_exp_f32 v80, v80
    v_exp_f32 v81, v81
    v_smfmac_f32_32x32x32_bf16 v[112:127], a[132:135], v[72:79], v2
    v_exp_f32 v82, v82
    v_exp_f32 v83, v83
    v_exp_f32 v84, v84
    v_mfma_f32_32x32x16_bf16 v[32:47], a[32:35], v[134:137], v[32:47]
    v_exp_f32 v85, v85
    v_exp_f32 v86, v86
    v_exp_f32 v87, v87
    v_mfma_f32_32x32x16_bf16 v[48:63], a[36:39], v[134:137], v[48:63]
    v_exp_f32 v88, v88
    v_exp_f32 v89, v89
    v_exp_f32 v90, v90
    v_smfmac_f32_32x32x32_bf16 v[112:127], a[136:139], v[80:87], v2
    v_exp_f32 v91, v91
    v_exp_f32 v92, v92
    v_exp_f32 v93, v93
    v_exp_f32 v94, v94
    v_exp_f32 v95, v95
    v_exp_f32 v32, v32
    v_exp_f32 v33, v33
    v_smfmac_f32_32x32x32_bf16 v[112:127], a[140:143], v[88:95], v2
    v_exp_f32 v34, v34
    v_exp_f32 v35, v35
    v_exp_f32 v36, v36
    v_mfma_f32_32x32x4_2b_bf16 v[64:95], a[74:75], v[138:139], v[208:239]
    v_exp_f32 v37, v37
    v_exp_f32 v38, v38
    v_exp_f32 v39, v39
    v_exp_f32 v40, v40
    v_exp_f32 v41, v41
    v_exp_f32 v42, v42
    v_exp_f32 v43, v43
    v_exp_f32 v44, v44
    v_smfmac_f32_32x32x32_bf16 v[112:127], a[144:147], v[32:39], v2
    v_exp_f32 v45, v45
    v_exp_f32 v46, v46
    v_exp_f32 v47, v47
    v_exp_f32 v48, v48
    v_exp_f32 v49, v49
    v_smfmac_f32_32x32x32_bf16 v[112:127], a[148:151], v[40:47], v2
    v_exp_f32 v50, v50
    v_exp_f32 v51, v51
    v_exp_f32 v52, v52
    v_mfma_f32_32x32x16_bf16 v[64:79], a[40:43], v[134:137], v[64:79]
    v_exp_f32 v53, v53
    v_exp_f32 v54, v54
    v_exp_f32 v55, v55
    v_mfma_f32_32x32x16_bf16 v[80:95], a[44:47], v[134:137], v[80:95]
    v_exp_f32 v56, v56
    v_exp_f32 v57, v57
    v_exp_f32 v58, v58
    v_smfmac_f32_32x32x32_bf16 v[112:127], a[152:155], v[48:55], v2
    v_exp_f32 v59, v59
    v_exp_f32 v60, v60
    v_exp_f32 v61, v61
    v_exp_f32 v62, v62
    v_exp_f32 v63, v63
    v_exp_f32 v64, v64
    v_exp_f32 v65, v65
    v_smfmac_f32_32x32x32_bf16 v[112:127], a[156:159], v[56:63], v2
    v_exp_f32 v66, v66
    v_exp_f32 v67, v67
    v_exp_f32 v68, v68
    v_mfma_f32_32x32x4_2b_bf16 v[32:63], a[76:77], v[138:139], v[208:239]
    v_exp_f32 v69, v69
    v_exp_f32 v70, v70
    v_exp_f32 v71, v71
    v_exp_f32 v72, v72
    v_exp_f32 v73, v73
    v_exp_f32 v74, v74
    v_exp_f32 v75, v75
    v_exp_f32 v76, v76
    v_smfmac_f32_32x32x32_bf16 v[112:127], a[160:163], v[64:71], v2
    v_exp_f32 v77, v77
    v_exp_f32 v78, v78
    v_exp_f32 v79, v79
    v_exp_f32 v80, v80
    v_exp_f32 v81, v81
    v_smfmac_f32_32x32x32_bf16 v[112:127], a[164:167], v[72:79], v2
    v_exp_f32 v82, v82
    v_exp_f32 v83, v83
    v_exp_f32 v84, v84
    v_mfma_f32_32x32x16_bf16 v[32:47], a[48:51], v[134:137], v[32:47]
    v_exp_f32 v85, v85
    v_exp_f32 v86, v86
    v_exp_f32 v87, v87
    v_mfma_f32_32x32x16_bf16 v[48:63], a[52:55], v[134:137], v[48:63]
    v_exp_f32 v88, v88
    v_exp_f32 v89, v89
    v_exp_f32 v90, v90
    v_smfmac_f32_32x32x32_bf16 v[112:127], a[168:171], v[80:87], v2
    v_exp_f32 v91, v91
    v_exp_f32 v92, v92
    v_exp_f32 v93, v93
    v_exp_f32 v94, v94
    v_exp_f32 v95, v95
    v_exp_f32 v32, v32
    v_exp_f32 v33, v33
    v_smfmac_f32_32x32x32_bf16 v[112:127], a[172:175], v[88:95], v2
    v_exp_f32 v34, v34
    v_exp_f32 v35, v35
    v_exp_f32 v36, v36
    v_mfma_f32_32x32x4_2b_bf16 v[64:95], a[78:79], v[138:139], v[208:239]
    v_exp_f32 v37, v37
    v_exp_f32 v38, v38
    v_exp_f32 v39, v39
    v_exp_f32 v40, v40
    v_exp_f32 v41, v41
    v_exp_f32 v42, v42
    v_exp_f32 v43, v43
    v_exp_f32 v44, v44
    v_smfmac_f32_32x32x32_bf16 v[112:127], a[176:179], v[32:39], v2
    v_exp_f32 v45, v45
    v_exp_f32 v46, v46
    v_exp_f32 v47, v47
    v_exp_f32 v48, v48
    v_exp_f32 v49, v49
    v_smfmac_f32_32x32x32_bf16 v[112:127], a[180:183], v[40:47], v2
    v_exp_f32 v50, v50
    v_exp_f32 v51, v51
    v_exp_f32 v52, v52
    v_mfma_f32_32x32x16_bf16 v[64:79], a[56:59], v[134:137], v[64:79]
    v_exp_f32 v53, v53
    v_exp_f32 v54, v54
    v_exp_f32 v55, v55
    v_mfma_f32_32x32x16_bf16 v[80:95], a[60:63], v[134:137], v[80:95]
    v_exp_f32 v56, v56
    v_exp_f32 v57, v57
    v_exp_f32 v58, v58
    v_smfmac_f32_32x32x32_bf16 v[112:127], a[184:187], v[48:55], v2
    v_exp_f32 v59, v59
    v_exp_f32 v60, v60
    v_exp_f32 v61, v61
    v_exp_f32 v62, v62
    v_exp_f32 v63, v63
    v_exp_f32 v64, v64
    v_exp_f32 v65, v65
    v_smfmac_f32_32x32x32_bf16 v[112:127], a[188:191], v[56:63], v2
    s_waitcnt vmcnt(2)
    v_exp_f32 v66, v66
    v_exp_f32 v67, v67
    v_exp_f32 v68, v68
    v_mfma_f32_32x32x4_2b_bf16 v[32:63], a[64:65], v[132:133], 0
    s_nop 15
    s_nop 1
    v_mfma_f32_32x32x16_bf16 v[32:47], a[0:3], v[128:131], v[32:47]
    v_mfma_f32_32x32x16_bf16 v[48:63], a[4:7], v[128:131], v[48:63]
    s_nop 10
    v_mov_b32 v24, v32
    v_max3_f32 v24, v24, v32, v33
    v_max3_f32 v24, v24, v34, v35
    v_max3_f32 v24, v24, v36, v37
    v_max3_f32 v24, v24, v38, v39
    v_max3_f32 v24, v24, v40, v41
    v_max3_f32 v24, v24, v42, v43
    v_max3_f32 v24, v24, v44, v45
    v_max3_f32 v24, v24, v46, v47
    v_max3_f32 v24, v24, v48, v49
    v_max3_f32 v24, v24, v50, v51
    v_max3_f32 v24, v24, v52, v53
    v_max3_f32 v24, v24, v54, v55
    v_max3_f32 v24, v24, v56, v57
    v_max3_f32 v24, v24, v58, v59
    v_max3_f32 v24, v24, v60, v61
    v_max3_f32 v24, v24, v62, v63
    v_mfma_f32_32x32x4_2b_bf16 v[32:63], a[66:67], v[132:133], 0
    s_nop 15
    s_nop 1
    v_mfma_f32_32x32x16_bf16 v[32:47], a[8:11], v[128:131], v[32:47]
    v_mfma_f32_32x32x16_bf16 v[48:63], a[12:15], v[128:131], v[48:63]
    s_nop 10
    v_max3_f32 v24, v24, v32, v33
    v_max3_f32 v24, v24, v34, v35
    v_max3_f32 v24, v24, v36, v37
    v_max3_f32 v24, v24, v38, v39
    v_max3_f32 v24, v24, v40, v41
    v_max3_f32 v24, v24, v42, v43
    v_max3_f32 v24, v24, v44, v45
    v_max3_f32 v24, v24, v46, v47
    v_max3_f32 v24, v24, v48, v49
    v_max3_f32 v24, v24, v50, v51
    v_max3_f32 v24, v24, v52, v53
    v_max3_f32 v24, v24, v54, v55
    v_max3_f32 v24, v24, v56, v57
    v_max3_f32 v24, v24, v58, v59
    v_max3_f32 v24, v24, v60, v61
    v_max3_f32 v24, v24, v62, v63
    v_mfma_f32_32x32x4_2b_bf16 v[32:63], a[68:69], v[132:133], 0
    s_nop 15
    s_nop 1
    v_mfma_f32_32x32x16_bf16 v[32:47], a[16:19], v[128:131], v[32:47]
    v_mfma_f32_32x32x16_bf16 v[48:63], a[20:23], v[128:131], v[48:63]
    s_nop 10
    v_max3_f32 v24, v24, v32, v33
    v_max3_f32 v24, v24, v34, v35
    v_max3_f32 v24, v24, v36, v37
    v_max3_f32 v24, v24, v38, v39
    v_max3_f32 v24, v24, v40, v41
    v_max3_f32 v24, v24, v42, v43
    v_max3_f32 v24, v24, v44, v45
    v_max3_f32 v24, v24, v46, v47
    v_max3_f32 v24, v24, v48, v49
    v_max3_f32 v24, v24, v50, v51
    v_max3_f32 v24, v24, v52, v53
    v_max3_f32 v24, v24, v54, v55
    v_max3_f32 v24, v24, v56, v57
    v_max3_f32 v24, v24, v58, v59
    v_max3_f32 v24, v24, v60, v61
    v_max3_f32 v24, v24, v62, v63
    v_mfma_f32_32x32x4_2b_bf16 v[32:63], a[70:71], v[132:133], 0
    s_nop 15
    s_nop 1
    v_mfma_f32_32x32x16_bf16 v[32:47], a[24:27], v[128:131], v[32:47]
    v_mfma_f32_32x32x16_bf16 v[48:63], a[28:31], v[128:131], v[48:63]
    s_nop 10
    v_max3_f32 v24, v24, v32, v33
    v_max3_f32 v24, v24, v34, v35
    v_max3_f32 v24, v24, v36, v37
    v_max3_f32 v24, v24, v38, v39
    v_max3_f32 v24, v24, v40, v41
    v_max3_f32 v24, v24, v42, v43
    v_max3_f32 v24, v24, v44, v45
    v_max3_f32 v24, v24, v46, v47
    v_max3_f32 v24, v24, v48, v49
    v_max3_f32 v24, v24, v50, v51
    v_max3_f32 v24, v24, v52, v53
    v_max3_f32 v24, v24, v54, v55
    v_max3_f32 v24, v24, v56, v57
    v_max3_f32 v24, v24, v58, v59
    v_max3_f32 v24, v24, v60, v61
    v_max3_f32 v24, v24, v62, v63
    v_mfma_f32_32x32x4_2b_bf16 v[32:63], a[72:73], v[132:133], 0
    s_nop 15
    s_nop 1
    v_mfma_f32_32x32x16_bf16 v[32:47], a[32:35], v[128:131], v[32:47]
    v_mfma_f32_32x32x16_bf16 v[48:63], a[36:39], v[128:131], v[48:63]
    s_nop 10
    v_max3_f32 v24, v24, v32, v33
    v_max3_f32 v24, v24, v34, v35
    v_max3_f32 v24, v24, v36, v37
    v_max3_f32 v24, v24, v38, v39
    v_max3_f32 v24, v24, v40, v41
    v_max3_f32 v24, v24, v42, v43
    v_max3_f32 v24, v24, v44, v45
    v_max3_f32 v24, v24, v46, v47
    v_max3_f32 v24, v24, v48, v49
    v_max3_f32 v24, v24, v50, v51
    v_max3_f32 v24, v24, v52, v53
    v_max3_f32 v24, v24, v54, v55
    v_max3_f32 v24, v24, v56, v57
    v_max3_f32 v24, v24, v58, v59
    v_max3_f32 v24, v24, v60, v61
    v_max3_f32 v24, v24, v62, v63
    v_mfma_f32_32x32x4_2b_bf16 v[32:63], a[74:75], v[132:133], 0
    s_nop 15
    s_nop 1
    v_mfma_f32_32x32x16_bf16 v[32:47], a[40:43], v[128:131], v[32:47]
    v_mfma_f32_32x32x16_bf16 v[48:63], a[44:47], v[128:131], v[48:63]
    s_nop 10
    v_max3_f32 v24, v24, v32, v33
    v_max3_f32 v24, v24, v34, v35
    v_max3_f32 v24, v24, v36, v37
    v_max3_f32 v24, v24, v38, v39
    v_max3_f32 v24, v24, v40, v41
    v_max3_f32 v24, v24, v42, v43
    v_max3_f32 v24, v24, v44, v45
    v_max3_f32 v24, v24, v46, v47
    v_max3_f32 v24, v24, v48, v49
    v_max3_f32 v24, v24, v50, v51
    v_max3_f32 v24, v24, v52, v53
    v_max3_f32 v24, v24, v54, v55
    v_max3_f32 v24, v24, v56, v57
    v_max3_f32 v24, v24, v58, v59
    v_max3_f32 v24, v24, v60, v61
    v_max3_f32 v24, v24, v62, v63
    v_mfma_f32_32x32x4_2b_bf16 v[32:63], a[76:77], v[132:133], 0
    s_nop 15
    s_nop 1
    v_mfma_f32_32x32x16_bf16 v[32:47], a[48:51], v[128:131], v[32:47]
    v_mfma_f32_32x32x16_bf16 v[48:63], a[52:55], v[128:131], v[48:63]
    s_nop 10
    v_max3_f32 v24, v24, v32, v33
    v_max3_f32 v24, v24, v34, v35
    v_max3_f32 v24, v24, v36, v37
    v_max3_f32 v24, v24, v38, v39
    v_max3_f32 v24, v24, v40, v41
    v_max3_f32 v24, v24, v42, v43
    v_max3_f32 v24, v24, v44, v45
    v_max3_f32 v24, v24, v46, v47
    v_max3_f32 v24, v24, v48, v49
    v_max3_f32 v24, v24, v50, v51
    v_max3_f32 v24, v24, v52, v53
    v_max3_f32 v24, v24, v54, v55
    v_max3_f32 v24, v24, v56, v57
    v_max3_f32 v24, v24, v58, v59
    v_max3_f32 v24, v24, v60, v61
    v_max3_f32 v24, v24, v62, v63
    v_mfma_f32_32x32x4_2b_bf16 v[32:63], a[78:79], v[132:133], 0
    s_nop 15
    s_nop 1
    v_mfma_f32_32x32x16_bf16 v[32:47], a[56:59], v[128:131], v[32:47]
    v_mfma_f32_32x32x16_bf16 v[48:63], a[60:63], v[128:131], v[48:63]
    s_nop 10
    v_max3_f32 v24, v24, v32, v33
    v_max3_f32 v24, v24, v34, v35
    v_max3_f32 v24, v24, v36, v37
    v_max3_f32 v24, v24, v38, v39
    v_max3_f32 v24, v24, v40, v41
    v_max3_f32 v24, v24, v42, v43
    v_max3_f32 v24, v24, v44, v45
    v_max3_f32 v24, v24, v46, v47
    v_max3_f32 v24, v24, v48, v49
    v_max3_f32 v24, v24, v50, v51
    v_max3_f32 v24, v24, v52, v53
    v_max3_f32 v24, v24, v54, v55
    v_max3_f32 v24, v24, v56, v57
    v_max3_f32 v24, v24, v58, v59
    v_max3_f32 v24, v24, v60, v61
    v_max3_f32 v24, v24, v62, v63
    v_mov_b32 v25, v24
    s_nop 1
    v_permlane32_swap_b32 v24, v25
    v_max_f32 v24, v24, v25
    s_lshl_b32 s51, s40, 2
    v_add_u32 v25, s51, v1
    s_waitcnt lgkmcnt(0)
    s_barrier
    ds_write_b32 v25, v24 offset:30720
    s_waitcnt lgkmcnt(0)
    s_barrier
    ds_read_b128 v[24:27], v1 offset:30720
    s_waitcnt lgkmcnt(0)
    v_max3_f32 v24, v24, v25, v26
    v_max_f32 v24, v24, v27
    v_sub_f32 v208, 0, v24
    v_sub_f32 v209, 0, v24
    v_sub_f32 v210, 0, v24
    v_sub_f32 v211, 0, v24
    v_sub_f32 v212, 0, v24
    v_sub_f32 v213, 0, v24
    v_sub_f32 v214, 0, v24
    v_sub_f32 v215, 0, v24
    v_sub_f32 v216, 0, v24
    v_sub_f32 v217, 0, v24
    v_sub_f32 v218, 0, v24
    v_sub_f32 v219, 0, v24
    v_sub_f32 v220, 0, v24
    v_sub_f32 v221, 0, v24
    v_sub_f32 v222, 0, v24
    v_sub_f32 v223, 0, v24
    v_sub_f32 v224, 0, v24
    v_sub_f32 v225, 0, v24
    v_sub_f32 v226, 0, v24
    v_sub_f32 v227, 0, v24
    v_sub_f32 v228, 0, v24
    v_sub_f32 v229, 0, v24
    v_sub_f32 v230, 0, v24
    v_sub_f32 v231, 0, v24
    v_sub_f32 v232, 0, v24
    v_sub_f32 v233, 0, v24
    v_sub_f32 v234, 0, v24
    v_sub_f32 v235, 0, v24
    v_sub_f32 v236, 0, v24
    v_sub_f32 v237, 0, v24
    v_sub_f32 v238, 0, v24
    v_sub_f32 v239, 0, v24
    s_nop 1
    v_mfma_f32_32x32x4_2b_bf16 v[32:63], a[64:65], v[132:133], v[208:239]
    v_exp_f32 v69, v69
    v_exp_f32 v70, v70
    v_exp_f32 v71, v71
    v_exp_f32 v72, v72
    v_exp_f32 v73, v73
    v_exp_f32 v74, v74
    v_exp_f32 v75, v75
    v_exp_f32 v76, v76
    v_smfmac_f32_32x32x32_bf16 v[112:127], a[192:195], v[64:71], v2
    v_exp_f32 v77, v77
    v_exp_f32 v78, v78
    v_exp_f32 v79, v79
    v_exp_f32 v80, v80
    v_exp_f32 v81, v81
    v_smfmac_f32_32x32x32_bf16 v[112:127], a[196:199], v[72:79], v2
    v_exp_f32 v82, v82
    v_exp_f32 v83, v83
    v_exp_f32 v84, v84
    v_mfma_f32_32x32x16_bf16 v[32:47], a[0:3], v[128:131], v[32:47]
    v_exp_f32 v85, v85
    v_exp_f32 v86, v86
    v_exp_f32 v87, v87
    v_mfma_f32_32x32x16_bf16 v[48:63], a[4:7], v[128:131], v[48:63]
    v_exp_f32 v88, v88
    v_exp_f32 v89, v89
    v_exp_f32 v90, v90
    v_smfmac_f32_32x32x32_bf16 v[112:127], a[200:203], v[80:87], v2
    v_exp_f32 v91, v91
    v_exp_f32 v92, v92
    v_exp_f32 v93, v93
    v_exp_f32 v94, v94
    v_exp_f32 v95, v95
    v_exp_f32 v32, v32
    v_exp_f32 v33, v33
    v_smfmac_f32_32x32x32_bf16 v[112:127], a[204:207], v[88:95], v2
    v_exp_f32 v34, v34
    v_exp_f32 v35, v35
    v_exp_f32 v36, v36
    v_mfma_f32_32x32x4_2b_bf16 v[64:95], a[66:67], v[132:133], v[208:239]
    v_exp_f32 v37, v37
    v_exp_f32 v38, v38
    v_exp_f32 v39, v39
    v_exp_f32 v40, v40
    v_exp_f32 v41, v41
    v_exp_f32 v42, v42
    v_exp_f32 v43, v43
    v_exp_f32 v44, v44
    v_smfmac_f32_32x32x32_bf16 v[96:111], a[80:83], v[32:39], v2
    ds_write_b128 v6, v[112:115] offset:12288
    v_exp_f32 v45, v45
    v_exp_f32 v46, v46
    v_exp_f32 v47, v47
    v_exp_f32 v48, v48
    v_exp_f32 v49, v49
    v_smfmac_f32_32x32x32_bf16 v[96:111], a[84:87], v[40:47], v2
    ds_write_b128 v6, v[116:119] offset:13312
    s_mov_b32 s45, 3840
    buffer_load_dwordx4 v[134:137], v11, s[16:19], s45 offen sc1
    buffer_load_dwordx2 v[138:139], v12, s[16:19], s45 offen offset:1024 sc1
    v_exp_f32 v50, v50
    v_exp_f32 v51, v51
    v_exp_f32 v52, v52
    v_mfma_f32_32x32x16_bf16 v[64:79], a[8:11], v[128:131], v[64:79]
    v_exp_f32 v53, v53
    v_exp_f32 v54, v54
    v_exp_f32 v55, v55
    v_mfma_f32_32x32x16_bf16 v[80:95], a[12:15], v[128:131], v[80:95]
    v_exp_f32 v56, v56
    v_exp_f32 v57, v57
    v_exp_f32 v58, v58
    v_smfmac_f32_32x32x32_bf16 v[96:111], a[88:91], v[48:55], v2
    ds_write_b128 v6, v[120:123] offset:14336
    v_exp_f32 v59, v59
    v_exp_f32 v60, v60
    v_exp_f32 v61, v61
    v_exp_f32 v62, v62
    v_exp_f32 v63, v63
    v_exp_f32 v64, v64
    v_exp_f32 v65, v65
    v_smfmac_f32_32x32x32_bf16 v[96:111], a[92:95], v[56:63], v2
    v_exp_f32 v66, v66
    v_exp_f32 v67, v67
    v_exp_f32 v68, v68
    v_mfma_f32_32x32x4_2b_bf16 v[32:63], a[68:69], v[132:133], v[208:239]
    v_exp_f32 v69, v69
    v_exp_f32 v70, v70
    v_exp_f32 v71, v71
    v_exp_f32 v72, v72
    v_exp_f32 v73, v73
    v_exp_f32 v74, v74
    v_exp_f32 v75, v75
    v_exp_f32 v76, v76
    v_smfmac_f32_32x32x32_bf16 v[96:111], a[96:99], v[64:71], v2
    s_waitcnt lgkmcnt(0)
    s_barrier
    v_exp_f32 v77, v77
    v_exp_f32 v78, v78
    v_exp_f32 v79, v79
    v_exp_f32 v80, v80
    v_exp_f32 v81, v81
    v_smfmac_f32_32x32x32_bf16 v[96:111], a[100:103], v[72:79], v2
    ds_read_b128 v[188:191], v7 offset:12288
    v_exp_f32 v82, v82
    v_exp_f32 v83, v83
    v_exp_f32 v84, v84
    v_mfma_f32_32x32x16_bf16 v[32:47], a[16:19], v[128:131], v[32:47]
    ds_read_b128 v[192:195], v7 offset:15360
    v_exp_f32 v85, v85
    v_exp_f32 v86, v86
    v_exp_f32 v87, v87
    v_mfma_f32_32x32x16_bf16 v[48:63], a[20:23], v[128:131], v[48:63]
    ds_read_b128 v[196:199], v7 offset:18432
    v_exp_f32 v88, v88
    v_exp_f32 v89, v89
    v_exp_f32 v90, v90
    v_smfmac_f32_32x32x32_bf16 v[96:111], a[104:107], v[80:87], v2
    ds_read_b128 v[200:203], v7 offset:21504
    ds_read_b128 v[180:183], v1 offset:24576
    v_exp_f32 v91, v91
    v_exp_f32 v92, v92
    v_exp_f32 v93, v93
    v_mfma_f32_32x32x8_bf16 v[112:127], v[4:5], v[4:5], 0
    v_exp_f32 v94, v94
    v_exp_f32 v95, v95
    v_exp_f32 v32, v32
    v_exp_f32 v33, v33
    v_smfmac_f32_32x32x32_bf16 v[96:111], a[108:111], v[88:95], v2
    v_exp_f32 v34, v34
    v_exp_f32 v35, v35
    v_exp_f32 v36, v36
    v_mfma_f32_32x32x4_2b_bf16 v[64:95], a[70:71], v[132:133], v[208:239]
    s_waitcnt lgkmcnt(0)
    v_exp_f32 v37, v37
    v_add_f32 v188, v188, v192
    v_exp_f32 v38, v38
    v_add_f32 v189, v189, v193
    v_exp_f32 v39, v39
    v_add_f32 v190, v190, v194
    v_exp_f32 v40, v40
    v_add_f32 v191, v191, v195
    v_exp_f32 v41, v41
    v_add_f32 v196, v196, v200
    v_exp_f32 v42, v42
    v_add_f32 v197, v197, v201
    v_exp_f32 v43, v43
    v_add_f32 v198, v198, v202
    v_exp_f32 v44, v44
    v_add_f32 v199, v199, v203
    v_smfmac_f32_32x32x32_bf16 v[96:111], a[112:115], v[32:39], v2
    v_exp_f32 v45, v45
    v_add_f32 v188, v188, v196
    v_exp_f32 v46, v46
    v_add_f32 v189, v189, v197
    v_exp_f32 v47, v47
    v_add_f32 v190, v190, v198
    v_smfmac_f32_16x16x64_bf16 v[140:143], v[180:183], a[208:215], v3
    buffer_load_dwordx4 a[208:211], v1, s[16:19], s50 offen offset:0 sc1
    buffer_load_dwordx4 a[212:215], v1, s[16:19], s50 offen offset:1024 sc1
    v_exp_f32 v48, v48
    v_rcp_f32_dpp v192, v188 quad_perm:[3,3,3,3] row_mask:0xf bank_mask:0xf
    v_exp_f32 v49, v49
    v_add_f32 v191, v191, v199
    v_smfmac_f32_32x32x32_bf16 v[96:111], a[116:119], v[40:47], v2
    v_exp_f32 v50, v50
    v_mul_f32 v188, v188, v192
    v_exp_f32 v51, v51
    v_mul_f32 v189, v189, v192
    v_exp_f32 v52, v52
    v_mul_f32 v190, v190, v192
    v_mfma_f32_32x32x16_bf16 v[64:79], a[24:27], v[128:131], v[64:79]
    v_exp_f32 v53, v53
    v_mul_f32 v191, v191, v192
    v_exp_f32 v54, v54
    v_cvt_pk_bf16_f32 v188, v188, v189
    v_exp_f32 v55, v55
    v_cvt_pk_bf16_f32 v189, v190, v191
    v_mfma_f32_32x32x16_bf16 v[80:95], a[28:31], v[128:131], v[80:95]
    v_exp_f32 v56, v56
    v_subrev_u32 v192, 528482304, v192
    v_exp_f32 v57, v57
    v_max_u32 v10, v10, v192
    v_exp_f32 v58, v58
    v_smfmac_f32_32x32x32_bf16 v[96:111], a[120:123], v[48:55], v2
    ds_write2_b32 v8, v188, v189 offset0:0 offset1:32
    v_add_u32 v8, v9, v8
    v_exp_f32 v59, v59
    v_exp_f32 v60, v60
    v_exp_f32 v61, v61
    v_smfmac_f32_16x16x64_bf16 v[144:147], v[180:183], a[216:223], v3
    buffer_load_dwordx4 a[216:219], v1, s[16:19], s50 offen offset:2048 sc1
    buffer_load_dwordx4 a[220:223], v1, s[16:19], s50 offen offset:3072 sc1
    v_exp_f32 v62, v62
    v_exp_f32 v63, v63
    v_exp_f32 v64, v64
    v_exp_f32 v65, v65
    v_smfmac_f32_32x32x32_bf16 v[96:111], a[124:127], v[56:63], v2
    s_add_u32 s50, s49, 16384
    v_exp_f32 v66, v66
    v_exp_f32 v67, v67
    v_exp_f32 v68, v68
    v_mfma_f32_32x32x4_2b_bf16 v[32:63], a[72:73], v[132:133], v[208:239]
    v_exp_f32 v69, v69
    v_exp_f32 v70, v70
    v_exp_f32 v71, v71
    v_exp_f32 v72, v72
    v_exp_f32 v73, v73
    v_exp_f32 v74, v74
    v_exp_f32 v75, v75
    v_exp_f32 v76, v76
    v_smfmac_f32_32x32x32_bf16 v[96:111], a[128:131], v[64:71], v2
    v_exp_f32 v77, v77
    v_exp_f32 v78, v78
    v_exp_f32 v79, v79
    v_smfmac_f32_16x16x64_bf16 v[148:151], v[180:183], a[224:231], v3
    buffer_load_dwordx4 a[224:227], v1, s[16:19], s50 offen offset:0 sc1
    buffer_load_dwordx4 a[228:231], v1, s[16:19], s50 offen offset:1024 sc1
    v_exp_f32 v80, v80
    v_exp_f32 v81, v81
    v_smfmac_f32_32x32x32_bf16 v[96:111], a[132:135], v[72:79], v2
    v_exp_f32 v82, v82
    v_exp_f32 v83, v83
    v_exp_f32 v84, v84
    v_mfma_f32_32x32x16_bf16 v[32:47], a[32:35], v[128:131], v[32:47]
    v_exp_f32 v85, v85
    v_exp_f32 v86, v86
    v_exp_f32 v87, v87
    v_mfma_f32_32x32x16_bf16 v[48:63], a[36:39], v[128:131], v[48:63]
    v_exp_f32 v88, v88
    v_exp_f32 v89, v89
    v_exp_f32 v90, v90
    v_smfmac_f32_32x32x32_bf16 v[96:111], a[136:139], v[80:87], v2
    v_exp_f32 v91, v91
    v_exp_f32 v92, v92
    v_exp_f32 v93, v93
    v_smfmac_f32_16x16x64_bf16 v[152:155], v[180:183], a[232:239], v3
    buffer_load_dwordx4 a[232:235], v1, s[16:19], s50 offen offset:2048 sc1
    buffer_load_dwordx4 a[236:239], v1, s[16:19], s50 offen offset:3072 sc1
    v_exp_f32 v94, v94
    v_exp_f32 v95, v95
    v_exp_f32 v32, v32
    v_exp_f32 v33, v33
    v_smfmac_f32_32x32x32_bf16 v[96:111], a[140:143], v[88:95], v2
    s_add_u32 s50, s49, 81920
    v_exp_f32 v34, v34
    v_exp_f32 v35, v35
    v_exp_f32 v36, v36
    v_mfma_f32_32x32x4_2b_bf16 v[64:95], a[74:75], v[132:133], v[208:239]
    v_exp_f32 v37, v37
    v_exp_f32 v38, v38
    v_exp_f32 v39, v39
    v_exp_f32 v40, v40
    v_exp_f32 v41, v41
    v_exp_f32 v42, v42
    v_exp_f32 v43, v43
    v_exp_f32 v44, v44
    v_smfmac_f32_32x32x32_bf16 v[96:111], a[144:147], v[32:39], v2
    v_exp_f32 v45, v45
    v_exp_f32 v46, v46
    v_exp_f32 v47, v47
    v_smfmac_f32_16x16x64_bf16 v[156:159], v[180:183], a[240:247], v3
    buffer_load_dwordx4 a[240:243], v1, s[16:19], s50 offen offset:0 sc1
    buffer_load_dwordx4 a[244:247], v1, s[16:19], s50 offen offset:1024 sc1
    v_exp_f32 v48, v48
    v_exp_f32 v49, v49
    v_smfmac_f32_32x32x32_bf16 v[96:111], a[148:151], v[40:47], v2
    v_exp_f32 v50, v50
    v_exp_f32 v51, v51
    v_exp_f32 v52, v52
    v_mfma_f32_32x32x16_bf16 v[64:79], a[40:43], v[128:131], v[64:79]
    v_exp_f32 v53, v53
    v_exp_f32 v54, v54
    v_exp_f32 v55, v55
    v_mfma_f32_32x32x16_bf16 v[80:95], a[44:47], v[128:131], v[80:95]
    v_exp_f32 v56, v56
    v_exp_f32 v57, v57
    v_exp_f32 v58, v58
    v_smfmac_f32_32x32x32_bf16 v[96:111], a[152:155], v[48:55], v2
    s_waitcnt vmcnt(12)
    v_exp_f32 v59, v59
    v_exp_f32 v60, v60
    v_exp_f32 v61, v61
    v_smfmac_f32_16x16x64_bf16 v[160:163], v[180:183], a[248:255], v3
    buffer_load_dwordx4 a[248:251], v1, s[16:19], s50 offen offset:2048 sc1
    buffer_load_dwordx4 a[252:255], v1, s[16:19], s50 offen offset:3072 sc1
    v_exp_f32 v62, v62
    v_exp_f32 v63, v63
    v_exp_f32 v64, v64
    v_exp_f32 v65, v65
    v_smfmac_f32_32x32x32_bf16 v[96:111], a[156:159], v[56:63], v2
    s_add_u32 s50, s49, 86016
    v_exp_f32 v66, v66
    v_exp_f32 v67, v67
    v_exp_f32 v68, v68
    v_mfma_f32_32x32x4_2b_bf16 v[32:63], a[76:77], v[132:133], v[208:239]
    v_exp_f32 v69, v69
    v_exp_f32 v70, v70
    v_exp_f32 v71, v71
    v_exp_f32 v72, v72
    v_exp_f32 v73, v73
    v_exp_f32 v74, v74
    v_exp_f32 v75, v75
    v_exp_f32 v76, v76
    v_smfmac_f32_32x32x32_bf16 v[96:111], a[160:163], v[64:71], v2
    s_waitcnt vmcnt(10)
    v_exp_f32 v77, v77
    v_exp_f32 v78, v78
    v_exp_f32 v79, v79
    v_smfmac_f32_16x16x64_bf16 v[164:167], v[180:183], a[208:215], v3
    buffer_load_dwordx4 a[208:211], v1, s[16:19], s50 offen offset:0 sc1
    buffer_load_dwordx4 a[212:215], v1, s[16:19], s50 offen offset:1024 sc1
    v_exp_f32 v80, v80
    v_exp_f32 v81, v81
    v_smfmac_f32_32x32x32_bf16 v[96:111], a[164:167], v[72:79], v2
    v_exp_f32 v82, v82
    v_exp_f32 v83, v83
    v_exp_f32 v84, v84
    v_mfma_f32_32x32x16_bf16 v[32:47], a[48:51], v[128:131], v[32:47]
    v_exp_f32 v85, v85
    v_exp_f32 v86, v86
    v_exp_f32 v87, v87
    v_mfma_f32_32x32x16_bf16 v[48:63], a[52:55], v[128:131], v[48:63]
    v_exp_f32 v88, v88
    v_exp_f32 v89, v89
    v_exp_f32 v90, v90
    v_smfmac_f32_32x32x32_bf16 v[96:111], a[168:171], v[80:87], v2
    s_waitcnt vmcnt(10)
    v_exp_f32 v91, v91
    v_exp_f32 v92, v92
    v_exp_f32 v93, v93
    v_smfmac_f32_16x16x64_bf16 v[168:171], v[180:183], a[216:223], v3
    buffer_load_dwordx4 a[216:219], v1, s[16:19], s50 offen offset:2048 sc1
    buffer_load_dwordx4 a[220:223], v1, s[16:19], s50 offen offset:3072 sc1
    v_exp_f32 v94, v94
    v_exp_f32 v95, v95
    v_exp_f32 v32, v32
    v_exp_f32 v33, v33
    v_smfmac_f32_32x32x32_bf16 v[96:111], a[172:175], v[88:95], v2
    s_add_u32 s50, s49, 90112
    v_exp_f32 v34, v34
    v_exp_f32 v35, v35
    v_exp_f32 v36, v36
    v_mfma_f32_32x32x4_2b_bf16 v[64:95], a[78:79], v[132:133], v[208:239]
    v_exp_f32 v37, v37
    v_exp_f32 v38, v38
    v_exp_f32 v39, v39
    v_exp_f32 v40, v40
    v_exp_f32 v41, v41
    v_exp_f32 v42, v42
    v_exp_f32 v43, v43
    v_exp_f32 v44, v44
    v_smfmac_f32_32x32x32_bf16 v[96:111], a[176:179], v[32:39], v2
    s_waitcnt vmcnt(10)
    v_exp_f32 v45, v45
    v_exp_f32 v46, v46
    v_exp_f32 v47, v47
    v_smfmac_f32_16x16x64_bf16 v[172:175], v[180:183], a[224:231], v3
    buffer_load_dwordx4 a[224:227], v1, s[16:19], s50 offen offset:0 sc1
    buffer_load_dwordx4 a[228:231], v1, s[16:19], s50 offen offset:1024 sc1
    v_exp_f32 v48, v48
    v_exp_f32 v49, v49
    v_smfmac_f32_32x32x32_bf16 v[96:111], a[180:183], v[40:47], v2
    v_exp_f32 v50, v50
    v_exp_f32 v51, v51
    v_exp_f32 v52, v52
    v_mfma_f32_32x32x16_bf16 v[64:79], a[56:59], v[128:131], v[64:79]
    v_exp_f32 v53, v53
    v_exp_f32 v54, v54
    v_exp_f32 v55, v55
    v_mfma_f32_32x32x16_bf16 v[80:95], a[60:63], v[128:131], v[80:95]
    v_exp_f32 v56, v56
    v_exp_f32 v57, v57
    v_exp_f32 v58, v58
    v_smfmac_f32_32x32x32_bf16 v[96:111], a[184:187], v[48:55], v2
    s_waitcnt vmcnt(10)
    v_exp_f32 v59, v59
    v_exp_f32 v60, v60
    v_exp_f32 v61, v61
    v_smfmac_f32_16x16x64_bf16 v[176:179], v[180:183], a[232:239], v3
    buffer_load_dwordx4 a[232:235], v1, s[16:19], s50 offen offset:2048 sc1
    buffer_load_dwordx4 a[236:239], v1, s[16:19], s50 offen offset:3072 sc1
    v_exp_f32 v62, v62
    v_exp_f32 v63, v63
    v_exp_f32 v64, v64
    v_exp_f32 v65, v65
    v_smfmac_f32_32x32x32_bf16 v[96:111], a[188:191], v[56:63], v2
    s_add_u32 s50, s49, 94208
    v_exp_f32 v66, v66
    v_exp_f32 v67, v67
    v_exp_f32 v68, v68
    v_mfma_f32_32x32x4_2b_bf16 v[32:63], a[64:65], v[138:139], 0
    s_nop 15
    s_nop 1
    v_mfma_f32_32x32x16_bf16 v[32:47], a[0:3], v[134:137], v[32:47]
    v_mfma_f32_32x32x16_bf16 v[48:63], a[4:7], v[134:137], v[48:63]
    s_nop 10
    v_mov_b32 v24, v32
    v_max3_f32 v24, v24, v32, v33
    v_max3_f32 v24, v24, v34, v35
    v_max3_f32 v24, v24, v36, v37
    v_max3_f32 v24, v24, v38, v39
    v_max3_f32 v24, v24, v40, v41
    v_max3_f32 v24, v24, v42, v43
    v_max3_f32 v24, v24, v44, v45
    v_max3_f32 v24, v24, v46, v47
    v_max3_f32 v24, v24, v48, v49
    v_max3_f32 v24, v24, v50, v51
    v_max3_f32 v24, v24, v52, v53
    v_max3_f32 v24, v24, v54, v55
    v_max3_f32 v24, v24, v56, v57
    v_max3_f32 v24, v24, v58, v59
    v_max3_f32 v24, v24, v60, v61
    v_max3_f32 v24, v24, v62, v63
    v_mfma_f32_32x32x4_2b_bf16 v[32:63], a[66:67], v[138:139], 0
    s_nop 15
    s_nop 1
    v_mfma_f32_32x32x16_bf16 v[32:47], a[8:11], v[134:137], v[32:47]
    v_mfma_f32_32x32x16_bf16 v[48:63], a[12:15], v[134:137], v[48:63]
    s_nop 10
    v_max3_f32 v24, v24, v32, v33
    v_max3_f32 v24, v24, v34, v35
    v_max3_f32 v24, v24, v36, v37
    v_max3_f32 v24, v24, v38, v39
    v_max3_f32 v24, v24, v40, v41
    v_max3_f32 v24, v24, v42, v43
    v_max3_f32 v24, v24, v44, v45
    v_max3_f32 v24, v24, v46, v47
    v_max3_f32 v24, v24, v48, v49
    v_max3_f32 v24, v24, v50, v51
    v_max3_f32 v24, v24, v52, v53
    v_max3_f32 v24, v24, v54, v55
    v_max3_f32 v24, v24, v56, v57
    v_max3_f32 v24, v24, v58, v59
    v_max3_f32 v24, v24, v60, v61
    v_max3_f32 v24, v24, v62, v63
    v_mfma_f32_32x32x4_2b_bf16 v[32:63], a[68:69], v[138:139], 0
    s_nop 15
    s_nop 1
    v_mfma_f32_32x32x16_bf16 v[32:47], a[16:19], v[134:137], v[32:47]
    v_mfma_f32_32x32x16_bf16 v[48:63], a[20:23], v[134:137], v[48:63]
    s_nop 10
    v_max3_f32 v24, v24, v32, v33
    v_max3_f32 v24, v24, v34, v35
    v_max3_f32 v24, v24, v36, v37
    v_max3_f32 v24, v24, v38, v39
    v_max3_f32 v24, v24, v40, v41
    v_max3_f32 v24, v24, v42, v43
    v_max3_f32 v24, v24, v44, v45
    v_max3_f32 v24, v24, v46, v47
    v_max3_f32 v24, v24, v48, v49
    v_max3_f32 v24, v24, v50, v51
    v_max3_f32 v24, v24, v52, v53
    v_max3_f32 v24, v24, v54, v55
    v_max3_f32 v24, v24, v56, v57
    v_max3_f32 v24, v24, v58, v59
    v_max3_f32 v24, v24, v60, v61
    v_max3_f32 v24, v24, v62, v63
    v_mfma_f32_32x32x4_2b_bf16 v[32:63], a[70:71], v[138:139], 0
    s_nop 15
    s_nop 1
    v_mfma_f32_32x32x16_bf16 v[32:47], a[24:27], v[134:137], v[32:47]
    v_mfma_f32_32x32x16_bf16 v[48:63], a[28:31], v[134:137], v[48:63]
    s_nop 10
    v_max3_f32 v24, v24, v32, v33
    v_max3_f32 v24, v24, v34, v35
    v_max3_f32 v24, v24, v36, v37
    v_max3_f32 v24, v24, v38, v39
    v_max3_f32 v24, v24, v40, v41
    v_max3_f32 v24, v24, v42, v43
    v_max3_f32 v24, v24, v44, v45
    v_max3_f32 v24, v24, v46, v47
    v_max3_f32 v24, v24, v48, v49
    v_max3_f32 v24, v24, v50, v51
    v_max3_f32 v24, v24, v52, v53
    v_max3_f32 v24, v24, v54, v55
    v_max3_f32 v24, v24, v56, v57
    v_max3_f32 v24, v24, v58, v59
    v_max3_f32 v24, v24, v60, v61
    v_max3_f32 v24, v24, v62, v63
    v_mfma_f32_32x32x4_2b_bf16 v[32:63], a[72:73], v[138:139], 0
    s_nop 15
    s_nop 1
    v_mfma_f32_32x32x16_bf16 v[32:47], a[32:35], v[134:137], v[32:47]
    v_mfma_f32_32x32x16_bf16 v[48:63], a[36:39], v[134:137], v[48:63]
    s_nop 10
    v_max3_f32 v24, v24, v32, v33
    v_max3_f32 v24, v24, v34, v35
    v_max3_f32 v24, v24, v36, v37
    v_max3_f32 v24, v24, v38, v39
    v_max3_f32 v24, v24, v40, v41
    v_max3_f32 v24, v24, v42, v43
    v_max3_f32 v24, v24, v44, v45
    v_max3_f32 v24, v24, v46, v47
    v_max3_f32 v24, v24, v48, v49
    v_max3_f32 v24, v24, v50, v51
    v_max3_f32 v24, v24, v52, v53
    v_max3_f32 v24, v24, v54, v55
    v_max3_f32 v24, v24, v56, v57
    v_max3_f32 v24, v24, v58, v59
    v_max3_f32 v24, v24, v60, v61
    v_max3_f32 v24, v24, v62, v63
    v_mfma_f32_32x32x4_2b_bf16 v[32:63], a[74:75], v[138:139], 0
    s_nop 15
    s_nop 1
    v_mfma_f32_32x32x16_bf16 v[32:47], a[40:43], v[134:137], v[32:47]
    v_mfma_f32_32x32x16_bf16 v[48:63], a[44:47], v[134:137], v[48:63]
    s_nop 10
    v_max3_f32 v24, v24, v32, v33
    v_max3_f32 v24, v24, v34, v35
    v_max3_f32 v24, v24, v36, v37
    v_max3_f32 v24, v24, v38, v39
    v_max3_f32 v24, v24, v40, v41
    v_max3_f32 v24, v24, v42, v43
    v_max3_f32 v24, v24, v44, v45
    v_max3_f32 v24, v24, v46, v47
    v_max3_f32 v24, v24, v48, v49
    v_max3_f32 v24, v24, v50, v51
    v_max3_f32 v24, v24, v52, v53
    v_max3_f32 v24, v24, v54, v55
    v_max3_f32 v24, v24, v56, v57
    v_max3_f32 v24, v24, v58, v59
    v_max3_f32 v24, v24, v60, v61
    v_max3_f32 v24, v24, v62, v63
    v_mfma_f32_32x32x4_2b_bf16 v[32:63], a[76:77], v[138:139], 0
    s_nop 15
    s_nop 1
    v_mfma_f32_32x32x16_bf16 v[32:47], a[48:51], v[134:137], v[32:47]
    v_mfma_f32_32x32x16_bf16 v[48:63], a[52:55], v[134:137], v[48:63]
    s_nop 10
    v_max3_f32 v24, v24, v32, v33
    v_max3_f32 v24, v24, v34, v35
    v_max3_f32 v24, v24, v36, v37
    v_max3_f32 v24, v24, v38, v39
    v_max3_f32 v24, v24, v40, v41
    v_max3_f32 v24, v24, v42, v43
    v_max3_f32 v24, v24, v44, v45
    v_max3_f32 v24, v24, v46, v47
    v_max3_f32 v24, v24, v48, v49
    v_max3_f32 v24, v24, v50, v51
    v_max3_f32 v24, v24, v52, v53
    v_max3_f32 v24, v24, v54, v55
    v_max3_f32 v24, v24, v56, v57
    v_max3_f32 v24, v24, v58, v59
    v_max3_f32 v24, v24, v60, v61
    v_max3_f32 v24, v24, v62, v63
    v_mfma_f32_32x32x4_2b_bf16 v[32:63], a[78:79], v[138:139], 0
    s_nop 15
    s_nop 1
    v_mfma_f32_32x32x16_bf16 v[32:47], a[56:59], v[134:137], v[32:47]
    v_mfma_f32_32x32x16_bf16 v[48:63], a[60:63], v[134:137], v[48:63]
    s_nop 10
    v_max3_f32 v24, v24, v32, v33
    v_max3_f32 v24, v24, v34, v35
    v_max3_f32 v24, v24, v36, v37
    v_max3_f32 v24, v24, v38, v39
    v_max3_f32 v24, v24, v40, v41
    v_max3_f32 v24, v24, v42, v43
    v_max3_f32 v24, v24, v44, v45
    v_max3_f32 v24, v24, v46, v47
    v_max3_f32 v24, v24, v48, v49
    v_max3_f32 v24, v24, v50, v51
    v_max3_f32 v24, v24, v52, v53
    v_max3_f32 v24, v24, v54, v55
    v_max3_f32 v24, v24, v56, v57
    v_max3_f32 v24, v24, v58, v59
    v_max3_f32 v24, v24, v60, v61
    v_max3_f32 v24, v24, v62, v63
    v_mov_b32 v25, v24
    s_nop 1
    v_permlane32_swap_b32 v24, v25
    v_max_f32 v24, v24, v25
    s_lshl_b32 s51, s40, 2
    v_add_u32 v25, s51, v1
    s_waitcnt lgkmcnt(0)
    s_barrier
    ds_write_b32 v25, v24 offset:30720
    s_waitcnt lgkmcnt(0)
    s_barrier
    ds_read_b128 v[24:27], v1 offset:30720
    s_waitcnt lgkmcnt(0)
    v_max3_f32 v24, v24, v25, v26
    v_max_f32 v24, v24, v27
    v_sub_f32 v208, 0, v24
    v_sub_f32 v209, 0, v24
    v_sub_f32 v210, 0, v24
    v_sub_f32 v211, 0, v24
    v_sub_f32 v212, 0, v24
    v_sub_f32 v213, 0, v24
    v_sub_f32 v214, 0, v24
    v_sub_f32 v215, 0, v24
    v_sub_f32 v216, 0, v24
    v_sub_f32 v217, 0, v24
    v_sub_f32 v218, 0, v24
    v_sub_f32 v219, 0, v24
    v_sub_f32 v220, 0, v24
    v_sub_f32 v221, 0, v24
    v_sub_f32 v222, 0, v24
    v_sub_f32 v223, 0, v24
    v_sub_f32 v224, 0, v24
    v_sub_f32 v225, 0, v24
    v_sub_f32 v226, 0, v24
    v_sub_f32 v227, 0, v24
    v_sub_f32 v228, 0, v24
    v_sub_f32 v229, 0, v24
    v_sub_f32 v230, 0, v24
    v_sub_f32 v231, 0, v24
    v_sub_f32 v232, 0, v24
    v_sub_f32 v233, 0, v24
    v_sub_f32 v234, 0, v24
    v_sub_f32 v235, 0, v24
    v_sub_f32 v236, 0, v24
    v_sub_f32 v237, 0, v24
    v_sub_f32 v238, 0, v24
    v_sub_f32 v239, 0, v24
    s_nop 1
    v_mfma_f32_32x32x4_2b_bf16 v[32:63], a[64:65], v[138:139], v[208:239]
    v_exp_f32 v69, v69
    v_exp_f32 v70, v70
    v_exp_f32 v71, v71
    v_exp_f32 v72, v72
    v_exp_f32 v73, v73
    v_exp_f32 v74, v74
    v_exp_f32 v75, v75
    v_exp_f32 v76, v76
    v_smfmac_f32_32x32x32_bf16 v[96:111], a[192:195], v[64:71], v2
    v_exp_f32 v77, v77
    v_exp_f32 v78, v78
    v_exp_f32 v79, v79
    v_exp_f32 v80, v80
    v_exp_f32 v81, v81
    v_smfmac_f32_32x32x32_bf16 v[96:111], a[196:199], v[72:79], v2
    v_exp_f32 v82, v82
    v_exp_f32 v83, v83
    v_exp_f32 v84, v84
    v_mfma_f32_32x32x16_bf16 v[32:47], a[0:3], v[134:137], v[32:47]
    v_exp_f32 v85, v85
    v_exp_f32 v86, v86
    v_exp_f32 v87, v87
    v_mfma_f32_32x32x16_bf16 v[48:63], a[4:7], v[134:137], v[48:63]
    v_exp_f32 v88, v88
    v_exp_f32 v89, v89
    v_exp_f32 v90, v90
    v_smfmac_f32_32x32x32_bf16 v[96:111], a[200:203], v[80:87], v2
    v_exp_f32 v91, v91
    v_exp_f32 v92, v92
    v_exp_f32 v93, v93
    v_exp_f32 v94, v94
    v_exp_f32 v95, v95
    v_exp_f32 v32, v32
    v_exp_f32 v33, v33
    v_smfmac_f32_32x32x32_bf16 v[96:111], a[204:207], v[88:95], v2
    v_exp_f32 v34, v34
    v_exp_f32 v35, v35
    v_exp_f32 v36, v36
    v_mfma_f32_32x32x4_2b_bf16 v[64:95], a[66:67], v[138:139], v[208:239]
    v_exp_f32 v37, v37
    v_exp_f32 v38, v38
    v_exp_f32 v39, v39
    v_exp_f32 v40, v40
    v_exp_f32 v41, v41
    v_exp_f32 v42, v42
    v_exp_f32 v43, v43
    v_exp_f32 v44, v44
    v_smfmac_f32_32x32x32_bf16 v[112:127], a[80:83], v[32:39], v2
    ds_write_b128 v6, v[96:99] offset:0
    v_exp_f32 v45, v45
    v_exp_f32 v46, v46
    v_exp_f32 v47, v47
    v_exp_f32 v48, v48
    v_exp_f32 v49, v49
    v_smfmac_f32_32x32x32_bf16 v[112:127], a[84:87], v[40:47], v2
    ds_write_b128 v6, v[100:103] offset:1024
    s_mov_b32 s45, 5120
    buffer_load_dwordx4 v[128:131], v11, s[16:19], s45 offen sc1
    buffer_load_dwordx2 v[132:133], v12, s[16:19], s45 offen offset:1024 sc1
    v_exp_f32 v50, v50
    v_exp_f32 v51, v51
    v_exp_f32 v52, v52
    v_mfma_f32_32x32x16_bf16 v[64:79], a[8:11], v[134:137], v[64:79]
    v_exp_f32 v53, v53
    v_exp_f32 v54, v54
    v_exp_f32 v55, v55
    v_mfma_f32_32x32x16_bf16 v[80:95], a[12:15], v[134:137], v[80:95]
    v_exp_f32 v56, v56
    v_exp_f32 v57, v57
    v_exp_f32 v58, v58
    v_smfmac_f32_32x32x32_bf16 v[112:127], a[88:91], v[48:55], v2
    ds_write_b128 v6, v[104:107] offset:2048
    v_exp_f32 v59, v59
    v_exp_f32 v60, v60
    v_exp_f32 v61, v61
    v_exp_f32 v62, v62
    v_exp_f32 v63, v63
    v_exp_f32 v64, v64
    v_exp_f32 v65, v65
    v_smfmac_f32_32x32x32_bf16 v[112:127], a[92:95], v[56:63], v2
    v_exp_f32 v66, v66
    v_exp_f32 v67, v67
    v_exp_f32 v68, v68
    v_mfma_f32_32x32x4_2b_bf16 v[32:63], a[68:69], v[138:139], v[208:239]
    v_exp_f32 v69, v69
    v_exp_f32 v70, v70
    v_exp_f32 v71, v71
    v_exp_f32 v72, v72
    v_exp_f32 v73, v73
    v_exp_f32 v74, v74
    v_exp_f32 v75, v75
    v_exp_f32 v76, v76
    v_smfmac_f32_32x32x32_bf16 v[112:127], a[96:99], v[64:71], v2
    s_waitcnt lgkmcnt(0)
    s_barrier
    v_exp_f32 v77, v77
    v_exp_f32 v78, v78
    v_exp_f32 v79, v79
    v_exp_f32 v80, v80
    v_exp_f32 v81, v81
    v_smfmac_f32_32x32x32_bf16 v[112:127], a[100:103], v[72:79], v2
    ds_read_b128 v[188:191], v7 offset:0
    v_exp_f32 v82, v82
    v_exp_f32 v83, v83
    v_exp_f32 v84, v84
    v_mfma_f32_32x32x16_bf16 v[32:47], a[16:19], v[134:137], v[32:47]
    ds_read_b128 v[192:195], v7 offset:3072
    v_exp_f32 v85, v85
    v_exp_f32 v86, v86
    v_exp_f32 v87, v87
    v_mfma_f32_32x32x16_bf16 v[48:63], a[20:23], v[134:137], v[48:63]
    ds_read_b128 v[196:199], v7 offset:6144
    v_exp_f32 v88, v88
    v_exp_f32 v89, v89
    v_exp_f32 v90, v90
    v_smfmac_f32_32x32x32_bf16 v[112:127], a[104:107], v[80:87], v2
    ds_read_b128 v[200:203], v7 offset:9216
    ds_read_b128 v[184:187], v1 offset:25600
    v_exp_f32 v91, v91
    v_exp_f32 v92, v92
    v_exp_f32 v93, v93
    v_mfma_f32_32x32x8_bf16 v[96:111], v[4:5], v[4:5], 0
    v_exp_f32 v94, v94
    v_exp_f32 v95, v95
    v_exp_f32 v32, v32
    v_exp_f32 v33, v33
    v_smfmac_f32_32x32x32_bf16 v[112:127], a[108:111], v[88:95], v2
    v_exp_f32 v34, v34
    v_exp_f32 v35, v35
    v_exp_f32 v36, v36
    v_mfma_f32_32x32x4_2b_bf16 v[64:95], a[70:71], v[138:139], v[208:239]
    s_waitcnt lgkmcnt(0)
    v_exp_f32 v37, v37
    v_add_f32 v188, v188, v192
    v_exp_f32 v38, v38
    v_add_f32 v189, v189, v193
    v_exp_f32 v39, v39
    v_add_f32 v190, v190, v194
    v_exp_f32 v40, v40
    v_add_f32 v191, v191, v195
    v_exp_f32 v41, v41
    v_add_f32 v196, v196, v200
    v_exp_f32 v42, v42
    v_add_f32 v197, v197, v201
    v_exp_f32 v43, v43
    v_add_f32 v198, v198, v202
    v_exp_f32 v44, v44
    v_add_f32 v199, v199, v203
    v_smfmac_f32_32x32x32_bf16 v[112:127], a[112:115], v[32:39], v2
    s_waitcnt vmcnt(12)
    v_exp_f32 v45, v45
    v_add_f32 v188, v188, v196
    v_exp_f32 v46, v46
    v_add_f32 v189, v189, v197
    v_exp_f32 v47, v47
    v_add_f32 v190, v190, v198
    v_smfmac_f32_16x16x64_bf16 v[140:143], v[184:187], a[240:247], v3
    buffer_load_dwordx4 a[240:243], v1, s[16:19], s50 offen offset:0 sc1
    buffer_load_dwordx4 a[244:247], v1, s[16:19], s50 offen offset:1024 sc1
    v_exp_f32 v48, v48
    v_rcp_f32_dpp v192, v188 quad_perm:[3,3,3,3] row_mask:0xf bank_mask:0xf
    v_exp_f32 v49, v49
    v_add_f32 v191, v191, v199
    v_smfmac_f32_32x32x32_bf16 v[112:127], a[116:119], v[40:47], v2
    v_exp_f32 v50, v50
    v_mul_f32 v188, v188, v192
    v_exp_f32 v51, v51
    v_mul_f32 v189, v189, v192
    v_exp_f32 v52, v52
    v_mul_f32 v190, v190, v192
    v_mfma_f32_32x32x16_bf16 v[64:79], a[24:27], v[134:137], v[64:79]
    v_exp_f32 v53, v53
    v_mul_f32 v191, v191, v192
    v_exp_f32 v54, v54
    v_cvt_pk_bf16_f32 v188, v188, v189
    v_exp_f32 v55, v55
    v_cvt_pk_bf16_f32 v189, v190, v191
    v_mfma_f32_32x32x16_bf16 v[80:95], a[28:31], v[134:137], v[80:95]
    v_exp_f32 v56, v56
    v_subrev_u32 v192, 528482304, v192
    v_exp_f32 v57, v57
    v_max_u32 v10, v10, v192
    v_exp_f32 v58, v58
    v_smfmac_f32_32x32x32_bf16 v[112:127], a[120:123], v[48:55], v2
    s_waitcnt vmcnt(12)
    ds_write2_b32 v8, v188, v189 offset0:0 offset1:32
    v_add_u32 v8, v9, v8
    v_exp_f32 v59, v59
    v_exp_f32 v60, v60
    v_exp_f32 v61, v61
    v_smfmac_f32_16x16x64_bf16 v[144:147], v[184:187], a[248:255], v3
    buffer_load_dwordx4 a[248:251], v1, s[16:19], s50 offen offset:2048 sc1
    buffer_load_dwordx4 a[252:255], v1, s[16:19], s50 offen offset:3072 sc1
    v_exp_f32 v62, v62
    v_exp_f32 v63, v63
    v_exp_f32 v64, v64
    v_exp_f32 v65, v65
    v_smfmac_f32_32x32x32_bf16 v[112:127], a[124:127], v[56:63], v2
    s_add_u32 s50, s49, 98304
    v_exp_f32 v66, v66
    v_exp_f32 v67, v67
    v_exp_f32 v68, v68
    v_mfma_f32_32x32x4_2b_bf16 v[32:63], a[72:73], v[138:139], v[208:239]
    v_exp_f32 v69, v69
    v_exp_f32 v70, v70
    v_exp_f32 v71, v71
    v_exp_f32 v72, v72
    v_exp_f32 v73, v73
    v_exp_f32 v74, v74
    v_exp_f32 v75, v75
    v_exp_f32 v76, v76
    v_smfmac_f32_32x32x32_bf16 v[112:127], a[128:131], v[64:71], v2
    s_waitcnt vmcnt(12)
    s_waitcnt lgkmcnt(0)
    s_barrier
    v_exp_f32 v77, v77
    v_exp_f32 v78, v78
    v_exp_f32 v79, v79
    v_smfmac_f32_16x16x64_bf16 v[148:151], v[184:187], a[208:215], v3
    buffer_load_dwordx4 a[208:211], v1, s[16:19], s50 offen offset:0 sc1
    buffer_load_dwordx4 a[212:215], v1, s[16:19], s50 offen offset:1024 sc1
    v_exp_f32 v80, v80
    v_exp_f32 v81, v81
    v_smfmac_f32_32x32x32_bf16 v[112:127], a[132:135], v[72:79], v2
    ds_read_b128 v[204:207], v1 offset:26624
    v_exp_f32 v82, v82
    v_exp_f32 v83, v83
    v_exp_f32 v84, v84
    v_mfma_f32_32x32x16_bf16 v[32:47], a[32:35], v[134:137], v[32:47]
    v_exp_f32 v85, v85
    v_exp_f32 v86, v86
    v_exp_f32 v87, v87
    v_mfma_f32_32x32x16_bf16 v[48:63], a[36:39], v[134:137], v[48:63]
    v_exp_f32 v88, v88
    v_exp_f32 v89, v89
    v_exp_f32 v90, v90
    v_smfmac_f32_32x32x32_bf16 v[112:127], a[136:139], v[80:87], v2
    s_waitcnt lgkmcnt(0)
    s_waitcnt vmcnt(12)
    v_exp_f32 v91, v91
    v_exp_f32 v92, v92
    v_exp_f32 v93, v93
    v_smfmac_f32_16x16x64_bf16 v[152:155], v[184:187], a[216:223], v3
    buffer_load_dwordx4 a[216:219], v1, s[16:19], s50 offen offset:2048 sc1
    buffer_load_dwordx4 a[220:223], v1, s[16:19], s50 offen offset:3072 sc1
    v_exp_f32 v94, v94
    v_exp_f32 v95, v95
    v_exp_f32 v32, v32
    v_exp_f32 v33, v33
    v_smfmac_f32_32x32x32_bf16 v[112:127], a[140:143], v[88:95], v2
    s_add_u32 s50, s49, 163840
    v_exp_f32 v34, v34
    v_exp_f32 v35, v35
    v_exp_f32 v36, v36
    v_mfma_f32_32x32x4_2b_bf16 v[64:95], a[74:75], v[138:139], v[208:239]
    v_exp_f32 v37, v37
    v_exp_f32 v38, v38
    v_exp_f32 v39, v39
    v_exp_f32 v40, v40
    v_exp_f32 v41, v41
    v_exp_f32 v42, v42
    v_exp_f32 v43, v43
    v_exp_f32 v44, v44
    v_smfmac_f32_32x32x32_bf16 v[112:127], a[144:147], v[32:39], v2
    s_waitcnt vmcnt(12)
    v_exp_f32 v45, v45
    v_exp_f32 v46, v46
    v_exp_f32 v47, v47
    v_smfmac_f32_16x16x64_bf16 v[156:159], v[184:187], a[224:231], v3
    buffer_load_dwordx4 a[224:227], v1, s[16:19], s50 offen offset:0 sc1
    buffer_load_dwordx4 a[228:231], v1, s[16:19], s50 offen offset:1024 sc1
    v_exp_f32 v48, v48
    v_exp_f32 v49, v49
    v_smfmac_f32_32x32x32_bf16 v[112:127], a[148:151], v[40:47], v2
    v_exp_f32 v50, v50
    v_exp_f32 v51, v51
    v_exp_f32 v52, v52
    v_mfma_f32_32x32x16_bf16 v[64:79], a[40:43], v[134:137], v[64:79]
    v_exp_f32 v53, v53
    v_exp_f32 v54, v54
    v_exp_f32 v55, v55
    v_mfma_f32_32x32x16_bf16 v[80:95], a[44:47], v[134:137], v[80:95]
    v_exp_f32 v56, v56
    v_exp_f32 v57, v57
    v_exp_f32 v58, v58
    v_smfmac_f32_32x32x32_bf16 v[112:127], a[152:155], v[48:55], v2
    s_waitcnt vmcnt(12)
    v_exp_f32 v59, v59
    v_exp_f32 v60, v60
    v_exp_f32 v61, v61
    v_smfmac_f32_16x16x64_bf16 v[160:163], v[184:187], a[232:239], v3
    buffer_load_dwordx4 a[232:235], v1, s[16:19], s50 offen offset:2048 sc1
    buffer_load_dwordx4 a[236:239], v1, s[16:19], s50 offen offset:3072 sc1
    v_exp_f32 v62, v62
    v_exp_f32 v63, v63
    v_exp_f32 v64, v64
    v_exp_f32 v65, v65
    v_smfmac_f32_32x32x32_bf16 v[112:127], a[156:159], v[56:63], v2
    s_add_u32 s50, s49, 167936
    v_exp_f32 v66, v66
    v_exp_f32 v67, v67
    v_exp_f32 v68, v68
    v_mfma_f32_32x32x4_2b_bf16 v[32:63], a[76:77], v[138:139], v[208:239]
    v_exp_f32 v69, v69
    v_exp_f32 v70, v70
    v_exp_f32 v71, v71
    v_exp_f32 v72, v72
    v_exp_f32 v73, v73
    v_exp_f32 v74, v74
    v_exp_f32 v75, v75
    v_exp_f32 v76, v76
    v_smfmac_f32_32x32x32_bf16 v[112:127], a[160:163], v[64:71], v2
    s_waitcnt vmcnt(10)
    v_exp_f32 v77, v77
    v_exp_f32 v78, v78
    v_exp_f32 v79, v79
    v_smfmac_f32_16x16x64_bf16 v[164:167], v[184:187], a[240:247], v3
    buffer_load_dwordx4 a[240:243], v1, s[16:19], s50 offen offset:0 sc1
    buffer_load_dwordx4 a[244:247], v1, s[16:19], s50 offen offset:1024 sc1
    v_exp_f32 v80, v80
    v_exp_f32 v81, v81
    v_smfmac_f32_32x32x32_bf16 v[112:127], a[164:167], v[72:79], v2
    v_exp_f32 v82, v82
    v_exp_f32 v83, v83
    v_exp_f32 v84, v84
    v_mfma_f32_32x32x16_bf16 v[32:47], a[48:51], v[134:137], v[32:47]
    v_exp_f32 v85, v85
    v_exp_f32 v86, v86
    v_exp_f32 v87, v87
    v_mfma_f32_32x32x16_bf16 v[48:63], a[52:55], v[134:137], v[48:63]
    v_exp_f32 v88, v88
    v_exp_f32 v89, v89
    v_exp_f32 v90, v90
    v_smfmac_f32_32x32x32_bf16 v[112:127], a[168:171], v[80:87], v2
    s_waitcnt vmcnt(10)
    v_exp_f32 v91, v91
    v_exp_f32 v92, v92
    v_exp_f32 v93, v93
    v_smfmac_f32_16x16x64_bf16 v[168:171], v[184:187], a[248:255], v3
    buffer_load_dwordx4 a[248:251], v1, s[16:19], s50 offen offset:2048 sc1
    buffer_load_dwordx4 a[252:255], v1, s[16:19], s50 offen offset:3072 sc1
    v_exp_f32 v94, v94
    v_exp_f32 v95, v95
    v_exp_f32 v32, v32
    v_exp_f32 v33, v33
    v_smfmac_f32_32x32x32_bf16 v[112:127], a[172:175], v[88:95], v2
    s_add_u32 s50, s49, 172032
    v_exp_f32 v34, v34
    v_exp_f32 v35, v35
    v_exp_f32 v36, v36
    v_mfma_f32_32x32x4_2b_bf16 v[64:95], a[78:79], v[138:139], v[208:239]
    v_exp_f32 v37, v37
    v_exp_f32 v38, v38
    v_exp_f32 v39, v39
    v_exp_f32 v40, v40
    v_exp_f32 v41, v41
    v_exp_f32 v42, v42
    v_exp_f32 v43, v43
    v_exp_f32 v44, v44
    v_smfmac_f32_32x32x32_bf16 v[112:127], a[176:179], v[32:39], v2
    s_waitcnt vmcnt(10)
    v_exp_f32 v45, v45
    v_exp_f32 v46, v46
    v_exp_f32 v47, v47
    v_smfmac_f32_16x16x64_bf16 v[172:175], v[184:187], a[208:215], v3
    buffer_load_dwordx4 a[208:211], v1, s[16:19], s50 offen offset:0 sc1
    buffer_load_dwordx4 a[212:215], v1, s[16:19], s50 offen offset:1024 sc1
    v_exp_f32 v48, v48
    v_exp_f32 v49, v49
    v_smfmac_f32_32x32x32_bf16 v[112:127], a[180:183], v[40:47], v2
    v_exp_f32 v50, v50
    v_exp_f32 v51, v51
    v_exp_f32 v52, v52
    v_mfma_f32_32x32x16_bf16 v[64:79], a[56:59], v[134:137], v[64:79]
    v_exp_f32 v53, v53
    v_exp_f32 v54, v54
    v_exp_f32 v55, v55
    v_mfma_f32_32x32x16_bf16 v[80:95], a[60:63], v[134:137], v[80:95]
    v_exp_f32 v56, v56
    v_exp_f32 v57, v57
    v_exp_f32 v58, v58
    v_smfmac_f32_32x32x32_bf16 v[112:127], a[184:187], v[48:55], v2
    s_waitcnt vmcnt(10)
    v_exp_f32 v59, v59
    v_exp_f32 v60, v60
    v_exp_f32 v61, v61
    v_smfmac_f32_16x16x64_bf16 v[176:179], v[184:187], a[216:223], v3
    buffer_load_dwordx4 a[216:219], v1, s[16:19], s50 offen offset:2048 sc1
    buffer_load_dwordx4 a[220:223], v1, s[16:19], s50 offen offset:3072 sc1
    v_exp_f32 v62, v62
    v_exp_f32 v63, v63
    v_exp_f32 v64, v64
    v_exp_f32 v65, v65
    v_smfmac_f32_32x32x32_bf16 v[112:127], a[188:191], v[56:63], v2
    s_add_u32 s50, s49, 176128
    v_exp_f32 v66, v66
    v_exp_f32 v67, v67
    v_exp_f32 v68, v68
    v_mfma_f32_32x32x4_2b_bf16 v[32:63], a[64:65], v[132:133], 0
    s_nop 15
    s_nop 1
    v_mfma_f32_32x32x16_bf16 v[32:47], a[0:3], v[128:131], v[32:47]
    v_mfma_f32_32x32x16_bf16 v[48:63], a[4:7], v[128:131], v[48:63]
    s_nop 10
    v_mov_b32 v24, v32
    v_max3_f32 v24, v24, v32, v33
    v_max3_f32 v24, v24, v34, v35
    v_max3_f32 v24, v24, v36, v37
    v_max3_f32 v24, v24, v38, v39
    v_max3_f32 v24, v24, v40, v41
    v_max3_f32 v24, v24, v42, v43
    v_max3_f32 v24, v24, v44, v45
    v_max3_f32 v24, v24, v46, v47
    v_max3_f32 v24, v24, v48, v49
    v_max3_f32 v24, v24, v50, v51
    v_max3_f32 v24, v24, v52, v53
    v_max3_f32 v24, v24, v54, v55
    v_max3_f32 v24, v24, v56, v57
    v_max3_f32 v24, v24, v58, v59
    v_max3_f32 v24, v24, v60, v61
    v_max3_f32 v24, v24, v62, v63
    v_mfma_f32_32x32x4_2b_bf16 v[32:63], a[66:67], v[132:133], 0
    s_nop 15
    s_nop 1
    v_mfma_f32_32x32x16_bf16 v[32:47], a[8:11], v[128:131], v[32:47]
    v_mfma_f32_32x32x16_bf16 v[48:63], a[12:15], v[128:131], v[48:63]
    s_nop 10
    v_max3_f32 v24, v24, v32, v33
    v_max3_f32 v24, v24, v34, v35
    v_max3_f32 v24, v24, v36, v37
    v_max3_f32 v24, v24, v38, v39
    v_max3_f32 v24, v24, v40, v41
    v_max3_f32 v24, v24, v42, v43
    v_max3_f32 v24, v24, v44, v45
    v_max3_f32 v24, v24, v46, v47
    v_max3_f32 v24, v24, v48, v49
    v_max3_f32 v24, v24, v50, v51
    v_max3_f32 v24, v24, v52, v53
    v_max3_f32 v24, v24, v54, v55
    v_max3_f32 v24, v24, v56, v57
    v_max3_f32 v24, v24, v58, v59
    v_max3_f32 v24, v24, v60, v61
    v_max3_f32 v24, v24, v62, v63
    v_mfma_f32_32x32x4_2b_bf16 v[32:63], a[68:69], v[132:133], 0
    s_nop 15
    s_nop 1
    v_mfma_f32_32x32x16_bf16 v[32:47], a[16:19], v[128:131], v[32:47]
    v_mfma_f32_32x32x16_bf16 v[48:63], a[20:23], v[128:131], v[48:63]
    s_nop 10
    v_max3_f32 v24, v24, v32, v33
    v_max3_f32 v24, v24, v34, v35
    v_max3_f32 v24, v24, v36, v37
    v_max3_f32 v24, v24, v38, v39
    v_max3_f32 v24, v24, v40, v41
    v_max3_f32 v24, v24, v42, v43
    v_max3_f32 v24, v24, v44, v45
    v_max3_f32 v24, v24, v46, v47
    v_max3_f32 v24, v24, v48, v49
    v_max3_f32 v24, v24, v50, v51
    v_max3_f32 v24, v24, v52, v53
    v_max3_f32 v24, v24, v54, v55
    v_max3_f32 v24, v24, v56, v57
    v_max3_f32 v24, v24, v58, v59
    v_max3_f32 v24, v24, v60, v61
    v_max3_f32 v24, v24, v62, v63
    v_mfma_f32_32x32x4_2b_bf16 v[32:63], a[70:71], v[132:133], 0
    s_nop 15
    s_nop 1
    v_mfma_f32_32x32x16_bf16 v[32:47], a[24:27], v[128:131], v[32:47]
    v_mfma_f32_32x32x16_bf16 v[48:63], a[28:31], v[128:131], v[48:63]
    s_nop 10
    v_max3_f32 v24, v24, v32, v33
    v_max3_f32 v24, v24, v34, v35
    v_max3_f32 v24, v24, v36, v37
    v_max3_f32 v24, v24, v38, v39
    v_max3_f32 v24, v24, v40, v41
    v_max3_f32 v24, v24, v42, v43
    v_max3_f32 v24, v24, v44, v45
    v_max3_f32 v24, v24, v46, v47
    v_max3_f32 v24, v24, v48, v49
    v_max3_f32 v24, v24, v50, v51
    v_max3_f32 v24, v24, v52, v53
    v_max3_f32 v24, v24, v54, v55
    v_max3_f32 v24, v24, v56, v57
    v_max3_f32 v24, v24, v58, v59
    v_max3_f32 v24, v24, v60, v61
    v_max3_f32 v24, v24, v62, v63
    v_mfma_f32_32x32x4_2b_bf16 v[32:63], a[72:73], v[132:133], 0
    s_nop 15
    s_nop 1
    v_mfma_f32_32x32x16_bf16 v[32:47], a[32:35], v[128:131], v[32:47]
    v_mfma_f32_32x32x16_bf16 v[48:63], a[36:39], v[128:131], v[48:63]
    s_nop 10
    v_max3_f32 v24, v24, v32, v33
    v_max3_f32 v24, v24, v34, v35
    v_max3_f32 v24, v24, v36, v37
    v_max3_f32 v24, v24, v38, v39
    v_max3_f32 v24, v24, v40, v41
    v_max3_f32 v24, v24, v42, v43
    v_max3_f32 v24, v24, v44, v45
    v_max3_f32 v24, v24, v46, v47
    v_max3_f32 v24, v24, v48, v49
    v_max3_f32 v24, v24, v50, v51
    v_max3_f32 v24, v24, v52, v53
    v_max3_f32 v24, v24, v54, v55
    v_max3_f32 v24, v24, v56, v57
    v_max3_f32 v24, v24, v58, v59
    v_max3_f32 v24, v24, v60, v61
    v_max3_f32 v24, v24, v62, v63
    v_mfma_f32_32x32x4_2b_bf16 v[32:63], a[74:75], v[132:133], 0
    s_nop 15
    s_nop 1
    v_mfma_f32_32x32x16_bf16 v[32:47], a[40:43], v[128:131], v[32:47]
    v_mfma_f32_32x32x16_bf16 v[48:63], a[44:47], v[128:131], v[48:63]
    s_nop 10
    v_max3_f32 v24, v24, v32, v33
    v_max3_f32 v24, v24, v34, v35
    v_max3_f32 v24, v24, v36, v37
    v_max3_f32 v24, v24, v38, v39
    v_max3_f32 v24, v24, v40, v41
    v_max3_f32 v24, v24, v42, v43
    v_max3_f32 v24, v24, v44, v45
    v_max3_f32 v24, v24, v46, v47
    v_max3_f32 v24, v24, v48, v49
    v_max3_f32 v24, v24, v50, v51
    v_max3_f32 v24, v24, v52, v53
    v_max3_f32 v24, v24, v54, v55
    v_max3_f32 v24, v24, v56, v57
    v_max3_f32 v24, v24, v58, v59
    v_max3_f32 v24, v24, v60, v61
    v_max3_f32 v24, v24, v62, v63
    v_mfma_f32_32x32x4_2b_bf16 v[32:63], a[76:77], v[132:133], 0
    s_nop 15
    s_nop 1
    v_mfma_f32_32x32x16_bf16 v[32:47], a[48:51], v[128:131], v[32:47]
    v_mfma_f32_32x32x16_bf16 v[48:63], a[52:55], v[128:131], v[48:63]
    s_nop 10
    v_max3_f32 v24, v24, v32, v33
    v_max3_f32 v24, v24, v34, v35
    v_max3_f32 v24, v24, v36, v37
    v_max3_f32 v24, v24, v38, v39
    v_max3_f32 v24, v24, v40, v41
    v_max3_f32 v24, v24, v42, v43
    v_max3_f32 v24, v24, v44, v45
    v_max3_f32 v24, v24, v46, v47
    v_max3_f32 v24, v24, v48, v49
    v_max3_f32 v24, v24, v50, v51
    v_max3_f32 v24, v24, v52, v53
    v_max3_f32 v24, v24, v54, v55
    v_max3_f32 v24, v24, v56, v57
    v_max3_f32 v24, v24, v58, v59
    v_max3_f32 v24, v24, v60, v61
    v_max3_f32 v24, v24, v62, v63
    v_mfma_f32_32x32x4_2b_bf16 v[32:63], a[78:79], v[132:133], 0
    s_nop 15
    s_nop 1
    v_mfma_f32_32x32x16_bf16 v[32:47], a[56:59], v[128:131], v[32:47]
    v_mfma_f32_32x32x16_bf16 v[48:63], a[60:63], v[128:131], v[48:63]
    s_nop 10
    v_max3_f32 v24, v24, v32, v33
    v_max3_f32 v24, v24, v34, v35
    v_max3_f32 v24, v24, v36, v37
    v_max3_f32 v24, v24, v38, v39
    v_max3_f32 v24, v24, v40, v41
    v_max3_f32 v24, v24, v42, v43
    v_max3_f32 v24, v24, v44, v45
    v_max3_f32 v24, v24, v46, v47
    v_max3_f32 v24, v24, v48, v49
    v_max3_f32 v24, v24, v50, v51
    v_max3_f32 v24, v24, v52, v53
    v_max3_f32 v24, v24, v54, v55
    v_max3_f32 v24, v24, v56, v57
    v_max3_f32 v24, v24, v58, v59
    v_max3_f32 v24, v24, v60, v61
    v_max3_f32 v24, v24, v62, v63
    v_mov_b32 v25, v24
    s_nop 1
    v_permlane32_swap_b32 v24, v25
    v_max_f32 v24, v24, v25
    s_lshl_b32 s51, s40, 2
    v_add_u32 v25, s51, v1
    s_barrier
    ds_write_b32 v25, v24 offset:30720
    s_waitcnt lgkmcnt(0)
    s_barrier
    ds_read_b128 v[24:27], v1 offset:30720
    s_waitcnt lgkmcnt(0)
    v_max3_f32 v24, v24, v25, v26
    v_max_f32 v24, v24, v27
    v_sub_f32 v208, 0, v24
    v_sub_f32 v209, 0, v24
    v_sub_f32 v210, 0, v24
    v_sub_f32 v211, 0, v24
    v_sub_f32 v212, 0, v24
    v_sub_f32 v213, 0, v24
    v_sub_f32 v214, 0, v24
    v_sub_f32 v215, 0, v24
    v_sub_f32 v216, 0, v24
    v_sub_f32 v217, 0, v24
    v_sub_f32 v218, 0, v24
    v_sub_f32 v219, 0, v24
    v_sub_f32 v220, 0, v24
    v_sub_f32 v221, 0, v24
    v_sub_f32 v222, 0, v24
    v_sub_f32 v223, 0, v24
    v_sub_f32 v224, 0, v24
    v_sub_f32 v225, 0, v24
    v_sub_f32 v226, 0, v24
    v_sub_f32 v227, 0, v24
    v_sub_f32 v228, 0, v24
    v_sub_f32 v229, 0, v24
    v_sub_f32 v230, 0, v24
    v_sub_f32 v231, 0, v24
    v_sub_f32 v232, 0, v24
    v_sub_f32 v233, 0, v24
    v_sub_f32 v234, 0, v24
    v_sub_f32 v235, 0, v24
    v_sub_f32 v236, 0, v24
    v_sub_f32 v237, 0, v24
    v_sub_f32 v238, 0, v24
    v_sub_f32 v239, 0, v24
    s_nop 1
    v_mfma_f32_32x32x4_2b_bf16 v[32:63], a[64:65], v[132:133], v[208:239]
    v_exp_f32 v69, v69
    v_exp_f32 v70, v70
    v_exp_f32 v71, v71
    v_exp_f32 v72, v72
    v_exp_f32 v73, v73
    v_exp_f32 v74, v74
    v_exp_f32 v75, v75
    v_exp_f32 v76, v76
    v_smfmac_f32_32x32x32_bf16 v[112:127], a[192:195], v[64:71], v2
    s_waitcnt vmcnt(10)
    v_exp_f32 v77, v77
    v_exp_f32 v78, v78
    v_exp_f32 v79, v79
    v_smfmac_f32_16x16x64_bf16 v[140:143], v[204:207], a[224:231], v3
    buffer_load_dwordx4 a[224:227], v1, s[16:19], s50 offen offset:0 sc1
    buffer_load_dwordx4 a[228:231], v1, s[16:19], s50 offen offset:1024 sc1
    v_exp_f32 v80, v80
    v_exp_f32 v81, v81
    v_smfmac_f32_32x32x32_bf16 v[112:127], a[196:199], v[72:79], v2
    v_exp_f32 v82, v82
    v_exp_f32 v83, v83
    v_exp_f32 v84, v84
    v_mfma_f32_32x32x16_bf16 v[32:47], a[0:3], v[128:131], v[32:47]
    v_exp_f32 v85, v85
    v_exp_f32 v86, v86
    v_exp_f32 v87, v87
    v_mfma_f32_32x32x16_bf16 v[48:63], a[4:7], v[128:131], v[48:63]
    v_exp_f32 v88, v88
    v_exp_f32 v89, v89
    v_exp_f32 v90, v90
    v_smfmac_f32_32x32x32_bf16 v[112:127], a[200:203], v[80:87], v2
    s_waitcnt vmcnt(10)
    v_exp_f32 v91, v91
    v_exp_f32 v92, v92
    v_exp_f32 v93, v93
    v_smfmac_f32_16x16x64_bf16 v[144:147], v[204:207], a[232:239], v3
    buffer_load_dwordx4 a[232:235], v1, s[16:19], s50 offen offset:2048 sc1
    buffer_load_dwordx4 a[236:239], v1, s[16:19], s50 offen offset:3072 sc1
    v_exp_f32 v94, v94
    v_exp_f32 v95, v95
    v_exp_f32 v32, v32
    v_exp_f32 v33, v33
    v_smfmac_f32_32x32x32_bf16 v[112:127], a[204:207], v[88:95], v2
    s_add_u32 s50, s49, 180224
    v_exp_f32 v34, v34
    v_exp_f32 v35, v35
    v_exp_f32 v36, v36
    v_mfma_f32_32x32x4_2b_bf16 v[64:95], a[66:67], v[132:133], v[208:239]
    v_exp_f32 v37, v37
    v_exp_f32 v38, v38
    v_exp_f32 v39, v39
    v_exp_f32 v40, v40
    v_exp_f32 v41, v41
    v_exp_f32 v42, v42
    v_exp_f32 v43, v43
    v_exp_f32 v44, v44
    v_smfmac_f32_32x32x32_bf16 v[96:111], a[80:83], v[32:39], v2
    s_waitcnt vmcnt(10)
    ds_write_b128 v6, v[112:115] offset:12288
    v_exp_f32 v45, v45
    v_exp_f32 v46, v46
    v_exp_f32 v47, v47
    v_smfmac_f32_16x16x64_bf16 v[148:151], v[204:207], a[240:247], v3
    buffer_load_dwordx4 a[240:243], v1, s[16:19], s50 offen offset:0 sc1
    buffer_load_dwordx4 a[244:247], v1, s[16:19], s50 offen offset:1024 sc1
    s_mov_b32 s45, 6400
    buffer_load_dwordx4 v[134:137], v11, s[16:19], s45 offen sc1
    buffer_load_dwordx2 v[138:139], v12, s[16:19], s45 offen offset:1024 sc1
    v_exp_f32 v48, v48
    v_exp_f32 v49, v49
    v_smfmac_f32_32x32x32_bf16 v[96:111], a[84:87], v[40:47], v2
    ds_write_b128 v6, v[116:119] offset:13312
    v_exp_f32 v50, v50
    v_exp_f32 v51, v51
    v_exp_f32 v52, v52
    v_mfma_f32_32x32x16_bf16 v[64:79], a[8:11], v[128:131], v[64:79]
    v_exp_f32 v53, v53
    v_exp_f32 v54, v54
    v_exp_f32 v55, v55
    v_mfma_f32_32x32x16_bf16 v[80:95], a[12:15], v[128:131], v[80:95]
    v_exp_f32 v56, v56
    v_exp_f32 v57, v57
    v_exp_f32 v58, v58
    v_smfmac_f32_32x32x32_bf16 v[96:111], a[88:91], v[48:55], v2
    s_waitcnt vmcnt(12)
    ds_write_b128 v6, v[120:123] offset:14336
    v_exp_f32 v59, v59
    v_exp_f32 v60, v60
    v_exp_f32 v61, v61
    v_smfmac_f32_16x16x64_bf16 v[152:155], v[204:207], a[248:255], v3
    buffer_load_dwordx4 a[248:251], v1, s[16:19], s50 offen offset:2048 sc1
    buffer_load_dwordx4 a[252:255], v1, s[16:19], s50 offen offset:3072 sc1
    v_exp_f32 v62, v62
    v_exp_f32 v63, v63
    v_exp_f32 v64, v64
    v_exp_f32 v65, v65
    v_smfmac_f32_32x32x32_bf16 v[96:111], a[92:95], v[56:63], v2
    s_add_u32 s50, s49, 245760
    v_exp_f32 v66, v66
    v_exp_f32 v67, v67
    v_exp_f32 v68, v68
    v_mfma_f32_32x32x4_2b_bf16 v[32:63], a[68:69], v[132:133], v[208:239]
    v_exp_f32 v69, v69
    v_exp_f32 v70, v70
    v_exp_f32 v71, v71
    v_exp_f32 v72, v72
    v_exp_f32 v73, v73
    v_exp_f32 v74, v74
    v_exp_f32 v75, v75
    v_exp_f32 v76, v76
    v_smfmac_f32_32x32x32_bf16 v[96:111], a[96:99], v[64:71], v2
    s_waitcnt vmcnt(12)
    s_waitcnt lgkmcnt(0)
    s_barrier
    v_exp_f32 v77, v77
    v_exp_f32 v78, v78
    v_exp_f32 v79, v79
    v_smfmac_f32_16x16x64_bf16 v[156:159], v[204:207], a[208:215], v3
    buffer_load_dwordx4 a[208:211], v1, s[16:19], s50 offen offset:0 sc1
    buffer_load_dwordx4 a[212:215], v1, s[16:19], s50 offen offset:1024 sc1
    v_exp_f32 v80, v80
    v_exp_f32 v81, v81
    v_smfmac_f32_32x32x32_bf16 v[96:111], a[100:103], v[72:79], v2
    ds_read_b128 v[188:191], v7 offset:12288
    v_exp_f32 v82, v82
    v_exp_f32 v83, v83
    v_exp_f32 v84, v84
    v_mfma_f32_32x32x16_bf16 v[32:47], a[16:19], v[128:131], v[32:47]
    ds_read_b128 v[192:195], v7 offset:15360
    v_exp_f32 v85, v85
    v_exp_f32 v86, v86
    v_exp_f32 v87, v87
    v_mfma_f32_32x32x16_bf16 v[48:63], a[20:23], v[128:131], v[48:63]
    ds_read_b128 v[196:199], v7 offset:18432
    v_exp_f32 v88, v88
    v_exp_f32 v89, v89
    v_exp_f32 v90, v90
    v_smfmac_f32_32x32x32_bf16 v[96:111], a[104:107], v[80:87], v2
    ds_read_b128 v[200:203], v7 offset:21504
    v_exp_f32 v91, v91
    v_exp_f32 v92, v92
    v_exp_f32 v93, v93
    v_mfma_f32_32x32x8_bf16 v[112:127], v[4:5], v[4:5], 0
    v_exp_f32 v94, v94
    v_exp_f32 v95, v95
    v_exp_f32 v32, v32
    v_exp_f32 v33, v33
    v_smfmac_f32_32x32x32_bf16 v[96:111], a[108:111], v[88:95], v2
    v_exp_f32 v34, v34
    v_exp_f32 v35, v35
    v_exp_f32 v36, v36
    v_mfma_f32_32x32x4_2b_bf16 v[64:95], a[70:71], v[132:133], v[208:239]
    s_waitcnt lgkmcnt(0)
    v_exp_f32 v37, v37
    v_add_f32 v188, v188, v192
    v_exp_f32 v38, v38
    v_add_f32 v189, v189, v193
    v_exp_f32 v39, v39
    v_add_f32 v190, v190, v194
    v_exp_f32 v40, v40
    v_add_f32 v191, v191, v195
    v_exp_f32 v41, v41
    v_add_f32 v196, v196, v200
    v_exp_f32 v42, v42
    v_add_f32 v197, v197, v201
    v_exp_f32 v43, v43
    v_add_f32 v198, v198, v202
    v_exp_f32 v44, v44
    v_add_f32 v199, v199, v203
    v_smfmac_f32_32x32x32_bf16 v[96:111], a[112:115], v[32:39], v2
    s_waitcnt vmcnt(12)
    v_exp_f32 v45, v45
    v_add_f32 v188, v188, v196
    v_exp_f32 v46, v46
    v_add_f32 v189, v189, v197
    v_exp_f32 v47, v47
    v_add_f32 v190, v190, v198
    v_smfmac_f32_16x16x64_bf16 v[160:163], v[204:207], a[216:223], v3
    buffer_load_dwordx4 a[216:219], v1, s[16:19], s50 offen offset:2048 sc1
    buffer_load_dwordx4 a[220:223], v1, s[16:19], s50 offen offset:3072 sc1
    v_exp_f32 v48, v48
    v_rcp_f32_dpp v192, v188 quad_perm:[3,3,3,3] row_mask:0xf bank_mask:0xf
    v_exp_f32 v49, v49
    v_add_f32 v191, v191, v199
    v_smfmac_f32_32x32x32_bf16 v[96:111], a[116:119], v[40:47], v2
    s_add_u32 s50, s49, 249856
    v_exp_f32 v50, v50
    v_mul_f32 v188, v188, v192
    v_exp_f32 v51, v51
    v_mul_f32 v189, v189, v192
    v_exp_f32 v52, v52
    v_mul_f32 v190, v190, v192
    v_mfma_f32_32x32x16_bf16 v[64:79], a[24:27], v[128:131], v[64:79]
    v_exp_f32 v53, v53
    v_mul_f32 v191, v191, v192
    v_exp_f32 v54, v54
    v_cvt_pk_bf16_f32 v188, v188, v189
    v_exp_f32 v55, v55
    v_cvt_pk_bf16_f32 v189, v190, v191
    v_mfma_f32_32x32x16_bf16 v[80:95], a[28:31], v[128:131], v[80:95]
    v_exp_f32 v56, v56
    v_subrev_u32 v192, 528482304, v192
    v_exp_f32 v57, v57
    v_max_u32 v10, v10, v192
    v_exp_f32 v58, v58
    v_smfmac_f32_32x32x32_bf16 v[96:111], a[120:123], v[48:55], v2
    s_waitcnt vmcnt(12)
    ds_write2_b32 v8, v188, v189 offset0:0 offset1:32
    v_mad_i32_i24 v8, v9, -3, v8
    v_exp_f32 v59, v59
    v_exp_f32 v60, v60
    v_exp_f32 v61, v61
    v_smfmac_f32_16x16x64_bf16 v[164:167], v[204:207], a[224:231], v3
    buffer_load_dwordx4 a[224:227], v1, s[16:19], s50 offen offset:0 sc1
    buffer_load_dwordx4 a[228:231], v1, s[16:19], s50 offen offset:1024 sc1
    v_exp_f32 v62, v62
    v_exp_f32 v63, v63
    v_exp_f32 v64, v64
    v_exp_f32 v65, v65
    v_smfmac_f32_32x32x32_bf16 v[96:111], a[124:127], v[56:63], v2
    v_exp_f32 v66, v66
    v_exp_f32 v67, v67
    v_exp_f32 v68, v68
    v_mfma_f32_32x32x4_2b_bf16 v[32:63], a[72:73], v[132:133], v[208:239]
    v_exp_f32 v69, v69
    v_exp_f32 v70, v70
    v_exp_f32 v71, v71
    v_exp_f32 v72, v72
    v_exp_f32 v73, v73
    v_exp_f32 v74, v74
    v_exp_f32 v75, v75
    v_exp_f32 v76, v76
    v_smfmac_f32_32x32x32_bf16 v[96:111], a[128:131], v[64:71], v2
    s_waitcnt vmcnt(12)
    s_waitcnt lgkmcnt(0)
    s_barrier
    v_exp_f32 v77, v77
    v_exp_f32 v78, v78
    v_exp_f32 v79, v79
    v_smfmac_f32_16x16x64_bf16 v[168:171], v[204:207], a[232:239], v3
    buffer_load_dwordx4 a[232:235], v1, s[16:19], s50 offen offset:2048 sc1
    buffer_load_dwordx4 a[236:239], v1, s[16:19], s50 offen offset:3072 sc1
    v_exp_f32 v80, v80
    v_exp_f32 v81, v81
    v_smfmac_f32_32x32x32_bf16 v[96:111], a[132:135], v[72:79], v2
    s_add_u32 s50, s49, 253952
    ds_read_b128 v[180:183], v1 offset:27648
    ds_read_b128 v[184:187], v1 offset:28672
    v_exp_f32 v82, v82
    v_exp_f32 v83, v83
    v_exp_f32 v84, v84
    v_mfma_f32_32x32x16_bf16 v[32:47], a[32:35], v[128:131], v[32:47]
    v_exp_f32 v85, v85
    v_exp_f32 v86, v86
    v_exp_f32 v87, v87
    v_mfma_f32_32x32x16_bf16 v[48:63], a[36:39], v[128:131], v[48:63]
    v_exp_f32 v88, v88
    v_exp_f32 v89, v89
    v_exp_f32 v90, v90
    v_smfmac_f32_32x32x32_bf16 v[96:111], a[136:139], v[80:87], v2
    s_waitcnt lgkmcnt(0)
    s_waitcnt vmcnt(12)
    v_exp_f32 v91, v91
    v_exp_f32 v92, v92
    v_exp_f32 v93, v93
    v_smfmac_f32_16x16x64_bf16 v[172:175], v[204:207], a[240:247], v3
    buffer_load_dwordx4 a[240:243], v1, s[16:19], s50 offen offset:0 sc1
    buffer_load_dwordx4 a[244:247], v1, s[16:19], s50 offen offset:1024 sc1
    v_exp_f32 v94, v94
    v_exp_f32 v95, v95
    v_exp_f32 v32, v32
    v_exp_f32 v33, v33
    v_smfmac_f32_32x32x32_bf16 v[96:111], a[140:143], v[88:95], v2
    v_exp_f32 v34, v34
    v_exp_f32 v35, v35
    v_exp_f32 v36, v36
    v_mfma_f32_32x32x4_2b_bf16 v[64:95], a[74:75], v[132:133], v[208:239]
    v_exp_f32 v37, v37
    v_exp_f32 v38, v38
    v_exp_f32 v39, v39
    v_exp_f32 v40, v40
    v_exp_f32 v41, v41
    v_exp_f32 v42, v42
    v_exp_f32 v43, v43
    v_exp_f32 v44, v44
    v_smfmac_f32_32x32x32_bf16 v[96:111], a[144:147], v[32:39], v2
    s_waitcnt vmcnt(10)
    v_exp_f32 v45, v45
    v_exp_f32 v46, v46
    v_exp_f32 v47, v47
    v_smfmac_f32_16x16x64_bf16 v[176:179], v[204:207], a[248:255], v3
    buffer_load_dwordx4 a[248:251], v1, s[16:19], s50 offen offset:2048 sc1
    buffer_load_dwordx4 a[252:255], v1, s[16:19], s50 offen offset:3072 sc1
    v_exp_f32 v48, v48
    v_exp_f32 v49, v49
    v_smfmac_f32_32x32x32_bf16 v[96:111], a[148:151], v[40:47], v2
    s_add_u32 s50, s49, 258048
    v_exp_f32 v50, v50
    v_exp_f32 v51, v51
    v_exp_f32 v52, v52
    v_mfma_f32_32x32x16_bf16 v[64:79], a[40:43], v[128:131], v[64:79]
    v_exp_f32 v53, v53
    v_exp_f32 v54, v54
    v_exp_f32 v55, v55
    v_mfma_f32_32x32x16_bf16 v[80:95], a[44:47], v[128:131], v[80:95]
    v_exp_f32 v56, v56
    v_exp_f32 v57, v57
    v_exp_f32 v58, v58
    v_smfmac_f32_32x32x32_bf16 v[96:111], a[152:155], v[48:55], v2
    s_waitcnt vmcnt(10)
    v_exp_f32 v59, v59
    v_exp_f32 v60, v60
    v_exp_f32 v61, v61
    v_smfmac_f32_16x16x64_bf16 v[140:143], v[180:183], a[208:215], v3
    buffer_load_dwordx4 a[208:211], v1, s[16:19], s50 offen offset:0 sc1
    buffer_load_dwordx4 a[212:215], v1, s[16:19], s50 offen offset:1024 sc1
    v_exp_f32 v62, v62
    v_exp_f32 v63, v63
    v_exp_f32 v64, v64
    v_exp_f32 v65, v65
    v_smfmac_f32_32x32x32_bf16 v[96:111], a[156:159], v[56:63], v2
    v_exp_f32 v66, v66
    v_exp_f32 v67, v67
    v_exp_f32 v68, v68
    v_mfma_f32_32x32x4_2b_bf16 v[32:63], a[76:77], v[132:133], v[208:239]
    v_exp_f32 v69, v69
    v_exp_f32 v70, v70
    v_exp_f32 v71, v71
    v_exp_f32 v72, v72
    v_exp_f32 v73, v73
    v_exp_f32 v74, v74
    v_exp_f32 v75, v75
    v_exp_f32 v76, v76
    v_smfmac_f32_32x32x32_bf16 v[96:111], a[160:163], v[64:71], v2
    s_waitcnt vmcnt(10)
    v_exp_f32 v77, v77
    v_exp_f32 v78, v78
    v_exp_f32 v79, v79
    v_smfmac_f32_16x16x64_bf16 v[144:147], v[180:183], a[216:223], v3
    buffer_load_dwordx4 a[216:219], v1, s[16:19], s50 offen offset:2048 sc1
    buffer_load_dwordx4 a[220:223], v1, s[16:19], s50 offen offset:3072 sc1
    v_exp_f32 v80, v80
    v_exp_f32 v81, v81
    v_smfmac_f32_32x32x32_bf16 v[96:111], a[164:167], v[72:79], v2
    s_add_u32 s50, s49, 262144
    v_exp_f32 v82, v82
    v_exp_f32 v83, v83
    v_exp_f32 v84, v84
    v_mfma_f32_32x32x16_bf16 v[32:47], a[48:51], v[128:131], v[32:47]
    v_exp_f32 v85, v85
    v_exp_f32 v86, v86
    v_exp_f32 v87, v87
    v_mfma_f32_32x32x16_bf16 v[48:63], a[52:55], v[128:131], v[48:63]
    v_exp_f32 v88, v88
    v_exp_f32 v89, v89
    v_exp_f32 v90, v90
    v_smfmac_f32_32x32x32_bf16 v[96:111], a[168:171], v[80:87], v2
    s_waitcnt vmcnt(10)
    v_exp_f32 v91, v91
    v_exp_f32 v92, v92
    v_exp_f32 v93, v93
    v_smfmac_f32_16x16x64_bf16 v[148:151], v[180:183], a[224:231], v3
    buffer_load_dwordx4 a[224:227], v1, s[16:19], s50 offen offset:0 sc1
    buffer_load_dwordx4 a[228:231], v1, s[16:19], s50 offen offset:1024 sc1
    v_exp_f32 v94, v94
    v_exp_f32 v95, v95
    v_exp_f32 v32, v32
    v_exp_f32 v33, v33
    v_smfmac_f32_32x32x32_bf16 v[96:111], a[172:175], v[88:95], v2
    v_exp_f32 v34, v34
    v_exp_f32 v35, v35
    v_exp_f32 v36, v36
    v_mfma_f32_32x32x4_2b_bf16 v[64:95], a[78:79], v[132:133], v[208:239]
    v_exp_f32 v37, v37
    v_exp_f32 v38, v38
    v_exp_f32 v39, v39
    v_exp_f32 v40, v40
    v_exp_f32 v41, v41
    v_exp_f32 v42, v42
    v_exp_f32 v43, v43
    v_exp_f32 v44, v44
    v_smfmac_f32_32x32x32_bf16 v[96:111], a[176:179], v[32:39], v2
    s_waitcnt vmcnt(10)
    v_exp_f32 v45, v45
    v_exp_f32 v46, v46
    v_exp_f32 v47, v47
    v_smfmac_f32_16x16x64_bf16 v[152:155], v[180:183], a[232:239], v3
    buffer_load_dwordx4 a[232:235], v1, s[16:19], s50 offen offset:2048 sc1
    buffer_load_dwordx4 a[236:239], v1, s[16:19], s50 offen offset:3072 sc1
    v_exp_f32 v48, v48
    v_exp_f32 v49, v49
    v_smfmac_f32_32x32x32_bf16 v[96:111], a[180:183], v[40:47], v2
    s_add_u32 s50, s49, 327680
    v_exp_f32 v50, v50
    v_exp_f32 v51, v51
    v_exp_f32 v52, v52
    v_mfma_f32_32x32x16_bf16 v[64:79], a[56:59], v[128:131], v[64:79]
    v_exp_f32 v53, v53
    v_exp_f32 v54, v54
    v_exp_f32 v55, v55
    v_mfma_f32_32x32x16_bf16 v[80:95], a[60:63], v[128:131], v[80:95]
    v_exp_f32 v56, v56
    v_exp_f32 v57, v57
    v_exp_f32 v58, v58
    v_smfmac_f32_32x32x32_bf16 v[96:111], a[184:187], v[48:55], v2
    s_waitcnt vmcnt(10)
    v_exp_f32 v59, v59
    v_exp_f32 v60, v60
    v_exp_f32 v61, v61
    v_smfmac_f32_16x16x64_bf16 v[156:159], v[180:183], a[240:247], v3
    buffer_load_dwordx4 a[240:243], v1, s[16:19], s50 offen offset:0 sc1
    buffer_load_dwordx4 a[244:247], v1, s[16:19], s50 offen offset:1024 sc1
    v_exp_f32 v62, v62
    v_exp_f32 v63, v63
    v_exp_f32 v64, v64
    v_exp_f32 v65, v65
    v_smfmac_f32_32x32x32_bf16 v[96:111], a[188:191], v[56:63], v2
    v_exp_f32 v66, v66
    v_exp_f32 v67, v67
    v_exp_f32 v68, v68
    v_mfma_f32_32x32x4_2b_bf16 v[32:63], a[64:65], v[138:139], 0
    s_nop 15
    s_nop 1
    v_mfma_f32_32x32x16_bf16 v[32:47], a[0:3], v[134:137], v[32:47]
    v_mfma_f32_32x32x16_bf16 v[48:63], a[4:7], v[134:137], v[48:63]
    s_nop 10
    v_mov_b32 v24, v32
    v_max3_f32 v24, v24, v32, v33
    v_max3_f32 v24, v24, v34, v35
    v_max3_f32 v24, v24, v36, v37
    v_max3_f32 v24, v24, v38, v39
    v_max3_f32 v24, v24, v40, v41
    v_max3_f32 v24, v24, v42, v43
    v_max3_f32 v24, v24, v44, v45
    v_max3_f32 v24, v24, v46, v47
    v_max3_f32 v24, v24, v48, v49
    v_max3_f32 v24, v24, v50, v51
    v_max3_f32 v24, v24, v52, v53
    v_max3_f32 v24, v24, v54, v55
    v_max3_f32 v24, v24, v56, v57
    v_max3_f32 v24, v24, v58, v59
    v_max3_f32 v24, v24, v60, v61
    v_max3_f32 v24, v24, v62, v63
    v_mfma_f32_32x32x4_2b_bf16 v[32:63], a[66:67], v[138:139], 0
    s_nop 15
    s_nop 1
    v_mfma_f32_32x32x16_bf16 v[32:47], a[8:11], v[134:137], v[32:47]
    v_mfma_f32_32x32x16_bf16 v[48:63], a[12:15], v[134:137], v[48:63]
    s_nop 10
    v_max3_f32 v24, v24, v32, v33
    v_max3_f32 v24, v24, v34, v35
    v_max3_f32 v24, v24, v36, v37
    v_max3_f32 v24, v24, v38, v39
    v_max3_f32 v24, v24, v40, v41
    v_max3_f32 v24, v24, v42, v43
    v_max3_f32 v24, v24, v44, v45
    v_max3_f32 v24, v24, v46, v47
    v_max3_f32 v24, v24, v48, v49
    v_max3_f32 v24, v24, v50, v51
    v_max3_f32 v24, v24, v52, v53
    v_max3_f32 v24, v24, v54, v55
    v_max3_f32 v24, v24, v56, v57
    v_max3_f32 v24, v24, v58, v59
    v_max3_f32 v24, v24, v60, v61
    v_max3_f32 v24, v24, v62, v63
    v_mfma_f32_32x32x4_2b_bf16 v[32:63], a[68:69], v[138:139], 0
    s_nop 15
    s_nop 1
    v_mfma_f32_32x32x16_bf16 v[32:47], a[16:19], v[134:137], v[32:47]
    v_mfma_f32_32x32x16_bf16 v[48:63], a[20:23], v[134:137], v[48:63]
    s_nop 10
    v_max3_f32 v24, v24, v32, v33
    v_max3_f32 v24, v24, v34, v35
    v_max3_f32 v24, v24, v36, v37
    v_max3_f32 v24, v24, v38, v39
    v_max3_f32 v24, v24, v40, v41
    v_max3_f32 v24, v24, v42, v43
    v_max3_f32 v24, v24, v44, v45
    v_max3_f32 v24, v24, v46, v47
    v_max3_f32 v24, v24, v48, v49
    v_max3_f32 v24, v24, v50, v51
    v_max3_f32 v24, v24, v52, v53
    v_max3_f32 v24, v24, v54, v55
    v_max3_f32 v24, v24, v56, v57
    v_max3_f32 v24, v24, v58, v59
    v_max3_f32 v24, v24, v60, v61
    v_max3_f32 v24, v24, v62, v63
    v_mfma_f32_32x32x4_2b_bf16 v[32:63], a[70:71], v[138:139], 0
    s_nop 15
    s_nop 1
    v_mfma_f32_32x32x16_bf16 v[32:47], a[24:27], v[134:137], v[32:47]
    v_mfma_f32_32x32x16_bf16 v[48:63], a[28:31], v[134:137], v[48:63]
    s_nop 10
    v_max3_f32 v24, v24, v32, v33
    v_max3_f32 v24, v24, v34, v35
    v_max3_f32 v24, v24, v36, v37
    v_max3_f32 v24, v24, v38, v39
    v_max3_f32 v24, v24, v40, v41
    v_max3_f32 v24, v24, v42, v43
    v_max3_f32 v24, v24, v44, v45
    v_max3_f32 v24, v24, v46, v47
    v_max3_f32 v24, v24, v48, v49
    v_max3_f32 v24, v24, v50, v51
    v_max3_f32 v24, v24, v52, v53
    v_max3_f32 v24, v24, v54, v55
    v_max3_f32 v24, v24, v56, v57
    v_max3_f32 v24, v24, v58, v59
    v_max3_f32 v24, v24, v60, v61
    v_max3_f32 v24, v24, v62, v63
    v_mfma_f32_32x32x4_2b_bf16 v[32:63], a[72:73], v[138:139], 0
    s_nop 15
    s_nop 1
    v_mfma_f32_32x32x16_bf16 v[32:47], a[32:35], v[134:137], v[32:47]
    v_mfma_f32_32x32x16_bf16 v[48:63], a[36:39], v[134:137], v[48:63]
    s_nop 10
    v_max3_f32 v24, v24, v32, v33
    v_max3_f32 v24, v24, v34, v35
    v_max3_f32 v24, v24, v36, v37
    v_max3_f32 v24, v24, v38, v39
    v_max3_f32 v24, v24, v40, v41
    v_max3_f32 v24, v24, v42, v43
    v_max3_f32 v24, v24, v44, v45
    v_max3_f32 v24, v24, v46, v47
    v_max3_f32 v24, v24, v48, v49
    v_max3_f32 v24, v24, v50, v51
    v_max3_f32 v24, v24, v52, v53
    v_max3_f32 v24, v24, v54, v55
    v_max3_f32 v24, v24, v56, v57
    v_max3_f32 v24, v24, v58, v59
    v_max3_f32 v24, v24, v60, v61
    v_max3_f32 v24, v24, v62, v63
    v_mfma_f32_32x32x4_2b_bf16 v[32:63], a[74:75], v[138:139], 0
    s_nop 15
    s_nop 1
    v_mfma_f32_32x32x16_bf16 v[32:47], a[40:43], v[134:137], v[32:47]
    v_mfma_f32_32x32x16_bf16 v[48:63], a[44:47], v[134:137], v[48:63]
    s_nop 10
    v_max3_f32 v24, v24, v32, v33
    v_max3_f32 v24, v24, v34, v35
    v_max3_f32 v24, v24, v36, v37
    v_max3_f32 v24, v24, v38, v39
    v_max3_f32 v24, v24, v40, v41
    v_max3_f32 v24, v24, v42, v43
    v_max3_f32 v24, v24, v44, v45
    v_max3_f32 v24, v24, v46, v47
    v_max3_f32 v24, v24, v48, v49
    v_max3_f32 v24, v24, v50, v51
    v_max3_f32 v24, v24, v52, v53
    v_max3_f32 v24, v24, v54, v55
    v_max3_f32 v24, v24, v56, v57
    v_max3_f32 v24, v24, v58, v59
    v_max3_f32 v24, v24, v60, v61
    v_max3_f32 v24, v24, v62, v63
    v_mfma_f32_32x32x4_2b_bf16 v[32:63], a[76:77], v[138:139], 0
    s_nop 15
    s_nop 1
    v_mfma_f32_32x32x16_bf16 v[32:47], a[48:51], v[134:137], v[32:47]
    v_mfma_f32_32x32x16_bf16 v[48:63], a[52:55], v[134:137], v[48:63]
    s_nop 10
    v_max3_f32 v24, v24, v32, v33
    v_max3_f32 v24, v24, v34, v35
    v_max3_f32 v24, v24, v36, v37
    v_max3_f32 v24, v24, v38, v39
    v_max3_f32 v24, v24, v40, v41
    v_max3_f32 v24, v24, v42, v43
    v_max3_f32 v24, v24, v44, v45
    v_max3_f32 v24, v24, v46, v47
    v_max3_f32 v24, v24, v48, v49
    v_max3_f32 v24, v24, v50, v51
    v_max3_f32 v24, v24, v52, v53
    v_max3_f32 v24, v24, v54, v55
    v_max3_f32 v24, v24, v56, v57
    v_max3_f32 v24, v24, v58, v59
    v_max3_f32 v24, v24, v60, v61
    v_max3_f32 v24, v24, v62, v63
    v_mfma_f32_32x32x4_2b_bf16 v[32:63], a[78:79], v[138:139], 0
    s_nop 15
    s_nop 1
    v_mfma_f32_32x32x16_bf16 v[32:47], a[56:59], v[134:137], v[32:47]
    v_mfma_f32_32x32x16_bf16 v[48:63], a[60:63], v[134:137], v[48:63]
    s_nop 10
    v_max3_f32 v24, v24, v32, v33
    v_max3_f32 v24, v24, v34, v35
    v_max3_f32 v24, v24, v36, v37
    v_max3_f32 v24, v24, v38, v39
    v_max3_f32 v24, v24, v40, v41
    v_max3_f32 v24, v24, v42, v43
    v_max3_f32 v24, v24, v44, v45
    v_max3_f32 v24, v24, v46, v47
    v_max3_f32 v24, v24, v48, v49
    v_max3_f32 v24, v24, v50, v51
    v_max3_f32 v24, v24, v52, v53
    v_max3_f32 v24, v24, v54, v55
    v_max3_f32 v24, v24, v56, v57
    v_max3_f32 v24, v24, v58, v59
    v_max3_f32 v24, v24, v60, v61
    v_max3_f32 v24, v24, v62, v63
    v_mov_b32 v25, v24
    s_nop 1
    v_permlane32_swap_b32 v24, v25
    v_max_f32 v24, v24, v25
    s_lshl_b32 s51, s40, 2
    v_add_u32 v25, s51, v1
    s_barrier
    ds_write_b32 v25, v24 offset:30720
    s_waitcnt lgkmcnt(0)
    s_barrier
    ds_read_b128 v[24:27], v1 offset:30720
    s_waitcnt lgkmcnt(0)
    v_max3_f32 v24, v24, v25, v26
    v_max_f32 v24, v24, v27
    v_sub_f32 v208, 0, v24
    v_sub_f32 v209, 0, v24
    v_sub_f32 v210, 0, v24
    v_sub_f32 v211, 0, v24
    v_sub_f32 v212, 0, v24
    v_sub_f32 v213, 0, v24
    v_sub_f32 v214, 0, v24
    v_sub_f32 v215, 0, v24
    v_sub_f32 v216, 0, v24
    v_sub_f32 v217, 0, v24
    v_sub_f32 v218, 0, v24
    v_sub_f32 v219, 0, v24
    v_sub_f32 v220, 0, v24
    v_sub_f32 v221, 0, v24
    v_sub_f32 v222, 0, v24
    v_sub_f32 v223, 0, v24
    v_sub_f32 v224, 0, v24
    v_sub_f32 v225, 0, v24
    v_sub_f32 v226, 0, v24
    v_sub_f32 v227, 0, v24
    v_sub_f32 v228, 0, v24
    v_sub_f32 v229, 0, v24
    v_sub_f32 v230, 0, v24
    v_sub_f32 v231, 0, v24
    v_sub_f32 v232, 0, v24
    v_sub_f32 v233, 0, v24
    v_sub_f32 v234, 0, v24
    v_sub_f32 v235, 0, v24
    v_sub_f32 v236, 0, v24
    v_sub_f32 v237, 0, v24
    v_sub_f32 v238, 0, v24
    v_sub_f32 v239, 0, v24
    s_nop 1
    v_mfma_f32_32x32x4_2b_bf16 v[32:63], a[64:65], v[138:139], v[208:239]
    v_exp_f32 v69, v69
    v_exp_f32 v70, v70
    v_exp_f32 v71, v71
    v_exp_f32 v72, v72
    v_exp_f32 v73, v73
    v_exp_f32 v74, v74
    v_exp_f32 v75, v75
    v_exp_f32 v76, v76
    v_smfmac_f32_32x32x32_bf16 v[96:111], a[192:195], v[64:71], v2
    s_waitcnt vmcnt(10)
    v_exp_f32 v77, v77
    v_exp_f32 v78, v78
    v_exp_f32 v79, v79
    v_smfmac_f32_16x16x64_bf16 v[160:163], v[180:183], a[248:255], v3
    buffer_load_dwordx4 a[248:251], v1, s[16:19], s50 offen offset:2048 sc1
    buffer_load_dwordx4 a[252:255], v1, s[16:19], s50 offen offset:3072 sc1
    v_exp_f32 v80, v80
    v_exp_f32 v81, v81
    v_smfmac_f32_32x32x32_bf16 v[96:111], a[196:199], v[72:79], v2
    s_add_u32 s50, s49, 331776
    v_exp_f32 v82, v82
    v_exp_f32 v83, v83
    v_exp_f32 v84, v84
    v_mfma_f32_32x32x16_bf16 v[32:47], a[0:3], v[134:137], v[32:47]
    v_exp_f32 v85, v85
    v_exp_f32 v86, v86
    v_exp_f32 v87, v87
    v_mfma_f32_32x32x16_bf16 v[48:63], a[4:7], v[134:137], v[48:63]
    v_exp_f32 v88, v88
    v_exp_f32 v89, v89
    v_exp_f32 v90, v90
    v_smfmac_f32_32x32x32_bf16 v[96:111], a[200:203], v[80:87], v2
    s_waitcnt vmcnt(10)
    v_exp_f32 v91, v91
    v_exp_f32 v92, v92
    v_exp_f32 v93, v93
    v_smfmac_f32_16x16x64_bf16 v[164:167], v[180:183], a[208:215], v3
    buffer_load_dwordx4 a[208:211], v1, s[16:19], s50 offen offset:0 sc1
    buffer_load_dwordx4 a[212:215], v1, s[16:19], s50 offen offset:1024 sc1
    v_exp_f32 v94, v94
    v_exp_f32 v95, v95
    v_exp_f32 v32, v32
    v_exp_f32 v33, v33
    v_smfmac_f32_32x32x32_bf16 v[96:111], a[204:207], v[88:95], v2
    v_exp_f32 v34, v34
    v_exp_f32 v35, v35
    v_exp_f32 v36, v36
    v_mfma_f32_32x32x4_2b_bf16 v[64:95], a[66:67], v[138:139], v[208:239]
    v_exp_f32 v37, v37
    v_exp_f32 v38, v38
    v_exp_f32 v39, v39
    v_exp_f32 v40, v40
    v_exp_f32 v41, v41
    v_exp_f32 v42, v42
    v_exp_f32 v43, v43
    v_exp_f32 v44, v44
    v_smfmac_f32_32x32x32_bf16 v[112:127], a[80:83], v[32:39], v2
    s_waitcnt vmcnt(10)
    ds_write_b128 v6, v[96:99] offset:0
    v_exp_f32 v45, v45
    v_exp_f32 v46, v46
    v_exp_f32 v47, v47
    v_smfmac_f32_16x16x64_bf16 v[168:171], v[180:183], a[216:223], v3
    buffer_load_dwordx4 a[216:219], v1, s[16:19], s50 offen offset:2048 sc1
    buffer_load_dwordx4 a[220:223], v1, s[16:19], s50 offen offset:3072 sc1
    s_mov_b32 s45, 7680
    buffer_load_dwordx4 v[128:131], v11, s[16:19], s45 offen sc1
    buffer_load_dwordx2 v[132:133], v12, s[16:19], s45 offen offset:1024 sc1
    v_exp_f32 v48, v48
    v_exp_f32 v49, v49
    v_smfmac_f32_32x32x32_bf16 v[112:127], a[84:87], v[40:47], v2
    s_add_u32 s50, s49, 335872
    ds_write_b128 v6, v[100:103] offset:1024
    v_exp_f32 v50, v50
    v_exp_f32 v51, v51
    v_exp_f32 v52, v52
    v_mfma_f32_32x32x16_bf16 v[64:79], a[8:11], v[134:137], v[64:79]
    v_exp_f32 v53, v53
    v_exp_f32 v54, v54
    v_exp_f32 v55, v55
    v_mfma_f32_32x32x16_bf16 v[80:95], a[12:15], v[134:137], v[80:95]
    v_exp_f32 v56, v56
    v_exp_f32 v57, v57
    v_exp_f32 v58, v58
    v_smfmac_f32_32x32x32_bf16 v[112:127], a[88:91], v[48:55], v2
    s_waitcnt vmcnt(12)
    ds_write_b128 v6, v[104:107] offset:2048
    v_exp_f32 v59, v59
    v_exp_f32 v60, v60
    v_exp_f32 v61, v61
    v_smfmac_f32_16x16x64_bf16 v[172:175], v[180:183], a[224:231], v3
    buffer_load_dwordx4 a[224:227], v1, s[16:19], s50 offen offset:0 sc1
    buffer_load_dwordx4 a[228:231], v1, s[16:19], s50 offen offset:1024 sc1
    v_exp_f32 v62, v62
    v_exp_f32 v63, v63
    v_exp_f32 v64, v64
    v_exp_f32 v65, v65
    v_smfmac_f32_32x32x32_bf16 v[112:127], a[92:95], v[56:63], v2
    v_exp_f32 v66, v66
    v_exp_f32 v67, v67
    v_exp_f32 v68, v68
    v_mfma_f32_32x32x4_2b_bf16 v[32:63], a[68:69], v[138:139], v[208:239]
    v_exp_f32 v69, v69
    v_exp_f32 v70, v70
    v_exp_f32 v71, v71
    v_exp_f32 v72, v72
    v_exp_f32 v73, v73
    v_exp_f32 v74, v74
    v_exp_f32 v75, v75
    v_exp_f32 v76, v76
    v_smfmac_f32_32x32x32_bf16 v[112:127], a[96:99], v[64:71], v2
    s_waitcnt vmcnt(12)
    s_waitcnt lgkmcnt(0)
    s_barrier
    v_exp_f32 v77, v77
    v_exp_f32 v78, v78
    v_exp_f32 v79, v79
    v_smfmac_f32_16x16x64_bf16 v[176:179], v[180:183], a[232:239], v3
    buffer_load_dwordx4 a[232:235], v1, s[16:19], s50 offen offset:2048 sc1
    buffer_load_dwordx4 a[236:239], v1, s[16:19], s50 offen offset:3072 sc1
    v_exp_f32 v80, v80
    v_exp_f32 v81, v81
    v_smfmac_f32_32x32x32_bf16 v[112:127], a[100:103], v[72:79], v2
    s_add_u32 s50, s49, 339968
    ds_read_b128 v[188:191], v7 offset:0
    v_exp_f32 v82, v82
    v_exp_f32 v83, v83
    v_exp_f32 v84, v84
    v_mfma_f32_32x32x16_bf16 v[32:47], a[16:19], v[134:137], v[32:47]
    ds_read_b128 v[192:195], v7 offset:3072
    v_exp_f32 v85, v85
    v_exp_f32 v86, v86
    v_exp_f32 v87, v87
    v_mfma_f32_32x32x16_bf16 v[48:63], a[20:23], v[134:137], v[48:63]
    ds_read_b128 v[196:199], v7 offset:6144
    v_exp_f32 v88, v88
    v_exp_f32 v89, v89
    v_exp_f32 v90, v90
    v_smfmac_f32_32x32x32_bf16 v[112:127], a[104:107], v[80:87], v2
    ds_read_b128 v[200:203], v7 offset:9216
    v_exp_f32 v91, v91
    v_exp_f32 v92, v92
    v_exp_f32 v93, v93
    v_mfma_f32_32x32x8_bf16 v[96:111], v[4:5], v[4:5], 0
    v_exp_f32 v94, v94
    v_exp_f32 v95, v95
    v_exp_f32 v32, v32
    v_exp_f32 v33, v33
    v_smfmac_f32_32x32x32_bf16 v[112:127], a[108:111], v[88:95], v2
    v_exp_f32 v34, v34
    v_exp_f32 v35, v35
    v_exp_f32 v36, v36
    v_mfma_f32_32x32x4_2b_bf16 v[64:95], a[70:71], v[138:139], v[208:239]
    s_waitcnt lgkmcnt(0)
    v_exp_f32 v37, v37
    v_add_f32 v188, v188, v192
    v_exp_f32 v38, v38
    v_add_f32 v189, v189, v193
    v_exp_f32 v39, v39
    v_add_f32 v190, v190, v194
    v_exp_f32 v40, v40
    v_add_f32 v191, v191, v195
    v_exp_f32 v41, v41
    v_add_f32 v196, v196, v200
    v_exp_f32 v42, v42
    v_add_f32 v197, v197, v201
    v_exp_f32 v43, v43
    v_add_f32 v198, v198, v202
    v_exp_f32 v44, v44
    v_add_f32 v199, v199, v203
    v_smfmac_f32_32x32x32_bf16 v[112:127], a[112:115], v[32:39], v2
    s_waitcnt vmcnt(12)
    v_exp_f32 v45, v45
    v_add_f32 v188, v188, v196
    v_exp_f32 v46, v46
    v_add_f32 v189, v189, v197
    v_exp_f32 v47, v47
    v_add_f32 v190, v190, v198
    v_smfmac_f32_16x16x64_bf16 v[140:143], v[184:187], a[240:247], v3
    buffer_load_dwordx4 a[240:243], v1, s[16:19], s50 offen offset:0 sc1
    buffer_load_dwordx4 a[244:247], v1, s[16:19], s50 offen offset:1024 sc1
    v_exp_f32 v48, v48
    v_rcp_f32_dpp v192, v188 quad_perm:[3,3,3,3] row_mask:0xf bank_mask:0xf
    v_exp_f32 v49, v49
    v_add_f32 v191, v191, v199
    v_smfmac_f32_32x32x32_bf16 v[112:127], a[116:119], v[40:47], v2
    v_exp_f32 v50, v50
    v_mul_f32 v188, v188, v192
    v_exp_f32 v51, v51
    v_mul_f32 v189, v189, v192
    v_exp_f32 v52, v52
    v_mul_f32 v190, v190, v192
    v_mfma_f32_32x32x16_bf16 v[64:79], a[24:27], v[134:137], v[64:79]
    v_exp_f32 v53, v53
    v_mul_f32 v191, v191, v192
    v_exp_f32 v54, v54
    v_cvt_pk_bf16_f32 v188, v188, v189
    v_exp_f32 v55, v55
    v_cvt_pk_bf16_f32 v189, v190, v191
    v_mfma_f32_32x32x16_bf16 v[80:95], a[28:31], v[134:137], v[80:95]
    v_exp_f32 v56, v56
    v_subrev_u32 v192, 528482304, v192
    v_exp_f32 v57, v57
    v_max_u32 v10, v10, v192
    v_exp_f32 v58, v58
    v_smfmac_f32_32x32x32_bf16 v[112:127], a[120:123], v[48:55], v2
    s_waitcnt vmcnt(12)
    ds_write2_b32 v8, v188, v189 offset0:0 offset1:32
    v_add_u32 v8, v9, v8
    v_exp_f32 v59, v59
    v_exp_f32 v60, v60
    v_exp_f32 v61, v61
    v_smfmac_f32_16x16x64_bf16 v[144:147], v[184:187], a[248:255], v3
    buffer_load_dwordx4 a[248:251], v1, s[16:19], s50 offen offset:2048 sc1
    buffer_load_dwordx4 a[252:255], v1, s[16:19], s50 offen offset:3072 sc1
    v_exp_f32 v62, v62
    v_exp_f32 v63, v63
    v_exp_f32 v64, v64
    v_exp_f32 v65, v65
    v_smfmac_f32_32x32x32_bf16 v[112:127], a[124:127], v[56:63], v2
    s_add_u32 s50, s49, 344064
    v_exp_f32 v66, v66
    v_exp_f32 v67, v67
    v_exp_f32 v68, v68
    v_mfma_f32_32x32x4_2b_bf16 v[32:63], a[72:73], v[138:139], v[208:239]
    v_exp_f32 v69, v69
    v_exp_f32 v70, v70
    v_exp_f32 v71, v71
    v_exp_f32 v72, v72
    v_exp_f32 v73, v73
    v_exp_f32 v74, v74
    v_exp_f32 v75, v75
    v_exp_f32 v76, v76
    v_smfmac_f32_32x32x32_bf16 v[112:127], a[128:131], v[64:71], v2
    s_waitcnt vmcnt(12)
    s_waitcnt lgkmcnt(0)
    s_barrier
    v_exp_f32 v77, v77
    v_exp_f32 v78, v78
    v_exp_f32 v79, v79
    v_smfmac_f32_16x16x64_bf16 v[148:151], v[184:187], a[208:215], v3
    buffer_load_dwordx4 a[208:211], v1, s[16:19], s50 offen offset:0 sc1
    buffer_load_dwordx4 a[212:215], v1, s[16:19], s50 offen offset:1024 sc1
    v_exp_f32 v80, v80
    v_exp_f32 v81, v81
    v_smfmac_f32_32x32x32_bf16 v[112:127], a[132:135], v[72:79], v2
    ds_read_b128 v[204:207], v1 offset:24576
    v_exp_f32 v82, v82
    v_exp_f32 v83, v83
    v_exp_f32 v84, v84
    v_mfma_f32_32x32x16_bf16 v[32:47], a[32:35], v[134:137], v[32:47]
    v_exp_f32 v85, v85
    v_exp_f32 v86, v86
    v_exp_f32 v87, v87
    v_mfma_f32_32x32x16_bf16 v[48:63], a[36:39], v[134:137], v[48:63]
    v_exp_f32 v88, v88
    v_exp_f32 v89, v89
    v_exp_f32 v90, v90
    v_smfmac_f32_32x32x32_bf16 v[112:127], a[136:139], v[80:87], v2
    s_waitcnt lgkmcnt(0)
    s_waitcnt vmcnt(12)
    v_exp_f32 v91, v91
    v_exp_f32 v92, v92
    v_exp_f32 v93, v93
    v_smfmac_f32_16x16x64_bf16 v[152:155], v[184:187], a[216:223], v3
    buffer_load_dwordx4 a[216:219], v1, s[16:19], s50 offen offset:2048 sc1
    buffer_load_dwordx4 a[220:223], v1, s[16:19], s50 offen offset:3072 sc1
    v_exp_f32 v94, v94
    v_exp_f32 v95, v95
    v_exp_f32 v32, v32
    v_exp_f32 v33, v33
    v_smfmac_f32_32x32x32_bf16 v[112:127], a[140:143], v[88:95], v2
    s_add_u32 s50, s49, 409600
    v_exp_f32 v34, v34
    v_exp_f32 v35, v35
    v_exp_f32 v36, v36
    v_mfma_f32_32x32x4_2b_bf16 v[64:95], a[74:75], v[138:139], v[208:239]
    v_exp_f32 v37, v37
    v_exp_f32 v38, v38
    v_exp_f32 v39, v39
    v_exp_f32 v40, v40
    v_exp_f32 v41, v41
    v_exp_f32 v42, v42
    v_exp_f32 v43, v43
    v_exp_f32 v44, v44
    v_smfmac_f32_32x32x32_bf16 v[112:127], a[144:147], v[32:39], v2
    s_waitcnt vmcnt(10)
    v_exp_f32 v45, v45
    v_exp_f32 v46, v46
    v_exp_f32 v47, v47
    v_smfmac_f32_16x16x64_bf16 v[156:159], v[184:187], a[224:231], v3
    buffer_load_dwordx4 a[224:227], v1, s[16:19], s50 offen offset:0 sc1
    buffer_load_dwordx4 a[228:231], v1, s[16:19], s50 offen offset:1024 sc1
    v_exp_f32 v48, v48
    v_exp_f32 v49, v49
    v_smfmac_f32_32x32x32_bf16 v[112:127], a[148:151], v[40:47], v2
    v_exp_f32 v50, v50
    v_exp_f32 v51, v51
    v_exp_f32 v52, v52
    v_mfma_f32_32x32x16_bf16 v[64:79], a[40:43], v[134:137], v[64:79]
    v_exp_f32 v53, v53
    v_exp_f32 v54, v54
    v_exp_f32 v55, v55
    v_mfma_f32_32x32x16_bf16 v[80:95], a[44:47], v[134:137], v[80:95]
    v_exp_f32 v56, v56
    v_exp_f32 v57, v57
    v_exp_f32 v58, v58
    v_smfmac_f32_32x32x32_bf16 v[112:127], a[152:155], v[48:55], v2
    s_waitcnt vmcnt(10)
    v_exp_f32 v59, v59
    v_exp_f32 v60, v60
    v_exp_f32 v61, v61
    v_smfmac_f32_16x16x64_bf16 v[160:163], v[184:187], a[232:239], v3
    buffer_load_dwordx4 a[232:235], v1, s[16:19], s50 offen offset:2048 sc1
    buffer_load_dwordx4 a[236:239], v1, s[16:19], s50 offen offset:3072 sc1
    v_exp_f32 v62, v62
    v_exp_f32 v63, v63
    v_exp_f32 v64, v64
    v_exp_f32 v65, v65
    v_smfmac_f32_32x32x32_bf16 v[112:127], a[156:159], v[56:63], v2
    s_add_u32 s50, s49, 413696
    v_exp_f32 v66, v66
    v_exp_f32 v67, v67
    v_exp_f32 v68, v68
    v_mfma_f32_32x32x4_2b_bf16 v[32:63], a[76:77], v[138:139], v[208:239]
    v_exp_f32 v69, v69
    v_exp_f32 v70, v70
    v_exp_f32 v71, v71
    v_exp_f32 v72, v72
    v_exp_f32 v73, v73
    v_exp_f32 v74, v74
    v_exp_f32 v75, v75
    v_exp_f32 v76, v76
    v_smfmac_f32_32x32x32_bf16 v[112:127], a[160:163], v[64:71], v2
    s_waitcnt vmcnt(10)
    v_exp_f32 v77, v77
    v_exp_f32 v78, v78
    v_exp_f32 v79, v79
    v_smfmac_f32_16x16x64_bf16 v[164:167], v[184:187], a[240:247], v3
    buffer_load_dwordx4 a[240:243], v1, s[16:19], s50 offen offset:0 sc1
    buffer_load_dwordx4 a[244:247], v1, s[16:19], s50 offen offset:1024 sc1
    v_exp_f32 v80, v80
    v_exp_f32 v81, v81
    v_smfmac_f32_32x32x32_bf16 v[112:127], a[164:167], v[72:79], v2
    v_exp_f32 v82, v82
    v_exp_f32 v83, v83
    v_exp_f32 v84, v84
    v_mfma_f32_32x32x16_bf16 v[32:47], a[48:51], v[134:137], v[32:47]
    v_exp_f32 v85, v85
    v_exp_f32 v86, v86
    v_exp_f32 v87, v87
    v_mfma_f32_32x32x16_bf16 v[48:63], a[52:55], v[134:137], v[48:63]
    v_exp_f32 v88, v88
    v_exp_f32 v89, v89
    v_exp_f32 v90, v90
    v_smfmac_f32_32x32x32_bf16 v[112:127], a[168:171], v[80:87], v2
    s_waitcnt vmcnt(10)
    v_exp_f32 v91, v91
    v_exp_f32 v92, v92
    v_exp_f32 v93, v93
    v_smfmac_f32_16x16x64_bf16 v[168:171], v[184:187], a[248:255], v3
    buffer_load_dwordx4 a[248:251], v1, s[16:19], s50 offen offset:2048 sc1
    buffer_load_dwordx4 a[252:255], v1, s[16:19], s50 offen offset:3072 sc1
    v_exp_f32 v94, v94
    v_exp_f32 v95, v95
    v_exp_f32 v32, v32
    v_exp_f32 v33, v33
    v_smfmac_f32_32x32x32_bf16 v[112:127], a[172:175], v[88:95], v2
    s_add_u32 s50, s49, 417792
    v_exp_f32 v34, v34
    v_exp_f32 v35, v35
    v_exp_f32 v36, v36
    v_mfma_f32_32x32x4_2b_bf16 v[64:95], a[78:79], v[138:139], v[208:239]
    v_exp_f32 v37, v37
    v_exp_f32 v38, v38
    v_exp_f32 v39, v39
    v_exp_f32 v40, v40
    v_exp_f32 v41, v41
    v_exp_f32 v42, v42
    v_exp_f32 v43, v43
    v_exp_f32 v44, v44
    v_smfmac_f32_32x32x32_bf16 v[112:127], a[176:179], v[32:39], v2
    s_waitcnt vmcnt(10)
    v_exp_f32 v45, v45
    v_exp_f32 v46, v46
    v_exp_f32 v47, v47
    v_smfmac_f32_16x16x64_bf16 v[172:175], v[184:187], a[208:215], v3
    buffer_load_dwordx4 a[208:211], v1, s[16:19], s50 offen offset:0 sc1
    buffer_load_dwordx4 a[212:215], v1, s[16:19], s50 offen offset:1024 sc1
    v_exp_f32 v48, v48
    v_exp_f32 v49, v49
    v_smfmac_f32_32x32x32_bf16 v[112:127], a[180:183], v[40:47], v2
    v_exp_f32 v50, v50
    v_exp_f32 v51, v51
    v_exp_f32 v52, v52
    v_mfma_f32_32x32x16_bf16 v[64:79], a[56:59], v[134:137], v[64:79]
    v_exp_f32 v53, v53
    v_exp_f32 v54, v54
    v_exp_f32 v55, v55
    v_mfma_f32_32x32x16_bf16 v[80:95], a[60:63], v[134:137], v[80:95]
    v_exp_f32 v56, v56
    v_exp_f32 v57, v57
    v_exp_f32 v58, v58
    v_smfmac_f32_32x32x32_bf16 v[112:127], a[184:187], v[48:55], v2
    s_waitcnt vmcnt(10)
    v_exp_f32 v59, v59
    v_exp_f32 v60, v60
    v_exp_f32 v61, v61
    v_smfmac_f32_16x16x64_bf16 v[176:179], v[184:187], a[216:223], v3
    buffer_load_dwordx4 a[216:219], v1, s[16:19], s50 offen offset:2048 sc1
    buffer_load_dwordx4 a[220:223], v1, s[16:19], s50 offen offset:3072 sc1
    v_exp_f32 v62, v62
    v_exp_f32 v63, v63
    v_exp_f32 v64, v64
    v_exp_f32 v65, v65
    v_smfmac_f32_32x32x32_bf16 v[112:127], a[188:191], v[56:63], v2
    s_add_u32 s50, s49, 421888
    v_exp_f32 v66, v66
    v_exp_f32 v67, v67
    v_exp_f32 v68, v68
    v_mfma_f32_32x32x4_2b_bf16 v[32:63], a[64:65], v[132:133], 0
    s_nop 15
    s_nop 1
    v_mfma_f32_32x32x16_bf16 v[32:47], a[0:3], v[128:131], v[32:47]
    v_mfma_f32_32x32x16_bf16 v[48:63], a[4:7], v[128:131], v[48:63]
    s_nop 10
    v_mov_b32 v24, v32
    v_max3_f32 v24, v24, v32, v33
    v_max3_f32 v24, v24, v34, v35
    v_max3_f32 v24, v24, v36, v37
    v_max3_f32 v24, v24, v38, v39
    v_max3_f32 v24, v24, v40, v41
    v_max3_f32 v24, v24, v42, v43
    v_max3_f32 v24, v24, v44, v45
    v_max3_f32 v24, v24, v46, v47
    v_max3_f32 v24, v24, v48, v49
    v_max3_f32 v24, v24, v50, v51
    v_max3_f32 v24, v24, v52, v53
    v_max3_f32 v24, v24, v54, v55
    v_max3_f32 v24, v24, v56, v57
    v_max3_f32 v24, v24, v58, v59
    v_max3_f32 v24, v24, v60, v61
    v_max3_f32 v24, v24, v62, v63
    v_mfma_f32_32x32x4_2b_bf16 v[32:63], a[66:67], v[132:133], 0
    s_nop 15
    s_nop 1
    v_mfma_f32_32x32x16_bf16 v[32:47], a[8:11], v[128:131], v[32:47]
    v_mfma_f32_32x32x16_bf16 v[48:63], a[12:15], v[128:131], v[48:63]
    s_nop 10
    v_max3_f32 v24, v24, v32, v33
    v_max3_f32 v24, v24, v34, v35
    v_max3_f32 v24, v24, v36, v37
    v_max3_f32 v24, v24, v38, v39
    v_max3_f32 v24, v24, v40, v41
    v_max3_f32 v24, v24, v42, v43
    v_max3_f32 v24, v24, v44, v45
    v_max3_f32 v24, v24, v46, v47
    v_max3_f32 v24, v24, v48, v49
    v_max3_f32 v24, v24, v50, v51
    v_max3_f32 v24, v24, v52, v53
    v_max3_f32 v24, v24, v54, v55
    v_max3_f32 v24, v24, v56, v57
    v_max3_f32 v24, v24, v58, v59
    v_max3_f32 v24, v24, v60, v61
    v_max3_f32 v24, v24, v62, v63
    v_mfma_f32_32x32x4_2b_bf16 v[32:63], a[68:69], v[132:133], 0
    s_nop 15
    s_nop 1
    v_mfma_f32_32x32x16_bf16 v[32:47], a[16:19], v[128:131], v[32:47]
    v_mfma_f32_32x32x16_bf16 v[48:63], a[20:23], v[128:131], v[48:63]
    s_nop 10
    v_max3_f32 v24, v24, v32, v33
    v_max3_f32 v24, v24, v34, v35
    v_max3_f32 v24, v24, v36, v37
    v_max3_f32 v24, v24, v38, v39
    v_max3_f32 v24, v24, v40, v41
    v_max3_f32 v24, v24, v42, v43
    v_max3_f32 v24, v24, v44, v45
    v_max3_f32 v24, v24, v46, v47
    v_max3_f32 v24, v24, v48, v49
    v_max3_f32 v24, v24, v50, v51
    v_max3_f32 v24, v24, v52, v53
    v_max3_f32 v24, v24, v54, v55
    v_max3_f32 v24, v24, v56, v57
    v_max3_f32 v24, v24, v58, v59
    v_max3_f32 v24, v24, v60, v61
    v_max3_f32 v24, v24, v62, v63
    v_mfma_f32_32x32x4_2b_bf16 v[32:63], a[70:71], v[132:133], 0
    s_nop 15
    s_nop 1
    v_mfma_f32_32x32x16_bf16 v[32:47], a[24:27], v[128:131], v[32:47]
    v_mfma_f32_32x32x16_bf16 v[48:63], a[28:31], v[128:131], v[48:63]
    s_nop 10
    v_max3_f32 v24, v24, v32, v33
    v_max3_f32 v24, v24, v34, v35
    v_max3_f32 v24, v24, v36, v37
    v_max3_f32 v24, v24, v38, v39
    v_max3_f32 v24, v24, v40, v41
    v_max3_f32 v24, v24, v42, v43
    v_max3_f32 v24, v24, v44, v45
    v_max3_f32 v24, v24, v46, v47
    v_max3_f32 v24, v24, v48, v49
    v_max3_f32 v24, v24, v50, v51
    v_max3_f32 v24, v24, v52, v53
    v_max3_f32 v24, v24, v54, v55
    v_max3_f32 v24, v24, v56, v57
    v_max3_f32 v24, v24, v58, v59
    v_max3_f32 v24, v24, v60, v61
    v_max3_f32 v24, v24, v62, v63
    v_mfma_f32_32x32x4_2b_bf16 v[32:63], a[72:73], v[132:133], 0
    s_nop 15
    s_nop 1
    v_mfma_f32_32x32x16_bf16 v[32:47], a[32:35], v[128:131], v[32:47]
    v_mfma_f32_32x32x16_bf16 v[48:63], a[36:39], v[128:131], v[48:63]
    s_nop 10
    v_max3_f32 v24, v24, v32, v33
    v_max3_f32 v24, v24, v34, v35
    v_max3_f32 v24, v24, v36, v37
    v_max3_f32 v24, v24, v38, v39
    v_max3_f32 v24, v24, v40, v41
    v_max3_f32 v24, v24, v42, v43
    v_max3_f32 v24, v24, v44, v45
    v_max3_f32 v24, v24, v46, v47
    v_max3_f32 v24, v24, v48, v49
    v_max3_f32 v24, v24, v50, v51
    v_max3_f32 v24, v24, v52, v53
    v_max3_f32 v24, v24, v54, v55
    v_max3_f32 v24, v24, v56, v57
    v_max3_f32 v24, v24, v58, v59
    v_max3_f32 v24, v24, v60, v61
    v_max3_f32 v24, v24, v62, v63
    v_mfma_f32_32x32x4_2b_bf16 v[32:63], a[74:75], v[132:133], 0
    s_nop 15
    s_nop 1
    v_mfma_f32_32x32x16_bf16 v[32:47], a[40:43], v[128:131], v[32:47]
    v_mfma_f32_32x32x16_bf16 v[48:63], a[44:47], v[128:131], v[48:63]
    s_nop 10
    v_max3_f32 v24, v24, v32, v33
    v_max3_f32 v24, v24, v34, v35
    v_max3_f32 v24, v24, v36, v37
    v_max3_f32 v24, v24, v38, v39
    v_max3_f32 v24, v24, v40, v41
    v_max3_f32 v24, v24, v42, v43
    v_max3_f32 v24, v24, v44, v45
    v_max3_f32 v24, v24, v46, v47
    v_max3_f32 v24, v24, v48, v49
    v_max3_f32 v24, v24, v50, v51
    v_max3_f32 v24, v24, v52, v53
    v_max3_f32 v24, v24, v54, v55
    v_max3_f32 v24, v24, v56, v57
    v_max3_f32 v24, v24, v58, v59
    v_max3_f32 v24, v24, v60, v61
    v_max3_f32 v24, v24, v62, v63
    v_mfma_f32_32x32x4_2b_bf16 v[32:63], a[76:77], v[132:133], 0
    s_nop 15
    s_nop 1
    v_mfma_f32_32x32x16_bf16 v[32:47], a[48:51], v[128:131], v[32:47]
    v_mfma_f32_32x32x16_bf16 v[48:63], a[52:55], v[128:131], v[48:63]
    s_nop 10
    v_max3_f32 v24, v24, v32, v33
    v_max3_f32 v24, v24, v34, v35
    v_max3_f32 v24, v24, v36, v37
    v_max3_f32 v24, v24, v38, v39
    v_max3_f32 v24, v24, v40, v41
    v_max3_f32 v24, v24, v42, v43
    v_max3_f32 v24, v24, v44, v45
    v_max3_f32 v24, v24, v46, v47
    v_max3_f32 v24, v24, v48, v49
    v_max3_f32 v24, v24, v50, v51
    v_max3_f32 v24, v24, v52, v53
    v_max3_f32 v24, v24, v54, v55
    v_max3_f32 v24, v24, v56, v57
    v_max3_f32 v24, v24, v58, v59
    v_max3_f32 v24, v24, v60, v61
    v_max3_f32 v24, v24, v62, v63
    v_mfma_f32_32x32x4_2b_bf16 v[32:63], a[78:79], v[132:133], 0
    s_nop 15
    s_nop 1
    v_mfma_f32_32x32x16_bf16 v[32:47], a[56:59], v[128:131], v[32:47]
    v_mfma_f32_32x32x16_bf16 v[48:63], a[60:63], v[128:131], v[48:63]
    s_nop 10
    v_max3_f32 v24, v24, v32, v33
    v_max3_f32 v24, v24, v34, v35
    v_max3_f32 v24, v24, v36, v37
    v_max3_f32 v24, v24, v38, v39
    v_max3_f32 v24, v24, v40, v41
    v_max3_f32 v24, v24, v42, v43
    v_max3_f32 v24, v24, v44, v45
    v_max3_f32 v24, v24, v46, v47
    v_max3_f32 v24, v24, v48, v49
    v_max3_f32 v24, v24, v50, v51
    v_max3_f32 v24, v24, v52, v53
    v_max3_f32 v24, v24, v54, v55
    v_max3_f32 v24, v24, v56, v57
    v_max3_f32 v24, v24, v58, v59
    v_max3_f32 v24, v24, v60, v61
    v_max3_f32 v24, v24, v62, v63
    v_mov_b32 v25, v24
    s_nop 1
    v_permlane32_swap_b32 v24, v25
    v_max_f32 v24, v24, v25
    s_lshl_b32 s51, s40, 2
    v_add_u32 v25, s51, v1
    s_barrier
    ds_write_b32 v25, v24 offset:30720
    s_waitcnt lgkmcnt(0)
    s_barrier
    ds_read_b128 v[24:27], v1 offset:30720
    s_waitcnt lgkmcnt(0)
    v_max3_f32 v24, v24, v25, v26
    v_max_f32 v24, v24, v27
    v_sub_f32 v208, 0, v24
    v_sub_f32 v209, 0, v24
    v_sub_f32 v210, 0, v24
    v_sub_f32 v211, 0, v24
    v_sub_f32 v212, 0, v24
    v_sub_f32 v213, 0, v24
    v_sub_f32 v214, 0, v24
    v_sub_f32 v215, 0, v24
    v_sub_f32 v216, 0, v24
    v_sub_f32 v217, 0, v24
    v_sub_f32 v218, 0, v24
    v_sub_f32 v219, 0, v24
    v_sub_f32 v220, 0, v24
    v_sub_f32 v221, 0, v24
    v_sub_f32 v222, 0, v24
    v_sub_f32 v223, 0, v24
    v_sub_f32 v224, 0, v24
    v_sub_f32 v225, 0, v24
    v_sub_f32 v226, 0, v24
    v_sub_f32 v227, 0, v24
    v_sub_f32 v228, 0, v24
    v_sub_f32 v229, 0, v24
    v_sub_f32 v230, 0, v24
    v_sub_f32 v231, 0, v24
    v_sub_f32 v232, 0, v24
    v_sub_f32 v233, 0, v24
    v_sub_f32 v234, 0, v24
    v_sub_f32 v235, 0, v24
    v_sub_f32 v236, 0, v24
    v_sub_f32 v237, 0, v24
    v_sub_f32 v238, 0, v24
    v_sub_f32 v239, 0, v24
    s_nop 1
    v_mfma_f32_32x32x4_2b_bf16 v[32:63], a[64:65], v[132:133], v[208:239]
    v_exp_f32 v69, v69
    v_exp_f32 v70, v70
    v_exp_f32 v71, v71
    v_exp_f32 v72, v72
    v_exp_f32 v73, v73
    v_exp_f32 v74, v74
    v_exp_f32 v75, v75
    v_exp_f32 v76, v76
    v_smfmac_f32_32x32x32_bf16 v[112:127], a[192:195], v[64:71], v2
    s_waitcnt vmcnt(10)
    v_exp_f32 v77, v77
    v_exp_f32 v78, v78
    v_exp_f32 v79, v79
    v_smfmac_f32_16x16x64_bf16 v[140:143], v[204:207], a[224:231], v3
    buffer_load_dwordx4 a[224:227], v1, s[16:19], s50 offen offset:0 sc1
    buffer_load_dwordx4 a[228:231], v1, s[16:19], s50 offen offset:1024 sc1
    v_exp_f32 v80, v80
    v_exp_f32 v81, v81
    v_smfmac_f32_32x32x32_bf16 v[112:127], a[196:199], v[72:79], v2
    v_exp_f32 v82, v82
    v_exp_f32 v83, v83
    v_exp_f32 v84, v84
    v_mfma_f32_32x32x16_bf16 v[32:47], a[0:3], v[128:131], v[32:47]
    v_exp_f32 v85, v85
    v_exp_f32 v86, v86
    v_exp_f32 v87, v87
    v_mfma_f32_32x32x16_bf16 v[48:63], a[4:7], v[128:131], v[48:63]
    v_exp_f32 v88, v88
    v_exp_f32 v89, v89
    v_exp_f32 v90, v90
    v_smfmac_f32_32x32x32_bf16 v[112:127], a[200:203], v[80:87], v2
    s_waitcnt vmcnt(10)
    v_exp_f32 v91, v91
    v_exp_f32 v92, v92
    v_exp_f32 v93, v93
    v_smfmac_f32_16x16x64_bf16 v[144:147], v[204:207], a[232:239], v3
    buffer_load_dwordx4 a[232:235], v1, s[16:19], s50 offen offset:2048 sc1
    buffer_load_dwordx4 a[236:239], v1, s[16:19], s50 offen offset:3072 sc1
    v_exp_f32 v94, v94
    v_exp_f32 v95, v95
    v_exp_f32 v32, v32
    v_exp_f32 v33, v33
    v_smfmac_f32_32x32x32_bf16 v[112:127], a[204:207], v[88:95], v2
    s_add_u32 s50, s49, 425984
    v_exp_f32 v34, v34
    v_exp_f32 v35, v35
    v_exp_f32 v36, v36
    v_mfma_f32_32x32x4_2b_bf16 v[64:95], a[66:67], v[132:133], v[208:239]
    v_exp_f32 v37, v37
    v_exp_f32 v38, v38
    v_exp_f32 v39, v39
    v_exp_f32 v40, v40
    v_exp_f32 v41, v41
    v_exp_f32 v42, v42
    v_exp_f32 v43, v43
    v_exp_f32 v44, v44
    v_smfmac_f32_32x32x32_bf16 v[96:111], a[80:83], v[32:39], v2
    s_waitcnt vmcnt(10)
    ds_write_b128 v6, v[112:115] offset:12288
    v_exp_f32 v45, v45
    v_exp_f32 v46, v46
    v_exp_f32 v47, v47
    v_smfmac_f32_16x16x64_bf16 v[148:151], v[204:207], a[240:247], v3
    buffer_load_dwordx4 a[240:243], v1, s[16:19], s50 offen offset:0 sc1
    buffer_load_dwordx4 a[244:247], v1, s[16:19], s50 offen offset:1024 sc1
    s_mov_b32 s45, 8960
    buffer_load_dwordx4 v[134:137], v11, s[16:19], s45 offen sc1
    buffer_load_dwordx2 v[138:139], v12, s[16:19], s45 offen offset:1024 sc1
    v_exp_f32 v48, v48
    v_exp_f32 v49, v49
    v_smfmac_f32_32x32x32_bf16 v[96:111], a[84:87], v[40:47], v2
    ds_write_b128 v6, v[116:119] offset:13312
    v_exp_f32 v50, v50
    v_exp_f32 v51, v51
    v_exp_f32 v52, v52
    v_mfma_f32_32x32x16_bf16 v[64:79], a[8:11], v[128:131], v[64:79]
    v_exp_f32 v53, v53
    v_exp_f32 v54, v54
    v_exp_f32 v55, v55
    v_mfma_f32_32x32x16_bf16 v[80:95], a[12:15], v[128:131], v[80:95]
    v_exp_f32 v56, v56
    v_exp_f32 v57, v57
    v_exp_f32 v58, v58
    v_smfmac_f32_32x32x32_bf16 v[96:111], a[88:91], v[48:55], v2
    s_waitcnt vmcnt(12)
    ds_write_b128 v6, v[120:123] offset:14336
    v_exp_f32 v59, v59
    v_exp_f32 v60, v60
    v_exp_f32 v61, v61
    v_smfmac_f32_16x16x64_bf16 v[152:155], v[204:207], a[248:255], v3
    buffer_load_dwordx4 a[248:251], v1, s[16:19], s50 offen offset:2048 sc1
    buffer_load_dwordx4 a[252:255], v1, s[16:19], s50 offen offset:3072 sc1
    v_exp_f32 v62, v62
    v_exp_f32 v63, v63
    v_exp_f32 v64, v64
    v_exp_f32 v65, v65
    v_smfmac_f32_32x32x32_bf16 v[96:111], a[92:95], v[56:63], v2
    s_add_u32 s50, s49, 491520
    v_exp_f32 v66, v66
    v_exp_f32 v67, v67
    v_exp_f32 v68, v68
    v_mfma_f32_32x32x4_2b_bf16 v[32:63], a[68:69], v[132:133], v[208:239]
    v_exp_f32 v69, v69
    v_exp_f32 v70, v70
    v_exp_f32 v71, v71
    v_exp_f32 v72, v72
    v_exp_f32 v73, v73
    v_exp_f32 v74, v74
    v_exp_f32 v75, v75
    v_exp_f32 v76, v76
    v_smfmac_f32_32x32x32_bf16 v[96:111], a[96:99], v[64:71], v2
    s_waitcnt vmcnt(12)
    s_waitcnt lgkmcnt(0)
    s_barrier
    v_exp_f32 v77, v77
    v_exp_f32 v78, v78
    v_exp_f32 v79, v79
    v_smfmac_f32_16x16x64_bf16 v[156:159], v[204:207], a[208:215], v3
    buffer_load_dwordx4 a[208:211], v1, s[16:19], s50 offen offset:0 sc1
    buffer_load_dwordx4 a[212:215], v1, s[16:19], s50 offen offset:1024 sc1
    v_exp_f32 v80, v80
    v_exp_f32 v81, v81
    v_smfmac_f32_32x32x32_bf16 v[96:111], a[100:103], v[72:79], v2
    ds_read_b128 v[188:191], v7 offset:12288
    v_exp_f32 v82, v82
    v_exp_f32 v83, v83
    v_exp_f32 v84, v84
    v_mfma_f32_32x32x16_bf16 v[32:47], a[16:19], v[128:131], v[32:47]
    ds_read_b128 v[192:195], v7 offset:15360
    v_exp_f32 v85, v85
    v_exp_f32 v86, v86
    v_exp_f32 v87, v87
    v_mfma_f32_32x32x16_bf16 v[48:63], a[20:23], v[128:131], v[48:63]
    ds_read_b128 v[196:199], v7 offset:18432
    v_exp_f32 v88, v88
    v_exp_f32 v89, v89
    v_exp_f32 v90, v90
    v_smfmac_f32_32x32x32_bf16 v[96:111], a[104:107], v[80:87], v2
    ds_read_b128 v[200:203], v7 offset:21504
    v_exp_f32 v91, v91
    v_exp_f32 v92, v92
    v_exp_f32 v93, v93
    v_mfma_f32_32x32x8_bf16 v[112:127], v[4:5], v[4:5], 0
    v_exp_f32 v94, v94
    v_exp_f32 v95, v95
    v_exp_f32 v32, v32
    v_exp_f32 v33, v33
    v_smfmac_f32_32x32x32_bf16 v[96:111], a[108:111], v[88:95], v2
    v_exp_f32 v34, v34
    v_exp_f32 v35, v35
    v_exp_f32 v36, v36
    v_mfma_f32_32x32x4_2b_bf16 v[64:95], a[70:71], v[132:133], v[208:239]
    s_waitcnt lgkmcnt(0)
    v_exp_f32 v37, v37
    v_add_f32 v188, v188, v192
    v_exp_f32 v38, v38
    v_add_f32 v189, v189, v193
    v_exp_f32 v39, v39
    v_add_f32 v190, v190, v194
    v_exp_f32 v40, v40
    v_add_f32 v191, v191, v195
    v_exp_f32 v41, v41
    v_add_f32 v196, v196, v200
    v_exp_f32 v42, v42
    v_add_f32 v197, v197, v201
    v_exp_f32 v43, v43
    v_add_f32 v198, v198, v202
    v_exp_f32 v44, v44
    v_add_f32 v199, v199, v203
    v_smfmac_f32_32x32x32_bf16 v[96:111], a[112:115], v[32:39], v2
    s_waitcnt vmcnt(12)
    v_exp_f32 v45, v45
    v_add_f32 v188, v188, v196
    v_exp_f32 v46, v46
    v_add_f32 v189, v189, v197
    v_exp_f32 v47, v47
    v_add_f32 v190, v190, v198
    v_smfmac_f32_16x16x64_bf16 v[160:163], v[204:207], a[216:223], v3
    buffer_load_dwordx4 a[216:219], v1, s[16:19], s50 offen offset:2048 sc1
    buffer_load_dwordx4 a[220:223], v1, s[16:19], s50 offen offset:3072 sc1
    v_exp_f32 v48, v48
    v_rcp_f32_dpp v192, v188 quad_perm:[3,3,3,3] row_mask:0xf bank_mask:0xf
    v_exp_f32 v49, v49
    v_add_f32 v191, v191, v199
    v_smfmac_f32_32x32x32_bf16 v[96:111], a[116:119], v[40:47], v2
    s_add_u32 s50, s49, 495616
    v_exp_f32 v50, v50
    v_mul_f32 v188, v188, v192
    v_exp_f32 v51, v51
    v_mul_f32 v189, v189, v192
    v_exp_f32 v52, v52
    v_mul_f32 v190, v190, v192
    v_mfma_f32_32x32x16_bf16 v[64:79], a[24:27], v[128:131], v[64:79]
    v_exp_f32 v53, v53
    v_mul_f32 v191, v191, v192
    v_exp_f32 v54, v54
    v_cvt_pk_bf16_f32 v188, v188, v189
    v_exp_f32 v55, v55
    v_cvt_pk_bf16_f32 v189, v190, v191
    v_mfma_f32_32x32x16_bf16 v[80:95], a[28:31], v[128:131], v[80:95]
    v_exp_f32 v56, v56
    v_subrev_u32 v192, 528482304, v192
    v_exp_f32 v57, v57
    v_max_u32 v10, v10, v192
    v_exp_f32 v58, v58
    v_smfmac_f32_32x32x32_bf16 v[96:111], a[120:123], v[48:55], v2
    s_waitcnt vmcnt(12)
    ds_write2_b32 v8, v188, v189 offset0:0 offset1:32
    v_add_u32 v8, v9, v8
    v_exp_f32 v59, v59
    v_exp_f32 v60, v60
    v_exp_f32 v61, v61
    v_smfmac_f32_16x16x64_bf16 v[164:167], v[204:207], a[224:231], v3
    buffer_load_dwordx4 a[224:227], v1, s[16:19], s50 offen offset:0 sc1
    buffer_load_dwordx4 a[228:231], v1, s[16:19], s50 offen offset:1024 sc1
    v_exp_f32 v62, v62
    v_exp_f32 v63, v63
    v_exp_f32 v64, v64
    v_exp_f32 v65, v65
    v_smfmac_f32_32x32x32_bf16 v[96:111], a[124:127], v[56:63], v2
    v_exp_f32 v66, v66
    v_exp_f32 v67, v67
    v_exp_f32 v68, v68
    v_mfma_f32_32x32x4_2b_bf16 v[32:63], a[72:73], v[132:133], v[208:239]
    v_exp_f32 v69, v69
    v_exp_f32 v70, v70
    v_exp_f32 v71, v71
    v_exp_f32 v72, v72
    v_exp_f32 v73, v73
    v_exp_f32 v74, v74
    v_exp_f32 v75, v75
    v_exp_f32 v76, v76
    v_smfmac_f32_32x32x32_bf16 v[96:111], a[128:131], v[64:71], v2
    s_waitcnt vmcnt(12)
    s_waitcnt lgkmcnt(0)
    s_barrier
    v_exp_f32 v77, v77
    v_exp_f32 v78, v78
    v_exp_f32 v79, v79
    v_smfmac_f32_16x16x64_bf16 v[168:171], v[204:207], a[232:239], v3
    buffer_load_dwordx4 a[232:235], v1, s[16:19], s50 offen offset:2048 sc1
    buffer_load_dwordx4 a[236:239], v1, s[16:19], s50 offen offset:3072 sc1
    v_exp_f32 v80, v80
    v_exp_f32 v81, v81
    v_smfmac_f32_32x32x32_bf16 v[96:111], a[132:135], v[72:79], v2
    s_add_u32 s50, s49, 499712
    ds_read_b128 v[180:183], v1 offset:25600
    v_exp_f32 v82, v82
    v_exp_f32 v83, v83
    v_exp_f32 v84, v84
    v_mfma_f32_32x32x16_bf16 v[32:47], a[32:35], v[128:131], v[32:47]
    v_exp_f32 v85, v85
    v_exp_f32 v86, v86
    v_exp_f32 v87, v87
    v_mfma_f32_32x32x16_bf16 v[48:63], a[36:39], v[128:131], v[48:63]
    v_exp_f32 v88, v88
    v_exp_f32 v89, v89
    v_exp_f32 v90, v90
    v_smfmac_f32_32x32x32_bf16 v[96:111], a[136:139], v[80:87], v2
    s_waitcnt lgkmcnt(0)
    s_waitcnt vmcnt(12)
    v_exp_f32 v91, v91
    v_exp_f32 v92, v92
    v_exp_f32 v93, v93
    v_smfmac_f32_16x16x64_bf16 v[172:175], v[204:207], a[240:247], v3
    buffer_load_dwordx4 a[240:243], v1, s[16:19], s50 offen offset:0 sc1
    buffer_load_dwordx4 a[244:247], v1, s[16:19], s50 offen offset:1024 sc1
    v_exp_f32 v94, v94
    v_exp_f32 v95, v95
    v_exp_f32 v32, v32
    v_exp_f32 v33, v33
    v_smfmac_f32_32x32x32_bf16 v[96:111], a[140:143], v[88:95], v2
    v_exp_f32 v34, v34
    v_exp_f32 v35, v35
    v_exp_f32 v36, v36
    v_mfma_f32_32x32x4_2b_bf16 v[64:95], a[74:75], v[132:133], v[208:239]
    v_exp_f32 v37, v37
    v_exp_f32 v38, v38
    v_exp_f32 v39, v39
    v_exp_f32 v40, v40
    v_exp_f32 v41, v41
    v_exp_f32 v42, v42
    v_exp_f32 v43, v43
    v_exp_f32 v44, v44
    v_smfmac_f32_32x32x32_bf16 v[96:111], a[144:147], v[32:39], v2
    s_waitcnt vmcnt(10)
    v_exp_f32 v45, v45
    v_exp_f32 v46, v46
    v_exp_f32 v47, v47
    v_smfmac_f32_16x16x64_bf16 v[176:179], v[204:207], a[248:255], v3
    buffer_load_dwordx4 a[248:251], v1, s[16:19], s50 offen offset:2048 sc1
    buffer_load_dwordx4 a[252:255], v1, s[16:19], s50 offen offset:3072 sc1
    v_exp_f32 v48, v48
    v_exp_f32 v49, v49
    v_smfmac_f32_32x32x32_bf16 v[96:111], a[148:151], v[40:47], v2
    s_add_u32 s50, s49, 503808
    v_exp_f32 v50, v50
    v_exp_f32 v51, v51
    v_exp_f32 v52, v52
    v_mfma_f32_32x32x16_bf16 v[64:79], a[40:43], v[128:131], v[64:79]
    v_exp_f32 v53, v53
    v_exp_f32 v54, v54
    v_exp_f32 v55, v55
    v_mfma_f32_32x32x16_bf16 v[80:95], a[44:47], v[128:131], v[80:95]
    v_exp_f32 v56, v56
    v_exp_f32 v57, v57
    v_exp_f32 v58, v58
    v_smfmac_f32_32x32x32_bf16 v[96:111], a[152:155], v[48:55], v2
    s_waitcnt vmcnt(10)
    v_exp_f32 v59, v59
    v_exp_f32 v60, v60
    v_exp_f32 v61, v61
    v_smfmac_f32_16x16x64_bf16 v[140:143], v[180:183], a[208:215], v3
    buffer_load_dwordx4 a[208:211], v1, s[16:19], s50 offen offset:0 sc1
    buffer_load_dwordx4 a[212:215], v1, s[16:19], s50 offen offset:1024 sc1
    v_exp_f32 v62, v62
    v_exp_f32 v63, v63
    v_exp_f32 v64, v64
    v_exp_f32 v65, v65
    v_smfmac_f32_32x32x32_bf16 v[96:111], a[156:159], v[56:63], v2
    v_exp_f32 v66, v66
    v_exp_f32 v67, v67
    v_exp_f32 v68, v68
    v_mfma_f32_32x32x4_2b_bf16 v[32:63], a[76:77], v[132:133], v[208:239]
    v_exp_f32 v69, v69
    v_exp_f32 v70, v70
    v_exp_f32 v71, v71
    v_exp_f32 v72, v72
    v_exp_f32 v73, v73
    v_exp_f32 v74, v74
    v_exp_f32 v75, v75
    v_exp_f32 v76, v76
    v_smfmac_f32_32x32x32_bf16 v[96:111], a[160:163], v[64:71], v2
    s_waitcnt vmcnt(10)
    v_exp_f32 v77, v77
    v_exp_f32 v78, v78
    v_exp_f32 v79, v79
    v_smfmac_f32_16x16x64_bf16 v[144:147], v[180:183], a[216:223], v3
    buffer_load_dwordx4 a[216:219], v1, s[16:19], s50 offen offset:2048 sc1
    buffer_load_dwordx4 a[220:223], v1, s[16:19], s50 offen offset:3072 sc1
    v_exp_f32 v80, v80
    v_exp_f32 v81, v81
    v_smfmac_f32_32x32x32_bf16 v[96:111], a[164:167], v[72:79], v2
    s_add_u32 s50, s49, 507904
    v_exp_f32 v82, v82
    v_exp_f32 v83, v83
    v_exp_f32 v84, v84
    v_mfma_f32_32x32x16_bf16 v[32:47], a[48:51], v[128:131], v[32:47]
    v_exp_f32 v85, v85
    v_exp_f32 v86, v86
    v_exp_f32 v87, v87
    v_mfma_f32_32x32x16_bf16 v[48:63], a[52:55], v[128:131], v[48:63]
    v_exp_f32 v88, v88
    v_exp_f32 v89, v89
    v_exp_f32 v90, v90
    v_smfmac_f32_32x32x32_bf16 v[96:111], a[168:171], v[80:87], v2
    s_waitcnt vmcnt(10)
    v_exp_f32 v91, v91
    v_exp_f32 v92, v92
    v_exp_f32 v93, v93
    v_smfmac_f32_16x16x64_bf16 v[148:151], v[180:183], a[224:231], v3
    buffer_load_dwordx4 a[224:227], v1, s[16:19], s50 offen offset:0 sc1
    buffer_load_dwordx4 a[228:231], v1, s[16:19], s50 offen offset:1024 sc1
    v_exp_f32 v94, v94
    v_exp_f32 v95, v95
    v_exp_f32 v32, v32
    v_exp_f32 v33, v33
    v_smfmac_f32_32x32x32_bf16 v[96:111], a[172:175], v[88:95], v2
    v_exp_f32 v34, v34
    v_exp_f32 v35, v35
    v_exp_f32 v36, v36
    v_mfma_f32_32x32x4_2b_bf16 v[64:95], a[78:79], v[132:133], v[208:239]
    v_exp_f32 v37, v37
    v_exp_f32 v38, v38
    v_exp_f32 v39, v39
    v_exp_f32 v40, v40
    v_exp_f32 v41, v41
    v_exp_f32 v42, v42
    v_exp_f32 v43, v43
    v_exp_f32 v44, v44
    v_smfmac_f32_32x32x32_bf16 v[96:111], a[176:179], v[32:39], v2
    s_waitcnt vmcnt(10)
    v_exp_f32 v45, v45
    v_exp_f32 v46, v46
    v_exp_f32 v47, v47
    v_smfmac_f32_16x16x64_bf16 v[152:155], v[180:183], a[232:239], v3
    buffer_load_dwordx4 a[232:235], v1, s[16:19], s50 offen offset:2048 sc1
    buffer_load_dwordx4 a[236:239], v1, s[16:19], s50 offen offset:3072 sc1
    v_exp_f32 v48, v48
    v_exp_f32 v49, v49
    v_smfmac_f32_32x32x32_bf16 v[96:111], a[180:183], v[40:47], v2
    s_add_u32 s50, s49, 573440
    v_exp_f32 v50, v50
    v_exp_f32 v51, v51
    v_exp_f32 v52, v52
    v_mfma_f32_32x32x16_bf16 v[64:79], a[56:59], v[128:131], v[64:79]
    v_exp_f32 v53, v53
    v_exp_f32 v54, v54
    v_exp_f32 v55, v55
    v_mfma_f32_32x32x16_bf16 v[80:95], a[60:63], v[128:131], v[80:95]
    v_exp_f32 v56, v56
    v_exp_f32 v57, v57
    v_exp_f32 v58, v58
    v_smfmac_f32_32x32x32_bf16 v[96:111], a[184:187], v[48:55], v2
    s_waitcnt vmcnt(10)
    v_exp_f32 v59, v59
    v_exp_f32 v60, v60
    v_exp_f32 v61, v61
    v_smfmac_f32_16x16x64_bf16 v[156:159], v[180:183], a[240:247], v3
    buffer_load_dwordx4 a[240:243], v1, s[16:19], s50 offen offset:0 sc1
    buffer_load_dwordx4 a[244:247], v1, s[16:19], s50 offen offset:1024 sc1
    v_exp_f32 v62, v62
    v_exp_f32 v63, v63
    v_exp_f32 v64, v64
    v_exp_f32 v65, v65
    v_smfmac_f32_32x32x32_bf16 v[96:111], a[188:191], v[56:63], v2
    v_exp_f32 v66, v66
    v_exp_f32 v67, v67
    v_exp_f32 v68, v68
    v_mfma_f32_32x32x4_2b_bf16 v[32:63], a[64:65], v[138:139], 0
    s_nop 15
    s_nop 1
    v_mfma_f32_32x32x16_bf16 v[32:47], a[0:3], v[134:137], v[32:47]
    v_mfma_f32_32x32x16_bf16 v[48:63], a[4:7], v[134:137], v[48:63]
    s_nop 10
    v_mov_b32 v24, v32
    v_max3_f32 v24, v24, v32, v33
    v_max3_f32 v24, v24, v34, v35
    v_max3_f32 v24, v24, v36, v37
    v_max3_f32 v24, v24, v38, v39
    v_max3_f32 v24, v24, v40, v41
    v_max3_f32 v24, v24, v42, v43
    v_max3_f32 v24, v24, v44, v45
    v_max3_f32 v24, v24, v46, v47
    v_max3_f32 v24, v24, v48, v49
    v_max3_f32 v24, v24, v50, v51
    v_max3_f32 v24, v24, v52, v53
    v_max3_f32 v24, v24, v54, v55
    v_max3_f32 v24, v24, v56, v57
    v_max3_f32 v24, v24, v58, v59
    v_max3_f32 v24, v24, v60, v61
    v_max3_f32 v24, v24, v62, v63
    v_mfma_f32_32x32x4_2b_bf16 v[32:63], a[66:67], v[138:139], 0
    s_nop 15
    s_nop 1
    v_mfma_f32_32x32x16_bf16 v[32:47], a[8:11], v[134:137], v[32:47]
    v_mfma_f32_32x32x16_bf16 v[48:63], a[12:15], v[134:137], v[48:63]
    s_nop 10
    v_max3_f32 v24, v24, v32, v33
    v_max3_f32 v24, v24, v34, v35
    v_max3_f32 v24, v24, v36, v37
    v_max3_f32 v24, v24, v38, v39
    v_max3_f32 v24, v24, v40, v41
    v_max3_f32 v24, v24, v42, v43
    v_max3_f32 v24, v24, v44, v45
    v_max3_f32 v24, v24, v46, v47
    v_max3_f32 v24, v24, v48, v49
    v_max3_f32 v24, v24, v50, v51
    v_max3_f32 v24, v24, v52, v53
    v_max3_f32 v24, v24, v54, v55
    v_max3_f32 v24, v24, v56, v57
    v_max3_f32 v24, v24, v58, v59
    v_max3_f32 v24, v24, v60, v61
    v_max3_f32 v24, v24, v62, v63
    v_mfma_f32_32x32x4_2b_bf16 v[32:63], a[68:69], v[138:139], 0
    s_nop 15
    s_nop 1
    v_mfma_f32_32x32x16_bf16 v[32:47], a[16:19], v[134:137], v[32:47]
    v_mfma_f32_32x32x16_bf16 v[48:63], a[20:23], v[134:137], v[48:63]
    s_nop 10
    v_max3_f32 v24, v24, v32, v33
    v_max3_f32 v24, v24, v34, v35
    v_max3_f32 v24, v24, v36, v37
    v_max3_f32 v24, v24, v38, v39
    v_max3_f32 v24, v24, v40, v41
    v_max3_f32 v24, v24, v42, v43
    v_max3_f32 v24, v24, v44, v45
    v_max3_f32 v24, v24, v46, v47
    v_max3_f32 v24, v24, v48, v49
    v_max3_f32 v24, v24, v50, v51
    v_max3_f32 v24, v24, v52, v53
    v_max3_f32 v24, v24, v54, v55
    v_max3_f32 v24, v24, v56, v57
    v_max3_f32 v24, v24, v58, v59
    v_max3_f32 v24, v24, v60, v61
    v_max3_f32 v24, v24, v62, v63
    v_mfma_f32_32x32x4_2b_bf16 v[32:63], a[70:71], v[138:139], 0
    s_nop 15
    s_nop 1
    v_mfma_f32_32x32x16_bf16 v[32:47], a[24:27], v[134:137], v[32:47]
    v_mfma_f32_32x32x16_bf16 v[48:63], a[28:31], v[134:137], v[48:63]
    s_nop 10
    v_max3_f32 v24, v24, v32, v33
    v_max3_f32 v24, v24, v34, v35
    v_max3_f32 v24, v24, v36, v37
    v_max3_f32 v24, v24, v38, v39
    v_max3_f32 v24, v24, v40, v41
    v_max3_f32 v24, v24, v42, v43
    v_max3_f32 v24, v24, v44, v45
    v_max3_f32 v24, v24, v46, v47
    v_max3_f32 v24, v24, v48, v49
    v_max3_f32 v24, v24, v50, v51
    v_max3_f32 v24, v24, v52, v53
    v_max3_f32 v24, v24, v54, v55
    v_max3_f32 v24, v24, v56, v57
    v_max3_f32 v24, v24, v58, v59
    v_max3_f32 v24, v24, v60, v61
    v_max3_f32 v24, v24, v62, v63
    v_mfma_f32_32x32x4_2b_bf16 v[32:63], a[72:73], v[138:139], 0
    s_nop 15
    s_nop 1
    v_mfma_f32_32x32x16_bf16 v[32:47], a[32:35], v[134:137], v[32:47]
    v_mfma_f32_32x32x16_bf16 v[48:63], a[36:39], v[134:137], v[48:63]
    s_nop 10
    v_max3_f32 v24, v24, v32, v33
    v_max3_f32 v24, v24, v34, v35
    v_max3_f32 v24, v24, v36, v37
    v_max3_f32 v24, v24, v38, v39
    v_max3_f32 v24, v24, v40, v41
    v_max3_f32 v24, v24, v42, v43
    v_max3_f32 v24, v24, v44, v45
    v_max3_f32 v24, v24, v46, v47
    v_max3_f32 v24, v24, v48, v49
    v_max3_f32 v24, v24, v50, v51
    v_max3_f32 v24, v24, v52, v53
    v_max3_f32 v24, v24, v54, v55
    v_max3_f32 v24, v24, v56, v57
    v_max3_f32 v24, v24, v58, v59
    v_max3_f32 v24, v24, v60, v61
    v_max3_f32 v24, v24, v62, v63
    v_mfma_f32_32x32x4_2b_bf16 v[32:63], a[74:75], v[138:139], 0
    s_nop 15
    s_nop 1
    v_mfma_f32_32x32x16_bf16 v[32:47], a[40:43], v[134:137], v[32:47]
    v_mfma_f32_32x32x16_bf16 v[48:63], a[44:47], v[134:137], v[48:63]
    s_nop 10
    v_max3_f32 v24, v24, v32, v33
    v_max3_f32 v24, v24, v34, v35
    v_max3_f32 v24, v24, v36, v37
    v_max3_f32 v24, v24, v38, v39
    v_max3_f32 v24, v24, v40, v41
    v_max3_f32 v24, v24, v42, v43
    v_max3_f32 v24, v24, v44, v45
    v_max3_f32 v24, v24, v46, v47
    v_max3_f32 v24, v24, v48, v49
    v_max3_f32 v24, v24, v50, v51
    v_max3_f32 v24, v24, v52, v53
    v_max3_f32 v24, v24, v54, v55
    v_max3_f32 v24, v24, v56, v57
    v_max3_f32 v24, v24, v58, v59
    v_max3_f32 v24, v24, v60, v61
    v_max3_f32 v24, v24, v62, v63
    v_mfma_f32_32x32x4_2b_bf16 v[32:63], a[76:77], v[138:139], 0
    s_nop 15
    s_nop 1
    v_mfma_f32_32x32x16_bf16 v[32:47], a[48:51], v[134:137], v[32:47]
    v_mfma_f32_32x32x16_bf16 v[48:63], a[52:55], v[134:137], v[48:63]
    s_nop 10
    v_max3_f32 v24, v24, v32, v33
    v_max3_f32 v24, v24, v34, v35
    v_max3_f32 v24, v24, v36, v37
    v_max3_f32 v24, v24, v38, v39
    v_max3_f32 v24, v24, v40, v41
    v_max3_f32 v24, v24, v42, v43
    v_max3_f32 v24, v24, v44, v45
    v_max3_f32 v24, v24, v46, v47
    v_max3_f32 v24, v24, v48, v49
    v_max3_f32 v24, v24, v50, v51
    v_max3_f32 v24, v24, v52, v53
    v_max3_f32 v24, v24, v54, v55
    v_max3_f32 v24, v24, v56, v57
    v_max3_f32 v24, v24, v58, v59
    v_max3_f32 v24, v24, v60, v61
    v_max3_f32 v24, v24, v62, v63
    v_mfma_f32_32x32x4_2b_bf16 v[32:63], a[78:79], v[138:139], 0
    s_nop 15
    s_nop 1
    v_mfma_f32_32x32x16_bf16 v[32:47], a[56:59], v[134:137], v[32:47]
    v_mfma_f32_32x32x16_bf16 v[48:63], a[60:63], v[134:137], v[48:63]
    s_nop 10
    v_max3_f32 v24, v24, v32, v33
    v_max3_f32 v24, v24, v34, v35
    v_max3_f32 v24, v24, v36, v37
    v_max3_f32 v24, v24, v38, v39
    v_max3_f32 v24, v24, v40, v41
    v_max3_f32 v24, v24, v42, v43
    v_max3_f32 v24, v24, v44, v45
    v_max3_f32 v24, v24, v46, v47
    v_max3_f32 v24, v24, v48, v49
    v_max3_f32 v24, v24, v50, v51
    v_max3_f32 v24, v24, v52, v53
    v_max3_f32 v24, v24, v54, v55
    v_max3_f32 v24, v24, v56, v57
    v_max3_f32 v24, v24, v58, v59
    v_max3_f32 v24, v24, v60, v61
    v_max3_f32 v24, v24, v62, v63
    v_mov_b32 v25, v24
    s_nop 1
    v_permlane32_swap_b32 v24, v25
    v_max_f32 v24, v24, v25
    s_lshl_b32 s51, s40, 2
    v_add_u32 v25, s51, v1
    s_barrier
    ds_write_b32 v25, v24 offset:30720
    s_waitcnt lgkmcnt(0)
    s_barrier
    ds_read_b128 v[24:27], v1 offset:30720
    s_waitcnt lgkmcnt(0)
    v_max3_f32 v24, v24, v25, v26
    v_max_f32 v24, v24, v27
    v_sub_f32 v208, 0, v24
    v_sub_f32 v209, 0, v24
    v_sub_f32 v210, 0, v24
    v_sub_f32 v211, 0, v24
    v_sub_f32 v212, 0, v24
    v_sub_f32 v213, 0, v24
    v_sub_f32 v214, 0, v24
    v_sub_f32 v215, 0, v24
    v_sub_f32 v216, 0, v24
    v_sub_f32 v217, 0, v24
    v_sub_f32 v218, 0, v24
    v_sub_f32 v219, 0, v24
    v_sub_f32 v220, 0, v24
    v_sub_f32 v221, 0, v24
    v_sub_f32 v222, 0, v24
    v_sub_f32 v223, 0, v24
    v_sub_f32 v224, 0, v24
    v_sub_f32 v225, 0, v24
    v_sub_f32 v226, 0, v24
    v_sub_f32 v227, 0, v24
    v_sub_f32 v228, 0, v24
    v_sub_f32 v229, 0, v24
    v_sub_f32 v230, 0, v24
    v_sub_f32 v231, 0, v24
    v_sub_f32 v232, 0, v24
    v_sub_f32 v233, 0, v24
    v_sub_f32 v234, 0, v24
    v_sub_f32 v235, 0, v24
    v_sub_f32 v236, 0, v24
    v_sub_f32 v237, 0, v24
    v_sub_f32 v238, 0, v24
    v_sub_f32 v239, 0, v24
    s_nop 1
    v_mfma_f32_32x32x4_2b_bf16 v[32:63], a[64:65], v[138:139], v[208:239]
    v_exp_f32 v69, v69
    v_exp_f32 v70, v70
    v_exp_f32 v71, v71
    v_exp_f32 v72, v72
    v_exp_f32 v73, v73
    v_exp_f32 v74, v74
    v_exp_f32 v75, v75
    v_exp_f32 v76, v76
    v_smfmac_f32_32x32x32_bf16 v[96:111], a[192:195], v[64:71], v2
    s_waitcnt vmcnt(10)
    v_exp_f32 v77, v77
    v_exp_f32 v78, v78
    v_exp_f32 v79, v79
    v_smfmac_f32_16x16x64_bf16 v[160:163], v[180:183], a[248:255], v3
    buffer_load_dwordx4 a[248:251], v1, s[16:19], s50 offen offset:2048 sc1
    buffer_load_dwordx4 a[252:255], v1, s[16:19], s50 offen offset:3072 sc1
    v_exp_f32 v80, v80
    v_exp_f32 v81, v81
    v_smfmac_f32_32x32x32_bf16 v[96:111], a[196:199], v[72:79], v2
    s_add_u32 s50, s49, 577536
    v_exp_f32 v82, v82
    v_exp_f32 v83, v83
    v_exp_f32 v84, v84
    v_mfma_f32_32x32x16_bf16 v[32:47], a[0:3], v[134:137], v[32:47]
    v_exp_f32 v85, v85
    v_exp_f32 v86, v86
    v_exp_f32 v87, v87
    v_mfma_f32_32x32x16_bf16 v[48:63], a[4:7], v[134:137], v[48:63]
    v_exp_f32 v88, v88
    v_exp_f32 v89, v89
    v_exp_f32 v90, v90
    v_smfmac_f32_32x32x32_bf16 v[96:111], a[200:203], v[80:87], v2
    s_waitcnt vmcnt(10)
    v_exp_f32 v91, v91
    v_exp_f32 v92, v92
    v_exp_f32 v93, v93
    v_smfmac_f32_16x16x64_bf16 v[164:167], v[180:183], a[208:215], v3
    buffer_load_dwordx4 a[208:211], v1, s[16:19], s50 offen offset:0 sc1
    buffer_load_dwordx4 a[212:215], v1, s[16:19], s50 offen offset:1024 sc1
    v_exp_f32 v94, v94
    v_exp_f32 v95, v95
    v_exp_f32 v32, v32
    v_exp_f32 v33, v33
    v_smfmac_f32_32x32x32_bf16 v[96:111], a[204:207], v[88:95], v2
    s_add_u32 s53, s49, 741376
    buffer_load_dwordx4 a[0:3], v1, s[16:19], s53 offen offset:0 sc1
    buffer_load_dwordx4 a[4:7], v1, s[16:19], s53 offen offset:1024 sc1
    v_exp_f32 v34, v34
    v_exp_f32 v35, v35
    v_exp_f32 v36, v36
    v_mfma_f32_32x32x4_2b_bf16 v[64:95], a[66:67], v[138:139], v[208:239]
    v_exp_f32 v37, v37
    v_exp_f32 v38, v38
    v_exp_f32 v39, v39
    v_exp_f32 v40, v40
    v_exp_f32 v41, v41
    v_exp_f32 v42, v42
    v_exp_f32 v43, v43
    v_exp_f32 v44, v44
    v_smfmac_f32_32x32x32_bf16 v[112:127], a[80:83], v[32:39], v2
    s_waitcnt vmcnt(12)
    ds_write_b128 v6, v[96:99] offset:0
    v_exp_f32 v45, v45
    v_exp_f32 v46, v46
    v_exp_f32 v47, v47
    v_smfmac_f32_16x16x64_bf16 v[168:171], v[180:183], a[216:223], v3
    buffer_load_dwordx4 a[216:219], v1, s[16:19], s50 offen offset:2048 sc1
    buffer_load_dwordx4 a[220:223], v1, s[16:19], s50 offen offset:3072 sc1
    v_exp_f32 v48, v48
    v_exp_f32 v49, v49
    v_smfmac_f32_32x32x32_bf16 v[112:127], a[84:87], v[40:47], v2
    s_add_u32 s50, s49, 581632
    ds_write_b128 v6, v[100:103] offset:1024
    v_exp_f32 v50, v50
    v_exp_f32 v51, v51
    v_exp_f32 v52, v52
    v_mfma_f32_32x32x16_bf16 v[64:79], a[8:11], v[134:137], v[64:79]
    v_exp_f32 v53, v53
    v_exp_f32 v54, v54
    v_exp_f32 v55, v55
    v_mfma_f32_32x32x16_bf16 v[80:95], a[12:15], v[134:137], v[80:95]
    v_exp_f32 v56, v56
    v_exp_f32 v57, v57
    v_exp_f32 v58, v58
    v_smfmac_f32_32x32x32_bf16 v[112:127], a[88:91], v[48:55], v2
    s_waitcnt vmcnt(12)
    ds_write_b128 v6, v[104:107] offset:2048
    v_exp_f32 v59, v59
    v_exp_f32 v60, v60
    v_exp_f32 v61, v61
    v_smfmac_f32_16x16x64_bf16 v[172:175], v[180:183], a[224:231], v3
    buffer_load_dwordx4 a[224:227], v1, s[16:19], s50 offen offset:0 sc1
    buffer_load_dwordx4 a[228:231], v1, s[16:19], s50 offen offset:1024 sc1
    v_exp_f32 v62, v62
    v_exp_f32 v63, v63
    v_exp_f32 v64, v64
    v_exp_f32 v65, v65
    v_smfmac_f32_32x32x32_bf16 v[112:127], a[92:95], v[56:63], v2
    buffer_load_dwordx4 a[8:11], v1, s[16:19], s53 offen offset:2048 sc1
    buffer_load_dwordx4 a[12:15], v1, s[16:19], s53 offen offset:3072 sc1
    v_exp_f32 v66, v66
    v_exp_f32 v67, v67
    v_exp_f32 v68, v68
    v_mfma_f32_32x32x4_2b_bf16 v[32:63], a[68:69], v[138:139], v[208:239]
    v_exp_f32 v69, v69
    v_exp_f32 v70, v70
    v_exp_f32 v71, v71
    v_exp_f32 v72, v72
    v_exp_f32 v73, v73
    v_exp_f32 v74, v74
    v_exp_f32 v75, v75
    v_exp_f32 v76, v76
    v_smfmac_f32_32x32x32_bf16 v[112:127], a[96:99], v[64:71], v2
    s_waitcnt vmcnt(14)
    s_waitcnt lgkmcnt(0)
    s_barrier
    v_exp_f32 v77, v77
    v_exp_f32 v78, v78
    v_exp_f32 v79, v79
    v_smfmac_f32_16x16x64_bf16 v[176:179], v[180:183], a[232:239], v3
    buffer_load_dwordx4 a[232:235], v1, s[16:19], s50 offen offset:2048 sc1
    buffer_load_dwordx4 a[236:239], v1, s[16:19], s50 offen offset:3072 sc1
    v_exp_f32 v80, v80
    v_exp_f32 v81, v81
    v_smfmac_f32_32x32x32_bf16 v[112:127], a[100:103], v[72:79], v2
    s_add_u32 s50, s49, 585728
    ds_read_b128 v[188:191], v7 offset:0
    v_exp_f32 v82, v82
    v_exp_f32 v83, v83
    v_exp_f32 v84, v84
    v_mfma_f32_32x32x16_bf16 v[32:47], a[16:19], v[134:137], v[32:47]
    ds_read_b128 v[192:195], v7 offset:3072
    v_exp_f32 v85, v85
    v_exp_f32 v86, v86
    v_exp_f32 v87, v87
    v_mfma_f32_32x32x16_bf16 v[48:63], a[20:23], v[134:137], v[48:63]
    ds_read_b128 v[196:199], v7 offset:6144
    v_exp_f32 v88, v88
    v_exp_f32 v89, v89
    v_exp_f32 v90, v90
    v_smfmac_f32_32x32x32_bf16 v[112:127], a[104:107], v[80:87], v2
    ds_read_b128 v[200:203], v7 offset:9216
    v_exp_f32 v91, v91
    v_exp_f32 v92, v92
    v_exp_f32 v93, v93
    v_exp_f32 v94, v94
    v_exp_f32 v95, v95
    v_exp_f32 v32, v32
    v_exp_f32 v33, v33
    v_smfmac_f32_32x32x32_bf16 v[112:127], a[108:111], v[88:95], v2
    s_add_u32 s53, s49, 745472
    buffer_load_dwordx4 a[16:19], v1, s[16:19], s53 offen offset:0 sc1
    buffer_load_dwordx4 a[20:23], v1, s[16:19], s53 offen offset:1024 sc1
    v_exp_f32 v34, v34
    v_exp_f32 v35, v35
    v_exp_f32 v36, v36
    v_mfma_f32_32x32x4_2b_bf16 v[64:95], a[70:71], v[138:139], v[208:239]
    s_waitcnt lgkmcnt(0)
    v_exp_f32 v37, v37
    v_add_f32 v188, v188, v192
    v_exp_f32 v38, v38
    v_add_f32 v189, v189, v193
    v_exp_f32 v39, v39
    v_add_f32 v190, v190, v194
    v_exp_f32 v40, v40
    v_add_f32 v191, v191, v195
    v_exp_f32 v41, v41
    v_add_f32 v196, v196, v200
    v_exp_f32 v42, v42
    v_add_f32 v197, v197, v201
    v_exp_f32 v43, v43
    v_add_f32 v198, v198, v202
    v_exp_f32 v44, v44
    v_add_f32 v199, v199, v203
    v_smfmac_f32_32x32x32_bf16 v[112:127], a[112:115], v[32:39], v2
    v_exp_f32 v45, v45
    v_add_f32 v188, v188, v196
    v_exp_f32 v46, v46
    v_add_f32 v189, v189, v197
    v_exp_f32 v47, v47
    v_add_f32 v190, v190, v198
    v_exp_f32 v48, v48
    v_rcp_f32_dpp v192, v188 quad_perm:[3,3,3,3] row_mask:0xf bank_mask:0xf
    v_exp_f32 v49, v49
    v_add_f32 v191, v191, v199
    v_smfmac_f32_32x32x32_bf16 v[112:127], a[116:119], v[40:47], v2
    v_exp_f32 v50, v50
    v_mul_f32 v188, v188, v192
    v_exp_f32 v51, v51
    v_mul_f32 v189, v189, v192
    v_exp_f32 v52, v52
    v_mul_f32 v190, v190, v192
    v_mfma_f32_32x32x16_bf16 v[64:79], a[24:27], v[134:137], v[64:79]
    v_exp_f32 v53, v53
    v_mul_f32 v191, v191, v192
    v_exp_f32 v54, v54
    v_cvt_pk_bf16_f32 v188, v188, v189
    v_exp_f32 v55, v55
    v_cvt_pk_bf16_f32 v189, v190, v191
    v_mfma_f32_32x32x16_bf16 v[80:95], a[28:31], v[134:137], v[80:95]
    v_exp_f32 v56, v56
    v_subrev_u32 v192, 528482304, v192
    v_exp_f32 v57, v57
    v_max_u32 v10, v10, v192
    v_exp_f32 v58, v58
    v_smfmac_f32_32x32x32_bf16 v[112:127], a[120:123], v[48:55], v2
    ds_write2_b32 v8, v188, v189 offset0:0 offset1:32
    v_add_u32 v8, v9, v8
    v_exp_f32 v59, v59
    v_exp_f32 v60, v60
    v_exp_f32 v61, v61
    v_exp_f32 v62, v62
    v_exp_f32 v63, v63
    v_exp_f32 v64, v64
    v_exp_f32 v65, v65
    v_smfmac_f32_32x32x32_bf16 v[112:127], a[124:127], v[56:63], v2
    buffer_load_dwordx4 a[24:27], v1, s[16:19], s53 offen offset:2048 sc1
    buffer_load_dwordx4 a[28:31], v1, s[16:19], s53 offen offset:3072 sc1
    v_exp_f32 v66, v66
    v_exp_f32 v67, v67
    v_exp_f32 v68, v68
    v_mfma_f32_32x32x4_2b_bf16 v[32:63], a[72:73], v[138:139], v[208:239]
    v_exp_f32 v69, v69
    v_exp_f32 v70, v70
    v_exp_f32 v71, v71
    v_exp_f32 v72, v72
    v_exp_f32 v73, v73
    v_exp_f32 v74, v74
    v_exp_f32 v75, v75
    v_exp_f32 v76, v76
    v_smfmac_f32_32x32x32_bf16 v[112:127], a[128:131], v[64:71], v2
    s_waitcnt lgkmcnt(0)
    s_barrier
    v_exp_f32 v77, v77
    v_exp_f32 v78, v78
    v_exp_f32 v79, v79
    v_exp_f32 v80, v80
    v_exp_f32 v81, v81
    v_smfmac_f32_32x32x32_bf16 v[112:127], a[132:135], v[72:79], v2
    ds_read_b128 v[184:187], v1 offset:26624
    v_exp_f32 v82, v82
    v_exp_f32 v83, v83
    v_exp_f32 v84, v84
    v_mfma_f32_32x32x16_bf16 v[32:47], a[32:35], v[134:137], v[32:47]
    v_exp_f32 v85, v85
    v_exp_f32 v86, v86
    v_exp_f32 v87, v87
    v_mfma_f32_32x32x16_bf16 v[48:63], a[36:39], v[134:137], v[48:63]
    v_exp_f32 v88, v88
    v_exp_f32 v89, v89
    v_exp_f32 v90, v90
    v_smfmac_f32_32x32x32_bf16 v[112:127], a[136:139], v[80:87], v2
    s_waitcnt lgkmcnt(0)
    s_waitcnt vmcnt(18)
    v_exp_f32 v91, v91
    v_exp_f32 v92, v92
    v_exp_f32 v93, v93
    v_smfmac_f32_16x16x64_bf16 v[140:143], v[184:187], a[240:247], v3
    buffer_load_dwordx4 a[240:243], v1, s[16:19], s50 offen offset:0 sc1
    buffer_load_dwordx4 a[244:247], v1, s[16:19], s50 offen offset:1024 sc1
    v_exp_f32 v94, v94
    v_exp_f32 v95, v95
    v_exp_f32 v32, v32
    v_exp_f32 v33, v33
    v_smfmac_f32_32x32x32_bf16 v[112:127], a[140:143], v[88:95], v2
    s_add_u32 s53, s49, 749568
    buffer_load_dwordx4 a[32:35], v1, s[16:19], s53 offen offset:0 sc1
    buffer_load_dwordx4 a[36:39], v1, s[16:19], s53 offen offset:1024 sc1
    v_exp_f32 v34, v34
    v_exp_f32 v35, v35
    v_exp_f32 v36, v36
    v_mfma_f32_32x32x4_2b_bf16 v[64:95], a[74:75], v[138:139], v[208:239]
    v_exp_f32 v37, v37
    v_exp_f32 v38, v38
    v_exp_f32 v39, v39
    v_exp_f32 v40, v40
    v_exp_f32 v41, v41
    v_exp_f32 v42, v42
    v_exp_f32 v43, v43
    v_exp_f32 v44, v44
    v_smfmac_f32_32x32x32_bf16 v[112:127], a[144:147], v[32:39], v2
    s_waitcnt vmcnt(20)
    v_exp_f32 v45, v45
    v_exp_f32 v46, v46
    v_exp_f32 v47, v47
    v_smfmac_f32_16x16x64_bf16 v[144:147], v[184:187], a[248:255], v3
    buffer_load_dwordx4 a[248:251], v1, s[16:19], s50 offen offset:2048 sc1
    buffer_load_dwordx4 a[252:255], v1, s[16:19], s50 offen offset:3072 sc1
    v_exp_f32 v48, v48
    v_exp_f32 v49, v49
    v_smfmac_f32_32x32x32_bf16 v[112:127], a[148:151], v[40:47], v2
    s_add_u32 s50, s49, 589824
    v_exp_f32 v50, v50
    v_exp_f32 v51, v51
    v_exp_f32 v52, v52
    v_mfma_f32_32x32x16_bf16 v[64:79], a[40:43], v[134:137], v[64:79]
    v_exp_f32 v53, v53
    v_exp_f32 v54, v54
    v_exp_f32 v55, v55
    v_mfma_f32_32x32x16_bf16 v[80:95], a[44:47], v[134:137], v[80:95]
    v_exp_f32 v56, v56
    v_exp_f32 v57, v57
    v_exp_f32 v58, v58
    v_smfmac_f32_32x32x32_bf16 v[112:127], a[152:155], v[48:55], v2
    s_waitcnt vmcnt(20)
    v_exp_f32 v59, v59
    v_exp_f32 v60, v60
    v_exp_f32 v61, v61
    v_smfmac_f32_16x16x64_bf16 v[148:151], v[184:187], a[208:215], v3
    buffer_load_dwordx4 a[208:211], v1, s[16:19], s50 offen offset:0 sc1
    buffer_load_dwordx4 a[212:215], v1, s[16:19], s50 offen offset:1024 sc1
    v_exp_f32 v62, v62
    v_exp_f32 v63, v63
    v_exp_f32 v64, v64
    v_exp_f32 v65, v65
    v_smfmac_f32_32x32x32_bf16 v[112:127], a[156:159], v[56:63], v2
    buffer_load_dwordx4 a[40:43], v1, s[16:19], s53 offen offset:2048 sc1
    buffer_load_dwordx4 a[44:47], v1, s[16:19], s53 offen offset:3072 sc1
    v_exp_f32 v66, v66
    v_exp_f32 v67, v67
    v_exp_f32 v68, v68
    v_mfma_f32_32x32x4_2b_bf16 v[32:63], a[76:77], v[138:139], v[208:239]
    v_exp_f32 v69, v69
    v_exp_f32 v70, v70
    v_exp_f32 v71, v71
    v_exp_f32 v72, v72
    v_exp_f32 v73, v73
    v_exp_f32 v74, v74
    v_exp_f32 v75, v75
    v_exp_f32 v76, v76
    v_smfmac_f32_32x32x32_bf16 v[112:127], a[160:163], v[64:71], v2
    s_waitcnt vmcnt(20)
    v_exp_f32 v77, v77
    v_exp_f32 v78, v78
    v_exp_f32 v79, v79
    v_smfmac_f32_16x16x64_bf16 v[152:155], v[184:187], a[216:223], v3
    buffer_load_dwordx4 a[216:219], v1, s[16:19], s50 offen offset:2048 sc1
    buffer_load_dwordx4 a[220:223], v1, s[16:19], s50 offen offset:3072 sc1
    v_exp_f32 v80, v80
    v_exp_f32 v81, v81
    v_smfmac_f32_32x32x32_bf16 v[112:127], a[164:167], v[72:79], v2
    s_add_u32 s50, s49, 655360
    v_exp_f32 v82, v82
    v_exp_f32 v83, v83
    v_exp_f32 v84, v84
    v_mfma_f32_32x32x16_bf16 v[32:47], a[48:51], v[134:137], v[32:47]
    v_exp_f32 v85, v85
    v_exp_f32 v86, v86
    v_exp_f32 v87, v87
    v_mfma_f32_32x32x16_bf16 v[48:63], a[52:55], v[134:137], v[48:63]
    v_exp_f32 v88, v88
    v_exp_f32 v89, v89
    v_exp_f32 v90, v90
    v_smfmac_f32_32x32x32_bf16 v[112:127], a[168:171], v[80:87], v2
    s_waitcnt vmcnt(20)
    v_exp_f32 v91, v91
    v_exp_f32 v92, v92
    v_exp_f32 v93, v93
    v_smfmac_f32_16x16x64_bf16 v[156:159], v[184:187], a[224:231], v3
    buffer_load_dwordx4 a[224:227], v1, s[16:19], s50 offen offset:0 sc1
    buffer_load_dwordx4 a[228:231], v1, s[16:19], s50 offen offset:1024 sc1
    v_exp_f32 v94, v94
    v_exp_f32 v95, v95
    v_exp_f32 v32, v32
    v_exp_f32 v33, v33
    v_smfmac_f32_32x32x32_bf16 v[112:127], a[172:175], v[88:95], v2
    s_add_u32 s53, s49, 753664
    buffer_load_dwordx4 a[48:51], v1, s[16:19], s53 offen offset:0 sc1
    buffer_load_dwordx4 a[52:55], v1, s[16:19], s53 offen offset:1024 sc1
    v_exp_f32 v34, v34
    v_exp_f32 v35, v35
    v_exp_f32 v36, v36
    v_mfma_f32_32x32x4_2b_bf16 v[64:95], a[78:79], v[138:139], v[208:239]
    v_exp_f32 v37, v37
    v_exp_f32 v38, v38
    v_exp_f32 v39, v39
    v_exp_f32 v40, v40
    v_exp_f32 v41, v41
    v_exp_f32 v42, v42
    v_exp_f32 v43, v43
    v_exp_f32 v44, v44
    v_smfmac_f32_32x32x32_bf16 v[112:127], a[176:179], v[32:39], v2
    s_waitcnt vmcnt(20)
    v_exp_f32 v45, v45
    v_exp_f32 v46, v46
    v_exp_f32 v47, v47
    v_smfmac_f32_16x16x64_bf16 v[160:163], v[184:187], a[232:239], v3
    buffer_load_dwordx4 a[232:235], v1, s[16:19], s50 offen offset:2048 sc1
    buffer_load_dwordx4 a[236:239], v1, s[16:19], s50 offen offset:3072 sc1
    v_exp_f32 v48, v48
    v_exp_f32 v49, v49
    v_smfmac_f32_32x32x32_bf16 v[112:127], a[180:183], v[40:47], v2
    s_add_u32 s50, s49, 659456
    v_exp_f32 v50, v50
    v_exp_f32 v51, v51
    v_exp_f32 v52, v52
    v_mfma_f32_32x32x16_bf16 v[64:79], a[56:59], v[134:137], v[64:79]
    v_exp_f32 v53, v53
    v_exp_f32 v54, v54
    v_exp_f32 v55, v55
    v_mfma_f32_32x32x16_bf16 v[80:95], a[60:63], v[134:137], v[80:95]
    v_exp_f32 v56, v56
    v_exp_f32 v57, v57
    v_exp_f32 v58, v58
    v_smfmac_f32_32x32x32_bf16 v[112:127], a[184:187], v[48:55], v2
    s_waitcnt vmcnt(16)
    v_exp_f32 v59, v59
    v_exp_f32 v60, v60
    v_exp_f32 v61, v61
    v_smfmac_f32_16x16x64_bf16 v[164:167], v[184:187], a[240:247], v3
    buffer_load_dwordx4 a[240:243], v1, s[16:19], s50 offen offset:0 sc1
    buffer_load_dwordx4 a[244:247], v1, s[16:19], s50 offen offset:1024 sc1
    v_exp_f32 v62, v62
    v_exp_f32 v63, v63
    v_exp_f32 v64, v64
    v_exp_f32 v65, v65
    v_smfmac_f32_32x32x32_bf16 v[112:127], a[188:191], v[56:63], v2
    buffer_load_dwordx4 a[56:59], v1, s[16:19], s53 offen offset:2048 sc1
    buffer_load_dwordx4 a[60:63], v1, s[16:19], s53 offen offset:3072 sc1
    v_exp_f32 v66, v66
    v_exp_f32 v67, v67
    v_exp_f32 v68, v68
    v_exp_f32 v69, v69
    v_exp_f32 v70, v70
    v_exp_f32 v71, v71
    v_exp_f32 v72, v72
    v_exp_f32 v73, v73
    v_exp_f32 v74, v74
    v_exp_f32 v75, v75
    v_exp_f32 v76, v76
    v_smfmac_f32_32x32x32_bf16 v[112:127], a[192:195], v[64:71], v2
    s_waitcnt vmcnt(16)
    v_exp_f32 v77, v77
    v_exp_f32 v78, v78
    v_exp_f32 v79, v79
    v_smfmac_f32_16x16x64_bf16 v[168:171], v[184:187], a[248:255], v3
    buffer_load_dwordx4 a[248:251], v1, s[16:19], s50 offen offset:2048 sc1
    buffer_load_dwordx4 a[252:255], v1, s[16:19], s50 offen offset:3072 sc1
    v_exp_f32 v80, v80
    v_exp_f32 v81, v81
    v_smfmac_f32_32x32x32_bf16 v[112:127], a[196:199], v[72:79], v2
    s_add_u32 s50, s49, 663552
    v_exp_f32 v82, v82
    v_exp_f32 v83, v83
    v_exp_f32 v84, v84
    v_exp_f32 v85, v85
    v_exp_f32 v86, v86
    v_exp_f32 v87, v87
    v_exp_f32 v88, v88
    v_exp_f32 v89, v89
    v_exp_f32 v90, v90
    v_smfmac_f32_32x32x32_bf16 v[112:127], a[200:203], v[80:87], v2
    s_waitcnt vmcnt(16)
    v_exp_f32 v91, v91
    v_exp_f32 v92, v92
    v_exp_f32 v93, v93
    v_smfmac_f32_16x16x64_bf16 v[172:175], v[184:187], a[208:215], v3
    buffer_load_dwordx4 a[208:211], v1, s[16:19], s50 offen offset:0 sc1
    buffer_load_dwordx4 a[212:215], v1, s[16:19], s50 offen offset:1024 sc1
    v_exp_f32 v94, v94
    v_exp_f32 v95, v95
    s_nop 1
    v_smfmac_f32_32x32x32_bf16 v[112:127], a[204:207], v[88:95], v2
    s_waitcnt vmcnt(14)
    v_smfmac_f32_16x16x64_bf16 v[176:179], v[184:187], a[216:223], v3
    buffer_load_dwordx4 a[216:219], v1, s[16:19], s50 offen offset:2048 sc1
    buffer_load_dwordx4 a[220:223], v1, s[16:19], s50 offen offset:3072 sc1
    s_nop 7
    ds_write_b128 v6, v[112:115] offset:12288
    ds_write_b128 v6, v[116:119] offset:13312
    ds_write_b128 v6, v[120:123] offset:14336
    s_waitcnt lgkmcnt(0)
    s_barrier
    ds_read_b128 v[188:191], v7 offset:12288
    ds_read_b128 v[192:195], v7 offset:15360
    ds_read_b128 v[196:199], v7 offset:18432
    ds_read_b128 v[200:203], v7 offset:21504
    s_waitcnt lgkmcnt(2)
    v_pk_add_f32 v[188:189], v[188:189], v[192:193]
    s_waitcnt lgkmcnt(0)
    v_pk_add_f32 v[196:197], v[196:197], v[200:201]
    v_pk_add_f32 v[188:189], v[188:189], v[196:197]
    v_pk_add_f32 v[190:191], v[190:191], v[194:195]
    v_pk_add_f32 v[198:199], v[198:199], v[202:203]
    v_rcp_f32_dpp v192, v188 quad_perm:[3,3,3,3] row_mask:0xf bank_mask:0xf
    v_pk_add_f32 v[190:191], v[190:191], v[198:199]
    v_pk_mul_f32 v[188:189], v[188:189], v[192:193] op_sel_hi:[1,0]
    v_pk_mul_f32 v[190:191], v[190:191], v[192:193] op_sel_hi:[1,0]
    v_cvt_pk_bf16_f32 v188, v188, v189
    v_cvt_pk_bf16_f32 v189, v190, v191
    v_subrev_u32 v192, 528482304, v192
    v_max_u32 v10, v10, v192
    ds_write2_b32 v8, v188, v189 offset0:0 offset1:32
    s_waitcnt lgkmcnt(0)
    s_barrier
    ds_read_b128 v[204:207], v1 offset:27648
    ds_read_b128 v[180:183], v1 offset:28672
    s_waitcnt vmcnt(14)
    s_waitcnt lgkmcnt(1)
    v_smfmac_f32_16x16x64_bf16 v[140:143], v[204:207], a[224:231], v3
    s_add_u32 s50, s49, 667648
    buffer_load_dwordx4 a[224:227], v1, s[16:19], s50 offen offset:0 sc1
    buffer_load_dwordx4 a[228:231], v1, s[16:19], s50 offen offset:1024 sc1
    v_lshrrev_b32 v24, 5, v0
    s_waitcnt vmcnt(12)
    v_smfmac_f32_16x16x64_bf16 v[144:147], v[204:207], a[232:239], v3
    buffer_load_dwordx4 a[232:235], v1, s[16:19], s50 offen offset:2048 sc1
    buffer_load_dwordx4 a[236:239], v1, s[16:19], s50 offen offset:3072 sc1
    v_lshlrev_b32 v24, 8, v24
    s_waitcnt vmcnt(12)
    v_smfmac_f32_16x16x64_bf16 v[148:151], v[204:207], a[240:247], v3
    s_add_u32 s50, s49, 671744
    buffer_load_dwordx4 a[240:243], v1, s[16:19], s50 offen offset:0 sc1
    buffer_load_dwordx4 a[244:247], v1, s[16:19], s50 offen offset:1024 sc1
    v_and_b32 v25, 15, v0
    s_waitcnt vmcnt(10)
    v_smfmac_f32_16x16x64_bf16 v[152:155], v[204:207], a[248:255], v3
    buffer_load_dwordx4 a[248:251], v1, s[16:19], s50 offen offset:2048 sc1
    buffer_load_dwordx4 a[252:255], v1, s[16:19], s50 offen offset:3072 sc1
    v_lshl_add_u32 v24, v25, 4, v24
    s_waitcnt vmcnt(10)
    v_smfmac_f32_16x16x64_bf16 v[156:159], v[204:207], a[208:215], v3
    s_add_u32 s50, s49, 737280
    buffer_load_dwordx4 a[208:211], v1, s[16:19], s50 offen offset:0 sc1
    buffer_load_dwordx4 a[212:215], v1, s[16:19], s50 offen offset:1024 sc1
    v_bfe_u32 v25, v0, 4, 1
    s_waitcnt vmcnt(10)
    v_smfmac_f32_16x16x64_bf16 v[160:163], v[204:207], a[216:223], v3
    buffer_load_dwordx4 a[216:219], v1, s[16:19], s50 offen offset:2048 sc1
    buffer_load_dwordx4 a[220:223], v1, s[16:19], s50 offen offset:3072 sc1
    v_lshl_add_u32 v14, v25, 17, v24
    s_waitcnt vmcnt(10)
    v_smfmac_f32_16x16x64_bf16 v[164:167], v[204:207], a[224:231], v3
    v_lshl_add_u32 v26, v25, 3, v24
    s_mul_i32 s52, s40, 655360
    s_lshl_b32 s57, s41, 9
    s_add_u32 s52, s52, s57
    s_add_u32 s52, s52, 3620864
    s_waitcnt vmcnt(8)
    v_smfmac_f32_16x16x64_bf16 v[168:171], v[204:207], a[232:239], v3
    v_bfe_u32 v24, v0, 2, 3
    s_waitcnt vmcnt(6)
    v_smfmac_f32_16x16x64_bf16 v[172:175], v[204:207], a[240:247], v3
    v_lshlrev_b32 v24, 6, v24
    s_waitcnt vmcnt(4)
    v_smfmac_f32_16x16x64_bf16 v[176:179], v[204:207], a[248:255], v3
    v_lshrrev_b32 v25, 5, v0
    s_lshl_b32 s57, s40, 4
    s_waitcnt vmcnt(2)
    s_waitcnt lgkmcnt(0)
    v_smfmac_f32_16x16x64_bf16 v[140:143], v[180:183], a[208:215], v3
    v_lshl_add_u32 v25, v25, 3, s57
    s_waitcnt vmcnt(0)
    v_smfmac_f32_16x16x64_bf16 v[144:147], v[180:183], a[216:223], v3
    v_add_u32 v15, v24, v25
    v_smfmac_f32_16x16x64_bf16 v[148:151], v[180:183], a[0:7], v3
    v_and_b32 v25, 3, v0
    v_smfmac_f32_16x16x64_bf16 v[152:155], v[180:183], a[8:15], v3
    v_lshl_add_u32 v28, v25, 4, v24
    v_smfmac_f32_16x16x64_bf16 v[156:159], v[180:183], a[16:23], v3
    v_lshrrev_b32 v30, 3, v24
    s_lshl_b32 s57, s41, 6
    s_add_u32 s57, s57, 6242304
    v_smfmac_f32_16x16x64_bf16 v[160:163], v[180:183], a[24:31], v3
    v_smfmac_f32_16x16x64_bf16 v[164:167], v[180:183], a[32:39], v3
    v_smfmac_f32_16x16x64_bf16 v[168:171], v[180:183], a[40:47], v3
    v_smfmac_f32_16x16x64_bf16 v[172:175], v[180:183], a[48:55], v3
    v_smfmac_f32_16x16x64_bf16 v[176:179], v[180:183], a[56:63], v3
    s_add_u32 m0, s64, 0
    s_mov_b32 s65, 0
    buffer_load_dwordx4 v17, s[24:27], s65 offen offset:0 lds
    s_mov_b32 s65, 23552
    buffer_load_dwordx4 v17, s[24:27], s65 offen offset:1024 lds
    s_mov_b32 s65, 47104
    buffer_load_dwordx4 v17, s[24:27], s65 offen offset:2048 lds
    s_mov_b32 s65, 70656
    buffer_load_dwordx4 v17, s[24:27], s65 offen offset:3072 lds
    s_add_u32 m0, s64, 4096
    s_mov_b32 s65, 98304
    buffer_load_dwordx4 v17, s[24:27], s65 offen offset:0 lds
    s_mov_b32 s65, 121856
    buffer_load_dwordx4 v17, s[24:27], s65 offen offset:1024 lds
    s_mov_b32 s65, 145408
    buffer_load_dwordx4 v17, s[24:27], s65 offen offset:2048 lds
    s_mov_b32 s65, 168960
    buffer_load_dwordx4 v17, s[24:27], s65 offen offset:3072 lds
    s_add_u32 m0, s64, 8192
    s_mov_b32 s65, 196608
    buffer_load_dwordx4 v17, s[24:27], s65 offen offset:0 lds
    s_mov_b32 s65, 220160
    buffer_load_dwordx4 v17, s[24:27], s65 offen offset:1024 lds
    s_mov_b32 s65, 243712
    buffer_load_dwordx4 v17, s[24:27], s65 offen offset:2048 lds
    s_mov_b32 s65, 267264
    buffer_load_dwordx4 v17, s[24:27], s65 offen offset:3072 lds
    s_add_u32 m0, s64, 12288
    s_mov_b32 s65, 294912
    buffer_load_dwordx4 v17, s[24:27], s65 offen offset:0 lds
    s_mov_b32 s65, 318464
    buffer_load_dwordx4 v17, s[24:27], s65 offen offset:1024 lds
    s_mov_b32 s65, 342016
    buffer_load_dwordx4 v17, s[24:27], s65 offen offset:2048 lds
    s_mov_b32 s65, 365568
    buffer_load_dwordx4 v17, s[24:27], s65 offen offset:3072 lds
    s_add_u32 m0, s64, 16384
    s_mov_b32 s65, 393216
    buffer_load_dwordx4 v17, s[24:27], s65 offen offset:0 lds
    s_mov_b32 s65, 416768
    buffer_load_dwordx4 v17, s[24:27], s65 offen offset:1024 lds
    s_mov_b32 s65, 440320
    buffer_load_dwordx4 v17, s[24:27], s65 offen offset:2048 lds
    s_mov_b32 s65, 463872
    buffer_load_dwordx4 v17, s[24:27], s65 offen offset:3072 lds
    s_add_u32 m0, s64, 20480
    s_mov_b32 s65, 491520
    buffer_load_dwordx4 v17, s[24:27], s65 offen offset:0 lds
    s_mov_b32 s65, 515072
    buffer_load_dwordx4 v17, s[24:27], s65 offen offset:1024 lds
    s_mov_b32 s65, 538624
    buffer_load_dwordx4 v17, s[24:27], s65 offen offset:2048 lds
    s_mov_b32 s65, 562176
    buffer_load_dwordx4 v17, s[24:27], s65 offen offset:3072 lds
    s_add_u32 m0, s64, 24576
    s_mov_b32 s65, 589824
    buffer_load_dwordx4 v17, s[24:27], s65 offen offset:0 lds
    s_mov_b32 s65, 613376
    buffer_load_dwordx4 v17, s[24:27], s65 offen offset:1024 lds
    s_mov_b32 s65, 636928
    buffer_load_dwordx4 v17, s[24:27], s65 offen offset:2048 lds
    s_mov_b32 s65, 660480
    buffer_load_dwordx4 v17, s[24:27], s65 offen offset:3072 lds
    s_add_u32 m0, s64, 28672
    s_mov_b32 s65, 688128
    buffer_load_dwordx4 v17, s[24:27], s65 offen offset:0 lds
    s_mov_b32 s65, 711680
    buffer_load_dwordx4 v17, s[24:27], s65 offen offset:1024 lds
    s_mov_b32 s65, 735232
    buffer_load_dwordx4 v17, s[24:27], s65 offen offset:2048 lds
    s_mov_b32 s65, 758784
    buffer_load_dwordx4 v17, s[24:27], s65 offen offset:3072 lds
    s_waitcnt vmcnt(0) lgkmcnt(0)
    ds_read_b64_tr_b16 a[80:81], v18 offset:0
    ds_read_b64_tr_b16 a[82:83], v18 offset:512
    ds_read_b64_tr_b16 a[84:85], v19 offset:0
    ds_read_b64_tr_b16 a[86:87], v19 offset:512
    ds_read_b64_tr_b16 a[88:89], v18 offset:2048
    ds_read_b64_tr_b16 a[90:91], v18 offset:2560
    ds_read_b64_tr_b16 a[92:93], v19 offset:2048
    ds_read_b64_tr_b16 a[94:95], v19 offset:2560
    ds_read_b64_tr_b16 a[96:97], v18 offset:4096
    ds_read_b64_tr_b16 a[98:99], v18 offset:4608
    ds_read_b64_tr_b16 a[100:101], v19 offset:4096
    ds_read_b64_tr_b16 a[102:103], v19 offset:4608
    ds_read_b64_tr_b16 a[104:105], v18 offset:6144
    ds_read_b64_tr_b16 a[106:107], v18 offset:6656
    ds_read_b64_tr_b16 a[108:109], v19 offset:6144
    ds_read_b64_tr_b16 a[110:111], v19 offset:6656
    ds_read_b64_tr_b16 a[112:113], v18 offset:8192
    ds_read_b64_tr_b16 a[114:115], v18 offset:8704
    ds_read_b64_tr_b16 a[116:117], v19 offset:8192
    ds_read_b64_tr_b16 a[118:119], v19 offset:8704
    ds_read_b64_tr_b16 a[120:121], v18 offset:10240
    ds_read_b64_tr_b16 a[122:123], v18 offset:10752
    ds_read_b64_tr_b16 a[124:125], v19 offset:10240
    ds_read_b64_tr_b16 a[126:127], v19 offset:10752
    ds_read_b64_tr_b16 a[128:129], v18 offset:12288
    ds_read_b64_tr_b16 a[130:131], v18 offset:12800
    ds_read_b64_tr_b16 a[132:133], v19 offset:12288
    ds_read_b64_tr_b16 a[134:135], v19 offset:12800
    ds_read_b64_tr_b16 a[136:137], v18 offset:14336
    ds_read_b64_tr_b16 a[138:139], v18 offset:14848
    ds_read_b64_tr_b16 a[140:141], v19 offset:14336
    ds_read_b64_tr_b16 a[142:143], v19 offset:14848
    ds_read_b64_tr_b16 a[144:145], v18 offset:16384
    ds_read_b64_tr_b16 a[146:147], v18 offset:16896
    ds_read_b64_tr_b16 a[148:149], v19 offset:16384
    ds_read_b64_tr_b16 a[150:151], v19 offset:16896
    ds_read_b64_tr_b16 a[152:153], v18 offset:18432
    ds_read_b64_tr_b16 a[154:155], v18 offset:18944
    ds_read_b64_tr_b16 a[156:157], v19 offset:18432
    ds_read_b64_tr_b16 a[158:159], v19 offset:18944
    ds_read_b64_tr_b16 a[160:161], v18 offset:20480
    ds_read_b64_tr_b16 a[162:163], v18 offset:20992
    ds_read_b64_tr_b16 a[164:165], v19 offset:20480
    ds_read_b64_tr_b16 a[166:167], v19 offset:20992
    ds_read_b64_tr_b16 a[168:169], v18 offset:22528
    ds_read_b64_tr_b16 a[170:171], v18 offset:23040
    ds_read_b64_tr_b16 a[172:173], v19 offset:22528
    ds_read_b64_tr_b16 a[174:175], v19 offset:23040
    ds_read_b64_tr_b16 a[176:177], v18 offset:24576
    ds_read_b64_tr_b16 a[178:179], v18 offset:25088
    ds_read_b64_tr_b16 a[180:181], v19 offset:24576
    ds_read_b64_tr_b16 a[182:183], v19 offset:25088
    ds_read_b64_tr_b16 a[184:185], v18 offset:26624
    ds_read_b64_tr_b16 a[186:187], v18 offset:27136
    ds_read_b64_tr_b16 a[188:189], v19 offset:26624
    ds_read_b64_tr_b16 a[190:191], v19 offset:27136
    ds_read_b64_tr_b16 a[192:193], v18 offset:28672
    ds_read_b64_tr_b16 a[194:195], v18 offset:29184
    ds_read_b64_tr_b16 a[196:197], v19 offset:28672
    ds_read_b64_tr_b16 a[198:199], v19 offset:29184
    ds_read_b64_tr_b16 a[200:201], v18 offset:30720
    ds_read_b64_tr_b16 a[202:203], v18 offset:31232
    ds_read_b64_tr_b16 a[204:205], v19 offset:30720
    ds_read_b64_tr_b16 a[206:207], v19 offset:31232
    s_waitcnt vmcnt(0) lgkmcnt(0)
    s_add_u32 m0, s64, 0
    s_mov_b32 s65, 786432
    buffer_load_dwordx4 v17, s[24:27], s65 offen offset:0 lds
    s_mov_b32 s65, 809984
    buffer_load_dwordx4 v17, s[24:27], s65 offen offset:1024 lds
    s_mov_b32 s65, 833536
    buffer_load_dwordx4 v17, s[24:27], s65 offen offset:2048 lds
    s_mov_b32 s65, 857088
    buffer_load_dwordx4 v17, s[24:27], s65 offen offset:3072 lds
    s_add_u32 m0, s64, 4096
    s_mov_b32 s65, 884736
    buffer_load_dwordx4 v17, s[24:27], s65 offen offset:0 lds
    s_mov_b32 s65, 908288
    buffer_load_dwordx4 v17, s[24:27], s65 offen offset:1024 lds
    s_mov_b32 s65, 931840
    buffer_load_dwordx4 v17, s[24:27], s65 offen offset:2048 lds
    s_mov_b32 s65, 955392
    buffer_load_dwordx4 v17, s[24:27], s65 offen offset:3072 lds
    s_add_u32 m0, s64, 8192
    s_mov_b32 s65, 983040
    buffer_load_dwordx4 v17, s[24:27], s65 offen offset:0 lds
    s_mov_b32 s65, 1006592
    buffer_load_dwordx4 v17, s[24:27], s65 offen offset:1024 lds
    s_mov_b32 s65, 1030144
    buffer_load_dwordx4 v17, s[24:27], s65 offen offset:2048 lds
    s_mov_b32 s65, 1053696
    buffer_load_dwordx4 v17, s[24:27], s65 offen offset:3072 lds
    s_add_u32 m0, s64, 12288
    s_mov_b32 s65, 1081344
    buffer_load_dwordx4 v17, s[24:27], s65 offen offset:0 lds
    s_mov_b32 s65, 1104896
    buffer_load_dwordx4 v17, s[24:27], s65 offen offset:1024 lds
    s_mov_b32 s65, 1128448
    buffer_load_dwordx4 v17, s[24:27], s65 offen offset:2048 lds
    s_mov_b32 s65, 1152000
    buffer_load_dwordx4 v17, s[24:27], s65 offen offset:3072 lds
    s_add_u32 m0, s64, 16384
    s_mov_b32 s65, 1179648
    buffer_load_dwordx4 v17, s[24:27], s65 offen offset:0 lds
    s_mov_b32 s65, 1203200
    buffer_load_dwordx4 v17, s[24:27], s65 offen offset:1024 lds
    s_mov_b32 s65, 1226752
    buffer_load_dwordx4 v17, s[24:27], s65 offen offset:2048 lds
    s_mov_b32 s65, 1250304
    buffer_load_dwordx4 v17, s[24:27], s65 offen offset:3072 lds
    s_add_u32 m0, s64, 20480
    s_mov_b32 s65, 1277952
    buffer_load_dwordx4 v17, s[24:27], s65 offen offset:0 lds
    s_mov_b32 s65, 1301504
    buffer_load_dwordx4 v17, s[24:27], s65 offen offset:1024 lds
    s_waitcnt vmcnt(0) lgkmcnt(0)
    s_nop 15
    s_nop 3
    s_branch L_p2_epi
L_end:
    s_endpgm
.section .rodata,"a"
.p2align 6
.amdhsa_kernel sequential_preLN__grouped_kv_mqa__mixer_token_mlp__prompt_kernel
  .amdhsa_next_free_vgpr 512
  .amdhsa_next_free_sgpr 102
  .amdhsa_accum_offset 256
  .amdhsa_group_segment_fixed_size 0
  .amdhsa_kernarg_size 104
  .amdhsa_user_sgpr_count 2
  .amdhsa_user_sgpr_kernarg_segment_ptr 1
  .amdhsa_system_sgpr_workgroup_id_x 1
.end_amdhsa_kernel
```
